```python
import torch

def _softmax(x, axis=-1):
    return torch.softmax(x, dim=axis)
def _gelu(x):
    return torch.nn.functional.gelu(x, approximate="tanh")
def _silu(x):
    return torch.nn.functional.silu(x)
def _sigmoid(x):
    return torch.sigmoid(x)
def _layernorm(x, axis=-1, eps=1e-5):
    m = x.mean(dim=axis, keepdim=True)
    v = x.var(dim=axis, keepdim=True, unbiased=False)
    return (x - m) / torch.sqrt(v + eps)
def _scatter_add(tgt, idx, src, axis=0):
    return tgt.clone().index_add_(axis, idx, src)
def _segment_sum(src, seg, n):
    out = torch.zeros((n,) + src.shape[1:], dtype=src.dtype)
    return out.index_add_(0, seg, src)
def _pad(x, pw):
    flat = tuple(v for pair in reversed(pw) for v in pair)
    return torch.nn.functional.pad(x, flat)

kernel_name = 'interleave_layers__linear_kernel_hedgehog__geglu_ffn__prompt'

def setup_inputs():

    _w = (lambda a: (lambda t: t.to(torch.bfloat16) if t.is_floating_point() else t)(torch.as_tensor(a)))
    def _A_setup():
        B, S, D, H = 1, 2048, 512, 32
        Dh = D // H
        return {
            "x": _w((lambda *s: torch.randn(*s, dtype=torch.bfloat16) * 0.05)(B, S, D)),
            "wqkv": _w((lambda *s: torch.randn(*s, dtype=torch.bfloat16) * 0.2)(D, 3 * D)),
            "w_phi": _w((lambda *s: torch.randn(*s, dtype=torch.bfloat16) * 0.2)(H, Dh, Dh) * (Dh ** -0.5)),
            "wo": _w((lambda *s: torch.randn(*s, dtype=torch.bfloat16) * 0.05)(D, D)),
        }
    _A_in = _A_setup()

    def _B_setup():
        B, S, D, F = 1, 2048, 512, 1376
        return {
            "x": _w((lambda *s: torch.randn(*s, dtype=torch.bfloat16) * 0.05)(B, S, D)),
            "w_gate": _w((lambda *s: torch.randn(*s, dtype=torch.bfloat16) * 0.05)(D, F)),
            "w_up": _w((lambda *s: torch.randn(*s, dtype=torch.bfloat16) * 0.05)(D, F)),
            "w_down": _w((lambda *s: torch.randn(*s, dtype=torch.bfloat16) * 0.05)(F, D)),
        }
    _B_in = _B_setup()

    return {
        "A_x": _A_in["x"],
        "A_wqkv": _A_in["wqkv"],
        "A_w_phi": _A_in["w_phi"],
        "A_wo": _A_in["wo"],
        "B_x": _B_in["x"],
        "B_w_gate": _B_in["w_gate"],
        "B_w_up": _B_in["w_up"],
        "B_w_down": _B_in["w_down"],
    }

def reference(A_x, A_wqkv, A_w_phi, A_wo, B_x, B_w_gate, B_w_up, B_w_down):
    def _A_ref(x, wqkv, w_phi, wo):
        B, S, D = x.shape
        H = 32; Dh = D // H
        qkv = (lambda x, *d: x.permute(*d))((x @ wqkv).reshape(B, S, 3, H, Dh), 2, 0, 3, 1, 4)
        q, k, v = qkv[0], qkv[1], qkv[2]
        pq = torch.einsum("bhsd,hdf->bhsf", q, w_phi)
        pk = torch.einsum("bhsd,hdf->bhsf", k, w_phi)
        phi_q = torch.concatenate([_softmax(pq, axis=-1), _softmax(-pq, axis=-1)], axis=-1)
        phi_k = torch.concatenate([_softmax(pk, axis=-1), _softmax(-pk, axis=-1)], axis=-1)
        kv = torch.einsum("bhsf,bhsd->bhfd", phi_k, v)
        z  = torch.einsum("bhsf->bhf", phi_k)
        num = torch.einsum("bhqf,bhfd->bhqd", phi_q, kv)
        den = torch.einsum("bhqf,bhf->bhq", phi_q, z)[..., None] + 1e-6
        o = num / den
        return (lambda x, *d: x.permute(*d))(o, 0, 2, 1, 3).reshape(B, S, D) @ wo

    def _B_ref(x, w_gate, w_up, w_down):
        return (_gelu(x @ w_gate) * (x @ w_up)) @ w_down

    x = A_x
    x = x + _A_ref(_layernorm(x, axis=-1), A_wqkv, A_w_phi, A_wo)
    x = x + _B_ref(_layernorm(x, axis=-1), B_w_gate, B_w_up, B_w_down)
    x = x + _A_ref(_layernorm(x, axis=-1), A_wqkv, A_w_phi, A_wo)
    x = x + _B_ref(_layernorm(x, axis=-1), B_w_gate, B_w_up, B_w_down)
    return x
```

```asm
; @launch grid=(256,1,1) block=(512,1,1) lds=163840
.amdgcn_target "amdgcn-amd-amdhsa--gfx950"
.text
.globl interleave_layers__linear_kernel_hedgehog__geglu_ffn__prompt_kernel
.p2align 8
.type interleave_layers__linear_kernel_hedgehog__geglu_ffn__prompt_kernel,@function
interleave_layers__linear_kernel_hedgehog__geglu_ffn__prompt_kernel:
  s_cmp_ge_u32 s2, 256
  s_cbranch_scc1 L_end
  s_load_dwordx16 s[72:87], s[0:1], 0
  s_load_dwordx2 s[4:5], s[0:1], 80
  s_load_dwordx2 s[8:9], s[0:1], 64
  v_lshlrev_b32 v2, 3, v0
  v_mov_b32 v4, 0
  v_mov_b32 v5, 0
  ds_write_b64 v2, v[4:5]
  s_getpc_b64 s[64:65]
L_pc0:
  s_lshr_b32 s66, s2, 3
  s_and_b32 s66, s66, 7
  v_lshlrev_b32 v20, 7, v0
  v_lshrrev_b32 v21, 6, v0
  v_cmp_gt_u32 vcc, L_cpfend-L_pc0, v20
  v_cmp_eq_u32 s[68:69], s66, v21
  s_nop 0
  s_and_b64 vcc, vcc, s[68:69]
  s_and_saveexec_b64 s[66:67], vcc
  global_load_dword v21, v20, s[64:65]
  s_mov_b64 exec, s[66:67]
  v_readfirstlane_b32 s14, v0
  v_and_b32 v0, 63, v0
  s_mov_b32 s6, 0x10000000
  s_mov_b32 s7, 0x20000
  s_lshr_b32 s14, s14, 6
  s_and_b32 s44, s2, 7
  s_lshr_b32 s45, s2, 3
  s_lshr_b32 s13, s45, 1
  s_and_b32 s45, s45, 1
  s_lshl_b32 s12, s44, 1
  s_add_u32 s12, s12, s45
  s_mov_b32 s16, 0
  s_xor_b32 s100, s13, s2
  s_and_b32 s100, s100, 7
  s_mov_b32 s56, 0x40000
  s_cmp_lt_u32 s13, 11
  s_cselect_b32 s15, 1, 0
  s_cmp_ge_u32 s14, 4
  s_cbranch_scc1 L_helper
  s_setprio 2
  s_mov_b32 s98, 0x200000
  s_mov_b32 s99, 0x20000
  s_mov_b32 s10, 0x200000
  s_mov_b32 s11, 0x20000
  s_lshl_b32 s17, s12, 2
  s_lshr_b32 s44, s13, 3
  s_lshl_b32 s44, s44, 1
  s_and_b32 s45, s14, 1
  s_add_u32 s44, s44, s45
  s_add_u32 s18, s17, s44
  s_add_u32 s17, s17, s14
  s_lshr_b32 s46, s14, 1
  s_and_b32 s47, s13, 7
  s_lshl_b32 s19, s47, 1
  s_add_u32 s19, s19, s46
  v_bfe_u32 v178, v0, 4, 2
  v_and_b32 v176, 7, v0
  v_xor_b32 v176, v176, v178
  v_lshlrev_b32 v176, 4, v176
  v_lshrrev_b32 v178, 3, v0
  v_lshl_add_u32 v176, v178, 10, v176
  s_lshl_b32 s48, s100, 7
  v_or_b32 v176, s48, v176
  v_xor_b32 v177, 64, v176
  s_lshl_b32 s30, s17, 15
  s_add_u32 s31, s30, 8192
  s_add_u32 s32, s30, 16384
  s_add_u32 s33, s30, 24576
  s_lshl_b32 s40, s14, 12
  s_waitcnt lgkmcnt(0)
  s_mov_b32 s96, s72
  s_mov_b32 s97, s73
  s_add_u32 m0, s40, 73728
  s_nop 0
  buffer_load_dwordx4 v176, s[96:99], s30 offen offset:0 lds
  s_add_u32 m0, s40, 74752
  s_nop 0
  buffer_load_dwordx4 v177, s[96:99], s31 offen offset:0 lds
  s_add_u32 m0, s40, 75776
  s_nop 0
  buffer_load_dwordx4 v176, s[96:99], s32 offen offset:0 lds
  s_add_u32 m0, s40, 76800
  s_nop 0
  buffer_load_dwordx4 v177, s[96:99], s33 offen offset:0 lds
  v_xor_b32 v176, 128, v176
  v_xor_b32 v177, 128, v177
  s_add_u32 m0, s40, 90112
  s_nop 0
  buffer_load_dwordx4 v176, s[96:99], s30 offen offset:0 lds
  s_add_u32 m0, s40, 91136
  s_nop 0
  buffer_load_dwordx4 v177, s[96:99], s31 offen offset:0 lds
  s_add_u32 m0, s40, 92160
  s_nop 0
  buffer_load_dwordx4 v176, s[96:99], s32 offen offset:0 lds
  s_add_u32 m0, s40, 93184
  s_nop 0
  buffer_load_dwordx4 v177, s[96:99], s33 offen offset:0 lds
  s_load_dword s3, s[4:5], 0x28000
  s_barrier
  v_and_b32 v249, 31, v0
  v_lshrrev_b32 v250, 5, v0
  v_lshlrev_b32 v179, 10, v249
  v_lshl_add_u32 v179, v250, 5, v179
  s_lshl_b32 s41, s18, 15
  s_lshl_b32 s49, s19, 6
  s_add_u32 s41, s41, s49
  s_and_b32 s47, s12, 14
  s_mul_i32 s20, s13, 131072
  s_mul_i32 s49, s47, 4096
  s_add_u32 s20, s20, s49
  s_add_u32 s20, s20, 0xe00000
  s_mul_i32 s21, s13, 131072
  s_mul_i32 s49, s12, 4096
  s_add_u32 s21, s21, s49
  s_add_u32 s21, s21, 0xe00000
  s_mul_i32 s22, s17, 32768
  s_mul_i32 s49, s13, 2048
  s_add_u32 s22, s22, s49
  s_add_u32 s22, s22, 0x600000
  s_mul_i32 s23, s18, 32768
  s_mul_i32 s49, s46, 16384
  s_add_u32 s23, s23, s49
  s_add_u32 s23, s23, 0x600000
  s_mul_i32 s24, s18, 32768
  s_mul_i32 s49, s19, 2048
  s_add_u32 s24, s24, s49
  s_add_u32 s24, s24, 0x400000
  s_mul_i32 s25, s18, 4096
  s_mul_i32 s49, s19, 256
  s_add_u32 s25, s25, s49
  s_add_u32 s25, s25, 0x1c0000
  s_mul_i32 s26, s17, 32768
  s_add_u32 s26, s26, 0x400000
  s_mul_i32 s27, s17, 4096
  s_add_u32 s27, s27, 0x1c0000
  s_mul_i32 s28, s17, 88064
  s_mul_i32 s49, s13, 1024
  s_add_u32 s28, s28, s49
  s_add_u32 s28, s28, 0x800000
  s_mul_i32 s29, s18, 88064
  s_mul_i32 s49, s46, 44032
  s_add_u32 s29, s29, s49
  s_add_u32 s29, s29, 0x800000
  s_mul_i32 s38, s18, 32768
  s_mul_i32 s49, s19, 2048
  s_add_u32 s38, s38, s49
  s_add_u32 s38, s38, 0x200000
  s_mul_i32 s39, s18, 4096
  s_mul_i32 s49, s19, 256
  s_add_u32 s39, s39, s49
  s_add_u32 s39, s39, 0x180000
  s_mov_b32 s42, 0
  s_mov_b32 s43, -1
  s_xor_b32 s47, s14, 2
  s_lshl_b32 s36, 0x11111111, s47
  s_mov_b32 s37, s36
  s_mov_b32 s51, 0x3f803f80
  s_mov_b32 s52, 0x3f80
  s_mov_b32 s53, 0x3f800000
  s_mov_b32 s54, 0xffff0000
  v_lshlrev_b32 v1, 4, v0
  v_lshlrev_b32 v4, 3, v0
  s_and_b32 s47, s12, 1
  v_xor_b32 v6, s47, v250
  v_lshlrev_b32 v6, 12, v6
  v_lshl_add_u32 v6, v249, 4, v6
  s_lshl_b32 s47, s14, 9
  v_add_u32 v6, s47, v6
  v_lshrrev_b32 v8, 1, v249
  v_and_b32 v8, 3, v8
  v_lshrrev_b32 v251, 2, v249
  v_and_b32 v251, 2, v251
  v_xor_b32 v8, v8, v251
  v_lshlrev_b32 v251, 1, v250
  v_xor_b32 v8, v8, v251
  v_lshlrev_b32 v8, 4, v8
  v_lshl_add_u32 v8, v249, 6, v8
  s_lshl_b32 s47, s14, 11
  s_add_u32 s47, s47, 106496
  v_add_u32 v8, s47, v8
  v_lshlrev_b32 v9, 3, v249
  v_mov_b32 v242, 0
  v_mov_b32 v243, 0
  v_and_b32 v14, 15, v0
  v_lshlrev_b32 v14, 2, v14
  v_and_b32 v5, 3, v0
  v_lshlrev_b32 v5, 4, v5
  s_lshl_b32 s47, s14, 2
  v_add_u32 v5, s47, v5
  v_bfe_u32 v180, v0, 1, 2
  v_bfe_u32 v181, v0, 3, 1
  v_lshl_add_u32 v180, v181, 2, v180
  v_xor_b32 v180, v180, v251
  v_lshlrev_b32 v180, 4, v180
  v_lshl_add_u32 v180, v249, 7, v180
  s_add_u32 s48, s40, 73728
  v_add_u32 v180, s48, v180
  v_xor_b32 v181, 16, v180
  v_xor_b32 v182, 64, v180
  v_xor_b32 v183, 80, v180
  v_add_u32 v184, 0x10000, v180
  v_add_u32 v185, 0x10000, v181
  v_add_u32 v186, 0x10000, v182
  v_add_u32 v187, 0x10000, v183
  v_bfe_u32 v248, v0, 4, 1
  v_and_b32 v249, 1, v0
  v_lshl_add_u32 v248, v248, 1, v249
  v_bfe_u32 v249, v0, 1, 1
  v_lshl_add_u32 v248, v248, 1, v249
  v_bfe_u32 v249, v0, 2, 2
  v_lshl_add_u32 v248, v249, 3, v248
  v_lshrrev_b32 v249, 5, v0
  v_lshl_add_u32 v248, v249, 7, v248
  v_lshlrev_b32 v2, 3, v248
  v_add_u32 v2, 8192, v2
  s_mov_b32 s49, 73728
  v_and_b32 v3, 0x250, v1
  v_bfe_u32 v248, v1, 7, 1
  v_lshl_or_b32 v3, v248, 8, v3
  v_bfe_u32 v248, v1, 5, 1
  v_lshl_or_b32 v3, v248, 7, v3
  v_bfe_u32 v248, v1, 8, 1
  v_lshl_or_b32 v3, v248, 5, v3
  v_lshrrev_b32 v248, 5, v1
  v_and_b32 v248, 16, v248
  v_xad_u32 v3, v3, v248, s49
  v_bfe_u32 v248, v0, 4, 1
  v_and_b32 v249, 1, v0
  v_lshl_add_u32 v248, v249, 1, v248
  v_bfe_u32 v249, v0, 1, 1
  v_lshl_add_u32 v248, v248, 1, v249
  v_bfe_u32 v249, v0, 2, 2
  v_lshl_add_u32 v248, v249, 3, v248
  v_lshrrev_b32 v249, 5, v0
  v_lshl_add_u32 v248, v249, 7, v248
  v_lshlrev_b32 v0, 3, v248
  v_bfe_u32 v249, v1, 6, 2
  v_lshrrev_b32 v251, 8, v1
  v_lshl_add_u32 v252, v251, 3, v249
  s_and_b32 s48, s14, 1
  s_lshl_b32 s48, s48, 13
  s_add_u32 s48, s48, 106496
  v_lshl_add_u32 v252, v252, 6, s48
  v_lshrrev_b32 v249, 1, v249
  v_and_b32 v251, 1, v251
  v_lshl_or_b32 v249, v251, 1, v249
  v_bfe_u32 v250, v1, 4, 1
  v_bfe_u32 v253, v1, 5, 1
  s_and_b32 s48, s14, 2
  v_or_b32 v10, s48, v253
  v_xor_b32 v10, v10, v249
  v_xor_b32 v12, v250, v249
  v_lshl_add_u32 v10, v10, 4, v252
  v_lshl_add_u32 v12, v12, 4, v252
  v_lshl_add_u32 v10, v250, 3, v10
  v_lshl_add_u32 v12, v253, 3, v12
  v_xor_b32 v11, 32, v10
  v_xor_b32 v13, 32, v12
  v_mov_b32 v192, 0
  v_mov_b32 v193, 0
  v_mov_b32 v194, 0
  v_mov_b32 v195, 0
  v_xor_b32 v176, 384, v176
  v_xor_b32 v177, 384, v177
  s_add_u32 m0, s40, 106496
  s_nop 0
  buffer_load_dwordx4 v176, s[96:99], s30 offen offset:0 lds
  s_add_u32 m0, s40, 107520
  s_nop 0
  buffer_load_dwordx4 v177, s[96:99], s31 offen offset:0 lds
  s_add_u32 m0, s40, 108544
  s_nop 0
  buffer_load_dwordx4 v176, s[96:99], s32 offen offset:0 lds
  s_add_u32 m0, s40, 109568
  s_nop 0
  buffer_load_dwordx4 v177, s[96:99], s33 offen offset:0 lds
  v_xor_b32 v176, 128, v176
  v_xor_b32 v177, 128, v177
  s_add_u32 m0, s40, 122880
  s_nop 0
  buffer_load_dwordx4 v176, s[96:99], s30 offen offset:0 lds
  s_add_u32 m0, s40, 123904
  s_nop 0
  buffer_load_dwordx4 v177, s[96:99], s31 offen offset:0 lds
  s_add_u32 m0, s40, 124928
  s_nop 0
  buffer_load_dwordx4 v176, s[96:99], s32 offen offset:0 lds
  s_add_u32 m0, s40, 125952
  s_nop 0
  buffer_load_dwordx4 v177, s[96:99], s33 offen offset:0 lds
  v_xor_b32 v176, 896, v176
  v_xor_b32 v177, 896, v177
  s_add_u32 m0, s40, 139264
  s_nop 0
  buffer_load_dwordx4 v176, s[96:99], s30 offen offset:0 lds
  s_add_u32 m0, s40, 140288
  s_nop 0
  buffer_load_dwordx4 v177, s[96:99], s31 offen offset:0 lds
  s_add_u32 m0, s40, 141312
  s_nop 0
  buffer_load_dwordx4 v176, s[96:99], s32 offen offset:0 lds
  s_add_u32 m0, s40, 142336
  s_nop 0
  buffer_load_dwordx4 v177, s[96:99], s33 offen offset:0 lds
  s_waitcnt vmcnt(16)
  s_waitcnt lgkmcnt(0)
  s_and_b32 s3, s3, 0x7ffffffe
  s_add_u32 s3, s3, 2
  v_mov_b32 v247, s3
  ds_read_b128 v[16:19], v180 offset:0
  ds_read_b128 v[20:23], v181 offset:0
  ds_read_b128 v[24:27], v182 offset:0
  ds_read_b128 v[28:31], v183 offset:0
  s_waitcnt lgkmcnt(3)
  v_dot2c_f32_bf16 v192, s51, v16
  v_dot2c_f32_bf16 v193, v16, v16
  v_dot2c_f32_bf16 v194, s51, v17
  v_dot2c_f32_bf16 v195, v17, v17
  v_dot2c_f32_bf16 v192, s51, v18
  v_dot2c_f32_bf16 v193, v18, v18
  v_dot2c_f32_bf16 v194, s51, v19
  v_dot2c_f32_bf16 v195, v19, v19
  s_waitcnt lgkmcnt(2)
  v_dot2c_f32_bf16 v192, s51, v20
  v_dot2c_f32_bf16 v193, v20, v20
  v_dot2c_f32_bf16 v194, s51, v21
  v_dot2c_f32_bf16 v195, v21, v21
  v_dot2c_f32_bf16 v192, s51, v22
  v_dot2c_f32_bf16 v193, v22, v22
  v_dot2c_f32_bf16 v194, s51, v23
  v_dot2c_f32_bf16 v195, v23, v23
  s_waitcnt lgkmcnt(1)
  v_dot2c_f32_bf16 v192, s51, v24
  v_dot2c_f32_bf16 v193, v24, v24
  v_dot2c_f32_bf16 v194, s51, v25
  v_dot2c_f32_bf16 v195, v25, v25
  v_dot2c_f32_bf16 v192, s51, v26
  v_dot2c_f32_bf16 v193, v26, v26
  v_dot2c_f32_bf16 v194, s51, v27
  v_dot2c_f32_bf16 v195, v27, v27
  s_waitcnt lgkmcnt(0)
  v_dot2c_f32_bf16 v192, s51, v28
  v_dot2c_f32_bf16 v193, v28, v28
  v_dot2c_f32_bf16 v194, s51, v29
  v_dot2c_f32_bf16 v195, v29, v29
  v_dot2c_f32_bf16 v192, s51, v30
  v_dot2c_f32_bf16 v193, v30, v30
  v_dot2c_f32_bf16 v194, s51, v31
  v_dot2c_f32_bf16 v195, v31, v31
  v_xor_b32 v176, 128, v176
  v_xor_b32 v177, 128, v177
  s_add_u32 m0, s40, 73728
  s_nop 0
  buffer_load_dwordx4 v176, s[96:99], s30 offen offset:0 lds
  s_add_u32 m0, s40, 74752
  s_nop 0
  buffer_load_dwordx4 v177, s[96:99], s31 offen offset:0 lds
  s_add_u32 m0, s40, 75776
  s_nop 0
  buffer_load_dwordx4 v176, s[96:99], s32 offen offset:0 lds
  s_add_u32 m0, s40, 76800
  s_nop 0
  buffer_load_dwordx4 v177, s[96:99], s33 offen offset:0 lds
  s_waitcnt vmcnt(16)
  ds_read_b128 v[32:35], v180 offset:16384
  ds_read_b128 v[36:39], v181 offset:16384
  ds_read_b128 v[40:43], v182 offset:16384
  ds_read_b128 v[44:47], v183 offset:16384
  ds_read_b32 v7, v14 offset:2176
  s_waitcnt lgkmcnt(4)
  v_dot2c_f32_bf16 v192, s51, v32
  v_dot2c_f32_bf16 v193, v32, v32
  v_dot2c_f32_bf16 v194, s51, v33
  v_dot2c_f32_bf16 v195, v33, v33
  v_dot2c_f32_bf16 v192, s51, v34
  v_dot2c_f32_bf16 v193, v34, v34
  v_dot2c_f32_bf16 v194, s51, v35
  v_dot2c_f32_bf16 v195, v35, v35
  s_waitcnt lgkmcnt(3)
  v_dot2c_f32_bf16 v192, s51, v36
  v_dot2c_f32_bf16 v193, v36, v36
  v_dot2c_f32_bf16 v194, s51, v37
  v_dot2c_f32_bf16 v195, v37, v37
  v_dot2c_f32_bf16 v192, s51, v38
  v_dot2c_f32_bf16 v193, v38, v38
  v_dot2c_f32_bf16 v194, s51, v39
  v_dot2c_f32_bf16 v195, v39, v39
  s_waitcnt lgkmcnt(2)
  v_dot2c_f32_bf16 v192, s51, v40
  v_dot2c_f32_bf16 v193, v40, v40
  v_dot2c_f32_bf16 v194, s51, v41
  v_dot2c_f32_bf16 v195, v41, v41
  v_dot2c_f32_bf16 v192, s51, v42
  v_dot2c_f32_bf16 v193, v42, v42
  v_dot2c_f32_bf16 v194, s51, v43
  v_dot2c_f32_bf16 v195, v43, v43
  s_waitcnt lgkmcnt(1)
  v_dot2c_f32_bf16 v192, s51, v44
  v_dot2c_f32_bf16 v193, v44, v44
  v_dot2c_f32_bf16 v194, s51, v45
  v_dot2c_f32_bf16 v195, v45, v45
  v_dot2c_f32_bf16 v192, s51, v46
  v_dot2c_f32_bf16 v193, v46, v46
  v_dot2c_f32_bf16 v194, s51, v47
  v_dot2c_f32_bf16 v195, v47, v47
  v_xor_b32 v176, 384, v176
  v_xor_b32 v177, 384, v177
  s_add_u32 m0, s40, 90112
  s_nop 0
  buffer_load_dwordx4 v176, s[96:99], s30 offen offset:0 lds
  s_add_u32 m0, s40, 91136
  s_nop 0
  buffer_load_dwordx4 v177, s[96:99], s31 offen offset:0 lds
  s_add_u32 m0, s40, 92160
  s_nop 0
  buffer_load_dwordx4 v176, s[96:99], s32 offen offset:0 lds
  s_add_u32 m0, s40, 93184
  s_nop 0
  buffer_load_dwordx4 v177, s[96:99], s33 offen offset:0 lds
  s_waitcnt lgkmcnt(0)
  v_cmp_gt_u32 vcc, v247, v7
  s_cbranch_vccnz L_lsl_1
L_lbk_2:
  ds_read_b64_tr_b16 v[208:209], v2 offset:0
  ds_read_b64_tr_b16 v[210:211], v2 offset:256
  ds_read_b64_tr_b16 v[212:213], v2 offset:32768
  ds_read_b64_tr_b16 v[214:215], v2 offset:33024
  ds_read_b64_tr_b16 v[216:217], v2 offset:512
  ds_read_b64_tr_b16 v[218:219], v2 offset:768
  ds_read_b64_tr_b16 v[220:221], v2 offset:33280
  ds_read_b64_tr_b16 v[222:223], v2 offset:33536
  ds_read_b64_tr_b16 v[224:225], v2 offset:2048
  ds_read_b64_tr_b16 v[226:227], v2 offset:2304
  s_waitcnt lgkmcnt(4)
  v_mfma_f32_32x32x16_bf16 v[144:159], v[208:211], v[16:19], 0
  ds_read_b64_tr_b16 v[228:229], v2 offset:34816
  ds_read_b64_tr_b16 v[230:231], v2 offset:35072
  v_mfma_f32_32x32x16_bf16 v[160:175], v[212:215], v[16:19], 0
  ds_read_b64_tr_b16 v[208:209], v2 offset:2560
  ds_read_b64_tr_b16 v[210:211], v2 offset:2816
  v_mfma_f32_32x32x16_bf16 v[144:159], v[216:219], v[20:23], v[144:159]
  ds_read_b64_tr_b16 v[212:213], v2 offset:35328
  ds_read_b64_tr_b16 v[214:215], v2 offset:35584
  s_waitcnt lgkmcnt(4)
  v_mfma_f32_32x32x16_bf16 v[160:175], v[220:223], v[20:23], v[160:175]
  ds_read_b64_tr_b16 v[216:217], v2 offset:4096
  ds_read_b64_tr_b16 v[218:219], v2 offset:4352
  v_mfma_f32_32x32x16_bf16 v[144:159], v[224:227], v[24:27], v[144:159]
  ds_read_b64_tr_b16 v[220:221], v2 offset:36864
  ds_read_b64_tr_b16 v[222:223], v2 offset:37120
  v_mfma_f32_32x32x16_bf16 v[160:175], v[228:231], v[24:27], v[160:175]
  ds_read_b64_tr_b16 v[224:225], v2 offset:4608
  ds_read_b64_tr_b16 v[226:227], v2 offset:4864
  ds_read_b32 v7, v14 offset:2240
  s_waitcnt lgkmcnt(5)
  v_mfma_f32_32x32x16_bf16 v[144:159], v[208:211], v[28:31], v[144:159]
  ds_read_b64_tr_b16 v[228:229], v2 offset:37376
  ds_read_b64_tr_b16 v[230:231], v2 offset:37632
  v_mfma_f32_32x32x16_bf16 v[160:175], v[212:215], v[28:31], v[160:175]
  ds_read_b64_tr_b16 v[208:209], v2 offset:6144
  ds_read_b64_tr_b16 v[210:211], v2 offset:6400
  v_mfma_f32_32x32x16_bf16 v[144:159], v[216:219], v[32:35], v[144:159]
  ds_read_b64_tr_b16 v[212:213], v2 offset:38912
  ds_read_b64_tr_b16 v[214:215], v2 offset:39168
  s_waitcnt lgkmcnt(4)
  v_mfma_f32_32x32x16_bf16 v[160:175], v[220:223], v[32:35], v[160:175]
  ds_read_b64_tr_b16 v[216:217], v2 offset:6656
  ds_read_b64_tr_b16 v[218:219], v2 offset:6912
  v_mfma_f32_32x32x16_bf16 v[144:159], v[224:227], v[36:39], v[144:159]
  ds_read_b64_tr_b16 v[220:221], v2 offset:39424
  ds_read_b64_tr_b16 v[222:223], v2 offset:39680
  v_cmp_gt_u32 vcc, v247, v7
  s_cbranch_vccnz L_lsl_3
L_lbk_4:
  v_mfma_f32_32x32x16_bf16 v[160:175], v[228:231], v[36:39], v[160:175]
  ds_read_b64_tr_b16 v[224:225], v2 offset:8192
  ds_read_b64_tr_b16 v[226:227], v2 offset:8448
  s_waitcnt lgkmcnt(4)
  v_mfma_f32_32x32x16_bf16 v[144:159], v[208:211], v[40:43], v[144:159]
  ds_read_b64_tr_b16 v[228:229], v2 offset:40960
  ds_read_b64_tr_b16 v[230:231], v2 offset:41216
  s_waitcnt vmcnt(16)
  ds_read_b128 v[48:51], v180 offset:32768
  ds_read_b128 v[52:55], v181 offset:32768
  ds_read_b128 v[56:59], v182 offset:32768
  ds_read_b128 v[60:63], v183 offset:32768
  v_mfma_f32_32x32x16_bf16 v[160:175], v[212:215], v[40:43], v[160:175]
  ds_read_b64_tr_b16 v[208:209], v2 offset:8704
  ds_read_b64_tr_b16 v[210:211], v2 offset:8960
  v_mfma_f32_32x32x16_bf16 v[144:159], v[216:219], v[44:47], v[144:159]
  ds_read_b64_tr_b16 v[212:213], v2 offset:41472
  ds_read_b64_tr_b16 v[214:215], v2 offset:41728
  s_waitcnt lgkmcnt(8)
  v_mfma_f32_32x32x16_bf16 v[160:175], v[220:223], v[44:47], v[160:175]
  ds_read_b64_tr_b16 v[216:217], v2 offset:10240
  ds_read_b64_tr_b16 v[218:219], v2 offset:10496
  s_waitcnt lgkmcnt(9)
  v_dot2c_f32_bf16 v192, s51, v48
  v_dot2c_f32_bf16 v193, v48, v48
  v_dot2c_f32_bf16 v194, s51, v49
  v_dot2c_f32_bf16 v195, v49, v49
  v_dot2c_f32_bf16 v192, s51, v50
  v_dot2c_f32_bf16 v193, v50, v50
  v_dot2c_f32_bf16 v194, s51, v51
  v_dot2c_f32_bf16 v195, v51, v51
  s_waitcnt lgkmcnt(8)
  v_dot2c_f32_bf16 v192, s51, v52
  v_dot2c_f32_bf16 v193, v52, v52
  v_dot2c_f32_bf16 v194, s51, v53
  v_dot2c_f32_bf16 v195, v53, v53
  v_dot2c_f32_bf16 v192, s51, v54
  v_dot2c_f32_bf16 v193, v54, v54
  v_dot2c_f32_bf16 v194, s51, v55
  v_dot2c_f32_bf16 v195, v55, v55
  s_waitcnt lgkmcnt(7)
  v_dot2c_f32_bf16 v192, s51, v56
  v_dot2c_f32_bf16 v193, v56, v56
  v_dot2c_f32_bf16 v194, s51, v57
  v_dot2c_f32_bf16 v195, v57, v57
  v_dot2c_f32_bf16 v192, s51, v58
  v_dot2c_f32_bf16 v193, v58, v58
  v_dot2c_f32_bf16 v194, s51, v59
  v_dot2c_f32_bf16 v195, v59, v59
  s_waitcnt lgkmcnt(6)
  v_dot2c_f32_bf16 v192, s51, v60
  v_dot2c_f32_bf16 v193, v60, v60
  v_dot2c_f32_bf16 v194, s51, v61
  v_dot2c_f32_bf16 v195, v61, v61
  v_dot2c_f32_bf16 v192, s51, v62
  v_dot2c_f32_bf16 v193, v62, v62
  v_dot2c_f32_bf16 v194, s51, v63
  v_dot2c_f32_bf16 v195, v63, v63
  v_xor_b32 v176, 128, v176
  v_xor_b32 v177, 128, v177
  s_add_u32 m0, s40, 106496
  s_nop 0
  buffer_load_dwordx4 v176, s[96:99], s30 offen offset:0 lds
  s_add_u32 m0, s40, 107520
  s_nop 0
  buffer_load_dwordx4 v177, s[96:99], s31 offen offset:0 lds
  s_add_u32 m0, s40, 108544
  s_nop 0
  buffer_load_dwordx4 v176, s[96:99], s32 offen offset:0 lds
  s_add_u32 m0, s40, 109568
  s_nop 0
  buffer_load_dwordx4 v177, s[96:99], s33 offen offset:0 lds
  buffer_load_dwordx4 v[232:235], v179, s[96:99], s41 offen
  buffer_load_dwordx4 v[236:239], v179, s[96:99], s41 offen offset:16
  ds_write_b32 v5, v247 offset:2752
  v_mfma_f32_32x32x16_bf16 v[144:159], v[224:227], v[48:51], v[144:159]
  ds_read_b64_tr_b16 v[220:221], v2 offset:43008
  ds_read_b64_tr_b16 v[222:223], v2 offset:43264
  v_mfma_f32_32x32x16_bf16 v[160:175], v[228:231], v[48:51], v[160:175]
  ds_read_b64_tr_b16 v[224:225], v2 offset:10752
  ds_read_b64_tr_b16 v[226:227], v2 offset:11008
  s_waitcnt lgkmcnt(5)
  v_mfma_f32_32x32x16_bf16 v[144:159], v[208:211], v[52:55], v[144:159]
  ds_read_b64_tr_b16 v[228:229], v2 offset:43520
  ds_read_b64_tr_b16 v[230:231], v2 offset:43776
  v_mfma_f32_32x32x16_bf16 v[160:175], v[212:215], v[52:55], v[160:175]
  ds_read_b64_tr_b16 v[208:209], v2 offset:12288
  ds_read_b64_tr_b16 v[210:211], v2 offset:12544
  v_mfma_f32_32x32x16_bf16 v[144:159], v[216:219], v[56:59], v[144:159]
  ds_read_b64_tr_b16 v[212:213], v2 offset:45056
  ds_read_b64_tr_b16 v[214:215], v2 offset:45312
  s_waitcnt vmcnt(18)
  ds_read_b128 v[64:67], v180 offset:49152
  ds_read_b128 v[68:71], v181 offset:49152
  ds_read_b128 v[72:75], v182 offset:49152
  ds_read_b128 v[76:79], v183 offset:49152
  s_waitcnt lgkmcnt(8)
  v_mfma_f32_32x32x16_bf16 v[160:175], v[220:223], v[56:59], v[160:175]
  ds_read_b64_tr_b16 v[216:217], v2 offset:12800
  ds_read_b64_tr_b16 v[218:219], v2 offset:13056
  ds_read_b32 v7, v14 offset:1216
  v_mfma_f32_32x32x16_bf16 v[144:159], v[224:227], v[60:63], v[144:159]
  ds_read_b64_tr_b16 v[220:221], v2 offset:45568
  ds_read_b64_tr_b16 v[222:223], v2 offset:45824
  v_mfma_f32_32x32x16_bf16 v[160:175], v[228:231], v[60:63], v[160:175]
  ds_read_b64_tr_b16 v[224:225], v2 offset:14336
  ds_read_b64_tr_b16 v[226:227], v2 offset:14592
  s_waitcnt lgkmcnt(10)
  v_dot2c_f32_bf16 v192, s51, v64
  v_dot2c_f32_bf16 v193, v64, v64
  v_dot2c_f32_bf16 v194, s51, v65
  v_dot2c_f32_bf16 v195, v65, v65
  v_dot2c_f32_bf16 v192, s51, v66
  v_dot2c_f32_bf16 v193, v66, v66
  v_dot2c_f32_bf16 v194, s51, v67
  v_dot2c_f32_bf16 v195, v67, v67
  s_waitcnt lgkmcnt(9)
  v_dot2c_f32_bf16 v192, s51, v68
  v_dot2c_f32_bf16 v193, v68, v68
  v_dot2c_f32_bf16 v194, s51, v69
  v_dot2c_f32_bf16 v195, v69, v69
  v_dot2c_f32_bf16 v192, s51, v70
  v_dot2c_f32_bf16 v193, v70, v70
  v_dot2c_f32_bf16 v194, s51, v71
  v_dot2c_f32_bf16 v195, v71, v71
  s_waitcnt lgkmcnt(8)
  v_dot2c_f32_bf16 v192, s51, v72
  v_dot2c_f32_bf16 v193, v72, v72
  v_dot2c_f32_bf16 v194, s51, v73
  v_dot2c_f32_bf16 v195, v73, v73
  v_dot2c_f32_bf16 v192, s51, v74
  v_dot2c_f32_bf16 v193, v74, v74
  v_dot2c_f32_bf16 v194, s51, v75
  v_dot2c_f32_bf16 v195, v75, v75
  s_waitcnt lgkmcnt(7)
  v_dot2c_f32_bf16 v192, s51, v76
  v_dot2c_f32_bf16 v193, v76, v76
  v_dot2c_f32_bf16 v194, s51, v77
  v_dot2c_f32_bf16 v195, v77, v77
  v_dot2c_f32_bf16 v192, s51, v78
  v_dot2c_f32_bf16 v193, v78, v78
  v_dot2c_f32_bf16 v194, s51, v79
  v_dot2c_f32_bf16 v195, v79, v79
  s_waitcnt lgkmcnt(5)
  v_mfma_f32_32x32x16_bf16 v[144:159], v[208:211], v[64:67], v[144:159]
  ds_read_b64_tr_b16 v[228:229], v2 offset:47104
  ds_read_b64_tr_b16 v[230:231], v2 offset:47360
  v_mfma_f32_32x32x16_bf16 v[160:175], v[212:215], v[64:67], v[160:175]
  ds_read_b64_tr_b16 v[208:209], v2 offset:14848
  ds_read_b64_tr_b16 v[210:211], v2 offset:15104
  v_mfma_f32_32x32x16_bf16 v[144:159], v[216:219], v[68:71], v[144:159]
  ds_read_b64_tr_b16 v[212:213], v2 offset:47616
  ds_read_b64_tr_b16 v[214:215], v2 offset:47872
  s_waitcnt lgkmcnt(10)
  v_cmp_gt_u32 vcc, v247, v7
  s_cbranch_vccnz L_lsl_5
L_lbk_6:
  s_waitcnt lgkmcnt(4)
  v_mfma_f32_32x32x16_bf16 v[160:175], v[220:223], v[68:71], v[160:175]
  ds_read_b64_tr_b16 v[216:217], v2 offset:16384
  ds_read_b64_tr_b16 v[218:219], v2 offset:16640
  v_mfma_f32_32x32x16_bf16 v[144:159], v[224:227], v[72:75], v[144:159]
  ds_read_b64_tr_b16 v[220:221], v2 offset:49152
  ds_read_b64_tr_b16 v[222:223], v2 offset:49408
  s_waitcnt vmcnt(14)
  ds_read_b128 v[80:83], v184 offset:0
  ds_read_b128 v[84:87], v185 offset:0
  ds_read_b128 v[88:91], v186 offset:0
  ds_read_b128 v[92:95], v187 offset:0
  v_mfma_f32_32x32x16_bf16 v[160:175], v[228:231], v[72:75], v[160:175]
  ds_read_b64_tr_b16 v[224:225], v2 offset:16896
  ds_read_b64_tr_b16 v[226:227], v2 offset:17152
  s_waitcnt lgkmcnt(8)
  v_mfma_f32_32x32x16_bf16 v[144:159], v[208:211], v[76:79], v[144:159]
  ds_read_b64_tr_b16 v[228:229], v2 offset:49664
  ds_read_b64_tr_b16 v[230:231], v2 offset:49920
  v_mfma_f32_32x32x16_bf16 v[160:175], v[212:215], v[76:79], v[160:175]
  ds_read_b64_tr_b16 v[208:209], v2 offset:18432
  ds_read_b64_tr_b16 v[210:211], v2 offset:18688
  s_waitcnt lgkmcnt(9)
  v_dot2c_f32_bf16 v192, s51, v80
  v_dot2c_f32_bf16 v193, v80, v80
  v_dot2c_f32_bf16 v194, s51, v81
  v_dot2c_f32_bf16 v195, v81, v81
  v_dot2c_f32_bf16 v192, s51, v82
  v_dot2c_f32_bf16 v193, v82, v82
  v_dot2c_f32_bf16 v194, s51, v83
  v_dot2c_f32_bf16 v195, v83, v83
  s_waitcnt lgkmcnt(8)
  v_dot2c_f32_bf16 v192, s51, v84
  v_dot2c_f32_bf16 v193, v84, v84
  v_dot2c_f32_bf16 v194, s51, v85
  v_dot2c_f32_bf16 v195, v85, v85
  v_dot2c_f32_bf16 v192, s51, v86
  v_dot2c_f32_bf16 v193, v86, v86
  v_dot2c_f32_bf16 v194, s51, v87
  v_dot2c_f32_bf16 v195, v87, v87
  s_waitcnt lgkmcnt(7)
  v_dot2c_f32_bf16 v192, s51, v88
  v_dot2c_f32_bf16 v193, v88, v88
  v_dot2c_f32_bf16 v194, s51, v89
  v_dot2c_f32_bf16 v195, v89, v89
  v_dot2c_f32_bf16 v192, s51, v90
  v_dot2c_f32_bf16 v193, v90, v90
  v_dot2c_f32_bf16 v194, s51, v91
  v_dot2c_f32_bf16 v195, v91, v91
  s_waitcnt lgkmcnt(6)
  v_dot2c_f32_bf16 v192, s51, v92
  v_dot2c_f32_bf16 v193, v92, v92
  v_dot2c_f32_bf16 v194, s51, v93
  v_dot2c_f32_bf16 v195, v93, v93
  v_dot2c_f32_bf16 v192, s51, v94
  v_dot2c_f32_bf16 v193, v94, v94
  v_dot2c_f32_bf16 v194, s51, v95
  v_dot2c_f32_bf16 v195, v95, v95
  v_mfma_f32_32x32x16_bf16 v[144:159], v[216:219], v[80:83], v[144:159]
  ds_read_b64_tr_b16 v[212:213], v2 offset:51200
  ds_read_b64_tr_b16 v[214:215], v2 offset:51456
  s_waitcnt lgkmcnt(4)
  v_mfma_f32_32x32x16_bf16 v[160:175], v[220:223], v[80:83], v[160:175]
  ds_read_b64_tr_b16 v[216:217], v2 offset:18944
  ds_read_b64_tr_b16 v[218:219], v2 offset:19200
  v_mfma_f32_32x32x16_bf16 v[144:159], v[224:227], v[84:87], v[144:159]
  ds_read_b64_tr_b16 v[220:221], v2 offset:51712
  ds_read_b64_tr_b16 v[222:223], v2 offset:51968
  v_mfma_f32_32x32x16_bf16 v[160:175], v[228:231], v[84:87], v[160:175]
  ds_read_b64_tr_b16 v[224:225], v2 offset:20480
  ds_read_b64_tr_b16 v[226:227], v2 offset:20736
  s_waitcnt lgkmcnt(4)
  v_mfma_f32_32x32x16_bf16 v[144:159], v[208:211], v[88:91], v[144:159]
  ds_read_b64_tr_b16 v[228:229], v2 offset:53248
  ds_read_b64_tr_b16 v[230:231], v2 offset:53504
  s_waitcnt vmcnt(10)
  ds_read_b128 v[96:99], v180 offset:0
  ds_read_b128 v[100:103], v181 offset:0
  ds_read_b128 v[104:107], v182 offset:0
  ds_read_b128 v[108:111], v183 offset:0
  v_mfma_f32_32x32x16_bf16 v[160:175], v[212:215], v[88:91], v[160:175]
  ds_read_b64_tr_b16 v[208:209], v2 offset:20992
  ds_read_b64_tr_b16 v[210:211], v2 offset:21248
  ds_read_b32 v7, v14 offset:1280
  v_mfma_f32_32x32x16_bf16 v[144:159], v[216:219], v[92:95], v[144:159]
  ds_read_b64_tr_b16 v[212:213], v2 offset:53760
  ds_read_b64_tr_b16 v[214:215], v2 offset:54016
  s_waitcnt lgkmcnt(9)
  v_mfma_f32_32x32x16_bf16 v[160:175], v[220:223], v[92:95], v[160:175]
  ds_read_b64_tr_b16 v[216:217], v2 offset:22528
  ds_read_b64_tr_b16 v[218:219], v2 offset:22784
  s_waitcnt lgkmcnt(10)
  v_dot2c_f32_bf16 v192, s51, v96
  v_dot2c_f32_bf16 v193, v96, v96
  v_dot2c_f32_bf16 v194, s51, v97
  v_dot2c_f32_bf16 v195, v97, v97
  v_dot2c_f32_bf16 v192, s51, v98
  v_dot2c_f32_bf16 v193, v98, v98
  v_dot2c_f32_bf16 v194, s51, v99
  v_dot2c_f32_bf16 v195, v99, v99
  s_waitcnt lgkmcnt(9)
  v_dot2c_f32_bf16 v192, s51, v100
  v_dot2c_f32_bf16 v193, v100, v100
  v_dot2c_f32_bf16 v194, s51, v101
  v_dot2c_f32_bf16 v195, v101, v101
  v_dot2c_f32_bf16 v192, s51, v102
  v_dot2c_f32_bf16 v193, v102, v102
  v_dot2c_f32_bf16 v194, s51, v103
  v_dot2c_f32_bf16 v195, v103, v103
  s_waitcnt lgkmcnt(8)
  v_dot2c_f32_bf16 v192, s51, v104
  v_dot2c_f32_bf16 v193, v104, v104
  v_dot2c_f32_bf16 v194, s51, v105
  v_dot2c_f32_bf16 v195, v105, v105
  v_dot2c_f32_bf16 v192, s51, v106
  v_dot2c_f32_bf16 v193, v106, v106
  v_dot2c_f32_bf16 v194, s51, v107
  v_dot2c_f32_bf16 v195, v107, v107
  s_waitcnt lgkmcnt(7)
  v_dot2c_f32_bf16 v192, s51, v108
  v_dot2c_f32_bf16 v193, v108, v108
  v_dot2c_f32_bf16 v194, s51, v109
  v_dot2c_f32_bf16 v195, v109, v109
  v_dot2c_f32_bf16 v192, s51, v110
  v_dot2c_f32_bf16 v193, v110, v110
  v_dot2c_f32_bf16 v194, s51, v111
  v_dot2c_f32_bf16 v195, v111, v111
  v_mfma_f32_32x32x16_bf16 v[144:159], v[224:227], v[96:99], v[144:159]
  ds_read_b64_tr_b16 v[220:221], v2 offset:55296
  ds_read_b64_tr_b16 v[222:223], v2 offset:55552
  v_mfma_f32_32x32x16_bf16 v[160:175], v[228:231], v[96:99], v[160:175]
  ds_read_b64_tr_b16 v[224:225], v2 offset:23040
  ds_read_b64_tr_b16 v[226:227], v2 offset:23296
  s_waitcnt lgkmcnt(4)
  v_mfma_f32_32x32x16_bf16 v[144:159], v[208:211], v[100:103], v[144:159]
  ds_read_b64_tr_b16 v[228:229], v2 offset:55808
  ds_read_b64_tr_b16 v[230:231], v2 offset:56064
  v_cmp_gt_u32 vcc, v247, v7
  s_cbranch_vccnz L_lsl_7
L_lbk_8:
  v_mfma_f32_32x32x16_bf16 v[160:175], v[212:215], v[100:103], v[160:175]
  ds_read_b64_tr_b16 v[208:209], v2 offset:24576
  ds_read_b64_tr_b16 v[210:211], v2 offset:24832
  v_mfma_f32_32x32x16_bf16 v[144:159], v[216:219], v[104:107], v[144:159]
  ds_read_b64_tr_b16 v[212:213], v2 offset:57344
  ds_read_b64_tr_b16 v[214:215], v2 offset:57600
  s_waitcnt vmcnt(6)
  ds_read_b128 v[112:115], v180 offset:16384
  ds_read_b128 v[116:119], v181 offset:16384
  ds_read_b128 v[120:123], v182 offset:16384
  ds_read_b128 v[124:127], v183 offset:16384
  s_waitcnt lgkmcnt(8)
  v_mfma_f32_32x32x16_bf16 v[160:175], v[220:223], v[104:107], v[160:175]
  ds_read_b64_tr_b16 v[216:217], v2 offset:25088
  ds_read_b64_tr_b16 v[218:219], v2 offset:25344
  ds_write_b32 v5, v247 offset:0
  v_mfma_f32_32x32x16_bf16 v[144:159], v[224:227], v[108:111], v[144:159]
  ds_read_b64_tr_b16 v[220:221], v2 offset:57856
  ds_read_b64_tr_b16 v[222:223], v2 offset:58112
  v_mfma_f32_32x32x16_bf16 v[160:175], v[228:231], v[108:111], v[160:175]
  ds_read_b64_tr_b16 v[224:225], v2 offset:26624
  ds_read_b64_tr_b16 v[226:227], v2 offset:26880
  s_waitcnt lgkmcnt(10)
  v_dot2c_f32_bf16 v192, s51, v112
  v_dot2c_f32_bf16 v193, v112, v112
  v_dot2c_f32_bf16 v194, s51, v113
  v_dot2c_f32_bf16 v195, v113, v113
  v_dot2c_f32_bf16 v192, s51, v114
  v_dot2c_f32_bf16 v193, v114, v114
  v_dot2c_f32_bf16 v194, s51, v115
  v_dot2c_f32_bf16 v195, v115, v115
  s_waitcnt lgkmcnt(9)
  v_dot2c_f32_bf16 v192, s51, v116
  v_dot2c_f32_bf16 v193, v116, v116
  v_dot2c_f32_bf16 v194, s51, v117
  v_dot2c_f32_bf16 v195, v117, v117
  v_dot2c_f32_bf16 v192, s51, v118
  v_dot2c_f32_bf16 v193, v118, v118
  v_dot2c_f32_bf16 v194, s51, v119
  v_dot2c_f32_bf16 v195, v119, v119
  s_waitcnt lgkmcnt(8)
  v_dot2c_f32_bf16 v192, s51, v120
  v_dot2c_f32_bf16 v193, v120, v120
  v_dot2c_f32_bf16 v194, s51, v121
  v_dot2c_f32_bf16 v195, v121, v121
  v_dot2c_f32_bf16 v192, s51, v122
  v_dot2c_f32_bf16 v193, v122, v122
  v_dot2c_f32_bf16 v194, s51, v123
  v_dot2c_f32_bf16 v195, v123, v123
  s_waitcnt lgkmcnt(7)
  v_dot2c_f32_bf16 v192, s51, v124
  v_dot2c_f32_bf16 v193, v124, v124
  v_dot2c_f32_bf16 v194, s51, v125
  v_dot2c_f32_bf16 v195, v125, v125
  v_dot2c_f32_bf16 v192, s51, v126
  v_dot2c_f32_bf16 v193, v126, v126
  v_dot2c_f32_bf16 v194, s51, v127
  v_dot2c_f32_bf16 v195, v127, v127
  s_waitcnt lgkmcnt(5)
  v_mfma_f32_32x32x16_bf16 v[144:159], v[208:211], v[112:115], v[144:159]
  ds_read_b64_tr_b16 v[228:229], v2 offset:59392
  ds_read_b64_tr_b16 v[230:231], v2 offset:59648
  v_mfma_f32_32x32x16_bf16 v[160:175], v[212:215], v[112:115], v[160:175]
  ds_read_b64_tr_b16 v[208:209], v2 offset:27136
  ds_read_b64_tr_b16 v[210:211], v2 offset:27392
  v_mfma_f32_32x32x16_bf16 v[144:159], v[216:219], v[116:119], v[144:159]
  ds_read_b64_tr_b16 v[212:213], v2 offset:59904
  ds_read_b64_tr_b16 v[214:215], v2 offset:60160
  s_waitcnt lgkmcnt(4)
  v_mfma_f32_32x32x16_bf16 v[160:175], v[220:223], v[116:119], v[160:175]
  ds_read_b64_tr_b16 v[216:217], v2 offset:28672
  ds_read_b64_tr_b16 v[218:219], v2 offset:28928
  ds_read_b32 v7, v14 offset:2112
  v_mfma_f32_32x32x16_bf16 v[144:159], v[224:227], v[120:123], v[144:159]
  ds_read_b64_tr_b16 v[220:221], v2 offset:61440
  ds_read_b64_tr_b16 v[222:223], v2 offset:61696
  s_waitcnt vmcnt(2)
  ds_read_b128 v[128:131], v180 offset:32768
  ds_read_b128 v[132:135], v181 offset:32768
  ds_read_b128 v[136:139], v182 offset:32768
  ds_read_b128 v[140:143], v183 offset:32768
  ds_write_b32 v5, v247 offset:64
  v_mfma_f32_32x32x16_bf16 v[160:175], v[228:231], v[120:123], v[160:175]
  ds_read_b64_tr_b16 v[224:225], v2 offset:29184
  ds_read_b64_tr_b16 v[226:227], v2 offset:29440
  s_waitcnt lgkmcnt(10)
  v_mfma_f32_32x32x16_bf16 v[144:159], v[208:211], v[124:127], v[144:159]
  ds_read_b64_tr_b16 v[228:229], v2 offset:61952
  ds_read_b64_tr_b16 v[230:231], v2 offset:62208
  v_mfma_f32_32x32x16_bf16 v[160:175], v[212:215], v[124:127], v[160:175]
  ds_read_b64_tr_b16 v[208:209], v2 offset:30720
  ds_read_b64_tr_b16 v[210:211], v2 offset:30976
  s_waitcnt lgkmcnt(10)
  v_dot2c_f32_bf16 v192, s51, v128
  v_dot2c_f32_bf16 v193, v128, v128
  v_dot2c_f32_bf16 v194, s51, v129
  v_dot2c_f32_bf16 v195, v129, v129
  v_dot2c_f32_bf16 v192, s51, v130
  v_dot2c_f32_bf16 v193, v130, v130
  v_dot2c_f32_bf16 v194, s51, v131
  v_dot2c_f32_bf16 v195, v131, v131
  s_waitcnt lgkmcnt(9)
  v_dot2c_f32_bf16 v192, s51, v132
  v_dot2c_f32_bf16 v193, v132, v132
  v_dot2c_f32_bf16 v194, s51, v133
  v_dot2c_f32_bf16 v195, v133, v133
  v_dot2c_f32_bf16 v192, s51, v134
  v_dot2c_f32_bf16 v193, v134, v134
  v_dot2c_f32_bf16 v194, s51, v135
  v_dot2c_f32_bf16 v195, v135, v135
  s_waitcnt lgkmcnt(8)
  v_dot2c_f32_bf16 v192, s51, v136
  v_dot2c_f32_bf16 v193, v136, v136
  v_dot2c_f32_bf16 v194, s51, v137
  v_dot2c_f32_bf16 v195, v137, v137
  v_dot2c_f32_bf16 v192, s51, v138
  v_dot2c_f32_bf16 v193, v138, v138
  v_dot2c_f32_bf16 v194, s51, v139
  v_dot2c_f32_bf16 v195, v139, v139
  s_waitcnt lgkmcnt(7)
  v_dot2c_f32_bf16 v192, s51, v140
  v_dot2c_f32_bf16 v193, v140, v140
  v_dot2c_f32_bf16 v194, s51, v141
  v_dot2c_f32_bf16 v195, v141, v141
  v_dot2c_f32_bf16 v192, s51, v142
  v_dot2c_f32_bf16 v193, v142, v142
  v_dot2c_f32_bf16 v194, s51, v143
  v_dot2c_f32_bf16 v195, v143, v143
  v_mfma_f32_32x32x16_bf16 v[144:159], v[216:219], v[128:131], v[144:159]
  ds_read_b64_tr_b16 v[212:213], v2 offset:63488
  ds_read_b64_tr_b16 v[214:215], v2 offset:63744
  v_add_f32 v192, v192, v194
  v_add_f32 v193, v193, v195
  v_mov_b32 v194, v192
  s_waitcnt lgkmcnt(4)
  v_mfma_f32_32x32x16_bf16 v[160:175], v[220:223], v[128:131], v[160:175]
  ds_read_b64_tr_b16 v[216:217], v2 offset:31232
  ds_read_b64_tr_b16 v[218:219], v2 offset:31488
  v_mov_b32 v195, v193
  v_permlane32_swap_b32 v194, v192
  s_nop 0
  v_permlane32_swap_b32 v195, v193
  v_mfma_f32_32x32x16_bf16 v[144:159], v[224:227], v[132:135], v[144:159]
  ds_read_b64_tr_b16 v[220:221], v2 offset:64000
  ds_read_b64_tr_b16 v[222:223], v2 offset:64256
  v_add_f32 v192, v192, v194
  v_add_f32 v193, v193, v195
  v_mul_f32 v192, 0xbb000000, v192
  v_cmp_eq_u32 vcc, 0, v7
  s_cbranch_vccnz L_lsl_9
L_lbk_10:
  ds_read_b64 v[224:225], v9 offset:6656
  v_mfma_f32_32x32x16_bf16 v[160:175], v[228:231], v[132:135], v[160:175]
  v_mul_f32 v193, 0x3b000000, v193
  v_fma_f32 v193, -v192, v192, v193
  v_cvt_pk_bf16_f32 v240, v192, v192
  ds_read_b32 v7, v14 offset:64
  ds_read_b64 v[228:229], v9 offset:6912
  s_waitcnt lgkmcnt(5)
  v_mfma_f32_32x32x16_bf16 v[144:159], v[208:211], v[136:139], v[144:159]
  v_max_f32 v193, 0, v193
  v_add_f32 v193, 0x3727c5ac, v193
  v_and_b32 v194, s54, v240
  v_mfma_f32_32x32x16_bf16 v[160:175], v[212:215], v[136:139], v[160:175]
  v_rsq_f32 v195, v193
  v_sub_f32 v194, v192, v194
  v_mfma_f32_32x32x16_bf16 v[144:159], v[216:219], v[140:143], v[144:159]
  v_cvt_pk_bf16_f32 v241, v194, v194
  v_cndmask_b32 v240, v240, v241, s[42:43]
  v_mov_b32 v241, v240
  s_waitcnt lgkmcnt(0)
  v_mfma_f32_32x32x16_bf16 v[160:175], v[220:223], v[140:143], v[160:175]
  v_mul_f32 v244, 0x3fb8aa3b, v195
  v_mov_b32 v246, v195
  v_mfma_f32_32x32x16_bf16 v[144:159], v[224:227], v[240:243], v[144:159]
  v_cmp_gt_u32 vcc, v247, v7
  s_cbranch_vccnz L_lsl_11
L_lbk_12:
  ds_read_b128 v[216:219], v1 offset:4608
  ds_read_b128 v[220:223], v1 offset:5632
  v_mfma_f32_32x32x16_bf16 v[160:175], v[228:231], v[240:243], v[160:175]
  s_nop 11
L_body:
  ds_write_b32 v5, v247 offset:128
  v_cvt_pk_bf16_f32 v144, v144, v145
  v_cvt_pk_bf16_f32 v145, v146, v147
  v_cvt_pk_bf16_f32 v146, v148, v149
  v_cvt_pk_bf16_f32 v147, v150, v151
  v_cvt_pk_bf16_f32 v148, v152, v153
  v_cvt_pk_bf16_f32 v149, v154, v155
  v_cvt_pk_bf16_f32 v150, v156, v157
  v_cvt_pk_bf16_f32 v151, v158, v159
  s_waitcnt lgkmcnt(2)
  v_mfma_f32_32x32x16_bf16 v[176:191], v[216:219], v[144:147], 0
  s_waitcnt lgkmcnt(1)
  v_mfma_f32_32x32x16_bf16 v[192:207], v[220:223], v[148:151], 0
  v_pk_mul_f32 v[160:161], v[160:161], v[246:247] op_sel_hi:[1,0]
  v_pk_mul_f32 v[162:163], v[162:163], v[246:247] op_sel_hi:[1,0]
  v_pk_mul_f32 v[164:165], v[164:165], v[246:247] op_sel_hi:[1,0]
  v_pk_mul_f32 v[166:167], v[166:167], v[246:247] op_sel_hi:[1,0]
  v_pk_mul_f32 v[168:169], v[168:169], v[246:247] op_sel_hi:[1,0]
  v_pk_mul_f32 v[170:171], v[170:171], v[246:247] op_sel_hi:[1,0]
  v_pk_mul_f32 v[172:173], v[172:173], v[246:247] op_sel_hi:[1,0]
  v_pk_mul_f32 v[174:175], v[174:175], v[246:247] op_sel_hi:[1,0]
  v_cvt_pk_bf16_f32 v160, v160, v161
  v_cvt_pk_bf16_f32 v161, v162, v163
  v_cvt_pk_bf16_f32 v162, v164, v165
  v_cvt_pk_bf16_f32 v163, v166, v167
  v_cvt_pk_bf16_f32 v164, v168, v169
  v_cvt_pk_bf16_f32 v165, v170, v171
  v_cvt_pk_bf16_f32 v166, v172, v173
  v_cvt_pk_bf16_f32 v167, v174, v175
  v_cndmask_b32 v172, 0, 48, s[42:43]
  v_xor_b32 v172, v172, v8
  v_xor_b32 v174, 16, v8
  ds_write_b128 v172, v[160:163] offset:16384
  ds_write_b128 v172, v[164:167] offset:24576
  v_max3_f32 v248, v176, v177, v178
  v_max3_f32 v250, v192, v193, v194
  v_max3_f32 v248, v248, v179, v180
  v_max3_f32 v250, v250, v195, v196
  v_max3_f32 v248, v248, v181, v182
  v_max3_f32 v250, v250, v197, v198
  v_max3_f32 v248, v248, v183, v184
  v_max3_f32 v250, v250, v199, v200
  v_max3_f32 v248, v248, v185, v186
  v_max3_f32 v250, v250, v201, v202
  v_max3_f32 v248, v248, v187, v188
  v_max3_f32 v250, v250, v203, v204
  v_max3_f32 v248, v248, v189, v190
  v_max3_f32 v250, v250, v205, v206
  v_max_f32 v248, v248, v191
  v_max_f32 v250, v250, v207
  v_mul_f32_e64 v248, -v244, v248
  v_mul_f32_e64 v250, -v244, v250
  v_pk_fma_f32 v[176:177], v[176:177], v[244:245], v[248:249] op_sel_hi:[1,0,0]
  v_pk_fma_f32 v[192:193], v[192:193], v[244:245], v[250:251] op_sel_hi:[1,0,0]
  v_pk_fma_f32 v[178:179], v[178:179], v[244:245], v[248:249] op_sel_hi:[1,0,0]
  v_pk_fma_f32 v[194:195], v[194:195], v[244:245], v[250:251] op_sel_hi:[1,0,0]
  v_pk_fma_f32 v[180:181], v[180:181], v[244:245], v[248:249] op_sel_hi:[1,0,0]
  v_pk_fma_f32 v[196:197], v[196:197], v[244:245], v[250:251] op_sel_hi:[1,0,0]
  v_pk_fma_f32 v[182:183], v[182:183], v[244:245], v[248:249] op_sel_hi:[1,0,0]
  v_pk_fma_f32 v[198:199], v[198:199], v[244:245], v[250:251] op_sel_hi:[1,0,0]
  v_pk_fma_f32 v[184:185], v[184:185], v[244:245], v[248:249] op_sel_hi:[1,0,0]
  v_pk_fma_f32 v[200:201], v[200:201], v[244:245], v[250:251] op_sel_hi:[1,0,0]
  v_pk_fma_f32 v[186:187], v[186:187], v[244:245], v[248:249] op_sel_hi:[1,0,0]
  v_pk_fma_f32 v[202:203], v[202:203], v[244:245], v[250:251] op_sel_hi:[1,0,0]
  v_pk_fma_f32 v[188:189], v[188:189], v[244:245], v[248:249] op_sel_hi:[1,0,0]
  v_pk_fma_f32 v[204:205], v[204:205], v[244:245], v[250:251] op_sel_hi:[1,0,0]
  v_pk_fma_f32 v[190:191], v[190:191], v[244:245], v[248:249] op_sel_hi:[1,0,0]
  v_pk_fma_f32 v[206:207], v[206:207], v[244:245], v[250:251] op_sel_hi:[1,0,0]
  v_exp_f32 v176, v176
  v_exp_f32 v192, v192
  v_exp_f32 v177, v177
  v_exp_f32 v193, v193
  v_exp_f32 v178, v178
  v_exp_f32 v194, v194
  v_exp_f32 v179, v179
  v_exp_f32 v195, v195
  v_exp_f32 v180, v180
  v_exp_f32 v196, v196
  v_exp_f32 v181, v181
  v_exp_f32 v197, v197
  v_exp_f32 v182, v182
  v_exp_f32 v198, v198
  v_exp_f32 v183, v183
  v_exp_f32 v199, v199
  v_exp_f32 v184, v184
  v_exp_f32 v200, v200
  v_exp_f32 v185, v185
  v_exp_f32 v201, v201
  v_exp_f32 v186, v186
  v_exp_f32 v202, v202
  v_exp_f32 v187, v187
  v_exp_f32 v203, v203
  v_exp_f32 v188, v188
  v_exp_f32 v204, v204
  v_exp_f32 v189, v189
  v_exp_f32 v205, v205
  v_exp_f32 v190, v190
  v_exp_f32 v206, v206
  v_exp_f32 v191, v191
  v_exp_f32 v207, v207
  v_pk_add_f32 v[252:253], v[176:177], v[178:179]
  v_pk_add_f32 v[254:255], v[192:193], v[194:195]
  v_pk_add_f32 v[252:253], v[252:253], v[180:181]
  v_pk_add_f32 v[254:255], v[254:255], v[196:197]
  v_pk_add_f32 v[252:253], v[252:253], v[182:183]
  v_pk_add_f32 v[254:255], v[254:255], v[198:199]
  v_pk_add_f32 v[252:253], v[252:253], v[184:185]
  v_pk_add_f32 v[254:255], v[254:255], v[200:201]
  v_pk_add_f32 v[252:253], v[252:253], v[186:187]
  v_pk_add_f32 v[254:255], v[254:255], v[202:203]
  v_pk_add_f32 v[252:253], v[252:253], v[188:189]
  v_pk_add_f32 v[254:255], v[254:255], v[204:205]
  v_pk_add_f32 v[252:253], v[252:253], v[190:191]
  v_pk_add_f32 v[254:255], v[254:255], v[206:207]
  v_add_f32 v252, v252, v253
  v_add_f32 v254, v254, v255
  v_rcp_f32 v252, v252
  v_rcp_f32 v254, v254
  v_pk_mul_f32 v[176:177], v[176:177], v[252:253] op_sel_hi:[1,0]
  v_pk_mul_f32 v[192:193], v[192:193], v[254:255] op_sel_hi:[1,0]
  v_pk_mul_f32 v[178:179], v[178:179], v[252:253] op_sel_hi:[1,0]
  v_pk_mul_f32 v[194:195], v[194:195], v[254:255] op_sel_hi:[1,0]
  v_pk_mul_f32 v[180:181], v[180:181], v[252:253] op_sel_hi:[1,0]
  v_pk_mul_f32 v[196:197], v[196:197], v[254:255] op_sel_hi:[1,0]
  v_pk_mul_f32 v[182:183], v[182:183], v[252:253] op_sel_hi:[1,0]
  v_pk_mul_f32 v[198:199], v[198:199], v[254:255] op_sel_hi:[1,0]
  v_pk_mul_f32 v[184:185], v[184:185], v[252:253] op_sel_hi:[1,0]
  v_pk_mul_f32 v[200:201], v[200:201], v[254:255] op_sel_hi:[1,0]
  v_pk_mul_f32 v[186:187], v[186:187], v[252:253] op_sel_hi:[1,0]
  v_pk_mul_f32 v[202:203], v[202:203], v[254:255] op_sel_hi:[1,0]
  v_pk_mul_f32 v[188:189], v[188:189], v[252:253] op_sel_hi:[1,0]
  v_pk_mul_f32 v[204:205], v[204:205], v[254:255] op_sel_hi:[1,0]
  v_pk_mul_f32 v[190:191], v[190:191], v[252:253] op_sel_hi:[1,0]
  v_pk_mul_f32 v[206:207], v[206:207], v[254:255] op_sel_hi:[1,0]
  v_cvt_pk_bf16_f32 v176, v176, v177
  v_cvt_pk_bf16_f32 v192, v192, v193
  v_cvt_pk_bf16_f32 v177, v178, v179
  v_cvt_pk_bf16_f32 v193, v194, v195
  v_cvt_pk_bf16_f32 v178, v180, v181
  v_cvt_pk_bf16_f32 v194, v196, v197
  v_cvt_pk_bf16_f32 v179, v182, v183
  v_cvt_pk_bf16_f32 v195, v198, v199
  v_cvt_pk_bf16_f32 v180, v184, v185
  v_cvt_pk_bf16_f32 v196, v200, v201
  v_cvt_pk_bf16_f32 v181, v186, v187
  v_cvt_pk_bf16_f32 v197, v202, v203
  v_cvt_pk_bf16_f32 v182, v188, v189
  v_cvt_pk_bf16_f32 v198, v204, v205
  v_cvt_pk_bf16_f32 v183, v190, v191
  v_cvt_pk_bf16_f32 v199, v206, v207
  ds_write_b128 v8, v[176:179]
  ds_write_b128 v174, v[180:183]
  ds_write_b128 v8, v[192:195] offset:8192
  ds_write_b128 v174, v[196:199] offset:8192
  ds_write_b32 v5, v247 offset:192
  s_waitcnt lgkmcnt(0)
  ds_read_b32 v7, v14 offset:192
  ds_read_b64_tr_b16 v[144:145], v10 offset:0
  ds_read_b64_tr_b16 v[146:147], v11 offset:256
  ds_read_b64_tr_b16 v[176:177], v12 offset:16384
  ds_read_b64_tr_b16 v[178:179], v13 offset:16640
  ds_read_b64_tr_b16 v[148:149], v10 offset:2048
  ds_read_b64_tr_b16 v[150:151], v11 offset:2304
  ds_read_b64_tr_b16 v[180:181], v12 offset:18432
  ds_read_b64_tr_b16 v[182:183], v13 offset:18688
  ds_read_b64_tr_b16 v[152:153], v10 offset:4096
  ds_read_b64_tr_b16 v[154:155], v11 offset:4352
  ds_read_b64_tr_b16 v[184:185], v12 offset:20480
  ds_read_b64_tr_b16 v[186:187], v13 offset:20736
  v_mov_b32 v216, s51
  v_mov_b32 v217, s51
  v_mov_b32 v218, s51
  v_mov_b32 v219, s51
  v_bfe_u32 v250, v1, 4, 5
  v_lshrrev_b32 v251, 9, v1
  s_and_b32 s46, s14, 1
  s_lshr_b32 s47, s14, 1
  s_lshl_b32 s44, s46, 2
  s_add_u32 s44, s44, s47
  s_lshl_b32 s45, s44, 4
  s_lshl_b32 s44, s44, 8
  s_add_u32 s45, s45, 2048
  v_lshlrev_b32 v248, 9, v251
  v_lshl_add_u32 v248, v250, 4, v248
  v_add_u32 v248, s44, v248
  v_lshl_add_u32 v251, v251, 5, s45
  v_cmp_eq_u32 vcc, 16, v250
  s_nop 1
  v_cndmask_b32 v248, v248, v251, vcc
  v_add_u32 v250, 143360, v248
  s_waitcnt lgkmcnt(12)
  v_cmp_gt_u32 vcc, v247, v7
  s_cbranch_vccnz L_lsl_13
L_lbk_14:
  s_waitcnt lgkmcnt(10)
  v_mfma_f32_16x16x32_bf16 v[212:215], v[144:147], v[216:219], 0
  ds_read_b64_tr_b16 v[156:157], v10 offset:6144
  ds_read_b64_tr_b16 v[158:159], v11 offset:6400
  ds_read_b64_tr_b16 v[188:189], v12 offset:22528
  ds_read_b64_tr_b16 v[190:191], v13 offset:22784
  ds_read_b32 v7, v14 offset:2624
  s_waitcnt lgkmcnt(13)
  v_mfma_f32_16x16x32_bf16 v[208:211], v[144:147], v[176:179], 0
  s_waitcnt lgkmcnt(11)
  v_mfma_f32_16x16x32_bf16 v[212:215], v[148:151], v[216:219], v[212:215]
  s_waitcnt lgkmcnt(9)
  v_mfma_f32_16x16x32_bf16 v[208:211], v[148:151], v[180:183], v[208:211]
  s_waitcnt lgkmcnt(7)
  v_mfma_f32_16x16x32_bf16 v[212:215], v[152:155], v[216:219], v[212:215]
  s_waitcnt lgkmcnt(5)
  v_mfma_f32_16x16x32_bf16 v[208:211], v[152:155], v[184:187], v[208:211]
  s_waitcnt lgkmcnt(3)
  v_mfma_f32_16x16x32_bf16 v[212:215], v[156:159], v[216:219], v[212:215]
  s_waitcnt lgkmcnt(1)
  v_mfma_f32_16x16x32_bf16 v[208:211], v[156:159], v[188:191], v[208:211]
  s_waitcnt lgkmcnt(0)
  v_cmp_eq_u32 vcc, 0, v7
  s_cbranch_vccnz L_lsl_15
L_lbk_16:
  s_nop 1
  v_cvt_pk_bf16_f32 v222, v212, v213
  v_cvt_pk_bf16_f32 v223, v214, v215
  s_nop 0
  v_cvt_pk_bf16_f32 v220, v208, v209
  v_cvt_pk_bf16_f32 v221, v210, v211
  s_nop 0
  v_permlane16_swap_b32 v220, v222
  v_permlane16_swap_b32 v221, v223
  s_mov_b32 exec_lo, 0x1ffff
  s_mov_b32 exec_hi, 0x1ffff
  buffer_store_dwordx4 v[220:223], v248, s[4:7], s21 offen sc1
  ds_write_b128 v250, v[220:223]
  s_mov_b64 exec, -1
  ds_write_b32 v5, v247 offset:2496
  s_cmp_ge_u32 s14, 2
  s_cbranch_scc1 L_nokv
  ds_read_b32 v7, v14 offset:1344
  s_lshl_b32 s46, s14, 2
  s_xor_b32 s46, s46, s12
  s_and_b32 s34, s20, 0xffff0000
  v_lshrrev_b32 v11, 8, v1
  v_xor_b32 v11, s46, v11
  v_and_b32 v12, 0x70, v1
  v_add_u32 v12, 2048, v12
  v_lshl_add_u32 v11, v11, 12, v12
  s_waitcnt lgkmcnt(0)
  v_cmp_gt_u32 vcc, v247, v7
  s_cbranch_vccnz L_lsl_17
L_lbk_18:
  ds_read_b128 v[208:211], v3 offset:0
  ds_read_b128 v[212:215], v3 offset:1024
  ds_read_b128 v[216:219], v3 offset:2048
  ds_read_b128 v[220:223], v3 offset:3072
  ds_read_b128 v[224:227], v3 offset:4096
  s_waitcnt lgkmcnt(2)
  v_mfma_f32_32x32x16_bf16 v[144:159], v[208:211], v[16:19], 0
  ds_read_b128 v[228:231], v3 offset:5120
  v_mfma_f32_32x32x16_bf16 v[144:159], v[212:215], v[20:23], v[144:159]
  ds_read_b128 v[208:211], v3 offset:6144
  v_mfma_f32_32x32x16_bf16 v[144:159], v[216:219], v[24:27], v[144:159]
  ds_read_b128 v[212:215], v3 offset:7168
  s_waitcnt lgkmcnt(2)
  v_mfma_f32_32x32x16_bf16 v[144:159], v[220:223], v[28:31], v[144:159]
  ds_read_b128 v[216:219], v3 offset:8192
  v_mfma_f32_32x32x16_bf16 v[144:159], v[224:227], v[32:35], v[144:159]
  ds_read_b128 v[220:223], v3 offset:9216
  v_mfma_f32_32x32x16_bf16 v[144:159], v[228:231], v[36:39], v[144:159]
  ds_read_b128 v[224:227], v3 offset:10240
  s_waitcnt lgkmcnt(2)
  v_mfma_f32_32x32x16_bf16 v[144:159], v[208:211], v[40:43], v[144:159]
  ds_read_b128 v[228:231], v3 offset:11264
  v_mfma_f32_32x32x16_bf16 v[144:159], v[212:215], v[44:47], v[144:159]
  ds_read_b128 v[208:211], v3 offset:12288
  v_mfma_f32_32x32x16_bf16 v[144:159], v[216:219], v[48:51], v[144:159]
  ds_read_b128 v[212:215], v3 offset:13312
  s_waitcnt lgkmcnt(2)
  v_mfma_f32_32x32x16_bf16 v[144:159], v[220:223], v[52:55], v[144:159]
  ds_read_b128 v[216:219], v3 offset:14336
  v_mfma_f32_32x32x16_bf16 v[144:159], v[224:227], v[56:59], v[144:159]
  ds_read_b128 v[220:223], v3 offset:15360
  v_mfma_f32_32x32x16_bf16 v[144:159], v[228:231], v[60:63], v[144:159]
  ds_read_b128 v[224:227], v3 offset:16384
  s_waitcnt lgkmcnt(2)
  v_mfma_f32_32x32x16_bf16 v[144:159], v[208:211], v[64:67], v[144:159]
  ds_read_b128 v[228:231], v3 offset:17408
  v_mfma_f32_32x32x16_bf16 v[144:159], v[212:215], v[68:71], v[144:159]
  ds_read_b128 v[208:211], v3 offset:18432
  v_mfma_f32_32x32x16_bf16 v[144:159], v[216:219], v[72:75], v[144:159]
  ds_read_b128 v[212:215], v3 offset:19456
  s_waitcnt lgkmcnt(2)
  v_mfma_f32_32x32x16_bf16 v[144:159], v[220:223], v[76:79], v[144:159]
  ds_read_b128 v[216:219], v3 offset:20480
  v_bfe_u32 v68, v1, 4, 1
  v_lshlrev_b32 v68, 4, v68
  v_lshlrev_b32 v68, v68, s52
  v_mfma_f32_32x32x16_bf16 v[144:159], v[224:227], v[80:83], v[144:159]
  ds_read_b128 v[220:223], v3 offset:21504
  v_bfe_u32 v69, v1, 5, 2
  v_cmp_eq_u32 vcc, 0, v69
  s_nop 1
  v_cndmask_b32 v56, 0, v68, vcc
  v_mfma_f32_32x32x16_bf16 v[144:159], v[228:231], v[84:87], v[144:159]
  ds_read_b128 v[224:227], v3 offset:22528
  v_cmp_eq_u32 vcc, 1, v69
  s_nop 1
  v_cndmask_b32 v57, 0, v68, vcc
  v_cmp_eq_u32 vcc, 2, v69
  ds_read_b32 v7, v14 offset:1152
  s_waitcnt lgkmcnt(3)
  v_mfma_f32_32x32x16_bf16 v[144:159], v[208:211], v[88:91], v[144:159]
  ds_read_b128 v[228:231], v3 offset:23552
  v_cndmask_b32 v58, 0, v68, vcc
  v_cmp_eq_u32 vcc, 3, v69
  s_nop 1
  v_cndmask_b32 v59, 0, v68, vcc
  v_mfma_f32_32x32x16_bf16 v[144:159], v[212:215], v[92:95], v[144:159]
  ds_read_b128 v[208:211], v3 offset:24576
  s_mov_b32 vcc_lo, 0xff0000ff
  s_mov_b32 vcc_hi, 0xff0000ff
  v_cndmask_b32 v52, 0, v56, vcc
  v_mfma_f32_32x32x16_bf16 v[144:159], v[216:219], v[96:99], v[144:159]
  ds_read_b128 v[212:215], v3 offset:25600
  v_cndmask_b32 v53, 0, v57, vcc
  v_cndmask_b32 v54, 0, v58, vcc
  v_cndmask_b32 v55, 0, v59, vcc
  s_waitcnt lgkmcnt(2)
  v_mfma_f32_32x32x16_bf16 v[144:159], v[220:223], v[100:103], v[144:159]
  ds_read_b128 v[216:219], v3 offset:26624
  v_bfe_u32 v68, v1, 8, 1
  v_lshlrev_b32 v68, 3, v68
  v_lshrrev_b32 v69, 9, v1
  v_mfma_f32_32x32x16_bf16 v[144:159], v[224:227], v[104:107], v[144:159]
  ds_read_b128 v[220:223], v3 offset:27648
  s_lshl_b32 s46, s14, 10
  s_add_u32 s46, s46, 139264
  s_lshl_b32 s47, s14, 4
  v_mfma_f32_32x32x16_bf16 v[144:159], v[228:231], v[108:111], v[144:159]
  ds_read_b128 v[224:227], v3 offset:28672
  s_add_u32 s47, s47, 139520
  v_and_b32 v70, 0xf0, v1
  v_lshl_add_u32 v70, v69, 9, v70
  v_cmp_eq_u32 vcc, 0, v7
  s_cbranch_vccnz L_lsl_19
L_lbk_20:
  v_readfirstlane_b32 s55, v7
  s_xor_b32 s32, s20, 57344
  buffer_load_dwordx4 v[16:19], v6, s[4:7], s32 offen offset:0 sc1
  s_waitcnt lgkmcnt(2)
  v_mfma_f32_32x32x16_bf16 v[144:159], v[208:211], v[112:115], v[144:159]
  ds_read_b128 v[228:231], v3 offset:29696
  v_add3_u32 v70, v70, v68, s46
  v_and_b32 v71, 0x70, v1
  v_lshlrev_b32 v71, 5, v71
  s_xor_b32 s32, s20, 49152
  buffer_load_dwordx4 v[20:23], v6, s[4:7], s32 offen offset:0 sc1
  v_mfma_f32_32x32x16_bf16 v[144:159], v[212:215], v[116:119], v[144:159]
  ds_read_b128 v[208:211], v3 offset:30720
  v_lshl_add_u32 v71, v69, 6, v71
  v_add3_u32 v71, v71, v68, s47
  v_add_u32 v72, 139264, v1
  s_xor_b32 s32, s20, 40960
  buffer_load_dwordx4 v[24:27], v6, s[4:7], s32 offen offset:0 sc1
  v_mfma_f32_32x32x16_bf16 v[144:159], v[216:219], v[120:123], v[144:159]
  ds_read_b128 v[212:215], v3 offset:31744
  s_xor_b32 s32, s20, 32768
  buffer_load_dwordx4 v[28:31], v6, s[4:7], s32 offen offset:0 sc1
  ds_read_b64 v[216:217], v9 offset:7168
  s_waitcnt lgkmcnt(3)
  v_mfma_f32_32x32x16_bf16 v[144:159], v[220:223], v[124:127], v[144:159]
  s_xor_b32 s32, s20, 24576
  buffer_load_dwordx4 v[32:35], v6, s[4:7], s32 offen offset:0 sc1
  v_mfma_f32_32x32x16_bf16 v[144:159], v[224:227], v[128:131], v[144:159]
  s_xor_b32 s32, s20, 16384
  buffer_load_dwordx4 v[36:39], v6, s[4:7], s32 offen offset:0 sc1
  v_mfma_f32_32x32x16_bf16 v[144:159], v[228:231], v[132:135], v[144:159]
  s_xor_b32 s32, s20, 8192
  buffer_load_dwordx4 v[40:43], v6, s[4:7], s32 offen offset:0 sc1
  s_waitcnt lgkmcnt(0)
  v_mfma_f32_32x32x16_bf16 v[144:159], v[208:211], v[136:139], v[144:159]
  s_cmp_eq_u32 s14, 0
  s_cselect_b32 exec_lo, 0xffff0000, -1
  buffer_load_dwordx4 v[44:47], v11, s[4:7], s34 offen offset:0 sc1
  s_mov_b32 exec_lo, -1
  v_mfma_f32_32x32x16_bf16 v[144:159], v[212:215], v[140:143], v[144:159]
  ds_read_b128 v[220:223], v1 offset:4608
  ds_read_b128 v[224:227], v1 offset:5632
  s_mov_b32 exec_lo, 0
  buffer_load_dwordx4 v[48:51], v6, s[4:7], s20 offen offset:0 sc1
  s_mov_b32 exec_lo, -1
  v_mfma_f32_32x32x16_bf16 v[144:159], v[216:219], v[240:243], v[144:159]
  s_nop 11
  s_branch L_qd
L_nokv:
  ds_read_b32 v7, v14 offset:1344
  s_lshl_b32 s46, s14, 2
  s_xor_b32 s46, s46, s12
  s_and_b32 s34, s20, 0xffff0000
  v_lshrrev_b32 v11, 8, v1
  v_xor_b32 v11, s46, v11
  v_and_b32 v12, 0x70, v1
  v_add_u32 v12, 2048, v12
  v_lshl_add_u32 v11, v11, 12, v12
  s_waitcnt lgkmcnt(0)
  v_cmp_gt_u32 vcc, v247, v7
  s_cbranch_vccnz L_lsl_21
L_lbk_22:
  ds_read_b128 v[208:211], v3 offset:0
  ds_read_b128 v[212:215], v3 offset:1024
  ds_read_b128 v[216:219], v3 offset:2048
  ds_read_b128 v[220:223], v3 offset:3072
  ds_read_b128 v[224:227], v3 offset:4096
  s_waitcnt lgkmcnt(2)
  v_mfma_f32_32x32x16_bf16 v[144:159], v[208:211], v[16:19], 0
  ds_read_b128 v[228:231], v3 offset:5120
  v_mfma_f32_32x32x16_bf16 v[144:159], v[212:215], v[20:23], v[144:159]
  ds_read_b128 v[208:211], v3 offset:6144
  v_mfma_f32_32x32x16_bf16 v[144:159], v[216:219], v[24:27], v[144:159]
  ds_read_b128 v[212:215], v3 offset:7168
  s_waitcnt lgkmcnt(2)
  v_mfma_f32_32x32x16_bf16 v[144:159], v[220:223], v[28:31], v[144:159]
  ds_read_b128 v[216:219], v3 offset:8192
  v_mfma_f32_32x32x16_bf16 v[144:159], v[224:227], v[32:35], v[144:159]
  ds_read_b128 v[220:223], v3 offset:9216
  v_mfma_f32_32x32x16_bf16 v[144:159], v[228:231], v[36:39], v[144:159]
  ds_read_b128 v[224:227], v3 offset:10240
  s_waitcnt lgkmcnt(2)
  v_mfma_f32_32x32x16_bf16 v[144:159], v[208:211], v[40:43], v[144:159]
  ds_read_b128 v[228:231], v3 offset:11264
  v_mfma_f32_32x32x16_bf16 v[144:159], v[212:215], v[44:47], v[144:159]
  ds_read_b128 v[208:211], v3 offset:12288
  v_mfma_f32_32x32x16_bf16 v[144:159], v[216:219], v[48:51], v[144:159]
  ds_read_b128 v[212:215], v3 offset:13312
  s_waitcnt lgkmcnt(2)
  v_mfma_f32_32x32x16_bf16 v[144:159], v[220:223], v[52:55], v[144:159]
  ds_read_b128 v[216:219], v3 offset:14336
  v_mfma_f32_32x32x16_bf16 v[144:159], v[224:227], v[56:59], v[144:159]
  ds_read_b128 v[220:223], v3 offset:15360
  v_mfma_f32_32x32x16_bf16 v[144:159], v[228:231], v[60:63], v[144:159]
  ds_read_b128 v[224:227], v3 offset:16384
  s_waitcnt lgkmcnt(2)
  v_mfma_f32_32x32x16_bf16 v[144:159], v[208:211], v[64:67], v[144:159]
  ds_read_b128 v[228:231], v3 offset:17408
  v_mfma_f32_32x32x16_bf16 v[144:159], v[212:215], v[68:71], v[144:159]
  ds_read_b128 v[208:211], v3 offset:18432
  v_mfma_f32_32x32x16_bf16 v[144:159], v[216:219], v[72:75], v[144:159]
  ds_read_b128 v[212:215], v3 offset:19456
  s_waitcnt lgkmcnt(2)
  v_mfma_f32_32x32x16_bf16 v[144:159], v[220:223], v[76:79], v[144:159]
  ds_read_b128 v[216:219], v3 offset:20480
  v_bfe_u32 v68, v1, 4, 1
  v_lshlrev_b32 v68, 4, v68
  v_lshlrev_b32 v68, v68, s52
  v_mfma_f32_32x32x16_bf16 v[144:159], v[224:227], v[80:83], v[144:159]
  ds_read_b128 v[220:223], v3 offset:21504
  v_bfe_u32 v69, v1, 5, 2
  v_cmp_eq_u32 vcc, 0, v69
  s_nop 1
  v_cndmask_b32 v56, 0, v68, vcc
  v_mfma_f32_32x32x16_bf16 v[144:159], v[228:231], v[84:87], v[144:159]
  ds_read_b128 v[224:227], v3 offset:22528
  v_cmp_eq_u32 vcc, 1, v69
  s_nop 1
  v_cndmask_b32 v57, 0, v68, vcc
  v_cmp_eq_u32 vcc, 2, v69
  s_waitcnt lgkmcnt(2)
  v_mfma_f32_32x32x16_bf16 v[144:159], v[208:211], v[88:91], v[144:159]
  ds_read_b128 v[228:231], v3 offset:23552
  v_cndmask_b32 v58, 0, v68, vcc
  v_cmp_eq_u32 vcc, 3, v69
  s_nop 1
  v_cndmask_b32 v59, 0, v68, vcc
  v_mfma_f32_32x32x16_bf16 v[144:159], v[212:215], v[92:95], v[144:159]
  ds_read_b128 v[208:211], v3 offset:24576
  s_mov_b32 vcc_lo, 0xff0000ff
  s_mov_b32 vcc_hi, 0xff0000ff
  v_cndmask_b32 v52, 0, v56, vcc
  v_mfma_f32_32x32x16_bf16 v[144:159], v[216:219], v[96:99], v[144:159]
  ds_read_b128 v[212:215], v3 offset:25600
  v_cndmask_b32 v53, 0, v57, vcc
  v_cndmask_b32 v54, 0, v58, vcc
  v_cndmask_b32 v55, 0, v59, vcc
  s_waitcnt lgkmcnt(2)
  v_mfma_f32_32x32x16_bf16 v[144:159], v[220:223], v[100:103], v[144:159]
  ds_read_b128 v[216:219], v3 offset:26624
  v_bfe_u32 v68, v1, 8, 1
  v_lshlrev_b32 v68, 3, v68
  v_lshrrev_b32 v69, 9, v1
  ds_read_b32 v7, v14 offset:1152
  v_mfma_f32_32x32x16_bf16 v[144:159], v[224:227], v[104:107], v[144:159]
  ds_read_b128 v[220:223], v3 offset:27648
  s_lshl_b32 s46, s14, 10
  s_add_u32 s46, s46, 139264
  s_lshl_b32 s47, s14, 4
  v_mfma_f32_32x32x16_bf16 v[144:159], v[228:231], v[108:111], v[144:159]
  ds_read_b128 v[224:227], v3 offset:28672
  s_add_u32 s47, s47, 139520
  v_and_b32 v70, 0xf0, v1
  v_lshl_add_u32 v70, v69, 9, v70
  s_waitcnt lgkmcnt(3)
  v_mfma_f32_32x32x16_bf16 v[144:159], v[208:211], v[112:115], v[144:159]
  ds_read_b128 v[228:231], v3 offset:29696
  v_add3_u32 v70, v70, v68, s46
  v_and_b32 v71, 0x70, v1
  v_lshlrev_b32 v71, 5, v71
  v_mfma_f32_32x32x16_bf16 v[144:159], v[212:215], v[116:119], v[144:159]
  ds_read_b128 v[208:211], v3 offset:30720
  v_lshl_add_u32 v71, v69, 6, v71
  v_add3_u32 v71, v71, v68, s47
  v_add_u32 v72, 139264, v1
  v_mfma_f32_32x32x16_bf16 v[144:159], v[216:219], v[120:123], v[144:159]
  ds_read_b128 v[212:215], v3 offset:31744
  ds_read_b64 v[216:217], v9 offset:7168
  s_waitcnt lgkmcnt(3)
  v_mfma_f32_32x32x16_bf16 v[144:159], v[220:223], v[124:127], v[144:159]
  v_cmp_eq_u32 vcc, 0, v7
  s_cbranch_vccnz L_lsl_23
L_lbk_24:
  v_readfirstlane_b32 s55, v7
  v_mfma_f32_32x32x16_bf16 v[144:159], v[224:227], v[128:131], v[144:159]
  v_mfma_f32_32x32x16_bf16 v[144:159], v[228:231], v[132:135], v[144:159]
  s_waitcnt lgkmcnt(0)
  v_mfma_f32_32x32x16_bf16 v[144:159], v[208:211], v[136:139], v[144:159]
  v_mfma_f32_32x32x16_bf16 v[144:159], v[212:215], v[140:143], v[144:159]
  ds_read_b128 v[220:223], v1 offset:4608
  ds_read_b128 v[224:227], v1 offset:5632
  v_mfma_f32_32x32x16_bf16 v[144:159], v[216:219], v[240:243], v[144:159]
  s_nop 11
L_qd:
  ds_write_b32 v5, v247 offset:256
  v_cvt_pk_bf16_f32 v144, v144, v145
  v_cvt_pk_bf16_f32 v145, v146, v147
  v_cvt_pk_bf16_f32 v146, v148, v149
  v_cvt_pk_bf16_f32 v147, v150, v151
  v_cvt_pk_bf16_f32 v148, v152, v153
  v_cvt_pk_bf16_f32 v149, v154, v155
  v_cvt_pk_bf16_f32 v150, v156, v157
  v_cvt_pk_bf16_f32 v151, v158, v159
  s_waitcnt lgkmcnt(2)
  v_mfma_f32_32x32x16_bf16 v[176:191], v[220:223], v[144:147], 0
  s_waitcnt lgkmcnt(1)
  v_mfma_f32_32x32x16_bf16 v[192:207], v[224:227], v[148:151], 0
  s_waitcnt lgkmcnt(0)
  s_cmp_eq_u32 s55, 1
  s_cbranch_scc1 L_j1s
L_j1:
  v_and_b32 v13, 0x1ff, v1
  s_lshl_b32 s46, s14, 9
  s_add_u32 s46, s46, 143360
  v_add_u32 v13, s46, v13
  v_add_u32 v12, 143360, v12
  ds_read_b32 v7, v14 offset:2496
  s_mov_b32 exec_hi, 0
  ds_read_b128 v[48:51], v13
  s_cmp_eq_u32 s14, 0
  s_cselect_b32 exec_lo, 0xffff, 0
  ds_read_b128 v[44:47], v12
  s_mov_b64 exec, -1
  v_max3_f32 v248, v176, v177, v178
  v_max3_f32 v250, v192, v193, v194
  v_max3_f32 v248, v248, v179, v180
  v_max3_f32 v250, v250, v195, v196
  v_max3_f32 v248, v248, v181, v182
  v_max3_f32 v250, v250, v197, v198
  v_max3_f32 v248, v248, v183, v184
  v_max3_f32 v250, v250, v199, v200
  v_max3_f32 v248, v248, v185, v186
  v_max3_f32 v250, v250, v201, v202
  v_max3_f32 v248, v248, v187, v188
  v_max3_f32 v250, v250, v203, v204
  v_max3_f32 v248, v248, v189, v190
  v_max3_f32 v250, v250, v205, v206
  v_max_f32 v248, v248, v191
  v_max_f32 v250, v250, v207
  v_mul_f32_e64 v248, -v244, v248
  v_mul_f32_e64 v250, -v244, v250
  v_pk_fma_f32 v[176:177], v[176:177], v[244:245], v[248:249] op_sel_hi:[1,0,0]
  v_pk_fma_f32 v[192:193], v[192:193], v[244:245], v[250:251] op_sel_hi:[1,0,0]
  v_pk_fma_f32 v[178:179], v[178:179], v[244:245], v[248:249] op_sel_hi:[1,0,0]
  v_pk_fma_f32 v[194:195], v[194:195], v[244:245], v[250:251] op_sel_hi:[1,0,0]
  v_pk_fma_f32 v[180:181], v[180:181], v[244:245], v[248:249] op_sel_hi:[1,0,0]
  v_pk_fma_f32 v[196:197], v[196:197], v[244:245], v[250:251] op_sel_hi:[1,0,0]
  v_pk_fma_f32 v[182:183], v[182:183], v[244:245], v[248:249] op_sel_hi:[1,0,0]
  v_pk_fma_f32 v[198:199], v[198:199], v[244:245], v[250:251] op_sel_hi:[1,0,0]
  v_pk_fma_f32 v[184:185], v[184:185], v[244:245], v[248:249] op_sel_hi:[1,0,0]
  v_pk_fma_f32 v[200:201], v[200:201], v[244:245], v[250:251] op_sel_hi:[1,0,0]
  v_pk_fma_f32 v[186:187], v[186:187], v[244:245], v[248:249] op_sel_hi:[1,0,0]
  v_pk_fma_f32 v[202:203], v[202:203], v[244:245], v[250:251] op_sel_hi:[1,0,0]
  v_pk_fma_f32 v[188:189], v[188:189], v[244:245], v[248:249] op_sel_hi:[1,0,0]
  v_pk_fma_f32 v[204:205], v[204:205], v[244:245], v[250:251] op_sel_hi:[1,0,0]
  v_pk_fma_f32 v[190:191], v[190:191], v[244:245], v[248:249] op_sel_hi:[1,0,0]
  v_pk_fma_f32 v[206:207], v[206:207], v[244:245], v[250:251] op_sel_hi:[1,0,0]
  v_exp_f32 v176, v176
  v_exp_f32 v192, v192
  v_exp_f32 v177, v177
  v_exp_f32 v193, v193
  v_exp_f32 v178, v178
  v_exp_f32 v194, v194
  v_exp_f32 v179, v179
  v_exp_f32 v195, v195
  v_exp_f32 v180, v180
  v_exp_f32 v196, v196
  v_exp_f32 v181, v181
  v_exp_f32 v197, v197
  v_exp_f32 v182, v182
  v_exp_f32 v198, v198
  v_exp_f32 v183, v183
  v_exp_f32 v199, v199
  v_exp_f32 v184, v184
  v_exp_f32 v200, v200
  v_exp_f32 v185, v185
  v_exp_f32 v201, v201
  v_exp_f32 v186, v186
  v_exp_f32 v202, v202
  v_exp_f32 v187, v187
  v_exp_f32 v203, v203
  v_exp_f32 v188, v188
  v_exp_f32 v204, v204
  v_exp_f32 v189, v189
  v_exp_f32 v205, v205
  v_exp_f32 v190, v190
  v_exp_f32 v206, v206
  v_exp_f32 v191, v191
  v_exp_f32 v207, v207
  v_pk_add_f32 v[252:253], v[176:177], v[178:179]
  v_pk_add_f32 v[254:255], v[192:193], v[194:195]
  v_pk_add_f32 v[252:253], v[252:253], v[180:181]
  v_pk_add_f32 v[254:255], v[254:255], v[196:197]
  v_pk_add_f32 v[252:253], v[252:253], v[182:183]
  v_pk_add_f32 v[254:255], v[254:255], v[198:199]
  v_pk_add_f32 v[252:253], v[252:253], v[184:185]
  v_pk_add_f32 v[254:255], v[254:255], v[200:201]
  v_pk_add_f32 v[252:253], v[252:253], v[186:187]
  v_pk_add_f32 v[254:255], v[254:255], v[202:203]
  v_pk_add_f32 v[252:253], v[252:253], v[188:189]
  v_pk_add_f32 v[254:255], v[254:255], v[204:205]
  v_pk_add_f32 v[252:253], v[252:253], v[190:191]
  v_pk_add_f32 v[254:255], v[254:255], v[206:207]
  v_add_f32 v252, v252, v253
  v_add_f32 v254, v254, v255
  v_rcp_f32 v252, v252
  v_rcp_f32 v254, v254
  v_pk_mul_f32 v[176:177], v[176:177], v[252:253] op_sel_hi:[1,0]
  v_pk_mul_f32 v[192:193], v[192:193], v[254:255] op_sel_hi:[1,0]
  v_pk_mul_f32 v[178:179], v[178:179], v[252:253] op_sel_hi:[1,0]
  v_pk_mul_f32 v[194:195], v[194:195], v[254:255] op_sel_hi:[1,0]
  v_pk_mul_f32 v[180:181], v[180:181], v[252:253] op_sel_hi:[1,0]
  v_pk_mul_f32 v[196:197], v[196:197], v[254:255] op_sel_hi:[1,0]
  v_pk_mul_f32 v[182:183], v[182:183], v[252:253] op_sel_hi:[1,0]
  v_pk_mul_f32 v[198:199], v[198:199], v[254:255] op_sel_hi:[1,0]
  v_pk_mul_f32 v[184:185], v[184:185], v[252:253] op_sel_hi:[1,0]
  v_pk_mul_f32 v[200:201], v[200:201], v[254:255] op_sel_hi:[1,0]
  v_pk_mul_f32 v[186:187], v[186:187], v[252:253] op_sel_hi:[1,0]
  v_pk_mul_f32 v[202:203], v[202:203], v[254:255] op_sel_hi:[1,0]
  v_pk_mul_f32 v[188:189], v[188:189], v[252:253] op_sel_hi:[1,0]
  v_pk_mul_f32 v[204:205], v[204:205], v[254:255] op_sel_hi:[1,0]
  v_pk_mul_f32 v[190:191], v[190:191], v[252:253] op_sel_hi:[1,0]
  v_pk_mul_f32 v[206:207], v[206:207], v[254:255] op_sel_hi:[1,0]
  v_cvt_pk_bf16_f32 v176, v176, v177
  v_cvt_pk_bf16_f32 v192, v192, v193
  v_cvt_pk_bf16_f32 v177, v178, v179
  v_cvt_pk_bf16_f32 v193, v194, v195
  v_cvt_pk_bf16_f32 v178, v180, v181
  v_cvt_pk_bf16_f32 v194, v196, v197
  v_cvt_pk_bf16_f32 v179, v182, v183
  v_cvt_pk_bf16_f32 v195, v198, v199
  v_cvt_pk_bf16_f32 v180, v184, v185
  v_cvt_pk_bf16_f32 v196, v200, v201
  v_cvt_pk_bf16_f32 v181, v186, v187
  v_cvt_pk_bf16_f32 v197, v202, v203
  v_cvt_pk_bf16_f32 v182, v188, v189
  v_cvt_pk_bf16_f32 v198, v204, v205
  v_cvt_pk_bf16_f32 v183, v190, v191
  v_cvt_pk_bf16_f32 v199, v206, v207
  s_cmp_lt_u32 s14, 2
  s_nop 0
  s_cbranch_scc1 L_gl
  s_xor_b32 s32, s20, 57344
  buffer_load_dwordx4 v[16:19], v6, s[4:7], s32 offen offset:0 sc1
  s_xor_b32 s32, s20, 49152
  buffer_load_dwordx4 v[20:23], v6, s[4:7], s32 offen offset:0 sc1
  s_xor_b32 s32, s20, 40960
  buffer_load_dwordx4 v[24:27], v6, s[4:7], s32 offen offset:0 sc1
  s_xor_b32 s32, s20, 32768
  buffer_load_dwordx4 v[28:31], v6, s[4:7], s32 offen offset:0 sc1
  s_xor_b32 s32, s20, 24576
  buffer_load_dwordx4 v[32:35], v6, s[4:7], s32 offen offset:0 sc1
  s_xor_b32 s32, s20, 16384
  buffer_load_dwordx4 v[36:39], v6, s[4:7], s32 offen offset:0 sc1
  s_xor_b32 s32, s20, 8192
  buffer_load_dwordx4 v[40:43], v6, s[4:7], s32 offen offset:0 sc1
  s_cmp_eq_u32 s14, 0
  s_cselect_b32 exec_lo, 0xffff0000, -1
  buffer_load_dwordx4 v[44:47], v11, s[4:7], s34 offen offset:0 sc1
  s_mov_b32 exec_lo, -1
  s_mov_b32 exec_lo, 0
  buffer_load_dwordx4 v[48:51], v6, s[4:7], s20 offen offset:0 sc1
  s_mov_b32 exec_lo, -1
L_gl:
  s_waitcnt lgkmcnt(2)
  v_cmp_gt_u32 vcc, v247, v7
  s_cbranch_vccnz L_lsl_25
L_lbk_26:
  s_waitcnt lgkmcnt(0)
  s_waitcnt vmcnt(6)
  v_max3_u32 v15, v16, v20, v24
  s_waitcnt vmcnt(5)
  v_max_u32 v15, v15, v28
  v_cmp_eq_u32 vcc, -1, v15
  s_cbranch_vccnz L_pl_27
L_plb_28:
  v_mfma_f32_16x16x32_bf16 v[60:63], v[52:55], v[16:19], 0
  v_mfma_f32_16x16x32_bf16 v[60:63], v[52:55], v[20:23], v[60:63]
  v_mfma_f32_16x16x32_bf16 v[60:63], v[52:55], v[24:27], v[60:63]
  v_mfma_f32_16x16x32_bf16 v[60:63], v[52:55], v[28:31], v[60:63]
  s_waitcnt vmcnt(2)
  v_max3_u32 v15, v32, v36, v40
  v_cmp_eq_u32 vcc, -1, v15
  s_cbranch_vccnz L_pl_31
L_plb_32:
  v_mfma_f32_16x16x32_bf16 v[60:63], v[52:55], v[32:35], v[60:63]
  v_mfma_f32_16x16x32_bf16 v[60:63], v[52:55], v[36:39], v[60:63]
  v_mfma_f32_16x16x32_bf16 v[60:63], v[52:55], v[40:43], v[60:63]
  s_waitcnt vmcnt(0)
  v_max_u32 v15, v44, v48
  v_cmp_eq_u32 vcc, -1, v15
  s_cbranch_vccnz L_pl_34
L_plb_35:
  v_mfma_f32_16x16x32_bf16 v[64:67], v[56:59], v[44:47], 0
  v_mfma_f32_16x16x32_bf16 v[60:63], v[52:55], v[48:51], v[60:63]
  s_nop 4
  v_cvt_pk_bf16_f32 v64, v64, v65
  v_cvt_pk_bf16_f32 v65, v66, v67
  ds_write_b64 v71, v[64:65]
  v_cvt_pk_bf16_f32 v60, v60, v61
  v_cvt_pk_bf16_f32 v61, v62, v63
  ds_write_b64 v70, v[60:61]
  ds_write_b32 v5, v247 offset:320
  ds_read_b32 v7, v14 offset:320
  ds_read_b128 v[208:211], v72 offset:0
  ds_read_b128 v[212:215], v72 offset:1024
  ds_read_b128 v[216:219], v72 offset:2048
  ds_read_b128 v[220:223], v72 offset:3072
  s_lshr_b32 s46, s14, 1
  s_mul_i32 s47, s46, 33280
  s_add_u32 s47, s47, 73728
  s_xor_b32 s48, s47, 512
  v_add_u32 v10, s47, v0
  v_add_u32 v11, s48, v0
  s_waitcnt lgkmcnt(4)
  v_cmp_gt_u32 vcc, v247, v7
  s_cbranch_vccnz L_lsl_36
L_lbk_37:
  ds_read_b32 v7, v14 offset:2688
  s_waitcnt lgkmcnt(4)
  v_mfma_f32_32x32x16_bf16 v[144:159], v[208:211], v[176:179], 0
  s_waitcnt lgkmcnt(3)
  v_mfma_f32_32x32x16_bf16 v[144:159], v[212:215], v[180:183], v[144:159]
  s_waitcnt lgkmcnt(2)
  v_mfma_f32_32x32x16_bf16 v[160:175], v[216:219], v[192:195], 0
  s_waitcnt lgkmcnt(1)
  v_mfma_f32_32x32x16_bf16 v[160:175], v[220:223], v[196:199], v[160:175]
  s_lshl_b32 s47, s14, 12
  s_xor_b32 s48, s47, 8192
  s_add_u32 s47, s47, 143360
  s_add_u32 s48, s48, 143360
  v_add_u32 v12, s47, v1
  v_add_u32 v13, s48, v1
  s_waitcnt lgkmcnt(0)
  v_cmp_gt_u32 vcc, v247, v7
  s_cbranch_vccnz L_lsl_38
L_lbk_39:
  v_pk_add_f32 v[152:153], v[152:153], v[154:155]
  v_add_f32 v152, v152, v153
  v_add_f32 v152, 0x358637bd, v152
  v_rcp_f32 v152, v152
  s_nop 0
  v_pk_mul_f32 v[144:145], v[144:145], v[152:153] op_sel_hi:[1,0]
  v_pk_mul_f32 v[146:147], v[146:147], v[152:153] op_sel_hi:[1,0]
  v_pk_mul_f32 v[148:149], v[148:149], v[152:153] op_sel_hi:[1,0]
  v_pk_mul_f32 v[150:151], v[150:151], v[152:153] op_sel_hi:[1,0]
  v_cvt_pk_bf16_f32 v144, v144, v145
  v_cvt_pk_bf16_f32 v145, v146, v147
  v_cvt_pk_bf16_f32 v146, v148, v149
  v_cvt_pk_bf16_f32 v147, v150, v151
  buffer_store_dwordx4 v[144:147], v1, s[4:7], s22 offen offset:0
  v_pk_add_f32 v[168:169], v[168:169], v[170:171]
  v_add_f32 v168, v168, v169
  v_add_f32 v168, 0x358637bd, v168
  v_rcp_f32 v168, v168
  s_nop 0
  v_pk_mul_f32 v[160:161], v[160:161], v[168:169] op_sel_hi:[1,0]
  v_pk_mul_f32 v[162:163], v[162:163], v[168:169] op_sel_hi:[1,0]
  v_pk_mul_f32 v[164:165], v[164:165], v[168:169] op_sel_hi:[1,0]
  v_pk_mul_f32 v[166:167], v[166:167], v[168:169] op_sel_hi:[1,0]
  v_cvt_pk_bf16_f32 v160, v160, v161
  v_cvt_pk_bf16_f32 v161, v162, v163
  v_cvt_pk_bf16_f32 v162, v164, v165
  v_cvt_pk_bf16_f32 v163, v166, v167
  buffer_store_dwordx4 v[160:163], v1, s[4:7], s22 offen offset:1024
  ds_read_b32 v7, v14 offset:1408
  v_lshlrev_b32 v176, 16, v232
  v_and_b32 v177, s54, v232
  v_lshlrev_b32 v178, 16, v233
  v_and_b32 v179, s54, v233
  v_lshlrev_b32 v180, 16, v234
  v_and_b32 v181, s54, v234
  v_lshlrev_b32 v182, 16, v235
  v_and_b32 v183, s54, v235
  v_lshlrev_b32 v184, 16, v236
  v_and_b32 v185, s54, v236
  v_lshlrev_b32 v186, 16, v237
  v_and_b32 v187, s54, v237
  v_lshlrev_b32 v188, 16, v238
  v_and_b32 v189, s54, v238
  v_lshlrev_b32 v190, 16, v239
  v_and_b32 v191, s54, v239
  s_waitcnt lgkmcnt(0)
  v_cmp_gt_u32 vcc, v247, v7
  s_cbranch_vccnz L_lsl_40
L_lbk_41:
  ds_read_b64_tr_b16 v[208:209], v10 offset:0
  ds_read_b64_tr_b16 v[210:211], v10 offset:256
  ds_read_b64_tr_b16 v[212:213], v11 offset:0
  ds_read_b64_tr_b16 v[214:215], v11 offset:256
  ds_read_b64_tr_b16 v[216:217], v10 offset:2048
  ds_read_b64_tr_b16 v[218:219], v10 offset:2304
  ds_read_b64_tr_b16 v[220:221], v11 offset:2048
  ds_read_b64_tr_b16 v[222:223], v11 offset:2304
  ds_read_b64_tr_b16 v[224:225], v10 offset:4096
  ds_read_b64_tr_b16 v[226:227], v10 offset:4352
  buffer_load_dwordx4 v[16:19], v1, s[4:7], s23 offen offset:0 sc1
  buffer_load_dwordx4 v[20:23], v1, s[4:7], s23 offen offset:1024 sc1
  buffer_load_dwordx4 v[24:27], v1, s[4:7], s23 offen offset:2048 sc1
  buffer_load_dwordx4 v[28:31], v1, s[4:7], s23 offen offset:3072 sc1
  s_add_u32 s44, s23, 4096
  buffer_load_dwordx4 v[32:35], v1, s[4:7], s44 offen offset:0 sc1
  buffer_load_dwordx4 v[36:39], v1, s[4:7], s44 offen offset:1024 sc1
  buffer_load_dwordx4 v[40:43], v1, s[4:7], s44 offen offset:2048 sc1
  buffer_load_dwordx4 v[44:47], v1, s[4:7], s44 offen offset:3072 sc1
  s_waitcnt vmcnt(6)
  v_max_u32 v15, v16, v20
  v_cmp_eq_u32 vcc, -1, v15
  s_cbranch_vccnz L_pl_42
L_plb_43:
  s_waitcnt lgkmcnt(4)
  v_mfma_f32_32x32x16_bf16 v[176:191], v[208:211], v[16:19], v[176:191]
  s_add_u32 s32, s23, 8192
  buffer_load_dwordx4 v[48:51], v1, s[4:7], s32 offen offset:0 sc1
  ds_read_b64_tr_b16 v[228:229], v11 offset:4096
  ds_read_b64_tr_b16 v[230:231], v11 offset:4352
  v_mfma_f32_32x32x16_bf16 v[192:207], v[212:215], v[16:19], 0
  buffer_load_dwordx4 v[52:55], v1, s[4:7], s32 offen offset:1024 sc1
  ds_read_b64_tr_b16 v[208:209], v10 offset:6144
  ds_read_b64_tr_b16 v[210:211], v10 offset:6400
  s_waitcnt vmcnt(6)
  v_max_u32 v15, v24, v28
  v_mfma_f32_32x32x16_bf16 v[176:191], v[216:219], v[20:23], v[176:191]
  buffer_load_dwordx4 v[56:59], v1, s[4:7], s32 offen offset:2048 sc1
  ds_read_b64_tr_b16 v[212:213], v11 offset:6144
  ds_read_b64_tr_b16 v[214:215], v11 offset:6400
  v_cmp_eq_u32 vcc, -1, v15
  s_waitcnt lgkmcnt(4)
  v_mfma_f32_32x32x16_bf16 v[192:207], v[220:223], v[20:23], v[192:207]
  buffer_load_dwordx4 v[60:63], v1, s[4:7], s32 offen offset:3072 sc1
  ds_read_b64_tr_b16 v[216:217], v10 offset:8192
  ds_read_b64_tr_b16 v[218:219], v10 offset:8448
  s_cbranch_vccnz L_pl_46
L_plb_47:
  v_mfma_f32_32x32x16_bf16 v[176:191], v[224:227], v[24:27], v[176:191]
  s_add_u32 s32, s23, 12288
  buffer_load_dwordx4 v[64:67], v1, s[4:7], s32 offen offset:0 sc1
  ds_read_b64_tr_b16 v[220:221], v11 offset:8192
  ds_read_b64_tr_b16 v[222:223], v11 offset:8448
  v_mfma_f32_32x32x16_bf16 v[192:207], v[228:231], v[24:27], v[192:207]
  buffer_load_dwordx4 v[68:71], v1, s[4:7], s32 offen offset:1024 sc1
  ds_read_b64_tr_b16 v[224:225], v10 offset:10240
  ds_read_b64_tr_b16 v[226:227], v10 offset:10496
  s_waitcnt vmcnt(6)
  v_max3_u32 v15, v32, v36, v40
  v_max_u32 v15, v15, v44
  s_waitcnt lgkmcnt(4)
  v_mfma_f32_32x32x16_bf16 v[176:191], v[208:211], v[28:31], v[176:191]
  buffer_load_dwordx4 v[72:75], v1, s[4:7], s32 offen offset:2048 sc1
  ds_read_b64_tr_b16 v[228:229], v11 offset:10240
  ds_read_b64_tr_b16 v[230:231], v11 offset:10496
  v_cmp_eq_u32 vcc, -1, v15
  v_mfma_f32_32x32x16_bf16 v[192:207], v[212:215], v[28:31], v[192:207]
  buffer_load_dwordx4 v[76:79], v1, s[4:7], s32 offen offset:3072 sc1
  ds_read_b64_tr_b16 v[208:209], v10 offset:12288
  ds_read_b64_tr_b16 v[210:211], v10 offset:12544
  ds_write_b32 v5, v247 offset:2560
  s_cbranch_vccnz L_pl_50
L_plb_51:
  v_mfma_f32_32x32x16_bf16 v[176:191], v[216:219], v[32:35], v[176:191]
  ds_read_b64_tr_b16 v[212:213], v11 offset:12288
  ds_read_b64_tr_b16 v[214:215], v11 offset:12544
  s_waitcnt lgkmcnt(5)
  v_mfma_f32_32x32x16_bf16 v[192:207], v[220:223], v[32:35], v[192:207]
  ds_read_b64_tr_b16 v[216:217], v10 offset:14336
  ds_read_b64_tr_b16 v[218:219], v10 offset:14592
  v_mfma_f32_32x32x16_bf16 v[176:191], v[224:227], v[36:39], v[176:191]
  ds_read_b64_tr_b16 v[220:221], v11 offset:14336
  ds_read_b64_tr_b16 v[222:223], v11 offset:14592
  v_mfma_f32_32x32x16_bf16 v[192:207], v[228:231], v[36:39], v[192:207]
  ds_read_b64_tr_b16 v[224:225], v11 offset:16384
  ds_read_b64_tr_b16 v[226:227], v11 offset:16640
  s_waitcnt lgkmcnt(4)
  v_mfma_f32_32x32x16_bf16 v[176:191], v[208:211], v[40:43], v[176:191]
  ds_read_b64_tr_b16 v[228:229], v11 offset:18432
  ds_read_b64_tr_b16 v[230:231], v11 offset:18688
  v_mfma_f32_32x32x16_bf16 v[192:207], v[212:215], v[40:43], v[192:207]
  ds_read_b64_tr_b16 v[208:209], v11 offset:20480
  ds_read_b64_tr_b16 v[210:211], v11 offset:20736
  s_waitcnt vmcnt(4)
  v_max3_u32 v15, v48, v52, v56
  v_max_u32 v15, v15, v60
  v_mfma_f32_32x32x16_bf16 v[176:191], v[216:219], v[44:47], v[176:191]
  ds_read_b64_tr_b16 v[212:213], v11 offset:22528
  ds_read_b64_tr_b16 v[214:215], v11 offset:22784
  v_cmp_eq_u32 vcc, -1, v15
  s_waitcnt lgkmcnt(4)
  v_mfma_f32_32x32x16_bf16 v[192:207], v[220:223], v[44:47], v[192:207]
  ds_read_b64_tr_b16 v[216:217], v11 offset:24576
  ds_read_b64_tr_b16 v[218:219], v11 offset:24832
  s_cbranch_vccnz L_pl_54
L_plb_55:
  v_mfma_f32_32x32x16_bf16 v[192:207], v[224:227], v[48:51], v[192:207]
  ds_read_b64_tr_b16 v[220:221], v11 offset:26624
  ds_read_b64_tr_b16 v[222:223], v11 offset:26880
  v_mfma_f32_32x32x16_bf16 v[192:207], v[228:231], v[52:55], v[192:207]
  ds_read_b64_tr_b16 v[224:225], v11 offset:28672
  ds_read_b64_tr_b16 v[226:227], v11 offset:28928
  s_waitcnt vmcnt(0)
  v_max3_u32 v15, v64, v68, v72
  v_max_u32 v15, v15, v76
  s_waitcnt lgkmcnt(4)
  v_mfma_f32_32x32x16_bf16 v[192:207], v[208:211], v[56:59], v[192:207]
  ds_read_b64_tr_b16 v[228:229], v11 offset:30720
  ds_read_b64_tr_b16 v[230:231], v11 offset:30976
  v_cmp_eq_u32 vcc, -1, v15
  v_mfma_f32_32x32x16_bf16 v[192:207], v[212:215], v[60:63], v[192:207]
  ds_read_b64_tr_b16 v[208:209], v10 offset:16384
  ds_read_b64_tr_b16 v[210:211], v10 offset:16640
  s_cbranch_vccnz L_pl_57
L_plb_58:
  v_mfma_f32_32x32x16_bf16 v[192:207], v[216:219], v[64:67], v[192:207]
  ds_read_b64_tr_b16 v[212:213], v10 offset:18432
  ds_read_b64_tr_b16 v[214:215], v10 offset:18688
  s_waitcnt lgkmcnt(4)
  v_mfma_f32_32x32x16_bf16 v[192:207], v[220:223], v[68:71], v[192:207]
  ds_read_b64_tr_b16 v[216:217], v10 offset:20480
  ds_read_b64_tr_b16 v[218:219], v10 offset:20736
  v_mfma_f32_32x32x16_bf16 v[192:207], v[224:227], v[72:75], v[192:207]
  ds_read_b64_tr_b16 v[220:221], v10 offset:22528
  ds_read_b64_tr_b16 v[222:223], v10 offset:22784
  v_mfma_f32_32x32x16_bf16 v[192:207], v[228:231], v[76:79], v[192:207]
  ds_read_b64_tr_b16 v[224:225], v10 offset:24576
  ds_read_b64_tr_b16 v[226:227], v10 offset:24832
  s_waitcnt lgkmcnt(4)
  v_mfma_f32_32x32x16_bf16 v[176:191], v[208:211], v[48:51], v[176:191]
  ds_read_b64_tr_b16 v[228:229], v10 offset:26624
  ds_read_b64_tr_b16 v[230:231], v10 offset:26880
  v_mfma_f32_32x32x16_bf16 v[176:191], v[212:215], v[52:55], v[176:191]
  ds_read_b64_tr_b16 v[208:209], v10 offset:28672
  ds_read_b64_tr_b16 v[210:211], v10 offset:28928
  ds_write_b128 v12, v[192:195] offset:0
  ds_write_b128 v12, v[196:199] offset:1024
  ds_write_b128 v12, v[200:203] offset:2048
  ds_write_b128 v12, v[204:207] offset:3072
  ds_write_b32 v5, v247 offset:384
  v_mfma_f32_32x32x16_bf16 v[176:191], v[216:219], v[56:59], v[176:191]
  ds_read_b64_tr_b16 v[212:213], v10 offset:30720
  ds_read_b64_tr_b16 v[214:215], v10 offset:30976
  s_waitcnt lgkmcnt(9)
  v_mfma_f32_32x32x16_bf16 v[176:191], v[220:223], v[60:63], v[176:191]
  v_mfma_f32_32x32x16_bf16 v[176:191], v[224:227], v[64:67], v[176:191]
  v_mfma_f32_32x32x16_bf16 v[176:191], v[228:231], v[68:71], v[176:191]
  ds_read_b32 v7, v14 offset:384
  ds_read_b128 v[144:147], v13 offset:0
  ds_read_b128 v[148:151], v13 offset:1024
  ds_read_b128 v[152:155], v13 offset:2048
  ds_read_b128 v[156:159], v13 offset:3072
  s_waitcnt lgkmcnt(5)
  v_mfma_f32_32x32x16_bf16 v[176:191], v[208:211], v[72:75], v[176:191]
  v_mfma_f32_32x32x16_bf16 v[176:191], v[212:215], v[76:79], v[176:191]
  s_waitcnt lgkmcnt(4)
  v_cmp_gt_u32 vcc, v247, v7
  s_nop 0
  s_and_b64 vcc, vcc, s[36:37]
  s_cbranch_scc1 L_lsl_59
L_lbk_60:
  s_waitcnt lgkmcnt(0)
  ds_write_b32 v5, v247 offset:448
  s_nop 4
  v_pk_add_f32 v[176:177], v[176:177], v[144:145]
  v_pk_add_f32 v[178:179], v[178:179], v[146:147]
  v_cvt_pk_bf16_f32 v232, v176, v177
  v_cvt_pk_bf16_f32 v233, v178, v179
  v_pk_add_f32 v[180:181], v[180:181], v[148:149]
  v_pk_add_f32 v[182:183], v[182:183], v[150:151]
  v_cvt_pk_bf16_f32 v234, v180, v181
  v_cvt_pk_bf16_f32 v235, v182, v183
  v_pk_add_f32 v[184:185], v[184:185], v[152:153]
  v_pk_add_f32 v[186:187], v[186:187], v[154:155]
  v_cvt_pk_bf16_f32 v236, v184, v185
  v_cvt_pk_bf16_f32 v237, v186, v187
  v_pk_add_f32 v[188:189], v[188:189], v[156:157]
  v_pk_add_f32 v[190:191], v[190:191], v[158:159]
  v_cvt_pk_bf16_f32 v238, v188, v189
  v_cvt_pk_bf16_f32 v239, v190, v191
  buffer_store_dwordx4 v[232:235], v1, s[4:7], s24 offen
  buffer_store_dwordx4 v[236:239], v1, s[4:7], s24 offen offset:1024
  buffer_load_dwordx4 v[16:19], v1, s[4:7], s26 offen offset:0 sc1
  buffer_load_dwordx4 v[20:23], v1, s[4:7], s26 offen offset:1024 sc1
  v_mov_b32 v248, 0
  v_mov_b32 v249, 0
  v_mov_b32 v250, 0
  v_mov_b32 v251, 0
  v_dot2c_f32_bf16 v248, s51, v232
  v_dot2c_f32_bf16 v249, v232, v232
  v_dot2c_f32_bf16 v250, s51, v233
  v_dot2c_f32_bf16 v251, v233, v233
  v_dot2c_f32_bf16 v248, s51, v234
  v_dot2c_f32_bf16 v249, v234, v234
  v_dot2c_f32_bf16 v250, s51, v235
  v_dot2c_f32_bf16 v251, v235, v235
  v_dot2c_f32_bf16 v248, s51, v236
  v_dot2c_f32_bf16 v249, v236, v236
  v_dot2c_f32_bf16 v250, s51, v237
  v_dot2c_f32_bf16 v251, v237, v237
  v_dot2c_f32_bf16 v248, s51, v238
  v_dot2c_f32_bf16 v249, v238, v238
  v_dot2c_f32_bf16 v250, s51, v239
  v_dot2c_f32_bf16 v251, v239, v239
  s_nop 2
  v_pk_add_f32 v[248:249], v[248:249], v[250:251]
  v_mov_b32 v250, v248
  v_mov_b32 v251, v249
  s_nop 0
  v_permlane32_swap_b32 v250, v248
  v_permlane32_swap_b32 v251, v249
  v_pk_add_f32 v[248:249], v[248:249], v[250:251]
  s_mov_b32 exec_hi, 0
  buffer_store_dwordx2 v[248:249], v4, s[4:7], s25 offen
  s_mov_b32 exec_hi, -1
  buffer_load_dwordx4 v[24:27], v1, s[4:7], s26 offen offset:2048 sc1
  buffer_load_dwordx4 v[28:31], v1, s[4:7], s26 offen offset:3072 sc1
  s_add_u32 s44, s26, 4096
  buffer_load_dwordx4 v[32:35], v1, s[4:7], s44 offen offset:0 sc1
  buffer_load_dwordx4 v[36:39], v1, s[4:7], s44 offen offset:1024 sc1
  buffer_load_dwordx4 v[40:43], v1, s[4:7], s44 offen offset:2048 sc1
  buffer_load_dwordx4 v[44:47], v1, s[4:7], s44 offen offset:3072 sc1
  s_add_u32 s45, s26, 8192
  buffer_load_dwordx4 v[48:51], v1, s[4:7], s45 offen offset:0 sc1
  buffer_load_dwordx4 v[52:55], v1, s[4:7], s45 offen offset:1024 sc1
  ds_read_b64_tr_b16 v[208:209], v2 offset:0
  ds_read_b64_tr_b16 v[210:211], v2 offset:256
  ds_read_b64_tr_b16 v[212:213], v2 offset:32768
  ds_read_b64_tr_b16 v[214:215], v2 offset:33024
  ds_read_b64_tr_b16 v[216:217], v2 offset:512
  ds_read_b64_tr_b16 v[218:219], v2 offset:768
  ds_read_b64_tr_b16 v[220:221], v2 offset:33280
  ds_read_b64_tr_b16 v[222:223], v2 offset:33536
  ds_read_b64_tr_b16 v[224:225], v2 offset:2048
  ds_read_b64_tr_b16 v[226:227], v2 offset:2304
  s_waitcnt vmcnt(9)
  v_max_u32 v15, v16, v20
  v_cmp_eq_u32 vcc, -1, v15
  s_cbranch_vccnz L_pl_61
L_plb_62:
  s_waitcnt lgkmcnt(4)
  v_mfma_f32_32x32x16_bf16 v[144:159], v[208:211], v[16:19], 0
  s_add_u32 s32, s26, 8192
  buffer_load_dwordx4 v[56:59], v1, s[4:7], s32 offen offset:2048 sc1
  ds_read_b64_tr_b16 v[228:229], v2 offset:34816
  ds_read_b64_tr_b16 v[230:231], v2 offset:35072
  v_mfma_f32_32x32x16_bf16 v[160:175], v[212:215], v[16:19], 0
  buffer_load_dwordx4 v[60:63], v1, s[4:7], s32 offen offset:3072 sc1
  ds_read_b64_tr_b16 v[208:209], v2 offset:2560
  ds_read_b64_tr_b16 v[210:211], v2 offset:2816
  s_waitcnt vmcnt(8)
  v_max_u32 v15, v24, v28
  v_mfma_f32_32x32x16_bf16 v[144:159], v[216:219], v[20:23], v[144:159]
  s_add_u32 s32, s26, 12288
  buffer_load_dwordx4 v[64:67], v1, s[4:7], s32 offen offset:0 sc1
  ds_read_b64_tr_b16 v[212:213], v2 offset:35328
  ds_read_b64_tr_b16 v[214:215], v2 offset:35584
  v_cmp_eq_u32 vcc, -1, v15
  s_waitcnt lgkmcnt(4)
  v_mfma_f32_32x32x16_bf16 v[160:175], v[220:223], v[20:23], v[160:175]
  buffer_load_dwordx4 v[68:71], v1, s[4:7], s32 offen offset:1024 sc1
  ds_read_b64_tr_b16 v[216:217], v2 offset:4096
  ds_read_b64_tr_b16 v[218:219], v2 offset:4352
  s_cbranch_vccnz L_pl_66
L_plb_67:
  v_mfma_f32_32x32x16_bf16 v[144:159], v[224:227], v[24:27], v[144:159]
  buffer_load_dwordx4 v[72:75], v1, s[4:7], s32 offen offset:2048 sc1
  ds_read_b64_tr_b16 v[220:221], v2 offset:36864
  ds_read_b64_tr_b16 v[222:223], v2 offset:37120
  v_mfma_f32_32x32x16_bf16 v[160:175], v[228:231], v[24:27], v[160:175]
  ds_read_b64_tr_b16 v[224:225], v2 offset:4608
  ds_read_b64_tr_b16 v[226:227], v2 offset:4864
  s_waitcnt vmcnt(7)
  v_max3_u32 v15, v32, v36, v40
  v_max_u32 v15, v15, v44
  s_waitcnt lgkmcnt(4)
  v_mfma_f32_32x32x16_bf16 v[144:159], v[208:211], v[28:31], v[144:159]
  buffer_load_dwordx4 v[76:79], v1, s[4:7], s32 offen offset:3072 sc1
  ds_read_b64_tr_b16 v[228:229], v2 offset:37376
  ds_read_b64_tr_b16 v[230:231], v2 offset:37632
  v_cmp_eq_u32 vcc, -1, v15
  v_mfma_f32_32x32x16_bf16 v[160:175], v[212:215], v[28:31], v[160:175]
  ds_read_b64_tr_b16 v[208:209], v2 offset:6144
  ds_read_b64_tr_b16 v[210:211], v2 offset:6400
  s_cbranch_vccnz L_pl_71
L_plb_72:
  v_mfma_f32_32x32x16_bf16 v[144:159], v[216:219], v[32:35], v[144:159]
  buffer_load_dwordx2 v[192:193], v4, s[4:7], s27 offen offset:0 sc1
  s_add_u32 s32, s26, 16384
  buffer_load_dwordx4 v[80:83], v1, s[4:7], s32 offen offset:0 sc1
  ds_read_b64_tr_b16 v[212:213], v2 offset:38912
  ds_read_b64_tr_b16 v[214:215], v2 offset:39168
  s_waitcnt lgkmcnt(4)
  v_mfma_f32_32x32x16_bf16 v[160:175], v[220:223], v[32:35], v[160:175]
  ds_read_b64_tr_b16 v[216:217], v2 offset:6656
  ds_read_b64_tr_b16 v[218:219], v2 offset:6912
  v_mfma_f32_32x32x16_bf16 v[144:159], v[224:227], v[36:39], v[144:159]
  buffer_load_dwordx2 v[194:195], v4, s[4:7], s27 offen offset:512 sc1
  buffer_load_dwordx4 v[84:87], v1, s[4:7], s32 offen offset:1024 sc1
  ds_read_b64_tr_b16 v[220:221], v2 offset:39424
  ds_read_b64_tr_b16 v[222:223], v2 offset:39680
  v_mfma_f32_32x32x16_bf16 v[160:175], v[228:231], v[36:39], v[160:175]
  ds_read_b64_tr_b16 v[224:225], v2 offset:8192
  ds_read_b64_tr_b16 v[226:227], v2 offset:8448
  s_waitcnt lgkmcnt(4)
  v_mfma_f32_32x32x16_bf16 v[144:159], v[208:211], v[40:43], v[144:159]
  buffer_load_dwordx2 v[196:197], v4, s[4:7], s27 offen offset:1024 sc1
  buffer_load_dwordx4 v[88:91], v1, s[4:7], s32 offen offset:2048 sc1
  ds_read_b64_tr_b16 v[228:229], v2 offset:40960
  ds_read_b64_tr_b16 v[230:231], v2 offset:41216
  v_mfma_f32_32x32x16_bf16 v[160:175], v[212:215], v[40:43], v[160:175]
  ds_read_b64_tr_b16 v[208:209], v2 offset:8704
  ds_read_b64_tr_b16 v[210:211], v2 offset:8960
  s_waitcnt vmcnt(10)
  v_max3_u32 v15, v48, v52, v56
  v_max_u32 v15, v15, v60
  v_mfma_f32_32x32x16_bf16 v[144:159], v[216:219], v[44:47], v[144:159]
  buffer_load_dwordx2 v[198:199], v4, s[4:7], s27 offen offset:1536 sc1
  buffer_load_dwordx4 v[92:95], v1, s[4:7], s32 offen offset:3072 sc1
  ds_read_b64_tr_b16 v[212:213], v2 offset:41472
  ds_read_b64_tr_b16 v[214:215], v2 offset:41728
  v_cmp_eq_u32 vcc, -1, v15
  s_waitcnt lgkmcnt(4)
  v_mfma_f32_32x32x16_bf16 v[160:175], v[220:223], v[44:47], v[160:175]
  ds_read_b64_tr_b16 v[216:217], v2 offset:10240
  ds_read_b64_tr_b16 v[218:219], v2 offset:10496
  s_cbranch_vccnz L_pl_75
L_plb_76:
  v_mfma_f32_32x32x16_bf16 v[144:159], v[224:227], v[48:51], v[144:159]
  buffer_load_dwordx2 v[200:201], v4, s[4:7], s27 offen offset:2048 sc1
  s_add_u32 s32, s26, 20480
  buffer_load_dwordx4 v[96:99], v1, s[4:7], s32 offen offset:0 sc1
  ds_read_b64_tr_b16 v[220:221], v2 offset:43008
  ds_read_b64_tr_b16 v[222:223], v2 offset:43264
  v_mfma_f32_32x32x16_bf16 v[160:175], v[228:231], v[48:51], v[160:175]
  ds_read_b64_tr_b16 v[224:225], v2 offset:10752
  ds_read_b64_tr_b16 v[226:227], v2 offset:11008
  s_waitcnt lgkmcnt(4)
  v_mfma_f32_32x32x16_bf16 v[144:159], v[208:211], v[52:55], v[144:159]
  buffer_load_dwordx2 v[202:203], v4, s[4:7], s27 offen offset:2560 sc1
  buffer_load_dwordx4 v[100:103], v1, s[4:7], s32 offen offset:1024 sc1
  ds_read_b64_tr_b16 v[228:229], v2 offset:43520
  ds_read_b64_tr_b16 v[230:231], v2 offset:43776
  v_mfma_f32_32x32x16_bf16 v[160:175], v[212:215], v[52:55], v[160:175]
  ds_read_b64_tr_b16 v[208:209], v2 offset:12288
  ds_read_b64_tr_b16 v[210:211], v2 offset:12544
  v_mfma_f32_32x32x16_bf16 v[144:159], v[216:219], v[56:59], v[144:159]
  buffer_load_dwordx2 v[204:205], v4, s[4:7], s27 offen offset:3072 sc1
  buffer_load_dwordx4 v[104:107], v1, s[4:7], s32 offen offset:2048 sc1
  ds_read_b64_tr_b16 v[212:213], v2 offset:45056
  ds_read_b64_tr_b16 v[214:215], v2 offset:45312
  s_waitcnt lgkmcnt(4)
  v_mfma_f32_32x32x16_bf16 v[160:175], v[220:223], v[56:59], v[160:175]
  ds_read_b64_tr_b16 v[216:217], v2 offset:12800
  ds_read_b64_tr_b16 v[218:219], v2 offset:13056
  s_waitcnt vmcnt(14)
  v_max3_u32 v15, v64, v68, v72
  v_max_u32 v15, v15, v76
  v_mfma_f32_32x32x16_bf16 v[144:159], v[224:227], v[60:63], v[144:159]
  buffer_load_dwordx2 v[206:207], v4, s[4:7], s27 offen offset:3584 sc1
  buffer_load_dwordx4 v[108:111], v1, s[4:7], s32 offen offset:3072 sc1
  ds_read_b64_tr_b16 v[220:221], v2 offset:45568
  ds_read_b64_tr_b16 v[222:223], v2 offset:45824
  v_cmp_eq_u32 vcc, -1, v15
  v_mfma_f32_32x32x16_bf16 v[160:175], v[228:231], v[60:63], v[160:175]
  ds_read_b64_tr_b16 v[224:225], v2 offset:14336
  ds_read_b64_tr_b16 v[226:227], v2 offset:14592
  s_cbranch_vccnz L_pl_80
L_plb_81:
  s_waitcnt lgkmcnt(4)
  v_mfma_f32_32x32x16_bf16 v[144:159], v[208:211], v[64:67], v[144:159]
  s_add_u32 s32, s26, 24576
  buffer_load_dwordx4 v[112:115], v1, s[4:7], s32 offen offset:0 sc1
  ds_read_b64_tr_b16 v[228:229], v2 offset:47104
  ds_read_b64_tr_b16 v[230:231], v2 offset:47360
  v_mfma_f32_32x32x16_bf16 v[160:175], v[212:215], v[64:67], v[160:175]
  ds_read_b64_tr_b16 v[208:209], v2 offset:14848
  ds_read_b64_tr_b16 v[210:211], v2 offset:15104
  v_mfma_f32_32x32x16_bf16 v[144:159], v[216:219], v[68:71], v[144:159]
  buffer_load_dwordx4 v[116:119], v1, s[4:7], s32 offen offset:1024 sc1
  ds_read_b64_tr_b16 v[212:213], v2 offset:47616
  ds_read_b64_tr_b16 v[214:215], v2 offset:47872
  s_waitcnt lgkmcnt(4)
  v_mfma_f32_32x32x16_bf16 v[160:175], v[220:223], v[68:71], v[160:175]
  ds_read_b64_tr_b16 v[216:217], v2 offset:16384
  ds_read_b64_tr_b16 v[218:219], v2 offset:16640
  v_mfma_f32_32x32x16_bf16 v[144:159], v[224:227], v[72:75], v[144:159]
  buffer_load_dwordx4 v[120:123], v1, s[4:7], s32 offen offset:2048 sc1
  ds_read_b64_tr_b16 v[220:221], v2 offset:49152
  ds_read_b64_tr_b16 v[222:223], v2 offset:49408
  v_mfma_f32_32x32x16_bf16 v[160:175], v[228:231], v[72:75], v[160:175]
  ds_read_b64_tr_b16 v[224:225], v2 offset:16896
  ds_read_b64_tr_b16 v[226:227], v2 offset:17152
  s_waitcnt vmcnt(11)
  v_max3_u32 v15, v80, v84, v88
  v_max_u32 v15, v15, v92
  s_waitcnt lgkmcnt(4)
  v_mfma_f32_32x32x16_bf16 v[144:159], v[208:211], v[76:79], v[144:159]
  buffer_load_dwordx4 v[124:127], v1, s[4:7], s32 offen offset:3072 sc1
  ds_read_b64_tr_b16 v[228:229], v2 offset:49664
  ds_read_b64_tr_b16 v[230:231], v2 offset:49920
  v_cmp_eq_u32 vcc, -1, v15
  v_mfma_f32_32x32x16_bf16 v[160:175], v[212:215], v[76:79], v[160:175]
  ds_read_b64_tr_b16 v[208:209], v2 offset:18432
  ds_read_b64_tr_b16 v[210:211], v2 offset:18688
  s_cbranch_vccnz L_pl_85
L_plb_86:
  v_mfma_f32_32x32x16_bf16 v[144:159], v[216:219], v[80:83], v[144:159]
  s_add_u32 s32, s26, 28672
  buffer_load_dwordx4 v[128:131], v1, s[4:7], s32 offen offset:0 sc1
  ds_read_b64_tr_b16 v[212:213], v2 offset:51200
  ds_read_b64_tr_b16 v[214:215], v2 offset:51456
  s_waitcnt lgkmcnt(4)
  v_mfma_f32_32x32x16_bf16 v[160:175], v[220:223], v[80:83], v[160:175]
  ds_read_b64_tr_b16 v[216:217], v2 offset:18944
  ds_read_b64_tr_b16 v[218:219], v2 offset:19200
  v_mfma_f32_32x32x16_bf16 v[144:159], v[224:227], v[84:87], v[144:159]
  buffer_load_dwordx4 v[132:135], v1, s[4:7], s32 offen offset:1024 sc1
  ds_read_b64_tr_b16 v[220:221], v2 offset:51712
  ds_read_b64_tr_b16 v[222:223], v2 offset:51968
  v_mfma_f32_32x32x16_bf16 v[160:175], v[228:231], v[84:87], v[160:175]
  ds_read_b64_tr_b16 v[224:225], v2 offset:20480
  ds_read_b64_tr_b16 v[226:227], v2 offset:20736
  s_waitcnt lgkmcnt(4)
  v_mfma_f32_32x32x16_bf16 v[144:159], v[208:211], v[88:91], v[144:159]
  buffer_load_dwordx4 v[136:139], v1, s[4:7], s32 offen offset:2048 sc1
  ds_read_b64_tr_b16 v[228:229], v2 offset:53248
  ds_read_b64_tr_b16 v[230:231], v2 offset:53504
  v_mfma_f32_32x32x16_bf16 v[160:175], v[212:215], v[88:91], v[160:175]
  ds_read_b64_tr_b16 v[208:209], v2 offset:20992
  ds_read_b64_tr_b16 v[210:211], v2 offset:21248
  s_waitcnt vmcnt(7)
  v_max3_u32 v15, v96, v100, v104
  v_max_u32 v15, v15, v108
  v_mfma_f32_32x32x16_bf16 v[144:159], v[216:219], v[92:95], v[144:159]
  buffer_load_dwordx4 v[140:143], v1, s[4:7], s32 offen offset:3072 sc1
  ds_read_b64_tr_b16 v[212:213], v2 offset:53760
  ds_read_b64_tr_b16 v[214:215], v2 offset:54016
  v_cmp_eq_u32 vcc, -1, v15
  s_waitcnt lgkmcnt(4)
  v_mfma_f32_32x32x16_bf16 v[160:175], v[220:223], v[92:95], v[160:175]
  ds_read_b64_tr_b16 v[216:217], v2 offset:22528
  ds_read_b64_tr_b16 v[218:219], v2 offset:22784
  s_cbranch_vccnz L_pl_90
L_plb_91:
  v_max3_u32 v15, v192, v194, v196
  v_max3_u32 v15, v15, v198, v200
  v_mfma_f32_32x32x16_bf16 v[144:159], v[224:227], v[96:99], v[144:159]
  ds_read_b64_tr_b16 v[220:221], v2 offset:55296
  ds_read_b64_tr_b16 v[222:223], v2 offset:55552
  v_max3_u32 v15, v15, v202, v204
  v_max_u32 v15, v15, v206
  v_mfma_f32_32x32x16_bf16 v[160:175], v[228:231], v[96:99], v[160:175]
  ds_read_b64_tr_b16 v[224:225], v2 offset:23040
  ds_read_b64_tr_b16 v[226:227], v2 offset:23296
  v_cmp_eq_u32 vcc, -1, v15
  s_waitcnt lgkmcnt(4)
  v_mfma_f32_32x32x16_bf16 v[144:159], v[208:211], v[100:103], v[144:159]
  ds_read_b64_tr_b16 v[228:229], v2 offset:55808
  ds_read_b64_tr_b16 v[230:231], v2 offset:56064
  s_cbranch_vccnz L_pl_96
L_plb_97:
  v_mfma_f32_32x32x16_bf16 v[160:175], v[212:215], v[100:103], v[160:175]
  ds_read_b64_tr_b16 v[208:209], v2 offset:24576
  ds_read_b64_tr_b16 v[210:211], v2 offset:24832
  v_add_f32 v192, v192, v194
  v_add_f32 v193, v193, v195
  v_mfma_f32_32x32x16_bf16 v[144:159], v[216:219], v[104:107], v[144:159]
  ds_read_b64_tr_b16 v[212:213], v2 offset:57344
  ds_read_b64_tr_b16 v[214:215], v2 offset:57600
  v_add_f32 v192, v192, v196
  v_add_f32 v193, v193, v197
  s_waitcnt lgkmcnt(4)
  v_mfma_f32_32x32x16_bf16 v[160:175], v[220:223], v[104:107], v[160:175]
  ds_read_b64_tr_b16 v[216:217], v2 offset:25088
  ds_read_b64_tr_b16 v[218:219], v2 offset:25344
  v_add_f32 v192, v192, v198
  v_add_f32 v193, v193, v199
  s_waitcnt vmcnt(4)
  v_max3_u32 v15, v112, v116, v120
  v_max_u32 v15, v15, v124
  ds_write_b32 v5, v247 offset:2304
  v_mfma_f32_32x32x16_bf16 v[144:159], v[224:227], v[108:111], v[144:159]
  ds_read_b64_tr_b16 v[220:221], v2 offset:57856
  ds_read_b64_tr_b16 v[222:223], v2 offset:58112
  v_add_f32 v192, v192, v200
  v_add_f32 v193, v193, v201
  v_cmp_eq_u32 vcc, -1, v15
  v_mfma_f32_32x32x16_bf16 v[160:175], v[228:231], v[108:111], v[160:175]
  ds_read_b64_tr_b16 v[224:225], v2 offset:26624
  ds_read_b64_tr_b16 v[226:227], v2 offset:26880
  v_add_f32 v192, v192, v202
  v_add_f32 v193, v193, v203
  s_cbranch_vccnz L_pl_101
L_plb_102:
  s_waitcnt lgkmcnt(5)
  v_mfma_f32_32x32x16_bf16 v[144:159], v[208:211], v[112:115], v[144:159]
  ds_read_b64_tr_b16 v[228:229], v2 offset:59392
  ds_read_b64_tr_b16 v[230:231], v2 offset:59648
  v_add_f32 v192, v192, v204
  v_add_f32 v193, v193, v205
  v_mfma_f32_32x32x16_bf16 v[160:175], v[212:215], v[112:115], v[160:175]
  ds_read_b64_tr_b16 v[208:209], v2 offset:27136
  ds_read_b64_tr_b16 v[210:211], v2 offset:27392
  v_add_f32 v192, v192, v206
  v_add_f32 v193, v193, v207
  v_mfma_f32_32x32x16_bf16 v[144:159], v[216:219], v[116:119], v[144:159]
  ds_read_b64_tr_b16 v[212:213], v2 offset:59904
  ds_read_b64_tr_b16 v[214:215], v2 offset:60160
  v_mov_b32 v194, v192
  v_mov_b32 v195, v193
  s_waitcnt lgkmcnt(4)
  v_mfma_f32_32x32x16_bf16 v[160:175], v[220:223], v[116:119], v[160:175]
  ds_read_b64_tr_b16 v[216:217], v2 offset:28672
  ds_read_b64_tr_b16 v[218:219], v2 offset:28928
  v_permlane32_swap_b32 v194, v192
  v_permlane32_swap_b32 v195, v193
  ds_read_b32 v7, v14 offset:1472
  v_mfma_f32_32x32x16_bf16 v[144:159], v[224:227], v[120:123], v[144:159]
  ds_read_b64_tr_b16 v[220:221], v2 offset:61440
  ds_read_b64_tr_b16 v[222:223], v2 offset:61696
  v_add_f32 v192, v192, v194
  v_add_f32 v193, v193, v195
  v_mfma_f32_32x32x16_bf16 v[160:175], v[228:231], v[120:123], v[160:175]
  ds_read_b64_tr_b16 v[224:225], v2 offset:29184
  ds_read_b64_tr_b16 v[226:227], v2 offset:29440
  v_mul_f32 v192, 0xbb000000, v192
  v_mul_f32 v193, 0x3b000000, v193
  s_waitcnt vmcnt(2)
  v_max_u32 v15, v128, v132
  s_waitcnt lgkmcnt(5)
  v_mfma_f32_32x32x16_bf16 v[144:159], v[208:211], v[124:127], v[144:159]
  ds_read_b64_tr_b16 v[228:229], v2 offset:61952
  ds_read_b64_tr_b16 v[230:231], v2 offset:62208
  v_fma_f32 v193, -v192, v192, v193
  v_cvt_pk_bf16_f32 v240, v192, v192
  v_cmp_eq_u32 vcc, -1, v15
  v_mfma_f32_32x32x16_bf16 v[160:175], v[212:215], v[124:127], v[160:175]
  ds_read_b64_tr_b16 v[208:209], v2 offset:30720
  ds_read_b64_tr_b16 v[210:211], v2 offset:30976
  v_max_f32 v193, 0, v193
  v_add_f32 v193, 0x3727c5ac, v193
  s_cbranch_vccnz L_pl_105
L_plb_106:
  v_mfma_f32_32x32x16_bf16 v[144:159], v[216:219], v[128:131], v[144:159]
  ds_read_b64_tr_b16 v[212:213], v2 offset:63488
  ds_read_b64_tr_b16 v[214:215], v2 offset:63744
  v_and_b32 v194, s54, v240
  v_rsq_f32 v195, v193
  s_waitcnt lgkmcnt(4)
  v_mfma_f32_32x32x16_bf16 v[160:175], v[220:223], v[128:131], v[160:175]
  ds_read_b64_tr_b16 v[216:217], v2 offset:31232
  ds_read_b64_tr_b16 v[218:219], v2 offset:31488
  v_sub_f32 v194, v192, v194
  v_cvt_pk_bf16_f32 v241, v194, v194
  s_waitcnt vmcnt(0)
  v_max_u32 v15, v136, v140
  v_mfma_f32_32x32x16_bf16 v[144:159], v[224:227], v[132:135], v[144:159]
  ds_read_b64_tr_b16 v[220:221], v2 offset:64000
  ds_read_b64_tr_b16 v[222:223], v2 offset:64256
  v_cndmask_b32 v240, v240, v241, s[42:43]
  v_mov_b32 v241, v240
  v_cmp_eq_u32 s[30:31], -1, v15
  v_cmp_gt_u32 vcc, v247, v7
  s_cbranch_vccnz L_lsl_108
L_lbk_109:
  ds_read_b64 v[224:225], v9 offset:3072
  v_mfma_f32_32x32x16_bf16 v[160:175], v[228:231], v[132:135], v[160:175]
  v_mul_f32 v244, 0xc0135761, v195
  v_mul_f32 v194, v195, v195
  s_cmp_lg_u64 s[30:31], 0
  s_cbranch_scc1 L_pl_110
L_plb_111:
  ds_read_b64 v[228:229], v9 offset:3328
  s_waitcnt lgkmcnt(4)
  v_mfma_f32_32x32x16_bf16 v[144:159], v[208:211], v[136:139], v[144:159]
  v_mul_f32 v194, 0x3d372713, v194
  v_mul_f32 v245, v244, v194
  v_mfma_f32_32x32x16_bf16 v[160:175], v[212:215], v[136:139], v[160:175]
  ds_read_b128 v[208:211], v3 offset:0
  v_mov_b32 v246, v193
  v_mfma_f32_32x32x16_bf16 v[144:159], v[216:219], v[140:143], v[144:159]
  ds_read_b128 v[212:215], v3 offset:32768
  s_waitcnt lgkmcnt(2)
  v_mfma_f32_32x32x16_bf16 v[160:175], v[220:223], v[140:143], v[160:175]
  ds_read_b128 v[216:219], v3 offset:1024
  v_mfma_f32_32x32x16_bf16 v[144:159], v[224:227], v[240:243], v[144:159]
  ds_read_b128 v[220:223], v3 offset:33792
  v_mfma_f32_32x32x16_bf16 v[160:175], v[228:231], v[240:243], v[160:175]
  ds_read_b128 v[224:227], v3 offset:2048
  s_waitcnt lgkmcnt(2)
  v_mfma_f32_32x32x16_bf16 v[176:191], v[208:211], v[16:19], 0
  ds_read_b128 v[228:231], v3 offset:34816
  ds_write_b32 v5, v247 offset:512
  v_mfma_f32_32x32x16_bf16 v[192:207], v[212:215], v[16:19], 0
  ds_read_b128 v[208:211], v3 offset:3072
  v_mul_f32 v248, v144, v144
  v_mul_f32 v249, v145, v145
  v_fma_f32 v248, v248, v245, v244
  v_mfma_f32_32x32x16_bf16 v[176:191], v[216:219], v[20:23], v[176:191]
  ds_read_b128 v[212:215], v3 offset:35840
  v_fma_f32 v249, v249, v245, v244
  v_mul_f32 v248, v248, v144
  v_mul_f32 v249, v249, v145
  s_waitcnt lgkmcnt(3)
  v_mfma_f32_32x32x16_bf16 v[192:207], v[220:223], v[20:23], v[192:207]
  ds_read_b128 v[216:219], v3 offset:4096
  v_exp_f32 v248, v248
  v_exp_f32 v249, v249
  v_mfma_f32_32x32x16_bf16 v[176:191], v[224:227], v[24:27], v[176:191]
  ds_read_b128 v[220:223], v3 offset:36864
  v_mul_f32 v160, v160, v144
  v_mul_f32 v161, v161, v145
  v_fma_f32 v248, v248, v246, v246
  v_mfma_f32_32x32x16_bf16 v[192:207], v[228:231], v[24:27], v[192:207]
  ds_read_b128 v[224:227], v3 offset:5120
  v_fma_f32 v249, v249, v246, v246
  v_rcp_f32 v248, v248
  s_waitcnt lgkmcnt(2)
  v_mfma_f32_32x32x16_bf16 v[176:191], v[208:211], v[28:31], v[176:191]
  ds_read_b128 v[228:231], v3 offset:37888
  v_rcp_f32 v249, v249
  v_nop
  v_mfma_f32_32x32x16_bf16 v[192:207], v[212:215], v[28:31], v[192:207]
  ds_read_b128 v[208:211], v3 offset:6144
  v_mul_f32 v160, v160, v248
  v_mul_f32 v161, v161, v249
  v_mul_f32 v250, v146, v146
  v_mfma_f32_32x32x16_bf16 v[176:191], v[216:219], v[32:35], v[176:191]
  ds_read_b128 v[212:215], v3 offset:38912
  v_mul_f32 v251, v147, v147
  v_fma_f32 v250, v250, v245, v244
  v_fma_f32 v251, v251, v245, v244
  s_waitcnt lgkmcnt(2)
  v_mfma_f32_32x32x16_bf16 v[192:207], v[220:223], v[32:35], v[192:207]
  ds_read_b128 v[216:219], v3 offset:7168
  v_mul_f32 v250, v250, v146
  v_mul_f32 v251, v251, v147
  v_exp_f32 v250, v250
  v_mfma_f32_32x32x16_bf16 v[176:191], v[224:227], v[36:39], v[176:191]
  ds_read_b128 v[220:223], v3 offset:39936
  v_exp_f32 v251, v251
  v_mul_f32 v162, v162, v146
  v_mfma_f32_32x32x16_bf16 v[192:207], v[228:231], v[36:39], v[192:207]
  ds_read_b128 v[224:227], v3 offset:8192
  v_mul_f32 v163, v163, v147
  v_fma_f32 v250, v250, v246, v246
  v_fma_f32 v251, v251, v246, v246
  s_waitcnt lgkmcnt(2)
  v_mfma_f32_32x32x16_bf16 v[176:191], v[208:211], v[40:43], v[176:191]
  ds_read_b128 v[228:231], v3 offset:40960
  v_rcp_f32 v250, v250
  v_rcp_f32 v251, v251
  v_mfma_f32_32x32x16_bf16 v[192:207], v[212:215], v[40:43], v[192:207]
  ds_read_b128 v[208:211], v3 offset:9216
  v_cvt_pk_bf16_f32 v144, v160, v161
  v_mul_f32 v162, v162, v250
  v_mul_f32 v163, v163, v251
  v_mfma_f32_32x32x16_bf16 v[176:191], v[216:219], v[44:47], v[176:191]
  ds_read_b128 v[212:215], v3 offset:41984
  v_mul_f32 v252, v148, v148
  v_mul_f32 v253, v149, v149
  v_fma_f32 v252, v252, v245, v244
  s_waitcnt lgkmcnt(2)
  v_mfma_f32_32x32x16_bf16 v[192:207], v[220:223], v[44:47], v[192:207]
  ds_read_b128 v[216:219], v3 offset:10240
  v_fma_f32 v253, v253, v245, v244
  v_mul_f32 v252, v252, v148
  v_mul_f32 v253, v253, v149
  v_mfma_f32_32x32x16_bf16 v[176:191], v[224:227], v[48:51], v[176:191]
  ds_read_b128 v[220:223], v3 offset:43008
  v_exp_f32 v252, v252
  v_exp_f32 v253, v253
  v_mfma_f32_32x32x16_bf16 v[192:207], v[228:231], v[48:51], v[192:207]
  ds_read_b128 v[224:227], v3 offset:11264
  v_mul_f32 v164, v164, v148
  v_mul_f32 v165, v165, v149
  v_fma_f32 v252, v252, v246, v246
  s_waitcnt lgkmcnt(2)
  v_mfma_f32_32x32x16_bf16 v[176:191], v[208:211], v[52:55], v[176:191]
  ds_read_b128 v[228:231], v3 offset:44032
  v_fma_f32 v253, v253, v246, v246
  v_rcp_f32 v252, v252
  v_mfma_f32_32x32x16_bf16 v[192:207], v[212:215], v[52:55], v[192:207]
  ds_read_b128 v[208:211], v3 offset:12288
  v_rcp_f32 v253, v253
  v_cvt_pk_bf16_f32 v145, v162, v163
  v_mfma_f32_32x32x16_bf16 v[176:191], v[216:219], v[56:59], v[176:191]
  ds_read_b128 v[212:215], v3 offset:45056
  v_mul_f32 v164, v164, v252
  v_mul_f32 v165, v165, v253
  v_mul_f32 v254, v150, v150
  s_waitcnt lgkmcnt(2)
  v_mfma_f32_32x32x16_bf16 v[192:207], v[220:223], v[56:59], v[192:207]
  ds_read_b128 v[216:219], v3 offset:13312
  v_mul_f32 v255, v151, v151
  v_fma_f32 v254, v254, v245, v244
  v_fma_f32 v255, v255, v245, v244
  v_mfma_f32_32x32x16_bf16 v[176:191], v[224:227], v[60:63], v[176:191]
  ds_read_b128 v[220:223], v3 offset:46080
  v_mul_f32 v254, v254, v150
  v_mul_f32 v255, v255, v151
  v_exp_f32 v254, v254
  v_mfma_f32_32x32x16_bf16 v[192:207], v[228:231], v[60:63], v[192:207]
  ds_read_b128 v[224:227], v3 offset:14336
  v_exp_f32 v255, v255
  v_mul_f32 v166, v166, v150
  s_waitcnt lgkmcnt(2)
  v_mfma_f32_32x32x16_bf16 v[176:191], v[208:211], v[64:67], v[176:191]
  ds_read_b128 v[228:231], v3 offset:47104
  v_mul_f32 v167, v167, v151
  v_fma_f32 v254, v254, v246, v246
  v_fma_f32 v255, v255, v246, v246
  v_mfma_f32_32x32x16_bf16 v[192:207], v[212:215], v[64:67], v[192:207]
  ds_read_b128 v[208:211], v3 offset:15360
  v_rcp_f32 v254, v254
  v_rcp_f32 v255, v255
  v_mfma_f32_32x32x16_bf16 v[176:191], v[216:219], v[68:71], v[176:191]
  ds_read_b128 v[212:215], v3 offset:48128
  v_cvt_pk_bf16_f32 v146, v164, v165
  v_mul_f32 v166, v166, v254
  v_mul_f32 v167, v167, v255
  ds_write_b32 v5, v247 offset:576
  s_waitcnt lgkmcnt(3)
  v_mfma_f32_32x32x16_bf16 v[192:207], v[220:223], v[68:71], v[192:207]
  ds_read_b128 v[216:219], v3 offset:16384
  v_mul_f32 v248, v152, v152
  v_mul_f32 v249, v153, v153
  v_fma_f32 v248, v248, v245, v244
  v_mfma_f32_32x32x16_bf16 v[176:191], v[224:227], v[72:75], v[176:191]
  ds_read_b128 v[220:223], v3 offset:49152
  v_fma_f32 v249, v249, v245, v244
  v_mul_f32 v248, v248, v152
  v_mul_f32 v249, v249, v153
  v_mfma_f32_32x32x16_bf16 v[192:207], v[228:231], v[72:75], v[192:207]
  ds_read_b128 v[224:227], v3 offset:17408
  v_exp_f32 v248, v248
  v_exp_f32 v249, v249
  s_waitcnt lgkmcnt(2)
  v_mfma_f32_32x32x16_bf16 v[176:191], v[208:211], v[76:79], v[176:191]
  ds_read_b128 v[228:231], v3 offset:50176
  v_mul_f32 v168, v168, v152
  v_mul_f32 v169, v169, v153
  v_fma_f32 v248, v248, v246, v246
  v_mfma_f32_32x32x16_bf16 v[192:207], v[212:215], v[76:79], v[192:207]
  ds_read_b128 v[208:211], v3 offset:18432
  v_fma_f32 v249, v249, v246, v246
  v_rcp_f32 v248, v248
  v_mfma_f32_32x32x16_bf16 v[176:191], v[216:219], v[80:83], v[176:191]
  ds_read_b128 v[212:215], v3 offset:51200
  v_rcp_f32 v249, v249
  v_cvt_pk_bf16_f32 v147, v166, v167
  s_waitcnt lgkmcnt(2)
  v_mfma_f32_32x32x16_bf16 v[192:207], v[220:223], v[80:83], v[192:207]
  ds_read_b128 v[216:219], v3 offset:19456
  v_mul_f32 v168, v168, v248
  v_mul_f32 v169, v169, v249
  v_mul_f32 v250, v154, v154
  v_mfma_f32_32x32x16_bf16 v[176:191], v[224:227], v[84:87], v[176:191]
  ds_read_b128 v[220:223], v3 offset:52224
  v_mul_f32 v251, v155, v155
  v_fma_f32 v250, v250, v245, v244
  v_fma_f32 v251, v251, v245, v244
  v_mfma_f32_32x32x16_bf16 v[192:207], v[228:231], v[84:87], v[192:207]
  ds_read_b128 v[224:227], v3 offset:20480
  v_mul_f32 v250, v250, v154
  v_mul_f32 v251, v251, v155
  v_exp_f32 v250, v250
  s_waitcnt lgkmcnt(2)
  v_mfma_f32_32x32x16_bf16 v[176:191], v[208:211], v[88:91], v[176:191]
  ds_read_b128 v[228:231], v3 offset:53248
  v_exp_f32 v251, v251
  v_mul_f32 v170, v170, v154
  v_mfma_f32_32x32x16_bf16 v[192:207], v[212:215], v[88:91], v[192:207]
  ds_read_b128 v[208:211], v3 offset:21504
  v_mul_f32 v171, v171, v155
  v_fma_f32 v250, v250, v246, v246
  v_fma_f32 v251, v251, v246, v246
  v_mfma_f32_32x32x16_bf16 v[176:191], v[216:219], v[92:95], v[176:191]
  ds_read_b128 v[212:215], v3 offset:54272
  v_rcp_f32 v250, v250
  v_rcp_f32 v251, v251
  s_waitcnt lgkmcnt(2)
  v_mfma_f32_32x32x16_bf16 v[192:207], v[220:223], v[92:95], v[192:207]
  ds_read_b128 v[216:219], v3 offset:22528
  v_cvt_pk_bf16_f32 v148, v168, v169
  v_mul_f32 v170, v170, v250
  v_mul_f32 v171, v171, v251
  v_mfma_f32_32x32x16_bf16 v[176:191], v[224:227], v[96:99], v[176:191]
  ds_read_b128 v[220:223], v3 offset:55296
  v_mul_f32 v252, v156, v156
  v_mul_f32 v253, v157, v157
  v_fma_f32 v252, v252, v245, v244
  v_mfma_f32_32x32x16_bf16 v[192:207], v[228:231], v[96:99], v[192:207]
  ds_read_b128 v[224:227], v3 offset:23552
  v_fma_f32 v253, v253, v245, v244
  v_mul_f32 v252, v252, v156
  v_mul_f32 v253, v253, v157
  s_waitcnt lgkmcnt(2)
  v_mfma_f32_32x32x16_bf16 v[176:191], v[208:211], v[100:103], v[176:191]
  ds_read_b128 v[228:231], v3 offset:56320
  v_exp_f32 v252, v252
  v_exp_f32 v253, v253
  v_mfma_f32_32x32x16_bf16 v[192:207], v[212:215], v[100:103], v[192:207]
  ds_read_b128 v[208:211], v3 offset:24576
  v_mul_f32 v172, v172, v156
  v_mul_f32 v173, v173, v157
  v_fma_f32 v252, v252, v246, v246
  v_mfma_f32_32x32x16_bf16 v[176:191], v[216:219], v[104:107], v[176:191]
  ds_read_b128 v[212:215], v3 offset:57344
  v_fma_f32 v253, v253, v246, v246
  v_rcp_f32 v252, v252
  s_waitcnt lgkmcnt(2)
  v_mfma_f32_32x32x16_bf16 v[192:207], v[220:223], v[104:107], v[192:207]
  ds_read_b128 v[216:219], v3 offset:25600
  v_rcp_f32 v253, v253
  v_cvt_pk_bf16_f32 v149, v170, v171
  v_mfma_f32_32x32x16_bf16 v[176:191], v[224:227], v[108:111], v[176:191]
  ds_read_b128 v[220:223], v3 offset:58368
  v_mul_f32 v172, v172, v252
  v_mul_f32 v173, v173, v253
  v_mul_f32 v254, v158, v158
  v_mfma_f32_32x32x16_bf16 v[192:207], v[228:231], v[108:111], v[192:207]
  ds_read_b128 v[224:227], v3 offset:26624
  v_mul_f32 v255, v159, v159
  v_fma_f32 v254, v254, v245, v244
  v_fma_f32 v255, v255, v245, v244
  s_waitcnt lgkmcnt(2)
  v_mfma_f32_32x32x16_bf16 v[176:191], v[208:211], v[112:115], v[176:191]
  ds_read_b128 v[228:231], v3 offset:59392
  v_mul_f32 v254, v254, v158
  v_mul_f32 v255, v255, v159
  v_exp_f32 v254, v254
  v_mfma_f32_32x32x16_bf16 v[192:207], v[212:215], v[112:115], v[192:207]
  ds_read_b128 v[208:211], v3 offset:27648
  v_exp_f32 v255, v255
  v_mul_f32 v174, v174, v158
  v_mfma_f32_32x32x16_bf16 v[176:191], v[216:219], v[116:119], v[176:191]
  ds_read_b128 v[212:215], v3 offset:60416
  v_mul_f32 v175, v175, v159
  v_fma_f32 v254, v254, v246, v246
  v_fma_f32 v255, v255, v246, v246
  s_waitcnt lgkmcnt(2)
  v_mfma_f32_32x32x16_bf16 v[192:207], v[220:223], v[116:119], v[192:207]
  ds_read_b128 v[216:219], v3 offset:28672
  v_rcp_f32 v254, v254
  v_rcp_f32 v255, v255
  ds_read_b32 v7, v14 offset:1536
  v_mfma_f32_32x32x16_bf16 v[176:191], v[224:227], v[120:123], v[176:191]
  ds_read_b128 v[220:223], v3 offset:61440
  v_cvt_pk_bf16_f32 v150, v172, v173
  v_mul_f32 v174, v174, v254
  v_mul_f32 v175, v175, v255
  v_mfma_f32_32x32x16_bf16 v[192:207], v[228:231], v[120:123], v[192:207]
  ds_read_b128 v[224:227], v3 offset:29696
  v_cvt_pk_bf16_f32 v151, v174, v175
  s_add_u32 s46, s28, 0
  s_add_u32 s47, s28, 44032
  buffer_store_dwordx4 v[144:147], v1, s[4:7], s46 offen
  buffer_store_dwordx4 v[148:151], v1, s[4:7], s47 offen
  s_waitcnt lgkmcnt(3)
  v_mfma_f32_32x32x16_bf16 v[176:191], v[208:211], v[124:127], v[176:191]
  ds_read_b128 v[228:231], v3 offset:62464
  v_mfma_f32_32x32x16_bf16 v[192:207], v[212:215], v[124:127], v[192:207]
  ds_read_b128 v[208:211], v3 offset:30720
  v_mfma_f32_32x32x16_bf16 v[176:191], v[216:219], v[128:131], v[176:191]
  ds_read_b128 v[212:215], v3 offset:63488
  s_waitcnt lgkmcnt(2)
  v_mfma_f32_32x32x16_bf16 v[192:207], v[220:223], v[128:131], v[192:207]
  ds_read_b128 v[216:219], v3 offset:31744
  v_mfma_f32_32x32x16_bf16 v[176:191], v[224:227], v[132:135], v[176:191]
  ds_read_b128 v[220:223], v3 offset:64512
  ds_write_b32 v5, v247 offset:640
  v_cmp_gt_u32 vcc, v247, v7
  s_cbranch_vccnz L_lsl_112
L_lbk_113:
  ds_read_b64 v[224:225], v9 offset:3584
  v_mfma_f32_32x32x16_bf16 v[192:207], v[228:231], v[132:135], v[192:207]
  ds_read_b64 v[228:229], v9 offset:3840
  s_waitcnt lgkmcnt(4)
  v_mfma_f32_32x32x16_bf16 v[176:191], v[208:211], v[136:139], v[176:191]
  v_mfma_f32_32x32x16_bf16 v[192:207], v[212:215], v[136:139], v[192:207]
  ds_read_b128 v[208:211], v3 offset:0
  v_mfma_f32_32x32x16_bf16 v[176:191], v[216:219], v[140:143], v[176:191]
  ds_read_b128 v[212:215], v3 offset:32768
  s_waitcnt lgkmcnt(2)
  v_mfma_f32_32x32x16_bf16 v[192:207], v[220:223], v[140:143], v[192:207]
  ds_read_b128 v[216:219], v3 offset:1024
  v_mfma_f32_32x32x16_bf16 v[176:191], v[224:227], v[240:243], v[176:191]
  ds_read_b128 v[220:223], v3 offset:33792
  v_mfma_f32_32x32x16_bf16 v[192:207], v[228:231], v[240:243], v[192:207]
  ds_read_b128 v[224:227], v3 offset:2048
  s_cmp_eq_u32 s15, 0
  s_nop 9
  s_cbranch_scc1 L_light
  s_waitcnt lgkmcnt(2)
  v_mfma_f32_32x32x16_bf16 v[144:159], v[208:211], v[16:19], 0
  ds_read_b128 v[228:231], v3 offset:34816
  v_mfma_f32_32x32x16_bf16 v[160:175], v[212:215], v[16:19], 0
  buffer_load_dwordx4 v[16:19], v1, s[4:7], s29 offen offset:0 sc1
  ds_read_b128 v[208:211], v3 offset:3072
  v_mul_f32 v248, v176, v176
  v_mul_f32 v249, v177, v177
  v_fma_f32 v248, v248, v245, v244
  v_mfma_f32_32x32x16_bf16 v[144:159], v[216:219], v[20:23], v[144:159]
  ds_read_b128 v[212:215], v3 offset:35840
  v_fma_f32 v249, v249, v245, v244
  v_mul_f32 v248, v248, v176
  v_mul_f32 v249, v249, v177
  s_waitcnt lgkmcnt(2)
  v_mfma_f32_32x32x16_bf16 v[160:175], v[220:223], v[20:23], v[160:175]
  buffer_load_dwordx4 v[20:23], v1, s[4:7], s29 offen offset:1024 sc1
  ds_read_b128 v[216:219], v3 offset:4096
  v_exp_f32 v248, v248
  v_exp_f32 v249, v249
  v_mfma_f32_32x32x16_bf16 v[144:159], v[224:227], v[24:27], v[144:159]
  ds_read_b128 v[220:223], v3 offset:36864
  v_mul_f32 v192, v192, v176
  v_mul_f32 v193, v193, v177
  v_fma_f32 v248, v248, v246, v246
  v_mfma_f32_32x32x16_bf16 v[160:175], v[228:231], v[24:27], v[160:175]
  buffer_load_dwordx4 v[24:27], v1, s[4:7], s29 offen offset:2048 sc1
  ds_read_b128 v[224:227], v3 offset:5120
  v_fma_f32 v249, v249, v246, v246
  v_rcp_f32 v248, v248
  s_waitcnt lgkmcnt(2)
  v_mfma_f32_32x32x16_bf16 v[144:159], v[208:211], v[28:31], v[144:159]
  ds_read_b128 v[228:231], v3 offset:37888
  v_rcp_f32 v249, v249
  v_nop
  v_mfma_f32_32x32x16_bf16 v[160:175], v[212:215], v[28:31], v[160:175]
  buffer_load_dwordx4 v[28:31], v1, s[4:7], s29 offen offset:3072 sc1
  ds_read_b128 v[208:211], v3 offset:6144
  v_mul_f32 v192, v192, v248
  v_mul_f32 v193, v193, v249
  v_mul_f32 v250, v178, v178
  v_mfma_f32_32x32x16_bf16 v[144:159], v[216:219], v[32:35], v[144:159]
  ds_read_b128 v[212:215], v3 offset:38912
  v_mul_f32 v251, v179, v179
  v_fma_f32 v250, v250, v245, v244
  v_fma_f32 v251, v251, v245, v244
  s_waitcnt lgkmcnt(2)
  v_mfma_f32_32x32x16_bf16 v[160:175], v[220:223], v[32:35], v[160:175]
  s_add_u32 s32, s29, 4096
  buffer_load_dwordx4 v[32:35], v1, s[4:7], s32 offen offset:0 sc1
  ds_read_b128 v[216:219], v3 offset:7168
  v_mul_f32 v250, v250, v178
  v_mul_f32 v251, v251, v179
  v_exp_f32 v250, v250
  v_mfma_f32_32x32x16_bf16 v[144:159], v[224:227], v[36:39], v[144:159]
  ds_read_b128 v[220:223], v3 offset:39936
  v_exp_f32 v251, v251
  v_mul_f32 v194, v194, v178
  v_mfma_f32_32x32x16_bf16 v[160:175], v[228:231], v[36:39], v[160:175]
  buffer_load_dwordx4 v[36:39], v1, s[4:7], s32 offen offset:1024 sc1
  ds_read_b128 v[224:227], v3 offset:8192
  v_mul_f32 v195, v195, v179
  v_fma_f32 v250, v250, v246, v246
  v_fma_f32 v251, v251, v246, v246
  s_waitcnt lgkmcnt(2)
  v_mfma_f32_32x32x16_bf16 v[144:159], v[208:211], v[40:43], v[144:159]
  ds_read_b128 v[228:231], v3 offset:40960
  v_rcp_f32 v250, v250
  v_rcp_f32 v251, v251
  v_mfma_f32_32x32x16_bf16 v[160:175], v[212:215], v[40:43], v[160:175]
  buffer_load_dwordx4 v[40:43], v1, s[4:7], s32 offen offset:2048 sc1
  ds_read_b128 v[208:211], v3 offset:9216
  v_cvt_pk_bf16_f32 v176, v192, v193
  v_mul_f32 v194, v194, v250
  v_mul_f32 v195, v195, v251
  v_mfma_f32_32x32x16_bf16 v[144:159], v[216:219], v[44:47], v[144:159]
  ds_read_b128 v[212:215], v3 offset:41984
  v_mul_f32 v252, v180, v180
  v_mul_f32 v253, v181, v181
  v_fma_f32 v252, v252, v245, v244
  s_waitcnt lgkmcnt(2)
  v_mfma_f32_32x32x16_bf16 v[160:175], v[220:223], v[44:47], v[160:175]
  buffer_load_dwordx4 v[44:47], v1, s[4:7], s32 offen offset:3072 sc1
  ds_read_b128 v[216:219], v3 offset:10240
  v_fma_f32 v253, v253, v245, v244
  v_mul_f32 v252, v252, v180
  v_mul_f32 v253, v253, v181
  ds_read_b32 v7, v14 offset:1600
  v_mfma_f32_32x32x16_bf16 v[144:159], v[224:227], v[48:51], v[144:159]
  ds_read_b128 v[220:223], v3 offset:43008
  v_exp_f32 v252, v252
  v_exp_f32 v253, v253
  v_mfma_f32_32x32x16_bf16 v[160:175], v[228:231], v[48:51], v[160:175]
  s_add_u32 s32, s29, 8192
  buffer_load_dwordx4 v[48:51], v1, s[4:7], s32 offen offset:0 sc1
  ds_read_b128 v[224:227], v3 offset:11264
  v_mul_f32 v196, v196, v180
  v_mul_f32 v197, v197, v181
  v_fma_f32 v252, v252, v246, v246
  s_waitcnt lgkmcnt(3)
  v_mfma_f32_32x32x16_bf16 v[144:159], v[208:211], v[52:55], v[144:159]
  ds_read_b128 v[228:231], v3 offset:44032
  v_fma_f32 v253, v253, v246, v246
  v_rcp_f32 v252, v252
  v_mfma_f32_32x32x16_bf16 v[160:175], v[212:215], v[52:55], v[160:175]
  buffer_load_dwordx4 v[52:55], v1, s[4:7], s32 offen offset:1024 sc1
  ds_read_b128 v[208:211], v3 offset:12288
  v_rcp_f32 v253, v253
  v_cvt_pk_bf16_f32 v177, v194, v195
  v_mfma_f32_32x32x16_bf16 v[144:159], v[216:219], v[56:59], v[144:159]
  ds_read_b128 v[212:215], v3 offset:45056
  v_mul_f32 v196, v196, v252
  v_mul_f32 v197, v197, v253
  v_mul_f32 v254, v182, v182
  s_waitcnt lgkmcnt(2)
  v_mfma_f32_32x32x16_bf16 v[160:175], v[220:223], v[56:59], v[160:175]
  buffer_load_dwordx4 v[56:59], v1, s[4:7], s32 offen offset:2048 sc1
  ds_read_b128 v[216:219], v3 offset:13312
  v_mul_f32 v255, v183, v183
  v_fma_f32 v254, v254, v245, v244
  v_fma_f32 v255, v255, v245, v244
  v_mfma_f32_32x32x16_bf16 v[144:159], v[224:227], v[60:63], v[144:159]
  ds_read_b128 v[220:223], v3 offset:46080
  v_mul_f32 v254, v254, v182
  v_mul_f32 v255, v255, v183
  v_exp_f32 v254, v254
  v_mfma_f32_32x32x16_bf16 v[160:175], v[228:231], v[60:63], v[160:175]
  buffer_load_dwordx4 v[60:63], v1, s[4:7], s32 offen offset:3072 sc1
  ds_read_b128 v[224:227], v3 offset:14336
  v_exp_f32 v255, v255
  v_mul_f32 v198, v198, v182
  s_waitcnt lgkmcnt(2)
  v_mfma_f32_32x32x16_bf16 v[144:159], v[208:211], v[64:67], v[144:159]
  ds_read_b128 v[228:231], v3 offset:47104
  v_mul_f32 v199, v199, v183
  v_fma_f32 v254, v254, v246, v246
  v_fma_f32 v255, v255, v246, v246
  v_mfma_f32_32x32x16_bf16 v[160:175], v[212:215], v[64:67], v[160:175]
  s_add_u32 s32, s29, 12288
  buffer_load_dwordx4 v[64:67], v1, s[4:7], s32 offen offset:0 sc1
  ds_read_b128 v[208:211], v3 offset:15360
  v_rcp_f32 v254, v254
  v_rcp_f32 v255, v255
  v_mfma_f32_32x32x16_bf16 v[144:159], v[216:219], v[68:71], v[144:159]
  ds_read_b128 v[212:215], v3 offset:48128
  v_cvt_pk_bf16_f32 v178, v196, v197
  v_mul_f32 v198, v198, v254
  v_mul_f32 v199, v199, v255
  v_cmp_gt_u32 vcc, v247, v7
  s_cbranch_vccnz L_lsl_114
L_lbk_115:
  ds_write_b32 v5, v247 offset:704
  s_waitcnt lgkmcnt(3)
  v_mfma_f32_32x32x16_bf16 v[160:175], v[220:223], v[68:71], v[160:175]
  buffer_load_dwordx4 v[68:71], v1, s[4:7], s32 offen offset:1024 sc1
  ds_read_b128 v[216:219], v3 offset:16384
  v_mul_f32 v248, v184, v184
  v_mul_f32 v249, v185, v185
  v_fma_f32 v248, v248, v245, v244
  v_mfma_f32_32x32x16_bf16 v[144:159], v[224:227], v[72:75], v[144:159]
  ds_read_b128 v[220:223], v3 offset:49152
  v_fma_f32 v249, v249, v245, v244
  v_mul_f32 v248, v248, v184
  v_mul_f32 v249, v249, v185
  v_mfma_f32_32x32x16_bf16 v[160:175], v[228:231], v[72:75], v[160:175]
  buffer_load_dwordx4 v[72:75], v1, s[4:7], s32 offen offset:2048 sc1
  ds_read_b128 v[224:227], v3 offset:17408
  v_exp_f32 v248, v248
  v_exp_f32 v249, v249
  s_waitcnt lgkmcnt(2)
  v_mfma_f32_32x32x16_bf16 v[144:159], v[208:211], v[76:79], v[144:159]
  ds_read_b128 v[228:231], v3 offset:50176
  v_mul_f32 v200, v200, v184
  v_mul_f32 v201, v201, v185
  v_fma_f32 v248, v248, v246, v246
  v_mfma_f32_32x32x16_bf16 v[160:175], v[212:215], v[76:79], v[160:175]
  buffer_load_dwordx4 v[76:79], v1, s[4:7], s32 offen offset:3072 sc1
  ds_read_b128 v[208:211], v3 offset:18432
  v_fma_f32 v249, v249, v246, v246
  v_rcp_f32 v248, v248
  v_mfma_f32_32x32x16_bf16 v[144:159], v[216:219], v[80:83], v[144:159]
  ds_read_b128 v[212:215], v3 offset:51200
  v_rcp_f32 v249, v249
  v_cvt_pk_bf16_f32 v179, v198, v199
  s_waitcnt lgkmcnt(2)
  v_mfma_f32_32x32x16_bf16 v[160:175], v[220:223], v[80:83], v[160:175]
  ds_read_b128 v[216:219], v3 offset:19456
  v_mul_f32 v200, v200, v248
  v_mul_f32 v201, v201, v249
  v_mul_f32 v250, v186, v186
  v_mfma_f32_32x32x16_bf16 v[144:159], v[224:227], v[84:87], v[144:159]
  ds_read_b128 v[220:223], v3 offset:52224
  v_mul_f32 v251, v187, v187
  v_fma_f32 v250, v250, v245, v244
  v_fma_f32 v251, v251, v245, v244
  v_mfma_f32_32x32x16_bf16 v[160:175], v[228:231], v[84:87], v[160:175]
  ds_read_b128 v[224:227], v3 offset:20480
  v_mul_f32 v250, v250, v186
  v_mul_f32 v251, v251, v187
  v_exp_f32 v250, v250
  s_waitcnt lgkmcnt(2)
  v_mfma_f32_32x32x16_bf16 v[144:159], v[208:211], v[88:91], v[144:159]
  ds_read_b128 v[228:231], v3 offset:53248
  v_exp_f32 v251, v251
  v_mul_f32 v202, v202, v186
  v_mfma_f32_32x32x16_bf16 v[160:175], v[212:215], v[88:91], v[160:175]
  ds_read_b128 v[208:211], v3 offset:21504
  v_mul_f32 v203, v203, v187
  v_fma_f32 v250, v250, v246, v246
  v_fma_f32 v251, v251, v246, v246
  v_mfma_f32_32x32x16_bf16 v[144:159], v[216:219], v[92:95], v[144:159]
  ds_read_b128 v[212:215], v3 offset:54272
  v_rcp_f32 v250, v250
  v_rcp_f32 v251, v251
  s_waitcnt lgkmcnt(2)
  v_mfma_f32_32x32x16_bf16 v[160:175], v[220:223], v[92:95], v[160:175]
  ds_read_b128 v[216:219], v3 offset:22528
  v_cvt_pk_bf16_f32 v180, v200, v201
  v_mul_f32 v202, v202, v250
  v_mul_f32 v203, v203, v251
  v_mfma_f32_32x32x16_bf16 v[144:159], v[224:227], v[96:99], v[144:159]
  ds_read_b128 v[220:223], v3 offset:55296
  v_mul_f32 v252, v188, v188
  v_mul_f32 v253, v189, v189
  v_fma_f32 v252, v252, v245, v244
  v_mfma_f32_32x32x16_bf16 v[160:175], v[228:231], v[96:99], v[160:175]
  ds_read_b128 v[224:227], v3 offset:23552
  v_fma_f32 v253, v253, v245, v244
  v_mul_f32 v252, v252, v188
  v_mul_f32 v253, v253, v189
  s_waitcnt lgkmcnt(2)
  v_mfma_f32_32x32x16_bf16 v[144:159], v[208:211], v[100:103], v[144:159]
  ds_read_b128 v[228:231], v3 offset:56320
  v_exp_f32 v252, v252
  v_exp_f32 v253, v253
  v_mfma_f32_32x32x16_bf16 v[160:175], v[212:215], v[100:103], v[160:175]
  ds_read_b128 v[208:211], v3 offset:24576
  v_mul_f32 v204, v204, v188
  v_mul_f32 v205, v205, v189
  v_fma_f32 v252, v252, v246, v246
  v_mfma_f32_32x32x16_bf16 v[144:159], v[216:219], v[104:107], v[144:159]
  ds_read_b128 v[212:215], v3 offset:57344
  v_fma_f32 v253, v253, v246, v246
  v_rcp_f32 v252, v252
  s_waitcnt lgkmcnt(2)
  v_mfma_f32_32x32x16_bf16 v[160:175], v[220:223], v[104:107], v[160:175]
  ds_read_b128 v[216:219], v3 offset:25600
  v_rcp_f32 v253, v253
  v_cvt_pk_bf16_f32 v181, v202, v203
  v_mfma_f32_32x32x16_bf16 v[144:159], v[224:227], v[108:111], v[144:159]
  ds_read_b128 v[220:223], v3 offset:58368
  v_mul_f32 v204, v204, v252
  v_mul_f32 v205, v205, v253
  v_mul_f32 v254, v190, v190
  v_mfma_f32_32x32x16_bf16 v[160:175], v[228:231], v[108:111], v[160:175]
  ds_read_b128 v[224:227], v3 offset:26624
  v_mul_f32 v255, v191, v191
  v_fma_f32 v254, v254, v245, v244
  v_fma_f32 v255, v255, v245, v244
  s_waitcnt lgkmcnt(2)
  v_mfma_f32_32x32x16_bf16 v[144:159], v[208:211], v[112:115], v[144:159]
  ds_read_b128 v[228:231], v3 offset:59392
  v_mul_f32 v254, v254, v190
  v_mul_f32 v255, v255, v191
  v_exp_f32 v254, v254
  v_mfma_f32_32x32x16_bf16 v[160:175], v[212:215], v[112:115], v[160:175]
  ds_read_b128 v[208:211], v3 offset:27648
  v_exp_f32 v255, v255
  v_mul_f32 v206, v206, v190
  v_mfma_f32_32x32x16_bf16 v[144:159], v[216:219], v[116:119], v[144:159]
  ds_read_b128 v[212:215], v3 offset:60416
  v_mul_f32 v207, v207, v191
  v_fma_f32 v254, v254, v246, v246
  v_fma_f32 v255, v255, v246, v246
  s_waitcnt lgkmcnt(2)
  v_mfma_f32_32x32x16_bf16 v[160:175], v[220:223], v[116:119], v[160:175]
  ds_read_b128 v[216:219], v3 offset:28672
  v_rcp_f32 v254, v254
  v_rcp_f32 v255, v255
  ds_read_b32 v7, v14 offset:1664
  v_mfma_f32_32x32x16_bf16 v[144:159], v[224:227], v[120:123], v[144:159]
  ds_read_b128 v[220:223], v3 offset:61440
  v_cvt_pk_bf16_f32 v182, v204, v205
  v_mul_f32 v206, v206, v254
  v_mul_f32 v207, v207, v255
  v_mfma_f32_32x32x16_bf16 v[160:175], v[228:231], v[120:123], v[160:175]
  ds_read_b128 v[224:227], v3 offset:29696
  v_cvt_pk_bf16_f32 v183, v206, v207
  s_add_u32 s46, s28, 16384
  s_add_u32 s47, s28, 60416
  buffer_store_dwordx4 v[176:179], v1, s[4:7], s46 offen
  buffer_store_dwordx4 v[180:183], v1, s[4:7], s47 offen
  s_lshl_b32 s47, s14, 12
  s_waitcnt lgkmcnt(3)
  v_mfma_f32_32x32x16_bf16 v[144:159], v[208:211], v[124:127], v[144:159]
  ds_read_b128 v[228:231], v3 offset:62464
  s_xor_b32 s48, s47, 8192
  s_add_u32 s47, s47, 73728
  s_add_u32 s48, s48, 73728
  v_mfma_f32_32x32x16_bf16 v[160:175], v[212:215], v[124:127], v[160:175]
  ds_read_b128 v[208:211], v3 offset:30720
  v_add_u32 v12, s47, v1
  v_add_u32 v13, s48, v1
  v_lshlrev_b32 v176, 16, v232
  v_mfma_f32_32x32x16_bf16 v[144:159], v[216:219], v[128:131], v[144:159]
  ds_read_b128 v[212:215], v3 offset:63488
  v_and_b32 v177, s54, v232
  v_lshlrev_b32 v178, 16, v233
  v_and_b32 v179, s54, v233
  s_waitcnt lgkmcnt(2)
  v_mfma_f32_32x32x16_bf16 v[160:175], v[220:223], v[128:131], v[160:175]
  ds_read_b128 v[216:219], v3 offset:31744
  v_lshlrev_b32 v180, 16, v234
  v_and_b32 v181, s54, v234
  v_lshlrev_b32 v182, 16, v235
  v_mfma_f32_32x32x16_bf16 v[144:159], v[224:227], v[132:135], v[144:159]
  ds_read_b128 v[220:223], v3 offset:64512
  v_and_b32 v183, s54, v235
  v_lshlrev_b32 v184, 16, v236
  v_and_b32 v185, s54, v236
  ds_write_b32 v5, v247 offset:768
  v_cmp_gt_u32 vcc, v247, v7
  s_cbranch_vccnz L_lsl_116
L_lbk_117:
  ds_read_b64 v[224:225], v9 offset:4096
  v_mfma_f32_32x32x16_bf16 v[160:175], v[228:231], v[132:135], v[160:175]
  v_lshlrev_b32 v186, 16, v237
  v_and_b32 v187, s54, v237
  v_lshlrev_b32 v188, 16, v238
  ds_read_b64 v[228:229], v9 offset:4352
  s_waitcnt lgkmcnt(4)
  v_mfma_f32_32x32x16_bf16 v[144:159], v[208:211], v[136:139], v[144:159]
  v_and_b32 v189, s54, v238
  v_lshlrev_b32 v190, 16, v239
  v_and_b32 v191, s54, v239
  s_lshr_b32 s46, s14, 1
  s_mul_i32 s47, s46, 2560
  s_add_u32 s47, s47, 98304
  s_xor_b32 s48, s47, 512
  v_add_u32 v10, s47, v0
  v_add_u32 v11, s48, v0
  v_mfma_f32_32x32x16_bf16 v[160:175], v[212:215], v[136:139], v[160:175]
  ds_read_b64_tr_b16 v[208:209], v10 offset:40960
  ds_read_b64_tr_b16 v[210:211], v10 offset:41216
  v_mfma_f32_32x32x16_bf16 v[144:159], v[216:219], v[140:143], v[144:159]
  ds_read_b64_tr_b16 v[212:213], v11 offset:40960
  ds_read_b64_tr_b16 v[214:215], v11 offset:41216
  s_waitcnt lgkmcnt(4)
  v_mfma_f32_32x32x16_bf16 v[160:175], v[220:223], v[140:143], v[160:175]
  ds_read_b64_tr_b16 v[216:217], v10 offset:45056
  ds_read_b64_tr_b16 v[218:219], v10 offset:45312
  v_mfma_f32_32x32x16_bf16 v[144:159], v[224:227], v[240:243], v[144:159]
  ds_read_b64_tr_b16 v[220:221], v11 offset:45056
  ds_read_b64_tr_b16 v[222:223], v11 offset:45312
  v_mfma_f32_32x32x16_bf16 v[160:175], v[228:231], v[240:243], v[160:175]
  ds_read_b64_tr_b16 v[224:225], v10 offset:49152
  ds_read_b64_tr_b16 v[226:227], v10 offset:49408
  s_nop 3
  v_pk_mul_f32 v[248:249], v[144:145], v[144:145]
  v_pk_mul_f32 v[250:251], v[146:147], v[146:147]
  v_pk_mul_f32 v[252:253], v[148:149], v[148:149]
  v_pk_mul_f32 v[254:255], v[150:151], v[150:151]
  v_pk_fma_f32 v[248:249], v[248:249], v[244:245], v[244:245] op_sel:[0,1,0] op_sel_hi:[1,1,0]
  v_pk_fma_f32 v[250:251], v[250:251], v[244:245], v[244:245] op_sel:[0,1,0] op_sel_hi:[1,1,0]
  v_pk_fma_f32 v[252:253], v[252:253], v[244:245], v[244:245] op_sel:[0,1,0] op_sel_hi:[1,1,0]
  v_pk_fma_f32 v[254:255], v[254:255], v[244:245], v[244:245] op_sel:[0,1,0] op_sel_hi:[1,1,0]
  v_pk_mul_f32 v[248:249], v[248:249], v[144:145]
  v_pk_mul_f32 v[250:251], v[250:251], v[146:147]
  v_pk_mul_f32 v[252:253], v[252:253], v[148:149]
  v_pk_mul_f32 v[254:255], v[254:255], v[150:151]
  v_exp_f32 v248, v248
  v_exp_f32 v249, v249
  v_exp_f32 v250, v250
  v_exp_f32 v251, v251
  v_exp_f32 v252, v252
  v_exp_f32 v253, v253
  v_exp_f32 v254, v254
  v_exp_f32 v255, v255
  v_pk_mul_f32 v[160:161], v[160:161], v[144:145]
  v_pk_mul_f32 v[162:163], v[162:163], v[146:147]
  v_pk_mul_f32 v[164:165], v[164:165], v[148:149]
  v_pk_mul_f32 v[166:167], v[166:167], v[150:151]
  v_pk_fma_f32 v[248:249], v[248:249], v[246:247], v[246:247] op_sel_hi:[1,0,0]
  v_pk_fma_f32 v[250:251], v[250:251], v[246:247], v[246:247] op_sel_hi:[1,0,0]
  v_pk_fma_f32 v[252:253], v[252:253], v[246:247], v[246:247] op_sel_hi:[1,0,0]
  v_pk_fma_f32 v[254:255], v[254:255], v[246:247], v[246:247] op_sel_hi:[1,0,0]
  v_rcp_f32 v248, v248
  v_rcp_f32 v249, v249
  v_rcp_f32 v250, v250
  v_rcp_f32 v251, v251
  v_rcp_f32 v252, v252
  v_rcp_f32 v253, v253
  v_rcp_f32 v254, v254
  v_rcp_f32 v255, v255
  v_pk_mul_f32 v[160:161], v[160:161], v[248:249]
  v_pk_mul_f32 v[162:163], v[162:163], v[250:251]
  v_pk_mul_f32 v[164:165], v[164:165], v[252:253]
  v_pk_mul_f32 v[166:167], v[166:167], v[254:255]
  v_cvt_pk_bf16_f32 v144, v160, v161
  v_cvt_pk_bf16_f32 v145, v162, v163
  v_cvt_pk_bf16_f32 v146, v164, v165
  v_cvt_pk_bf16_f32 v147, v166, v167
  v_pk_mul_f32 v[248:249], v[152:153], v[152:153]
  v_pk_mul_f32 v[250:251], v[154:155], v[154:155]
  v_pk_mul_f32 v[252:253], v[156:157], v[156:157]
  v_pk_mul_f32 v[254:255], v[158:159], v[158:159]
  v_pk_fma_f32 v[248:249], v[248:249], v[244:245], v[244:245] op_sel:[0,1,0] op_sel_hi:[1,1,0]
  v_pk_fma_f32 v[250:251], v[250:251], v[244:245], v[244:245] op_sel:[0,1,0] op_sel_hi:[1,1,0]
  v_pk_fma_f32 v[252:253], v[252:253], v[244:245], v[244:245] op_sel:[0,1,0] op_sel_hi:[1,1,0]
  v_pk_fma_f32 v[254:255], v[254:255], v[244:245], v[244:245] op_sel:[0,1,0] op_sel_hi:[1,1,0]
  v_pk_mul_f32 v[248:249], v[248:249], v[152:153]
  v_pk_mul_f32 v[250:251], v[250:251], v[154:155]
  v_pk_mul_f32 v[252:253], v[252:253], v[156:157]
  v_pk_mul_f32 v[254:255], v[254:255], v[158:159]
  v_exp_f32 v248, v248
  v_exp_f32 v249, v249
  v_exp_f32 v250, v250
  v_exp_f32 v251, v251
  v_exp_f32 v252, v252
  v_exp_f32 v253, v253
  v_exp_f32 v254, v254
  v_exp_f32 v255, v255
  v_pk_mul_f32 v[168:169], v[168:169], v[152:153]
  v_pk_mul_f32 v[170:171], v[170:171], v[154:155]
  v_pk_mul_f32 v[172:173], v[172:173], v[156:157]
  v_pk_mul_f32 v[174:175], v[174:175], v[158:159]
  v_pk_fma_f32 v[248:249], v[248:249], v[246:247], v[246:247] op_sel_hi:[1,0,0]
  v_pk_fma_f32 v[250:251], v[250:251], v[246:247], v[246:247] op_sel_hi:[1,0,0]
  v_pk_fma_f32 v[252:253], v[252:253], v[246:247], v[246:247] op_sel_hi:[1,0,0]
  v_pk_fma_f32 v[254:255], v[254:255], v[246:247], v[246:247] op_sel_hi:[1,0,0]
  v_rcp_f32 v248, v248
  v_rcp_f32 v249, v249
  v_rcp_f32 v250, v250
  v_rcp_f32 v251, v251
  v_rcp_f32 v252, v252
  v_rcp_f32 v253, v253
  v_rcp_f32 v254, v254
  v_rcp_f32 v255, v255
  v_pk_mul_f32 v[168:169], v[168:169], v[248:249]
  v_pk_mul_f32 v[170:171], v[170:171], v[250:251]
  v_pk_mul_f32 v[172:173], v[172:173], v[252:253]
  v_pk_mul_f32 v[174:175], v[174:175], v[254:255]
  v_cvt_pk_bf16_f32 v148, v168, v169
  v_cvt_pk_bf16_f32 v149, v170, v171
  v_cvt_pk_bf16_f32 v150, v172, v173
  v_cvt_pk_bf16_f32 v151, v174, v175
  s_add_u32 s46, s28, 32768
  s_add_u32 s47, s28, 76800
  buffer_store_dwordx4 v[144:147], v1, s[4:7], s46 offen
  buffer_store_dwordx4 v[148:151], v1, s[4:7], s47 offen
  s_waitcnt vmcnt(18)
  v_max_u32 v15, v16, v20
  v_cmp_eq_u32 vcc, -1, v15
  s_cbranch_vccnz L_pl_118
L_plb_119:
  s_waitcnt lgkmcnt(4)
  v_mfma_f32_32x32x16_bf16 v[176:191], v[208:211], v[16:19], v[176:191]
  ds_read_b64_tr_b16 v[228:229], v11 offset:49152
  ds_read_b64_tr_b16 v[230:231], v11 offset:49408
  v_mfma_f32_32x32x16_bf16 v[192:207], v[212:215], v[16:19], 0
  ds_read_b64_tr_b16 v[208:209], v10 offset:53248
  ds_read_b64_tr_b16 v[210:211], v10 offset:53504
  s_waitcnt vmcnt(16)
  v_max_u32 v15, v24, v28
  v_mfma_f32_32x32x16_bf16 v[176:191], v[216:219], v[20:23], v[176:191]
  ds_read_b64_tr_b16 v[212:213], v11 offset:53248
  ds_read_b64_tr_b16 v[214:215], v11 offset:53504
  v_cmp_eq_u32 vcc, -1, v15
  s_waitcnt lgkmcnt(4)
  v_mfma_f32_32x32x16_bf16 v[192:207], v[220:223], v[20:23], v[192:207]
  s_add_u32 s32, s29, 16384
  buffer_load_dwordx4 v[80:83], v1, s[4:7], s32 offen offset:0 sc1
  ds_read_b64_tr_b16 v[216:217], v10 offset:57344
  ds_read_b64_tr_b16 v[218:219], v10 offset:57600
  s_cbranch_vccnz L_pl_124
L_plb_125:
  v_mfma_f32_32x32x16_bf16 v[176:191], v[224:227], v[24:27], v[176:191]
  ds_read_b64_tr_b16 v[220:221], v11 offset:57344
  ds_read_b64_tr_b16 v[222:223], v11 offset:57600
  v_mfma_f32_32x32x16_bf16 v[192:207], v[228:231], v[24:27], v[192:207]
  buffer_load_dwordx4 v[84:87], v1, s[4:7], s32 offen offset:1024 sc1
  ds_read_b64_tr_b16 v[224:225], v10 offset:61440
  ds_read_b64_tr_b16 v[226:227], v10 offset:61696
  s_waitcnt vmcnt(14)
  v_max3_u32 v15, v32, v36, v40
  v_max_u32 v15, v15, v44
  s_waitcnt lgkmcnt(4)
  v_mfma_f32_32x32x16_bf16 v[176:191], v[208:211], v[28:31], v[176:191]
  ds_read_b64_tr_b16 v[228:229], v11 offset:61440
  ds_read_b64_tr_b16 v[230:231], v11 offset:61696
  v_cmp_eq_u32 vcc, -1, v15
  ds_write_b32 v5, v247 offset:832
  v_add_u32 v10, 0xfffea000, v10
  v_add_u32 v11, 0xfffea000, v11
  v_mfma_f32_32x32x16_bf16 v[192:207], v[212:215], v[28:31], v[192:207]
  buffer_load_dwordx4 v[88:91], v1, s[4:7], s32 offen offset:2048 sc1
  ds_read_b64_tr_b16 v[208:209], v10 offset:0
  ds_read_b64_tr_b16 v[210:211], v10 offset:256
  s_cbranch_vccnz L_pl_130
L_plb_131:
  v_mfma_f32_32x32x16_bf16 v[176:191], v[216:219], v[32:35], v[176:191]
  ds_read_b64_tr_b16 v[212:213], v11 offset:0
  ds_read_b64_tr_b16 v[214:215], v11 offset:256
  s_waitcnt lgkmcnt(5)
  v_mfma_f32_32x32x16_bf16 v[192:207], v[220:223], v[32:35], v[192:207]
  buffer_load_dwordx4 v[92:95], v1, s[4:7], s32 offen offset:3072 sc1
  ds_read_b64_tr_b16 v[216:217], v10 offset:4096
  ds_read_b64_tr_b16 v[218:219], v10 offset:4352
  v_mfma_f32_32x32x16_bf16 v[176:191], v[224:227], v[36:39], v[176:191]
  ds_read_b64_tr_b16 v[220:221], v11 offset:4096
  ds_read_b64_tr_b16 v[222:223], v11 offset:4352
  v_mfma_f32_32x32x16_bf16 v[192:207], v[228:231], v[36:39], v[192:207]
  s_add_u32 s32, s29, 20480
  buffer_load_dwordx4 v[96:99], v1, s[4:7], s32 offen offset:0 sc1
  ds_read_b64_tr_b16 v[224:225], v10 offset:8192
  ds_read_b64_tr_b16 v[226:227], v10 offset:8448
  s_waitcnt lgkmcnt(4)
  v_mfma_f32_32x32x16_bf16 v[176:191], v[208:211], v[40:43], v[176:191]
  ds_read_b64_tr_b16 v[228:229], v11 offset:8192
  ds_read_b64_tr_b16 v[230:231], v11 offset:8448
  v_mfma_f32_32x32x16_bf16 v[192:207], v[212:215], v[40:43], v[192:207]
  buffer_load_dwordx4 v[100:103], v1, s[4:7], s32 offen offset:1024 sc1
  ds_read_b64_tr_b16 v[208:209], v10 offset:12288
  ds_read_b64_tr_b16 v[210:211], v10 offset:12544
  s_waitcnt vmcnt(14)
  v_max3_u32 v15, v48, v52, v56
  v_max_u32 v15, v15, v60
  v_mfma_f32_32x32x16_bf16 v[176:191], v[216:219], v[44:47], v[176:191]
  ds_read_b64_tr_b16 v[212:213], v11 offset:12288
  ds_read_b64_tr_b16 v[214:215], v11 offset:12544
  v_cmp_eq_u32 vcc, -1, v15
  s_waitcnt lgkmcnt(4)
  v_mfma_f32_32x32x16_bf16 v[192:207], v[220:223], v[44:47], v[192:207]
  buffer_load_dwordx4 v[104:107], v1, s[4:7], s32 offen offset:2048 sc1
  ds_read_b64_tr_b16 v[216:217], v10 offset:16384
  ds_read_b64_tr_b16 v[218:219], v10 offset:16640
  s_cbranch_vccnz L_pl_135
L_plb_136:
  v_mfma_f32_32x32x16_bf16 v[176:191], v[224:227], v[48:51], v[176:191]
  ds_read_b64_tr_b16 v[220:221], v11 offset:16384
  ds_read_b64_tr_b16 v[222:223], v11 offset:16640
  v_mfma_f32_32x32x16_bf16 v[192:207], v[228:231], v[48:51], v[192:207]
  buffer_load_dwordx4 v[108:111], v1, s[4:7], s32 offen offset:3072 sc1
  ds_read_b64_tr_b16 v[224:225], v10 offset:20480
  ds_read_b64_tr_b16 v[226:227], v10 offset:20736
  s_waitcnt lgkmcnt(4)
  v_mfma_f32_32x32x16_bf16 v[176:191], v[208:211], v[52:55], v[176:191]
  ds_read_b64_tr_b16 v[228:229], v11 offset:20480
  ds_read_b64_tr_b16 v[230:231], v11 offset:20736
  v_mfma_f32_32x32x16_bf16 v[192:207], v[212:215], v[52:55], v[192:207]
  s_add_u32 s32, s29, 24576
  buffer_load_dwordx4 v[112:115], v1, s[4:7], s32 offen offset:0 sc1
  ds_read_b64_tr_b16 v[208:209], v10 offset:24576
  ds_read_b64_tr_b16 v[210:211], v10 offset:24832
  v_mfma_f32_32x32x16_bf16 v[176:191], v[216:219], v[56:59], v[176:191]
  ds_read_b64_tr_b16 v[212:213], v11 offset:24576
  ds_read_b64_tr_b16 v[214:215], v11 offset:24832
  s_waitcnt lgkmcnt(4)
  v_mfma_f32_32x32x16_bf16 v[192:207], v[220:223], v[56:59], v[192:207]
  buffer_load_dwordx4 v[116:119], v1, s[4:7], s32 offen offset:1024 sc1
  ds_read_b64_tr_b16 v[216:217], v10 offset:28672
  ds_read_b64_tr_b16 v[218:219], v10 offset:28928
  s_waitcnt vmcnt(14)
  v_max3_u32 v15, v64, v68, v72
  v_max_u32 v15, v15, v76
  v_mfma_f32_32x32x16_bf16 v[176:191], v[224:227], v[60:63], v[176:191]
  ds_read_b64_tr_b16 v[220:221], v11 offset:28672
  ds_read_b64_tr_b16 v[222:223], v11 offset:28928
  v_cmp_eq_u32 vcc, -1, v15
  v_mfma_f32_32x32x16_bf16 v[192:207], v[228:231], v[60:63], v[192:207]
  buffer_load_dwordx4 v[120:123], v1, s[4:7], s32 offen offset:2048 sc1
  ds_read_b64_tr_b16 v[224:225], v10 offset:32768
  ds_read_b64_tr_b16 v[226:227], v10 offset:33024
  s_cbranch_vccnz L_pl_140
L_plb_141:
  s_waitcnt lgkmcnt(4)
  v_mfma_f32_32x32x16_bf16 v[176:191], v[208:211], v[64:67], v[176:191]
  ds_read_b64_tr_b16 v[228:229], v11 offset:32768
  ds_read_b64_tr_b16 v[230:231], v11 offset:33024
  v_mfma_f32_32x32x16_bf16 v[192:207], v[212:215], v[64:67], v[192:207]
  buffer_load_dwordx4 v[124:127], v1, s[4:7], s32 offen offset:3072 sc1
  ds_read_b64_tr_b16 v[208:209], v10 offset:36864
  ds_read_b64_tr_b16 v[210:211], v10 offset:37120
  v_mfma_f32_32x32x16_bf16 v[176:191], v[216:219], v[68:71], v[176:191]
  ds_read_b64_tr_b16 v[212:213], v11 offset:36864
  ds_read_b64_tr_b16 v[214:215], v11 offset:37120
  s_waitcnt lgkmcnt(4)
  v_mfma_f32_32x32x16_bf16 v[192:207], v[220:223], v[68:71], v[192:207]
  s_add_u32 s32, s29, 28672
  buffer_load_dwordx4 v[128:131], v1, s[4:7], s32 offen offset:0 sc1
  ds_read_b64_tr_b16 v[216:217], v10 offset:40960
  ds_read_b64_tr_b16 v[218:219], v10 offset:41216
  v_mfma_f32_32x32x16_bf16 v[176:191], v[224:227], v[72:75], v[176:191]
  ds_read_b64_tr_b16 v[220:221], v11 offset:40960
  ds_read_b64_tr_b16 v[222:223], v11 offset:41216
  v_mfma_f32_32x32x16_bf16 v[192:207], v[228:231], v[72:75], v[192:207]
  buffer_load_dwordx4 v[132:135], v1, s[4:7], s32 offen offset:1024 sc1
  ds_read_b64_tr_b16 v[224:225], v10 offset:45056
  ds_read_b64_tr_b16 v[226:227], v10 offset:45312
  s_waitcnt vmcnt(10)
  v_max3_u32 v15, v80, v84, v88
  v_max_u32 v15, v15, v92
  s_waitcnt lgkmcnt(4)
  v_mfma_f32_32x32x16_bf16 v[176:191], v[208:211], v[76:79], v[176:191]
  ds_read_b64_tr_b16 v[228:229], v11 offset:45056
  ds_read_b64_tr_b16 v[230:231], v11 offset:45312
  v_cmp_eq_u32 vcc, -1, v15
  v_mfma_f32_32x32x16_bf16 v[192:207], v[212:215], v[76:79], v[192:207]
  buffer_load_dwordx4 v[136:139], v1, s[4:7], s32 offen offset:2048 sc1
  ds_read_b64_tr_b16 v[208:209], v10 offset:49152
  ds_read_b64_tr_b16 v[210:211], v10 offset:49408
  s_cbranch_vccnz L_pl_145
L_plb_146:
  v_mfma_f32_32x32x16_bf16 v[176:191], v[216:219], v[80:83], v[176:191]
  ds_read_b64_tr_b16 v[212:213], v11 offset:49152
  ds_read_b64_tr_b16 v[214:215], v11 offset:49408
  ds_read_b32 v7, v14 offset:1728
  s_waitcnt lgkmcnt(5)
  v_mfma_f32_32x32x16_bf16 v[192:207], v[220:223], v[80:83], v[192:207]
  buffer_load_dwordx4 v[140:143], v1, s[4:7], s32 offen offset:3072 sc1
  ds_read_b64_tr_b16 v[216:217], v10 offset:53248
  ds_read_b64_tr_b16 v[218:219], v10 offset:53504
  v_mfma_f32_32x32x16_bf16 v[176:191], v[224:227], v[84:87], v[176:191]
  ds_read_b64_tr_b16 v[220:221], v11 offset:53248
  ds_read_b64_tr_b16 v[222:223], v11 offset:53504
  v_mfma_f32_32x32x16_bf16 v[192:207], v[228:231], v[84:87], v[192:207]
  ds_read_b64_tr_b16 v[224:225], v10 offset:57344
  ds_read_b64_tr_b16 v[226:227], v10 offset:57600
  s_waitcnt lgkmcnt(4)
  v_mfma_f32_32x32x16_bf16 v[176:191], v[208:211], v[88:91], v[176:191]
  s_add_u32 s32, s29, 32768
  buffer_load_dwordx4 v[16:19], v1, s[4:7], s32 offen offset:0 sc1
  ds_read_b64_tr_b16 v[228:229], v11 offset:57344
  ds_read_b64_tr_b16 v[230:231], v11 offset:57600
  v_mfma_f32_32x32x16_bf16 v[192:207], v[212:215], v[88:91], v[192:207]
  ds_read_b64_tr_b16 v[208:209], v10 offset:61440
  ds_read_b64_tr_b16 v[210:211], v10 offset:61696
  s_waitcnt vmcnt(9)
  v_max3_u32 v15, v96, v100, v104
  v_max_u32 v15, v15, v108
  v_mfma_f32_32x32x16_bf16 v[176:191], v[216:219], v[92:95], v[176:191]
  buffer_load_dwordx4 v[20:23], v1, s[4:7], s32 offen offset:1024 sc1
  ds_read_b64_tr_b16 v[212:213], v11 offset:61440
  ds_read_b64_tr_b16 v[214:215], v11 offset:61696
  v_cmp_eq_u32 s[30:31], -1, v15
  ds_write_b32 v5, v247 offset:896
  v_cmp_gt_u32 vcc, v247, v7
  s_cbranch_vccnz L_lsl_150
L_lbk_151:
  v_add_u32 v10, 0x10000, v10
  v_add_u32 v11, 0x10000, v11
  s_waitcnt lgkmcnt(5)
  v_mfma_f32_32x32x16_bf16 v[192:207], v[220:223], v[92:95], v[192:207]
  ds_read_b64_tr_b16 v[216:217], v10 offset:0
  ds_read_b64_tr_b16 v[218:219], v10 offset:256
  s_cmp_lg_u64 s[30:31], 0
  s_cbranch_scc1 L_pl_152
L_plb_153:
  v_mfma_f32_32x32x16_bf16 v[176:191], v[224:227], v[96:99], v[176:191]
  buffer_load_dwordx4 v[24:27], v1, s[4:7], s32 offen offset:2048 sc1
  ds_read_b64_tr_b16 v[220:221], v11 offset:0
  ds_read_b64_tr_b16 v[222:223], v11 offset:256
  v_mfma_f32_32x32x16_bf16 v[192:207], v[228:231], v[96:99], v[192:207]
  ds_read_b64_tr_b16 v[224:225], v10 offset:4096
  ds_read_b64_tr_b16 v[226:227], v10 offset:4352
  s_waitcnt lgkmcnt(4)
  v_mfma_f32_32x32x16_bf16 v[176:191], v[208:211], v[100:103], v[176:191]
  buffer_load_dwordx4 v[28:31], v1, s[4:7], s32 offen offset:3072 sc1
  ds_read_b64_tr_b16 v[228:229], v11 offset:4096
  ds_read_b64_tr_b16 v[230:231], v11 offset:4352
  v_mfma_f32_32x32x16_bf16 v[192:207], v[212:215], v[100:103], v[192:207]
  ds_read_b64_tr_b16 v[208:209], v10 offset:8192
  ds_read_b64_tr_b16 v[210:211], v10 offset:8448
  v_mfma_f32_32x32x16_bf16 v[176:191], v[216:219], v[104:107], v[176:191]
  s_add_u32 s32, s29, 36864
  buffer_load_dwordx4 v[32:35], v1, s[4:7], s32 offen offset:0 sc1
  ds_read_b64_tr_b16 v[212:213], v11 offset:8192
  ds_read_b64_tr_b16 v[214:215], v11 offset:8448
  s_waitcnt lgkmcnt(4)
  v_mfma_f32_32x32x16_bf16 v[192:207], v[220:223], v[104:107], v[192:207]
  ds_read_b64_tr_b16 v[216:217], v10 offset:12288
  ds_read_b64_tr_b16 v[218:219], v10 offset:12544
  s_waitcnt vmcnt(9)
  v_max3_u32 v15, v112, v116, v120
  v_max_u32 v15, v15, v124
  v_mfma_f32_32x32x16_bf16 v[176:191], v[224:227], v[108:111], v[176:191]
  buffer_load_dwordx4 v[36:39], v1, s[4:7], s32 offen offset:1024 sc1
  ds_read_b64_tr_b16 v[220:221], v11 offset:12288
  ds_read_b64_tr_b16 v[222:223], v11 offset:12544
  v_cmp_eq_u32 vcc, -1, v15
  ds_write_b32 v5, v247 offset:960
  v_mfma_f32_32x32x16_bf16 v[192:207], v[228:231], v[108:111], v[192:207]
  ds_read_b64_tr_b16 v[224:225], v10 offset:32768
  ds_read_b64_tr_b16 v[226:227], v10 offset:33024
  s_cbranch_vccnz L_pl_157
L_plb_158:
  s_waitcnt lgkmcnt(5)
  v_mfma_f32_32x32x16_bf16 v[176:191], v[208:211], v[112:115], v[176:191]
  buffer_load_dwordx4 v[40:43], v1, s[4:7], s32 offen offset:2048 sc1
  ds_read_b64_tr_b16 v[228:229], v11 offset:32768
  ds_read_b64_tr_b16 v[230:231], v11 offset:33024
  ds_read_b32 v7, v14 offset:1792
  v_mfma_f32_32x32x16_bf16 v[192:207], v[212:215], v[112:115], v[192:207]
  ds_read_b64_tr_b16 v[208:209], v10 offset:36864
  ds_read_b64_tr_b16 v[210:211], v10 offset:37120
  v_mfma_f32_32x32x16_bf16 v[176:191], v[216:219], v[116:119], v[176:191]
  buffer_load_dwordx4 v[44:47], v1, s[4:7], s32 offen offset:3072 sc1
  ds_read_b64_tr_b16 v[212:213], v11 offset:36864
  ds_read_b64_tr_b16 v[214:215], v11 offset:37120
  s_waitcnt lgkmcnt(5)
  v_mfma_f32_32x32x16_bf16 v[192:207], v[220:223], v[116:119], v[192:207]
  ds_read_b64_tr_b16 v[216:217], v10 offset:40960
  ds_read_b64_tr_b16 v[218:219], v10 offset:41216
  v_mfma_f32_32x32x16_bf16 v[176:191], v[224:227], v[120:123], v[176:191]
  s_add_u32 s32, s29, 40960
  buffer_load_dwordx4 v[48:51], v1, s[4:7], s32 offen offset:0 sc1
  ds_read_b64_tr_b16 v[220:221], v11 offset:40960
  ds_read_b64_tr_b16 v[222:223], v11 offset:41216
  v_mfma_f32_32x32x16_bf16 v[192:207], v[228:231], v[120:123], v[192:207]
  ds_read_b64_tr_b16 v[224:225], v10 offset:45056
  ds_read_b64_tr_b16 v[226:227], v10 offset:45312
  s_waitcnt vmcnt(9)
  v_max3_u32 v15, v128, v132, v136
  v_max_u32 v15, v15, v140
  s_waitcnt lgkmcnt(4)
  v_mfma_f32_32x32x16_bf16 v[176:191], v[208:211], v[124:127], v[176:191]
  buffer_load_dwordx4 v[52:55], v1, s[4:7], s32 offen offset:1024 sc1
  ds_read_b64_tr_b16 v[228:229], v11 offset:45056
  ds_read_b64_tr_b16 v[230:231], v11 offset:45312
  v_cmp_eq_u32 s[30:31], -1, v15
  v_cmp_gt_u32 vcc, v247, v7
  s_cbranch_vccnz L_lsl_162
L_lbk_163:
  v_mfma_f32_32x32x16_bf16 v[192:207], v[212:215], v[124:127], v[192:207]
  ds_read_b64_tr_b16 v[208:209], v10 offset:16384
  ds_read_b64_tr_b16 v[210:211], v10 offset:16640
  s_cmp_lg_u64 s[30:31], 0
  s_cbranch_scc1 L_pl_164
L_plb_165:
  v_mfma_f32_32x32x16_bf16 v[176:191], v[216:219], v[128:131], v[176:191]
  buffer_load_dwordx4 v[56:59], v1, s[4:7], s32 offen offset:2048 sc1
  ds_read_b64_tr_b16 v[212:213], v11 offset:16384
  ds_read_b64_tr_b16 v[214:215], v11 offset:16640
  s_waitcnt lgkmcnt(4)
  v_mfma_f32_32x32x16_bf16 v[192:207], v[220:223], v[128:131], v[192:207]
  ds_read_b64_tr_b16 v[216:217], v10 offset:20480
  ds_read_b64_tr_b16 v[218:219], v10 offset:20736
  v_mfma_f32_32x32x16_bf16 v[176:191], v[224:227], v[132:135], v[176:191]
  ds_read_b64_tr_b16 v[220:221], v11 offset:20480
  ds_read_b64_tr_b16 v[222:223], v11 offset:20736
  v_mfma_f32_32x32x16_bf16 v[192:207], v[228:231], v[132:135], v[192:207]
  ds_read_b64_tr_b16 v[224:225], v10 offset:24576
  ds_read_b64_tr_b16 v[226:227], v10 offset:24832
  s_waitcnt lgkmcnt(4)
  v_mfma_f32_32x32x16_bf16 v[176:191], v[208:211], v[136:139], v[176:191]
  ds_read_b64_tr_b16 v[228:229], v11 offset:24576
  ds_read_b64_tr_b16 v[230:231], v11 offset:24832
  v_mfma_f32_32x32x16_bf16 v[192:207], v[212:215], v[136:139], v[192:207]
  ds_read_b64_tr_b16 v[208:209], v10 offset:28672
  ds_read_b64_tr_b16 v[210:211], v10 offset:28928
  ds_read_b32 v7, v14 offset:1856
  s_waitcnt vmcnt(8)
  v_max3_u32 v15, v16, v20, v24
  v_mfma_f32_32x32x16_bf16 v[176:191], v[216:219], v[140:143], v[176:191]
  ds_read_b64_tr_b16 v[212:213], v11 offset:28672
  ds_read_b64_tr_b16 v[214:215], v11 offset:28928
  v_cmp_eq_u32 vcc, -1, v15
  v_add_u32 v10, 0x6000, v10
  v_add_u32 v11, 0x6000, v11
  s_waitcnt lgkmcnt(5)
  v_mfma_f32_32x32x16_bf16 v[192:207], v[220:223], v[140:143], v[192:207]
  ds_read_b64_tr_b16 v[216:217], v10 offset:24576
  ds_read_b64_tr_b16 v[218:219], v10 offset:24832
  ds_write_b32 v5, v247 offset:2368
  s_cbranch_vccnz L_pl_169
L_plb_170:
  v_mfma_f32_32x32x16_bf16 v[176:191], v[224:227], v[16:19], v[176:191]
  ds_read_b64_tr_b16 v[220:221], v11 offset:24576
  ds_read_b64_tr_b16 v[222:223], v11 offset:24832
  v_mfma_f32_32x32x16_bf16 v[192:207], v[228:231], v[16:19], v[192:207]
  ds_read_b64_tr_b16 v[224:225], v11 offset:28672
  ds_read_b64_tr_b16 v[226:227], v11 offset:28928
  s_waitcnt lgkmcnt(5)
  v_mfma_f32_32x32x16_bf16 v[176:191], v[208:211], v[20:23], v[176:191]
  ds_read_b64_tr_b16 v[228:229], v11 offset:32768
  ds_read_b64_tr_b16 v[230:231], v11 offset:33024
  v_mfma_f32_32x32x16_bf16 v[192:207], v[212:215], v[20:23], v[192:207]
  ds_read_b64_tr_b16 v[208:209], v11 offset:36864
  ds_read_b64_tr_b16 v[210:211], v11 offset:37120
  s_waitcnt vmcnt(4)
  v_max3_u32 v15, v28, v32, v36
  v_max_u32 v15, v15, v40
  v_cmp_gt_u32 vcc, v247, v7
  s_cbranch_vccnz L_lsl_173
L_lbk_174:
  v_mfma_f32_32x32x16_bf16 v[176:191], v[216:219], v[24:27], v[176:191]
  ds_read_b64_tr_b16 v[212:213], v11 offset:40960
  ds_read_b64_tr_b16 v[214:215], v11 offset:41216
  v_cmp_eq_u32 vcc, -1, v15
  s_waitcnt lgkmcnt(4)
  v_mfma_f32_32x32x16_bf16 v[192:207], v[220:223], v[24:27], v[192:207]
  ds_read_b64_tr_b16 v[216:217], v11 offset:45056
  ds_read_b64_tr_b16 v[218:219], v11 offset:45312
  s_cbranch_vccnz L_pl_175
L_plb_176:
  v_mfma_f32_32x32x16_bf16 v[192:207], v[224:227], v[28:31], v[192:207]
  ds_read_b64_tr_b16 v[220:221], v11 offset:49152
  ds_read_b64_tr_b16 v[222:223], v11 offset:49408
  v_mfma_f32_32x32x16_bf16 v[192:207], v[228:231], v[32:35], v[192:207]
  ds_read_b64_tr_b16 v[224:225], v11 offset:53248
  ds_read_b64_tr_b16 v[226:227], v11 offset:53504
  s_waitcnt vmcnt(0)
  v_max3_u32 v15, v44, v48, v52
  v_max_u32 v15, v15, v56
  s_waitcnt lgkmcnt(4)
  v_mfma_f32_32x32x16_bf16 v[192:207], v[208:211], v[36:39], v[192:207]
  ds_read_b64_tr_b16 v[228:229], v11 offset:57344
  ds_read_b64_tr_b16 v[230:231], v11 offset:57600
  v_cmp_eq_u32 vcc, -1, v15
  v_mfma_f32_32x32x16_bf16 v[192:207], v[212:215], v[40:43], v[192:207]
  ds_read_b64_tr_b16 v[208:209], v10 offset:28672
  ds_read_b64_tr_b16 v[210:211], v10 offset:28928
  s_cbranch_vccnz L_pl_178
L_plb_179:
  v_mfma_f32_32x32x16_bf16 v[192:207], v[216:219], v[44:47], v[192:207]
  ds_read_b64_tr_b16 v[212:213], v10 offset:32768
  ds_read_b64_tr_b16 v[214:215], v10 offset:33024
  ds_read_b32 v7, v14 offset:960
  s_waitcnt lgkmcnt(5)
  v_mfma_f32_32x32x16_bf16 v[192:207], v[220:223], v[48:51], v[192:207]
  ds_read_b64_tr_b16 v[216:217], v10 offset:36864
  ds_read_b64_tr_b16 v[218:219], v10 offset:37120
  v_mfma_f32_32x32x16_bf16 v[192:207], v[224:227], v[52:55], v[192:207]
  ds_read_b64_tr_b16 v[220:221], v10 offset:40960
  ds_read_b64_tr_b16 v[222:223], v10 offset:41216
  v_mfma_f32_32x32x16_bf16 v[192:207], v[228:231], v[56:59], v[192:207]
  ds_read_b64_tr_b16 v[224:225], v10 offset:45056
  ds_read_b64_tr_b16 v[226:227], v10 offset:45312
  s_waitcnt lgkmcnt(4)
  v_mfma_f32_32x32x16_bf16 v[176:191], v[208:211], v[28:31], v[176:191]
  ds_read_b64_tr_b16 v[228:229], v10 offset:49152
  ds_read_b64_tr_b16 v[230:231], v10 offset:49408
  v_mfma_f32_32x32x16_bf16 v[176:191], v[212:215], v[32:35], v[176:191]
  ds_read_b64_tr_b16 v[208:209], v10 offset:53248
  ds_read_b64_tr_b16 v[210:211], v10 offset:53504
  v_cmp_gt_u32 vcc, v247, v7
  s_cbranch_vccnz L_lsl_180
L_lbk_181:
  ds_write_b128 v12, v[192:195] offset:0
  ds_write_b128 v12, v[196:199] offset:1024
  ds_write_b128 v12, v[200:203] offset:2048
  ds_write_b128 v12, v[204:207] offset:3072
  ds_write_b32 v5, v247 offset:1024
  v_mfma_f32_32x32x16_bf16 v[176:191], v[216:219], v[36:39], v[176:191]
  ds_read_b64_tr_b16 v[212:213], v10 offset:57344
  ds_read_b64_tr_b16 v[214:215], v10 offset:57600
  s_waitcnt lgkmcnt(9)
  v_mfma_f32_32x32x16_bf16 v[176:191], v[220:223], v[40:43], v[176:191]
  v_mfma_f32_32x32x16_bf16 v[176:191], v[224:227], v[44:47], v[176:191]
  v_mfma_f32_32x32x16_bf16 v[176:191], v[228:231], v[48:51], v[176:191]
  ds_read_b32 v7, v14 offset:1024
  ds_read_b128 v[144:147], v13 offset:0
  ds_read_b128 v[148:151], v13 offset:1024
  ds_read_b128 v[152:155], v13 offset:2048
  ds_read_b128 v[156:159], v13 offset:3072
  s_waitcnt lgkmcnt(5)
  v_mfma_f32_32x32x16_bf16 v[176:191], v[208:211], v[52:55], v[176:191]
  v_mfma_f32_32x32x16_bf16 v[176:191], v[212:215], v[56:59], v[176:191]
  s_nop 11
  s_branch L_p4done
L_light:
  s_waitcnt lgkmcnt(0)
  v_pk_mul_f32 v[248:249], v[176:177], v[176:177]
  v_pk_mul_f32 v[250:251], v[178:179], v[178:179]
  v_pk_mul_f32 v[252:253], v[180:181], v[180:181]
  v_pk_mul_f32 v[254:255], v[182:183], v[182:183]
  v_pk_fma_f32 v[248:249], v[248:249], v[244:245], v[244:245] op_sel:[0,1,0] op_sel_hi:[1,1,0]
  v_pk_fma_f32 v[250:251], v[250:251], v[244:245], v[244:245] op_sel:[0,1,0] op_sel_hi:[1,1,0]
  v_pk_fma_f32 v[252:253], v[252:253], v[244:245], v[244:245] op_sel:[0,1,0] op_sel_hi:[1,1,0]
  v_pk_fma_f32 v[254:255], v[254:255], v[244:245], v[244:245] op_sel:[0,1,0] op_sel_hi:[1,1,0]
  v_pk_mul_f32 v[248:249], v[248:249], v[176:177]
  v_pk_mul_f32 v[250:251], v[250:251], v[178:179]
  v_pk_mul_f32 v[252:253], v[252:253], v[180:181]
  v_pk_mul_f32 v[254:255], v[254:255], v[182:183]
  v_exp_f32 v248, v248
  v_exp_f32 v249, v249
  v_exp_f32 v250, v250
  v_exp_f32 v251, v251
  v_exp_f32 v252, v252
  v_exp_f32 v253, v253
  v_exp_f32 v254, v254
  v_exp_f32 v255, v255
  v_pk_mul_f32 v[192:193], v[192:193], v[176:177]
  v_pk_mul_f32 v[194:195], v[194:195], v[178:179]
  v_pk_mul_f32 v[196:197], v[196:197], v[180:181]
  v_pk_mul_f32 v[198:199], v[198:199], v[182:183]
  v_pk_fma_f32 v[248:249], v[248:249], v[246:247], v[246:247] op_sel_hi:[1,0,0]
  v_pk_fma_f32 v[250:251], v[250:251], v[246:247], v[246:247] op_sel_hi:[1,0,0]
  v_pk_fma_f32 v[252:253], v[252:253], v[246:247], v[246:247] op_sel_hi:[1,0,0]
  v_pk_fma_f32 v[254:255], v[254:255], v[246:247], v[246:247] op_sel_hi:[1,0,0]
  v_rcp_f32 v248, v248
  v_rcp_f32 v249, v249
  v_rcp_f32 v250, v250
  v_rcp_f32 v251, v251
  v_rcp_f32 v252, v252
  v_rcp_f32 v253, v253
  v_rcp_f32 v254, v254
  v_rcp_f32 v255, v255
  v_pk_mul_f32 v[192:193], v[192:193], v[248:249]
  v_pk_mul_f32 v[194:195], v[194:195], v[250:251]
  v_pk_mul_f32 v[196:197], v[196:197], v[252:253]
  v_pk_mul_f32 v[198:199], v[198:199], v[254:255]
  v_cvt_pk_bf16_f32 v176, v192, v193
  v_cvt_pk_bf16_f32 v177, v194, v195
  v_cvt_pk_bf16_f32 v178, v196, v197
  v_cvt_pk_bf16_f32 v179, v198, v199
  v_pk_mul_f32 v[248:249], v[184:185], v[184:185]
  v_pk_mul_f32 v[250:251], v[186:187], v[186:187]
  v_pk_mul_f32 v[252:253], v[188:189], v[188:189]
  v_pk_mul_f32 v[254:255], v[190:191], v[190:191]
  v_pk_fma_f32 v[248:249], v[248:249], v[244:245], v[244:245] op_sel:[0,1,0] op_sel_hi:[1,1,0]
  v_pk_fma_f32 v[250:251], v[250:251], v[244:245], v[244:245] op_sel:[0,1,0] op_sel_hi:[1,1,0]
  v_pk_fma_f32 v[252:253], v[252:253], v[244:245], v[244:245] op_sel:[0,1,0] op_sel_hi:[1,1,0]
  v_pk_fma_f32 v[254:255], v[254:255], v[244:245], v[244:245] op_sel:[0,1,0] op_sel_hi:[1,1,0]
  v_pk_mul_f32 v[248:249], v[248:249], v[184:185]
  v_pk_mul_f32 v[250:251], v[250:251], v[186:187]
  v_pk_mul_f32 v[252:253], v[252:253], v[188:189]
  v_pk_mul_f32 v[254:255], v[254:255], v[190:191]
  v_exp_f32 v248, v248
  v_exp_f32 v249, v249
  v_exp_f32 v250, v250
  v_exp_f32 v251, v251
  v_exp_f32 v252, v252
  v_exp_f32 v253, v253
  v_exp_f32 v254, v254
  v_exp_f32 v255, v255
  v_pk_mul_f32 v[200:201], v[200:201], v[184:185]
  v_pk_mul_f32 v[202:203], v[202:203], v[186:187]
  v_pk_mul_f32 v[204:205], v[204:205], v[188:189]
  v_pk_mul_f32 v[206:207], v[206:207], v[190:191]
  v_pk_fma_f32 v[248:249], v[248:249], v[246:247], v[246:247] op_sel_hi:[1,0,0]
  v_pk_fma_f32 v[250:251], v[250:251], v[246:247], v[246:247] op_sel_hi:[1,0,0]
  v_pk_fma_f32 v[252:253], v[252:253], v[246:247], v[246:247] op_sel_hi:[1,0,0]
  v_pk_fma_f32 v[254:255], v[254:255], v[246:247], v[246:247] op_sel_hi:[1,0,0]
  v_rcp_f32 v248, v248
  v_rcp_f32 v249, v249
  v_rcp_f32 v250, v250
  v_rcp_f32 v251, v251
  v_rcp_f32 v252, v252
  v_rcp_f32 v253, v253
  v_rcp_f32 v254, v254
  v_rcp_f32 v255, v255
  v_pk_mul_f32 v[200:201], v[200:201], v[248:249]
  v_pk_mul_f32 v[202:203], v[202:203], v[250:251]
  v_pk_mul_f32 v[204:205], v[204:205], v[252:253]
  v_pk_mul_f32 v[206:207], v[206:207], v[254:255]
  v_cvt_pk_bf16_f32 v180, v200, v201
  v_cvt_pk_bf16_f32 v181, v202, v203
  v_cvt_pk_bf16_f32 v182, v204, v205
  v_cvt_pk_bf16_f32 v183, v206, v207
  s_add_u32 s46, s28, 16384
  s_add_u32 s47, s28, 60416
  buffer_store_dwordx4 v[176:179], v1, s[4:7], s46 offen
  buffer_store_dwordx4 v[180:183], v1, s[4:7], s47 offen
  ds_read_b32 v7, v14 offset:1664
  s_lshl_b32 s47, s14, 12
  s_xor_b32 s48, s47, 8192
  s_add_u32 s47, s47, 73728
  s_add_u32 s48, s48, 73728
  v_add_u32 v12, s47, v1
  v_add_u32 v13, s48, v1
  v_lshlrev_b32 v176, 16, v232
  v_and_b32 v177, s54, v232
  v_lshlrev_b32 v178, 16, v233
  v_and_b32 v179, s54, v233
  v_lshlrev_b32 v180, 16, v234
  v_and_b32 v181, s54, v234
  v_lshlrev_b32 v182, 16, v235
  v_and_b32 v183, s54, v235
  v_lshlrev_b32 v184, 16, v236
  v_and_b32 v185, s54, v236
  v_lshlrev_b32 v186, 16, v237
  v_and_b32 v187, s54, v237
  v_lshlrev_b32 v188, 16, v238
  v_and_b32 v189, s54, v238
  v_lshlrev_b32 v190, 16, v239
  v_and_b32 v191, s54, v239
  buffer_load_dwordx4 v[16:19], v1, s[4:7], s29 offen offset:0 sc1
  buffer_load_dwordx4 v[20:23], v1, s[4:7], s29 offen offset:1024 sc1
  buffer_load_dwordx4 v[24:27], v1, s[4:7], s29 offen offset:2048 sc1
  buffer_load_dwordx4 v[28:31], v1, s[4:7], s29 offen offset:3072 sc1
  s_add_u32 s44, s29, 4096
  buffer_load_dwordx4 v[32:35], v1, s[4:7], s44 offen offset:0 sc1
  buffer_load_dwordx4 v[36:39], v1, s[4:7], s44 offen offset:1024 sc1
  buffer_load_dwordx4 v[40:43], v1, s[4:7], s44 offen offset:2048 sc1
  buffer_load_dwordx4 v[44:47], v1, s[4:7], s44 offen offset:3072 sc1
  s_add_u32 s45, s29, 8192
  buffer_load_dwordx4 v[48:51], v1, s[4:7], s45 offen offset:0 sc1
  buffer_load_dwordx4 v[52:55], v1, s[4:7], s45 offen offset:1024 sc1
  buffer_load_dwordx4 v[56:59], v1, s[4:7], s45 offen offset:2048 sc1
  buffer_load_dwordx4 v[60:63], v1, s[4:7], s45 offen offset:3072 sc1
  s_add_u32 s44, s29, 12288
  buffer_load_dwordx4 v[64:67], v1, s[4:7], s44 offen offset:0 sc1
  buffer_load_dwordx4 v[68:71], v1, s[4:7], s44 offen offset:1024 sc1
  buffer_load_dwordx4 v[72:75], v1, s[4:7], s44 offen offset:2048 sc1
  buffer_load_dwordx4 v[76:79], v1, s[4:7], s44 offen offset:3072 sc1
  s_waitcnt lgkmcnt(0)
  v_cmp_gt_u32 vcc, v247, v7
  s_cbranch_vccnz L_lsl_182
L_lbk_183:
  s_lshr_b32 s46, s14, 1
  s_mul_i32 s47, s46, 2560
  s_add_u32 s47, s47, 98304
  s_xor_b32 s48, s47, 512
  v_add_u32 v10, s47, v0
  v_add_u32 v11, s48, v0
  ds_read_b64_tr_b16 v[208:209], v10 offset:40960
  ds_read_b64_tr_b16 v[210:211], v10 offset:41216
  ds_read_b64_tr_b16 v[212:213], v11 offset:40960
  ds_read_b64_tr_b16 v[214:215], v11 offset:41216
  ds_read_b64_tr_b16 v[216:217], v10 offset:45056
  ds_read_b64_tr_b16 v[218:219], v10 offset:45312
  ds_read_b64_tr_b16 v[220:221], v11 offset:45056
  ds_read_b64_tr_b16 v[222:223], v11 offset:45312
  ds_read_b64_tr_b16 v[224:225], v10 offset:49152
  ds_read_b64_tr_b16 v[226:227], v10 offset:49408
  s_waitcnt vmcnt(14)
  v_max_u32 v15, v16, v20
  v_cmp_eq_u32 vcc, -1, v15
  s_cbranch_vccnz L_pl_184
L_plb_185:
  s_waitcnt lgkmcnt(4)
  v_mfma_f32_32x32x16_bf16 v[176:191], v[208:211], v[16:19], v[176:191]
  ds_read_b64_tr_b16 v[228:229], v11 offset:49152
  ds_read_b64_tr_b16 v[230:231], v11 offset:49408
  v_mfma_f32_32x32x16_bf16 v[192:207], v[212:215], v[16:19], 0
  ds_read_b64_tr_b16 v[208:209], v10 offset:53248
  ds_read_b64_tr_b16 v[210:211], v10 offset:53504
  s_waitcnt vmcnt(12)
  v_max_u32 v15, v24, v28
  v_mfma_f32_32x32x16_bf16 v[176:191], v[216:219], v[20:23], v[176:191]
  ds_read_b64_tr_b16 v[212:213], v11 offset:53248
  ds_read_b64_tr_b16 v[214:215], v11 offset:53504
  v_cmp_eq_u32 vcc, -1, v15
  s_waitcnt lgkmcnt(4)
  v_mfma_f32_32x32x16_bf16 v[192:207], v[220:223], v[20:23], v[192:207]
  s_add_u32 s32, s29, 16384
  buffer_load_dwordx4 v[80:83], v1, s[4:7], s32 offen offset:0 sc1
  ds_read_b64_tr_b16 v[216:217], v10 offset:57344
  ds_read_b64_tr_b16 v[218:219], v10 offset:57600
  s_cbranch_vccnz L_pl_190
L_plb_191:
  v_mfma_f32_32x32x16_bf16 v[176:191], v[224:227], v[24:27], v[176:191]
  ds_read_b64_tr_b16 v[220:221], v11 offset:57344
  ds_read_b64_tr_b16 v[222:223], v11 offset:57600
  v_mfma_f32_32x32x16_bf16 v[192:207], v[228:231], v[24:27], v[192:207]
  buffer_load_dwordx4 v[84:87], v1, s[4:7], s32 offen offset:1024 sc1
  ds_read_b64_tr_b16 v[224:225], v10 offset:61440
  ds_read_b64_tr_b16 v[226:227], v10 offset:61696
  s_waitcnt vmcnt(10)
  v_max3_u32 v15, v32, v36, v40
  v_max_u32 v15, v15, v44
  s_waitcnt lgkmcnt(4)
  v_mfma_f32_32x32x16_bf16 v[176:191], v[208:211], v[28:31], v[176:191]
  ds_read_b64_tr_b16 v[228:229], v11 offset:61440
  ds_read_b64_tr_b16 v[230:231], v11 offset:61696
  v_cmp_eq_u32 vcc, -1, v15
  ds_write_b32 v5, v247 offset:832
  v_add_u32 v10, 0xfffea000, v10
  v_add_u32 v11, 0xfffea000, v11
  v_mfma_f32_32x32x16_bf16 v[192:207], v[212:215], v[28:31], v[192:207]
  buffer_load_dwordx4 v[88:91], v1, s[4:7], s32 offen offset:2048 sc1
  ds_read_b64_tr_b16 v[208:209], v10 offset:0
  ds_read_b64_tr_b16 v[210:211], v10 offset:256
  s_cbranch_vccnz L_pl_196
L_plb_197:
  v_mfma_f32_32x32x16_bf16 v[176:191], v[216:219], v[32:35], v[176:191]
  ds_read_b64_tr_b16 v[212:213], v11 offset:0
  ds_read_b64_tr_b16 v[214:215], v11 offset:256
  s_waitcnt lgkmcnt(5)
  v_mfma_f32_32x32x16_bf16 v[192:207], v[220:223], v[32:35], v[192:207]
  buffer_load_dwordx4 v[92:95], v1, s[4:7], s32 offen offset:3072 sc1
  ds_read_b64_tr_b16 v[216:217], v10 offset:4096
  ds_read_b64_tr_b16 v[218:219], v10 offset:4352
  v_mfma_f32_32x32x16_bf16 v[176:191], v[224:227], v[36:39], v[176:191]
  ds_read_b64_tr_b16 v[220:221], v11 offset:4096
  ds_read_b64_tr_b16 v[222:223], v11 offset:4352
  v_mfma_f32_32x32x16_bf16 v[192:207], v[228:231], v[36:39], v[192:207]
  s_add_u32 s32, s29, 20480
  buffer_load_dwordx4 v[96:99], v1, s[4:7], s32 offen offset:0 sc1
  ds_read_b64_tr_b16 v[224:225], v10 offset:8192
  ds_read_b64_tr_b16 v[226:227], v10 offset:8448
  s_waitcnt lgkmcnt(4)
  v_mfma_f32_32x32x16_bf16 v[176:191], v[208:211], v[40:43], v[176:191]
  ds_read_b64_tr_b16 v[228:229], v11 offset:8192
  ds_read_b64_tr_b16 v[230:231], v11 offset:8448
  v_mfma_f32_32x32x16_bf16 v[192:207], v[212:215], v[40:43], v[192:207]
  buffer_load_dwordx4 v[100:103], v1, s[4:7], s32 offen offset:1024 sc1
  ds_read_b64_tr_b16 v[208:209], v10 offset:12288
  ds_read_b64_tr_b16 v[210:211], v10 offset:12544
  s_waitcnt vmcnt(10)
  v_max3_u32 v15, v48, v52, v56
  v_max_u32 v15, v15, v60
  v_mfma_f32_32x32x16_bf16 v[176:191], v[216:219], v[44:47], v[176:191]
  ds_read_b64_tr_b16 v[212:213], v11 offset:12288
  ds_read_b64_tr_b16 v[214:215], v11 offset:12544
  v_cmp_eq_u32 vcc, -1, v15
  s_waitcnt lgkmcnt(4)
  v_mfma_f32_32x32x16_bf16 v[192:207], v[220:223], v[44:47], v[192:207]
  buffer_load_dwordx4 v[104:107], v1, s[4:7], s32 offen offset:2048 sc1
  ds_read_b64_tr_b16 v[216:217], v10 offset:16384
  ds_read_b64_tr_b16 v[218:219], v10 offset:16640
  s_cbranch_vccnz L_pl_201
L_plb_202:
  v_mfma_f32_32x32x16_bf16 v[176:191], v[224:227], v[48:51], v[176:191]
  ds_read_b64_tr_b16 v[220:221], v11 offset:16384
  ds_read_b64_tr_b16 v[222:223], v11 offset:16640
  v_mfma_f32_32x32x16_bf16 v[192:207], v[228:231], v[48:51], v[192:207]
  buffer_load_dwordx4 v[108:111], v1, s[4:7], s32 offen offset:3072 sc1
  ds_read_b64_tr_b16 v[224:225], v10 offset:20480
  ds_read_b64_tr_b16 v[226:227], v10 offset:20736
  s_waitcnt lgkmcnt(4)
  v_mfma_f32_32x32x16_bf16 v[176:191], v[208:211], v[52:55], v[176:191]
  ds_read_b64_tr_b16 v[228:229], v11 offset:20480
  ds_read_b64_tr_b16 v[230:231], v11 offset:20736
  v_mfma_f32_32x32x16_bf16 v[192:207], v[212:215], v[52:55], v[192:207]
  s_add_u32 s32, s29, 24576
  buffer_load_dwordx4 v[112:115], v1, s[4:7], s32 offen offset:0 sc1
  ds_read_b64_tr_b16 v[208:209], v10 offset:24576
  ds_read_b64_tr_b16 v[210:211], v10 offset:24832
  v_mfma_f32_32x32x16_bf16 v[176:191], v[216:219], v[56:59], v[176:191]
  ds_read_b64_tr_b16 v[212:213], v11 offset:24576
  ds_read_b64_tr_b16 v[214:215], v11 offset:24832
  s_waitcnt lgkmcnt(4)
  v_mfma_f32_32x32x16_bf16 v[192:207], v[220:223], v[56:59], v[192:207]
  buffer_load_dwordx4 v[116:119], v1, s[4:7], s32 offen offset:1024 sc1
  ds_read_b64_tr_b16 v[216:217], v10 offset:28672
  ds_read_b64_tr_b16 v[218:219], v10 offset:28928
  s_waitcnt vmcnt(10)
  v_max3_u32 v15, v64, v68, v72
  v_max_u32 v15, v15, v76
  v_mfma_f32_32x32x16_bf16 v[176:191], v[224:227], v[60:63], v[176:191]
  ds_read_b64_tr_b16 v[220:221], v11 offset:28672
  ds_read_b64_tr_b16 v[222:223], v11 offset:28928
  v_cmp_eq_u32 vcc, -1, v15
  v_mfma_f32_32x32x16_bf16 v[192:207], v[228:231], v[60:63], v[192:207]
  buffer_load_dwordx4 v[120:123], v1, s[4:7], s32 offen offset:2048 sc1
  ds_read_b64_tr_b16 v[224:225], v10 offset:32768
  ds_read_b64_tr_b16 v[226:227], v10 offset:33024
  s_cbranch_vccnz L_pl_206
L_plb_207:
  s_waitcnt lgkmcnt(4)
  v_mfma_f32_32x32x16_bf16 v[176:191], v[208:211], v[64:67], v[176:191]
  ds_read_b64_tr_b16 v[228:229], v11 offset:32768
  ds_read_b64_tr_b16 v[230:231], v11 offset:33024
  v_mfma_f32_32x32x16_bf16 v[192:207], v[212:215], v[64:67], v[192:207]
  buffer_load_dwordx4 v[124:127], v1, s[4:7], s32 offen offset:3072 sc1
  ds_read_b64_tr_b16 v[208:209], v10 offset:36864
  ds_read_b64_tr_b16 v[210:211], v10 offset:37120
  v_mfma_f32_32x32x16_bf16 v[176:191], v[216:219], v[68:71], v[176:191]
  ds_read_b64_tr_b16 v[212:213], v11 offset:36864
  ds_read_b64_tr_b16 v[214:215], v11 offset:37120
  s_waitcnt lgkmcnt(4)
  v_mfma_f32_32x32x16_bf16 v[192:207], v[220:223], v[68:71], v[192:207]
  s_add_u32 s32, s29, 28672
  buffer_load_dwordx4 v[128:131], v1, s[4:7], s32 offen offset:0 sc1
  ds_read_b64_tr_b16 v[216:217], v10 offset:40960
  ds_read_b64_tr_b16 v[218:219], v10 offset:41216
  v_mfma_f32_32x32x16_bf16 v[176:191], v[224:227], v[72:75], v[176:191]
  ds_read_b64_tr_b16 v[220:221], v11 offset:40960
  ds_read_b64_tr_b16 v[222:223], v11 offset:41216
  v_mfma_f32_32x32x16_bf16 v[192:207], v[228:231], v[72:75], v[192:207]
  buffer_load_dwordx4 v[132:135], v1, s[4:7], s32 offen offset:1024 sc1
  ds_read_b64_tr_b16 v[224:225], v10 offset:45056
  ds_read_b64_tr_b16 v[226:227], v10 offset:45312
  s_waitcnt vmcnt(10)
  v_max3_u32 v15, v80, v84, v88
  v_max_u32 v15, v15, v92
  s_waitcnt lgkmcnt(4)
  v_mfma_f32_32x32x16_bf16 v[176:191], v[208:211], v[76:79], v[176:191]
  ds_read_b64_tr_b16 v[228:229], v11 offset:45056
  ds_read_b64_tr_b16 v[230:231], v11 offset:45312
  v_cmp_eq_u32 vcc, -1, v15
  v_mfma_f32_32x32x16_bf16 v[192:207], v[212:215], v[76:79], v[192:207]
  buffer_load_dwordx4 v[136:139], v1, s[4:7], s32 offen offset:2048 sc1
  ds_read_b64_tr_b16 v[208:209], v10 offset:49152
  ds_read_b64_tr_b16 v[210:211], v10 offset:49408
  s_cbranch_vccnz L_pl_211
L_plb_212:
  v_mfma_f32_32x32x16_bf16 v[176:191], v[216:219], v[80:83], v[176:191]
  ds_read_b64_tr_b16 v[212:213], v11 offset:49152
  ds_read_b64_tr_b16 v[214:215], v11 offset:49408
  ds_read_b32 v7, v14 offset:1728
  s_waitcnt lgkmcnt(5)
  v_mfma_f32_32x32x16_bf16 v[192:207], v[220:223], v[80:83], v[192:207]
  buffer_load_dwordx4 v[140:143], v1, s[4:7], s32 offen offset:3072 sc1
  ds_read_b64_tr_b16 v[216:217], v10 offset:53248
  ds_read_b64_tr_b16 v[218:219], v10 offset:53504
  v_mfma_f32_32x32x16_bf16 v[176:191], v[224:227], v[84:87], v[176:191]
  ds_read_b64_tr_b16 v[220:221], v11 offset:53248
  ds_read_b64_tr_b16 v[222:223], v11 offset:53504
  v_mfma_f32_32x32x16_bf16 v[192:207], v[228:231], v[84:87], v[192:207]
  ds_read_b64_tr_b16 v[224:225], v10 offset:57344
  ds_read_b64_tr_b16 v[226:227], v10 offset:57600
  s_waitcnt lgkmcnt(4)
  v_mfma_f32_32x32x16_bf16 v[176:191], v[208:211], v[88:91], v[176:191]
  ds_read_b64_tr_b16 v[228:229], v11 offset:57344
  ds_read_b64_tr_b16 v[230:231], v11 offset:57600
  v_mfma_f32_32x32x16_bf16 v[192:207], v[212:215], v[88:91], v[192:207]
  ds_read_b64_tr_b16 v[208:209], v10 offset:61440
  ds_read_b64_tr_b16 v[210:211], v10 offset:61696
  s_waitcnt vmcnt(8)
  v_max3_u32 v15, v96, v100, v104
  v_max_u32 v15, v15, v108
  v_mfma_f32_32x32x16_bf16 v[176:191], v[216:219], v[92:95], v[176:191]
  ds_read_b64_tr_b16 v[212:213], v11 offset:61440
  ds_read_b64_tr_b16 v[214:215], v11 offset:61696
  v_cmp_eq_u32 s[30:31], -1, v15
  ds_write_b32 v5, v247 offset:896
  v_cmp_gt_u32 vcc, v247, v7
  s_cbranch_vccnz L_lsl_216
L_lbk_217:
  v_add_u32 v10, 0x10000, v10
  v_add_u32 v11, 0x10000, v11
  s_waitcnt lgkmcnt(5)
  v_mfma_f32_32x32x16_bf16 v[192:207], v[220:223], v[92:95], v[192:207]
  ds_read_b64_tr_b16 v[216:217], v10 offset:0
  ds_read_b64_tr_b16 v[218:219], v10 offset:256
  s_cmp_lg_u64 s[30:31], 0
  s_cbranch_scc1 L_pl_218
L_plb_219:
  v_mfma_f32_32x32x16_bf16 v[176:191], v[224:227], v[96:99], v[176:191]
  ds_read_b64_tr_b16 v[220:221], v11 offset:0
  ds_read_b64_tr_b16 v[222:223], v11 offset:256
  v_mfma_f32_32x32x16_bf16 v[192:207], v[228:231], v[96:99], v[192:207]
  ds_read_b64_tr_b16 v[224:225], v10 offset:4096
  ds_read_b64_tr_b16 v[226:227], v10 offset:4352
  s_waitcnt lgkmcnt(4)
  v_mfma_f32_32x32x16_bf16 v[176:191], v[208:211], v[100:103], v[176:191]
  ds_read_b64_tr_b16 v[228:229], v11 offset:4096
  ds_read_b64_tr_b16 v[230:231], v11 offset:4352
  v_mfma_f32_32x32x16_bf16 v[192:207], v[212:215], v[100:103], v[192:207]
  ds_read_b64_tr_b16 v[208:209], v10 offset:8192
  ds_read_b64_tr_b16 v[210:211], v10 offset:8448
  v_mfma_f32_32x32x16_bf16 v[176:191], v[216:219], v[104:107], v[176:191]
  s_add_u32 s32, s29, 32768
  buffer_load_dwordx4 v[16:19], v1, s[4:7], s32 offen offset:0 sc1
  ds_read_b64_tr_b16 v[212:213], v11 offset:8192
  ds_read_b64_tr_b16 v[214:215], v11 offset:8448
  s_waitcnt lgkmcnt(4)
  v_mfma_f32_32x32x16_bf16 v[192:207], v[220:223], v[104:107], v[192:207]
  ds_read_b64_tr_b16 v[216:217], v10 offset:12288
  ds_read_b64_tr_b16 v[218:219], v10 offset:12544
  s_waitcnt vmcnt(5)
  v_max3_u32 v15, v112, v116, v120
  v_max_u32 v15, v15, v124
  v_mfma_f32_32x32x16_bf16 v[176:191], v[224:227], v[108:111], v[176:191]
  buffer_load_dwordx4 v[20:23], v1, s[4:7], s32 offen offset:1024 sc1
  ds_read_b64_tr_b16 v[220:221], v11 offset:12288
  ds_read_b64_tr_b16 v[222:223], v11 offset:12544
  v_cmp_eq_u32 vcc, -1, v15
  ds_write_b32 v5, v247 offset:960
  v_mfma_f32_32x32x16_bf16 v[192:207], v[228:231], v[108:111], v[192:207]
  ds_read_b64_tr_b16 v[224:225], v10 offset:32768
  ds_read_b64_tr_b16 v[226:227], v10 offset:33024
  s_cbranch_vccnz L_pl_222
L_plb_223:
  s_waitcnt lgkmcnt(5)
  v_mfma_f32_32x32x16_bf16 v[176:191], v[208:211], v[112:115], v[176:191]
  buffer_load_dwordx4 v[24:27], v1, s[4:7], s32 offen offset:2048 sc1
  ds_read_b64_tr_b16 v[228:229], v11 offset:32768
  ds_read_b64_tr_b16 v[230:231], v11 offset:33024
  ds_read_b32 v7, v14 offset:1792
  v_mfma_f32_32x32x16_bf16 v[192:207], v[212:215], v[112:115], v[192:207]
  ds_read_b64_tr_b16 v[208:209], v10 offset:36864
  ds_read_b64_tr_b16 v[210:211], v10 offset:37120
  v_mfma_f32_32x32x16_bf16 v[176:191], v[216:219], v[116:119], v[176:191]
  buffer_load_dwordx4 v[28:31], v1, s[4:7], s32 offen offset:3072 sc1
  ds_read_b64_tr_b16 v[212:213], v11 offset:36864
  ds_read_b64_tr_b16 v[214:215], v11 offset:37120
  s_waitcnt lgkmcnt(5)
  v_mfma_f32_32x32x16_bf16 v[192:207], v[220:223], v[116:119], v[192:207]
  ds_read_b64_tr_b16 v[216:217], v10 offset:40960
  ds_read_b64_tr_b16 v[218:219], v10 offset:41216
  v_mfma_f32_32x32x16_bf16 v[176:191], v[224:227], v[120:123], v[176:191]
  s_add_u32 s32, s29, 36864
  buffer_load_dwordx4 v[32:35], v1, s[4:7], s32 offen offset:0 sc1
  ds_read_b64_tr_b16 v[220:221], v11 offset:40960
  ds_read_b64_tr_b16 v[222:223], v11 offset:41216
  v_mfma_f32_32x32x16_bf16 v[192:207], v[228:231], v[120:123], v[192:207]
  ds_read_b64_tr_b16 v[224:225], v10 offset:45056
  ds_read_b64_tr_b16 v[226:227], v10 offset:45312
  s_waitcnt vmcnt(5)
  v_max3_u32 v15, v128, v132, v136
  v_max_u32 v15, v15, v140
  s_waitcnt lgkmcnt(4)
  v_mfma_f32_32x32x16_bf16 v[176:191], v[208:211], v[124:127], v[176:191]
  buffer_load_dwordx4 v[36:39], v1, s[4:7], s32 offen offset:1024 sc1
  ds_read_b64_tr_b16 v[228:229], v11 offset:45056
  ds_read_b64_tr_b16 v[230:231], v11 offset:45312
  v_cmp_eq_u32 s[30:31], -1, v15
  v_cmp_gt_u32 vcc, v247, v7
  s_cbranch_vccnz L_lsl_226
L_lbk_227:
  v_mfma_f32_32x32x16_bf16 v[192:207], v[212:215], v[124:127], v[192:207]
  ds_read_b64_tr_b16 v[208:209], v10 offset:16384
  ds_read_b64_tr_b16 v[210:211], v10 offset:16640
  s_cmp_lg_u64 s[30:31], 0
  s_cbranch_scc1 L_pl_228
L_plb_229:
  v_mfma_f32_32x32x16_bf16 v[176:191], v[216:219], v[128:131], v[176:191]
  buffer_load_dwordx4 v[40:43], v1, s[4:7], s32 offen offset:2048 sc1
  ds_read_b64_tr_b16 v[212:213], v11 offset:16384
  ds_read_b64_tr_b16 v[214:215], v11 offset:16640
  s_waitcnt lgkmcnt(4)
  v_mfma_f32_32x32x16_bf16 v[192:207], v[220:223], v[128:131], v[192:207]
  ds_read_b64_tr_b16 v[216:217], v10 offset:20480
  ds_read_b64_tr_b16 v[218:219], v10 offset:20736
  v_mfma_f32_32x32x16_bf16 v[176:191], v[224:227], v[132:135], v[176:191]
  buffer_load_dwordx4 v[44:47], v1, s[4:7], s32 offen offset:3072 sc1
  ds_read_b64_tr_b16 v[220:221], v11 offset:20480
  ds_read_b64_tr_b16 v[222:223], v11 offset:20736
  v_mfma_f32_32x32x16_bf16 v[192:207], v[228:231], v[132:135], v[192:207]
  ds_read_b64_tr_b16 v[224:225], v10 offset:24576
  ds_read_b64_tr_b16 v[226:227], v10 offset:24832
  s_waitcnt lgkmcnt(4)
  v_mfma_f32_32x32x16_bf16 v[176:191], v[208:211], v[136:139], v[176:191]
  s_add_u32 s32, s29, 40960
  buffer_load_dwordx4 v[48:51], v1, s[4:7], s32 offen offset:0 sc1
  ds_read_b64_tr_b16 v[228:229], v11 offset:24576
  ds_read_b64_tr_b16 v[230:231], v11 offset:24832
  v_mfma_f32_32x32x16_bf16 v[192:207], v[212:215], v[136:139], v[192:207]
  ds_read_b64_tr_b16 v[208:209], v10 offset:28672
  ds_read_b64_tr_b16 v[210:211], v10 offset:28928
  ds_read_b32 v7, v14 offset:1856
  s_waitcnt vmcnt(6)
  v_max3_u32 v15, v16, v20, v24
  v_mfma_f32_32x32x16_bf16 v[176:191], v[216:219], v[140:143], v[176:191]
  buffer_load_dwordx4 v[52:55], v1, s[4:7], s32 offen offset:1024 sc1
  ds_read_b64_tr_b16 v[212:213], v11 offset:28672
  ds_read_b64_tr_b16 v[214:215], v11 offset:28928
  v_cmp_eq_u32 vcc, -1, v15
  v_add_u32 v10, 0x6000, v10
  v_add_u32 v11, 0x6000, v11
  s_waitcnt lgkmcnt(5)
  v_mfma_f32_32x32x16_bf16 v[192:207], v[220:223], v[140:143], v[192:207]
  ds_read_b64_tr_b16 v[216:217], v10 offset:24576
  ds_read_b64_tr_b16 v[218:219], v10 offset:24832
  s_cbranch_vccnz L_pl_232
L_plb_233:
  v_mfma_f32_32x32x16_bf16 v[176:191], v[224:227], v[16:19], v[176:191]
  buffer_load_dwordx4 v[56:59], v1, s[4:7], s32 offen offset:2048 sc1
  ds_read_b64_tr_b16 v[220:221], v11 offset:24576
  ds_read_b64_tr_b16 v[222:223], v11 offset:24832
  v_mfma_f32_32x32x16_bf16 v[192:207], v[228:231], v[16:19], v[192:207]
  ds_read_b64_tr_b16 v[224:225], v11 offset:28672
  ds_read_b64_tr_b16 v[226:227], v11 offset:28928
  s_waitcnt lgkmcnt(4)
  v_mfma_f32_32x32x16_bf16 v[176:191], v[208:211], v[20:23], v[176:191]
  ds_read_b64_tr_b16 v[228:229], v11 offset:32768
  ds_read_b64_tr_b16 v[230:231], v11 offset:33024
  v_mfma_f32_32x32x16_bf16 v[192:207], v[212:215], v[20:23], v[192:207]
  ds_read_b64_tr_b16 v[208:209], v11 offset:36864
  ds_read_b64_tr_b16 v[210:211], v11 offset:37120
  s_waitcnt vmcnt(4)
  v_max3_u32 v15, v28, v32, v36
  v_max_u32 v15, v15, v40
  v_cmp_gt_u32 vcc, v247, v7
  s_cbranch_vccnz L_lsl_236
L_lbk_237:
  v_mfma_f32_32x32x16_bf16 v[176:191], v[216:219], v[24:27], v[176:191]
  ds_read_b64_tr_b16 v[212:213], v11 offset:40960
  ds_read_b64_tr_b16 v[214:215], v11 offset:41216
  v_cmp_eq_u32 vcc, -1, v15
  s_waitcnt lgkmcnt(4)
  v_mfma_f32_32x32x16_bf16 v[192:207], v[220:223], v[24:27], v[192:207]
  ds_read_b64_tr_b16 v[216:217], v11 offset:45056
  ds_read_b64_tr_b16 v[218:219], v11 offset:45312
  s_cbranch_vccnz L_pl_238
L_plb_239:
  v_mfma_f32_32x32x16_bf16 v[192:207], v[224:227], v[28:31], v[192:207]
  ds_read_b64_tr_b16 v[220:221], v11 offset:49152
  ds_read_b64_tr_b16 v[222:223], v11 offset:49408
  v_mfma_f32_32x32x16_bf16 v[192:207], v[228:231], v[32:35], v[192:207]
  ds_read_b64_tr_b16 v[224:225], v11 offset:53248
  ds_read_b64_tr_b16 v[226:227], v11 offset:53504
  ds_write_b32 v5, v247 offset:2368
  s_waitcnt vmcnt(0)
  v_max3_u32 v15, v44, v48, v52
  v_max_u32 v15, v15, v56
  s_waitcnt lgkmcnt(5)
  v_mfma_f32_32x32x16_bf16 v[192:207], v[208:211], v[36:39], v[192:207]
  ds_read_b64_tr_b16 v[228:229], v11 offset:57344
  ds_read_b64_tr_b16 v[230:231], v11 offset:57600
  v_cmp_eq_u32 vcc, -1, v15
  v_mfma_f32_32x32x16_bf16 v[192:207], v[212:215], v[40:43], v[192:207]
  ds_read_b64_tr_b16 v[208:209], v10 offset:28672
  ds_read_b64_tr_b16 v[210:211], v10 offset:28928
  s_cbranch_vccnz L_pl_241
L_plb_242:
  v_mfma_f32_32x32x16_bf16 v[192:207], v[216:219], v[44:47], v[192:207]
  ds_read_b64_tr_b16 v[212:213], v10 offset:32768
  ds_read_b64_tr_b16 v[214:215], v10 offset:33024
  ds_read_b32 v7, v14 offset:960
  s_waitcnt lgkmcnt(5)
  v_mfma_f32_32x32x16_bf16 v[192:207], v[220:223], v[48:51], v[192:207]
  ds_read_b64_tr_b16 v[216:217], v10 offset:36864
  ds_read_b64_tr_b16 v[218:219], v10 offset:37120
  v_mfma_f32_32x32x16_bf16 v[192:207], v[224:227], v[52:55], v[192:207]
  ds_read_b64_tr_b16 v[220:221], v10 offset:40960
  ds_read_b64_tr_b16 v[222:223], v10 offset:41216
  v_mfma_f32_32x32x16_bf16 v[192:207], v[228:231], v[56:59], v[192:207]
  ds_read_b64_tr_b16 v[224:225], v10 offset:45056
  ds_read_b64_tr_b16 v[226:227], v10 offset:45312
  s_waitcnt lgkmcnt(4)
  v_mfma_f32_32x32x16_bf16 v[176:191], v[208:211], v[28:31], v[176:191]
  ds_read_b64_tr_b16 v[228:229], v10 offset:49152
  ds_read_b64_tr_b16 v[230:231], v10 offset:49408
  v_mfma_f32_32x32x16_bf16 v[176:191], v[212:215], v[32:35], v[176:191]
  ds_read_b64_tr_b16 v[208:209], v10 offset:53248
  ds_read_b64_tr_b16 v[210:211], v10 offset:53504
  v_cmp_gt_u32 vcc, v247, v7
  s_cbranch_vccnz L_lsl_243
L_lbk_244:
  ds_write_b128 v12, v[192:195] offset:0
  ds_write_b128 v12, v[196:199] offset:1024
  ds_write_b128 v12, v[200:203] offset:2048
  ds_write_b128 v12, v[204:207] offset:3072
  ds_write_b32 v5, v247 offset:1024
  v_mfma_f32_32x32x16_bf16 v[176:191], v[216:219], v[36:39], v[176:191]
  ds_read_b64_tr_b16 v[212:213], v10 offset:57344
  ds_read_b64_tr_b16 v[214:215], v10 offset:57600
  s_waitcnt lgkmcnt(9)
  v_mfma_f32_32x32x16_bf16 v[176:191], v[220:223], v[40:43], v[176:191]
  v_mfma_f32_32x32x16_bf16 v[176:191], v[224:227], v[44:47], v[176:191]
  v_mfma_f32_32x32x16_bf16 v[176:191], v[228:231], v[48:51], v[176:191]
  ds_read_b32 v7, v14 offset:1024
  ds_read_b128 v[144:147], v13 offset:0
  ds_read_b128 v[148:151], v13 offset:1024
  ds_read_b128 v[152:155], v13 offset:2048
  ds_read_b128 v[156:159], v13 offset:3072
  s_waitcnt lgkmcnt(5)
  v_mfma_f32_32x32x16_bf16 v[176:191], v[208:211], v[52:55], v[176:191]
  v_mfma_f32_32x32x16_bf16 v[176:191], v[212:215], v[56:59], v[176:191]
  s_nop 11
L_p4done:
  s_waitcnt lgkmcnt(4)
  v_cmp_gt_u32 vcc, v247, v7
  s_nop 0
  s_and_b64 vcc, vcc, s[36:37]
  s_cbranch_scc1 L_lsl_245
L_lbk_246:
  s_waitcnt lgkmcnt(0)
  ds_write_b32 v5, v247 offset:1088
  v_pk_add_f32 v[176:177], v[176:177], v[144:145]
  v_pk_add_f32 v[178:179], v[178:179], v[146:147]
  v_cvt_pk_bf16_f32 v232, v176, v177
  v_cvt_pk_bf16_f32 v233, v178, v179
  v_pk_add_f32 v[180:181], v[180:181], v[148:149]
  v_pk_add_f32 v[182:183], v[182:183], v[150:151]
  v_cvt_pk_bf16_f32 v234, v180, v181
  v_cvt_pk_bf16_f32 v235, v182, v183
  v_pk_add_f32 v[184:185], v[184:185], v[152:153]
  v_pk_add_f32 v[186:187], v[186:187], v[154:155]
  v_cvt_pk_bf16_f32 v236, v184, v185
  v_cvt_pk_bf16_f32 v237, v186, v187
  v_pk_add_f32 v[188:189], v[188:189], v[156:157]
  v_pk_add_f32 v[190:191], v[190:191], v[158:159]
  v_cvt_pk_bf16_f32 v238, v188, v189
  v_cvt_pk_bf16_f32 v239, v190, v191
  s_cmp_eq_u32 s16, 1
  s_nop 0
  s_cbranch_scc1 L_final
  buffer_store_dwordx4 v[232:235], v1, s[4:7], s38 offen
  buffer_store_dwordx4 v[236:239], v1, s[4:7], s38 offen offset:1024
  s_mov_b32 s35, s39
  s_add_u32 s20, s20, 65536
  s_add_u32 s21, s21, 65536
  s_mov_b32 s16, 1
  s_add_u32 s38, s26, 0xffe00000
  s_add_u32 s39, s27, 0xfffc0000
  s_lshl_b32 s44, s100, 12
  s_or_b32 s38, s38, s44
  v_add_u32 v247, 1, v247
  buffer_load_dwordx4 v[16:19], v1, s[4:7], s38 offen offset:0 sc1
  buffer_load_dwordx4 v[20:23], v1, s[4:7], s38 offen offset:1024 sc1
  v_mov_b32 v248, 0
  v_mov_b32 v249, 0
  v_mov_b32 v250, 0
  v_mov_b32 v251, 0
  v_dot2c_f32_bf16 v248, s51, v232
  v_dot2c_f32_bf16 v249, v232, v232
  v_dot2c_f32_bf16 v250, s51, v233
  v_dot2c_f32_bf16 v251, v233, v233
  v_dot2c_f32_bf16 v248, s51, v234
  v_dot2c_f32_bf16 v249, v234, v234
  v_dot2c_f32_bf16 v250, s51, v235
  v_dot2c_f32_bf16 v251, v235, v235
  v_dot2c_f32_bf16 v248, s51, v236
  v_dot2c_f32_bf16 v249, v236, v236
  v_dot2c_f32_bf16 v250, s51, v237
  v_dot2c_f32_bf16 v251, v237, v237
  v_dot2c_f32_bf16 v248, s51, v238
  v_dot2c_f32_bf16 v249, v238, v238
  v_dot2c_f32_bf16 v250, s51, v239
  v_dot2c_f32_bf16 v251, v239, v239
  s_nop 2
  v_pk_add_f32 v[248:249], v[248:249], v[250:251]
  v_mov_b32 v250, v248
  v_mov_b32 v251, v249
  s_nop 0
  v_permlane32_swap_b32 v250, v248
  v_permlane32_swap_b32 v251, v249
  v_pk_add_f32 v[248:249], v[248:249], v[250:251]
  s_mov_b32 exec_hi, 0
  buffer_store_dwordx2 v[248:249], v4, s[4:7], s35 offen
  s_mov_b32 exec_hi, -1
  buffer_load_dwordx4 v[24:27], v1, s[4:7], s38 offen offset:2048 sc1
  buffer_load_dwordx4 v[28:31], v1, s[4:7], s38 offen offset:3072 sc1
  s_xor_b32 s44, s38, 4096
  buffer_load_dwordx4 v[32:35], v1, s[4:7], s44 offen offset:0 sc1
  buffer_load_dwordx4 v[36:39], v1, s[4:7], s44 offen offset:1024 sc1
  buffer_load_dwordx4 v[40:43], v1, s[4:7], s44 offen offset:2048 sc1
  buffer_load_dwordx4 v[44:47], v1, s[4:7], s44 offen offset:3072 sc1
  s_xor_b32 s45, s38, 8192
  buffer_load_dwordx4 v[48:51], v1, s[4:7], s45 offen offset:0 sc1
  buffer_load_dwordx4 v[52:55], v1, s[4:7], s45 offen offset:1024 sc1
  ds_read_b32 v7, v14 offset:2176
  s_waitcnt lgkmcnt(0)
  v_cmp_gt_u32 vcc, v247, v7
  s_cbranch_vccnz L_lsl_247
L_lbk_248:
  ds_read_b128 v[208:211], v1 offset:8192
  ds_read_b128 v[212:215], v1 offset:40960
  ds_read_b128 v[216:219], v1 offset:9216
  ds_read_b128 v[220:223], v1 offset:41984
  ds_read_b128 v[224:227], v1 offset:10240
  s_waitcnt vmcnt(9)
  v_max_u32 v15, v16, v20
  v_cmp_eq_u32 vcc, -1, v15
  s_cbranch_vccnz L_pl_249
L_plb_250:
  s_waitcnt lgkmcnt(2)
  v_mfma_f32_32x32x16_bf16 v[144:159], v[208:211], v[16:19], 0
  s_xor_b32 s32, s38, 8192
  buffer_load_dwordx4 v[56:59], v1, s[4:7], s32 offen offset:2048 sc1
  ds_read_b128 v[228:231], v1 offset:43008
  v_bfe_u32 v249, v1, 6, 2
  v_lshrrev_b32 v251, 8, v1
  v_mfma_f32_32x32x16_bf16 v[160:175], v[212:215], v[16:19], 0
  buffer_load_dwordx4 v[60:63], v1, s[4:7], s32 offen offset:3072 sc1
  ds_read_b128 v[208:211], v1 offset:11264
  v_lshl_add_u32 v252, v251, 3, v249
  s_and_b32 s48, s14, 1
  s_waitcnt vmcnt(8)
  v_max_u32 v15, v24, v28
  v_mfma_f32_32x32x16_bf16 v[144:159], v[216:219], v[20:23], v[144:159]
  s_xor_b32 s32, s38, 12288
  buffer_load_dwordx4 v[64:67], v1, s[4:7], s32 offen offset:0 sc1
  ds_read_b128 v[212:215], v1 offset:44032
  s_lshl_b32 s48, s48, 13
  s_add_u32 s48, s48, 106496
  v_cmp_eq_u32 vcc, -1, v15
  s_waitcnt lgkmcnt(2)
  v_mfma_f32_32x32x16_bf16 v[160:175], v[220:223], v[20:23], v[160:175]
  buffer_load_dwordx4 v[68:71], v1, s[4:7], s32 offen offset:1024 sc1
  ds_read_b128 v[216:219], v1 offset:12288
  v_lshl_add_u32 v252, v252, 6, s48
  v_lshrrev_b32 v249, 1, v249
  s_cbranch_vccnz L_pl_254
L_plb_255:
  v_mfma_f32_32x32x16_bf16 v[144:159], v[224:227], v[24:27], v[144:159]
  buffer_load_dwordx4 v[72:75], v1, s[4:7], s32 offen offset:2048 sc1
  ds_read_b128 v[220:223], v1 offset:45056
  v_and_b32 v251, 1, v251
  v_lshl_or_b32 v249, v251, 1, v249
  ds_read_b32 v7, v14 offset:2240
  v_mfma_f32_32x32x16_bf16 v[160:175], v[228:231], v[24:27], v[160:175]
  ds_read_b128 v[224:227], v1 offset:13312
  v_bfe_u32 v250, v1, 4, 1
  v_bfe_u32 v253, v1, 5, 1
  s_waitcnt vmcnt(7)
  v_max3_u32 v15, v32, v36, v40
  v_max_u32 v15, v15, v44
  s_waitcnt lgkmcnt(3)
  v_mfma_f32_32x32x16_bf16 v[144:159], v[208:211], v[28:31], v[144:159]
  buffer_load_dwordx4 v[76:79], v1, s[4:7], s32 offen offset:3072 sc1
  ds_read_b128 v[228:231], v1 offset:46080
  s_and_b32 s48, s14, 2
  v_or_b32 v10, s48, v253
  v_cmp_eq_u32 vcc, -1, v15
  v_mfma_f32_32x32x16_bf16 v[160:175], v[212:215], v[28:31], v[160:175]
  ds_read_b128 v[208:211], v1 offset:14336
  v_xor_b32 v10, v10, v249
  v_xor_b32 v12, v250, v249
  s_cbranch_vccnz L_pl_259
L_plb_260:
  v_mfma_f32_32x32x16_bf16 v[144:159], v[216:219], v[32:35], v[144:159]
  buffer_load_dwordx2 v[192:193], v4, s[4:7], s39 offen offset:0 sc1
  s_xor_b32 s32, s38, 16384
  buffer_load_dwordx4 v[80:83], v1, s[4:7], s32 offen offset:0 sc1
  ds_read_b128 v[212:215], v1 offset:47104
  v_lshl_add_u32 v10, v10, 4, v252
  v_lshl_add_u32 v12, v12, 4, v252
  s_waitcnt lgkmcnt(2)
  v_mfma_f32_32x32x16_bf16 v[160:175], v[220:223], v[32:35], v[160:175]
  ds_read_b128 v[216:219], v1 offset:15360
  v_lshl_add_u32 v10, v250, 3, v10
  v_lshl_add_u32 v12, v253, 3, v12
  v_mfma_f32_32x32x16_bf16 v[144:159], v[224:227], v[36:39], v[144:159]
  buffer_load_dwordx2 v[194:195], v4, s[4:7], s39 offen offset:512 sc1
  buffer_load_dwordx4 v[84:87], v1, s[4:7], s32 offen offset:1024 sc1
  ds_read_b128 v[220:223], v1 offset:48128
  v_xor_b32 v11, 32, v10
  v_xor_b32 v13, 32, v12
  v_cmp_gt_u32 vcc, v247, v7
  s_cbranch_vccnz L_lsl_263
L_lbk_264:
  v_mfma_f32_32x32x16_bf16 v[160:175], v[228:231], v[36:39], v[160:175]
  ds_read_b128 v[224:227], v1 offset:16384
  v_add_u32 v254, 0x10000, v1
  s_waitcnt lgkmcnt(2)
  v_mfma_f32_32x32x16_bf16 v[144:159], v[208:211], v[40:43], v[144:159]
  buffer_load_dwordx2 v[196:197], v4, s[4:7], s39 offen offset:1024 sc1
  buffer_load_dwordx4 v[88:91], v1, s[4:7], s32 offen offset:2048 sc1
  ds_read_b128 v[228:231], v1 offset:49152
  v_mfma_f32_32x32x16_bf16 v[160:175], v[212:215], v[40:43], v[160:175]
  ds_read_b128 v[208:211], v1 offset:17408
  s_waitcnt vmcnt(10)
  v_max3_u32 v15, v48, v52, v56
  v_max_u32 v15, v15, v60
  v_mfma_f32_32x32x16_bf16 v[144:159], v[216:219], v[44:47], v[144:159]
  buffer_load_dwordx2 v[198:199], v4, s[4:7], s39 offen offset:1536 sc1
  buffer_load_dwordx4 v[92:95], v1, s[4:7], s32 offen offset:3072 sc1
  ds_read_b128 v[212:215], v1 offset:50176
  v_cmp_eq_u32 vcc, -1, v15
  s_waitcnt lgkmcnt(2)
  v_mfma_f32_32x32x16_bf16 v[160:175], v[220:223], v[44:47], v[160:175]
  ds_read_b128 v[216:219], v1 offset:18432
  s_cbranch_vccnz L_pl_265
L_plb_266:
  v_mfma_f32_32x32x16_bf16 v[144:159], v[224:227], v[48:51], v[144:159]
  buffer_load_dwordx2 v[200:201], v4, s[4:7], s39 offen offset:2048 sc1
  s_xor_b32 s32, s38, 20480
  buffer_load_dwordx4 v[96:99], v1, s[4:7], s32 offen offset:0 sc1
  ds_read_b128 v[220:223], v1 offset:51200
  v_mfma_f32_32x32x16_bf16 v[160:175], v[228:231], v[48:51], v[160:175]
  ds_read_b128 v[224:227], v1 offset:19456
  s_waitcnt lgkmcnt(2)
  v_mfma_f32_32x32x16_bf16 v[144:159], v[208:211], v[52:55], v[144:159]
  buffer_load_dwordx2 v[202:203], v4, s[4:7], s39 offen offset:2560 sc1
  buffer_load_dwordx4 v[100:103], v1, s[4:7], s32 offen offset:1024 sc1
  ds_read_b128 v[228:231], v1 offset:52224
  v_mfma_f32_32x32x16_bf16 v[160:175], v[212:215], v[52:55], v[160:175]
  ds_read_b128 v[208:211], v1 offset:20480
  v_mfma_f32_32x32x16_bf16 v[144:159], v[216:219], v[56:59], v[144:159]
  buffer_load_dwordx2 v[204:205], v4, s[4:7], s39 offen offset:3072 sc1
  buffer_load_dwordx4 v[104:107], v1, s[4:7], s32 offen offset:2048 sc1
  ds_read_b128 v[212:215], v1 offset:53248
  ds_read_b32 v7, v14 offset:1216
  s_waitcnt lgkmcnt(3)
  v_mfma_f32_32x32x16_bf16 v[160:175], v[220:223], v[56:59], v[160:175]
  ds_read_b128 v[216:219], v1 offset:21504
  s_waitcnt vmcnt(14)
  v_max3_u32 v15, v64, v68, v72
  v_max_u32 v15, v15, v76
  v_mfma_f32_32x32x16_bf16 v[144:159], v[224:227], v[60:63], v[144:159]
  buffer_load_dwordx2 v[206:207], v4, s[4:7], s39 offen offset:3584 sc1
  buffer_load_dwordx4 v[108:111], v1, s[4:7], s32 offen offset:3072 sc1
  ds_read_b128 v[220:223], v1 offset:54272
  v_cmp_eq_u32 vcc, -1, v15
  v_mfma_f32_32x32x16_bf16 v[160:175], v[228:231], v[60:63], v[160:175]
  ds_read_b128 v[224:227], v1 offset:22528
  s_cbranch_vccnz L_pl_270
L_plb_271:
  s_waitcnt lgkmcnt(2)
  v_mfma_f32_32x32x16_bf16 v[144:159], v[208:211], v[64:67], v[144:159]
  s_xor_b32 s32, s38, 24576
  buffer_load_dwordx4 v[112:115], v1, s[4:7], s32 offen offset:0 sc1
  ds_read_b128 v[228:231], v1 offset:55296
  v_mfma_f32_32x32x16_bf16 v[160:175], v[212:215], v[64:67], v[160:175]
  ds_read_b128 v[208:211], v1 offset:23552
  v_mfma_f32_32x32x16_bf16 v[144:159], v[216:219], v[68:71], v[144:159]
  buffer_load_dwordx4 v[116:119], v1, s[4:7], s32 offen offset:1024 sc1
  ds_read_b128 v[212:215], v1 offset:56320
  v_cmp_gt_u32 vcc, v247, v7
  s_cbranch_vccnz L_lsl_275
L_lbk_276:
  s_waitcnt lgkmcnt(2)
  v_mfma_f32_32x32x16_bf16 v[160:175], v[220:223], v[68:71], v[160:175]
  ds_read_b128 v[216:219], v1 offset:24576
  v_mfma_f32_32x32x16_bf16 v[144:159], v[224:227], v[72:75], v[144:159]
  buffer_load_dwordx4 v[120:123], v1, s[4:7], s32 offen offset:2048 sc1
  ds_read_b128 v[220:223], v1 offset:57344
  v_mfma_f32_32x32x16_bf16 v[160:175], v[228:231], v[72:75], v[160:175]
  ds_read_b128 v[224:227], v1 offset:25600
  s_waitcnt vmcnt(11)
  v_max3_u32 v15, v80, v84, v88
  v_max_u32 v15, v15, v92
  s_waitcnt lgkmcnt(2)
  v_mfma_f32_32x32x16_bf16 v[144:159], v[208:211], v[76:79], v[144:159]
  buffer_load_dwordx4 v[124:127], v1, s[4:7], s32 offen offset:3072 sc1
  ds_read_b128 v[228:231], v1 offset:58368
  v_cmp_eq_u32 vcc, -1, v15
  v_mfma_f32_32x32x16_bf16 v[160:175], v[212:215], v[76:79], v[160:175]
  ds_read_b128 v[208:211], v1 offset:26624
  s_cbranch_vccnz L_pl_277
L_plb_278:
  v_mfma_f32_32x32x16_bf16 v[144:159], v[216:219], v[80:83], v[144:159]
  s_xor_b32 s32, s38, 28672
  buffer_load_dwordx4 v[128:131], v1, s[4:7], s32 offen offset:0 sc1
  ds_read_b128 v[212:215], v1 offset:59392
  s_waitcnt lgkmcnt(2)
  v_mfma_f32_32x32x16_bf16 v[160:175], v[220:223], v[80:83], v[160:175]
  ds_read_b128 v[216:219], v1 offset:27648
  v_mfma_f32_32x32x16_bf16 v[144:159], v[224:227], v[84:87], v[144:159]
  buffer_load_dwordx4 v[132:135], v1, s[4:7], s32 offen offset:1024 sc1
  ds_read_b128 v[220:223], v1 offset:60416
  v_mfma_f32_32x32x16_bf16 v[160:175], v[228:231], v[84:87], v[160:175]
  ds_read_b128 v[224:227], v1 offset:28672
  s_waitcnt lgkmcnt(2)
  v_mfma_f32_32x32x16_bf16 v[144:159], v[208:211], v[88:91], v[144:159]
  buffer_load_dwordx4 v[136:139], v1, s[4:7], s32 offen offset:2048 sc1
  ds_read_b128 v[228:231], v1 offset:61440
  ds_read_b32 v7, v14 offset:1280
  v_mfma_f32_32x32x16_bf16 v[160:175], v[212:215], v[88:91], v[160:175]
  ds_read_b128 v[208:211], v1 offset:29696
  s_waitcnt vmcnt(7)
  v_max3_u32 v15, v96, v100, v104
  v_max_u32 v15, v15, v108
  v_mfma_f32_32x32x16_bf16 v[144:159], v[216:219], v[92:95], v[144:159]
  buffer_load_dwordx4 v[140:143], v1, s[4:7], s32 offen offset:3072 sc1
  ds_read_b128 v[212:215], v1 offset:62464
  v_cmp_eq_u32 vcc, -1, v15
  s_waitcnt lgkmcnt(3)
  v_mfma_f32_32x32x16_bf16 v[160:175], v[220:223], v[92:95], v[160:175]
  ds_read_b128 v[216:219], v1 offset:30720
  s_cbranch_vccnz L_pl_282
L_plb_283:
  v_max3_u32 v15, v192, v194, v196
  v_max3_u32 v15, v15, v198, v200
  v_mfma_f32_32x32x16_bf16 v[144:159], v[224:227], v[96:99], v[144:159]
  ds_read_b128 v[220:223], v1 offset:63488
  v_max3_u32 v15, v15, v202, v204
  v_max_u32 v15, v15, v206
  v_mfma_f32_32x32x16_bf16 v[160:175], v[228:231], v[96:99], v[160:175]
  ds_read_b128 v[224:227], v1 offset:31744
  v_cmp_eq_u32 vcc, -1, v15
  s_waitcnt lgkmcnt(2)
  v_mfma_f32_32x32x16_bf16 v[144:159], v[208:211], v[100:103], v[144:159]
  ds_read_b128 v[228:231], v1 offset:64512
  s_cbranch_vccnz L_pl_288
L_plb_289:
  v_cmp_gt_u32 vcc, v247, v7
  s_cbranch_vccnz L_lsl_293
L_lbk_294:
  v_mfma_f32_32x32x16_bf16 v[160:175], v[212:215], v[100:103], v[160:175]
  ds_read_b128 v[208:211], v1 offset:32768
  v_add_f32 v192, v192, v194
  v_add_f32 v193, v193, v195
  v_mfma_f32_32x32x16_bf16 v[144:159], v[216:219], v[104:107], v[144:159]
  ds_read_b128 v[212:215], v254 offset:0
  v_add_f32 v192, v192, v196
  v_add_f32 v193, v193, v197
  s_waitcnt lgkmcnt(2)
  v_mfma_f32_32x32x16_bf16 v[160:175], v[220:223], v[104:107], v[160:175]
  ds_read_b128 v[216:219], v1 offset:33792
  v_add_f32 v192, v192, v198
  v_add_f32 v193, v193, v199
  s_waitcnt vmcnt(4)
  v_max3_u32 v15, v112, v116, v120
  v_max_u32 v15, v15, v124
  ds_write_b32 v5, v247 offset:0
  v_mfma_f32_32x32x16_bf16 v[144:159], v[224:227], v[108:111], v[144:159]
  ds_read_b128 v[220:223], v254 offset:1024
  v_add_f32 v192, v192, v200
  v_add_f32 v193, v193, v201
  v_cmp_eq_u32 vcc, -1, v15
  v_mfma_f32_32x32x16_bf16 v[160:175], v[228:231], v[108:111], v[160:175]
  ds_read_b128 v[224:227], v1 offset:34816
  v_add_f32 v192, v192, v202
  v_add_f32 v193, v193, v203
  s_cbranch_vccnz L_pl_295
L_plb_296:
  s_waitcnt lgkmcnt(3)
  v_mfma_f32_32x32x16_bf16 v[144:159], v[208:211], v[112:115], v[144:159]
  ds_read_b128 v[228:231], v254 offset:2048
  v_add_f32 v192, v192, v204
  v_add_f32 v193, v193, v205
  v_mfma_f32_32x32x16_bf16 v[160:175], v[212:215], v[112:115], v[160:175]
  ds_read_b128 v[208:211], v1 offset:35840
  v_add_f32 v192, v192, v206
  v_add_f32 v193, v193, v207
  v_mfma_f32_32x32x16_bf16 v[144:159], v[216:219], v[116:119], v[144:159]
  ds_read_b128 v[212:215], v254 offset:3072
  v_mov_b32 v194, v192
  v_mov_b32 v195, v193
  s_waitcnt lgkmcnt(2)
  v_mfma_f32_32x32x16_bf16 v[160:175], v[220:223], v[116:119], v[160:175]
  ds_read_b128 v[216:219], v1 offset:36864
  v_permlane32_swap_b32 v194, v192
  v_permlane32_swap_b32 v195, v193
  ds_read_b32 v7, v14 offset:2112
  v_mfma_f32_32x32x16_bf16 v[144:159], v[224:227], v[120:123], v[144:159]
  ds_read_b128 v[220:223], v254 offset:4096
  v_add_f32 v192, v192, v194
  v_add_f32 v193, v193, v195
  v_mfma_f32_32x32x16_bf16 v[160:175], v[228:231], v[120:123], v[160:175]
  ds_read_b128 v[224:227], v1 offset:37888
  v_mul_f32 v192, 0xbb000000, v192
  v_mul_f32 v193, 0x3b000000, v193
  s_waitcnt vmcnt(2)
  v_max_u32 v15, v128, v132
  s_waitcnt lgkmcnt(3)
  v_mfma_f32_32x32x16_bf16 v[144:159], v[208:211], v[124:127], v[144:159]
  ds_read_b128 v[228:231], v254 offset:5120
  v_fma_f32 v193, -v192, v192, v193
  v_cvt_pk_bf16_f32 v240, v192, v192
  v_cmp_eq_u32 vcc, -1, v15
  v_mfma_f32_32x32x16_bf16 v[160:175], v[212:215], v[124:127], v[160:175]
  ds_read_b128 v[208:211], v1 offset:38912
  v_max_f32 v193, 0, v193
  v_add_f32 v193, 0x3727c5ac, v193
  s_cbranch_vccnz L_pl_299
L_plb_300:
  v_mfma_f32_32x32x16_bf16 v[144:159], v[216:219], v[128:131], v[144:159]
  ds_read_b128 v[212:215], v254 offset:6144
  v_and_b32 v194, s54, v240
  v_rsq_f32 v195, v193
  s_waitcnt lgkmcnt(2)
  v_mfma_f32_32x32x16_bf16 v[160:175], v[220:223], v[128:131], v[160:175]
  ds_read_b128 v[216:219], v1 offset:39936
  v_sub_f32 v194, v192, v194
  v_cvt_pk_bf16_f32 v241, v194, v194
  s_waitcnt vmcnt(0)
  v_max_u32 v15, v136, v140
  v_mfma_f32_32x32x16_bf16 v[144:159], v[224:227], v[132:135], v[144:159]
  ds_read_b128 v[220:223], v254 offset:7168
  v_cndmask_b32 v240, v240, v241, s[42:43]
  v_mov_b32 v241, v240
  v_cmp_eq_u32 s[30:31], -1, v15
  v_cmp_eq_u32 vcc, 0, v7
  s_cbranch_vccnz L_lsl_302
L_lbk_303:
  ds_read_b64 v[224:225], v9 offset:6656
  v_mfma_f32_32x32x16_bf16 v[160:175], v[228:231], v[132:135], v[160:175]
  v_mul_f32 v244, 0x3fb8aa3b, v195
  v_mov_b32 v246, v195
  s_cmp_lg_u64 s[30:31], 0
  s_cbranch_scc1 L_pl_304
L_plb_305:
  ds_read_b64 v[228:229], v9 offset:6912
  s_waitcnt lgkmcnt(3)
  v_mfma_f32_32x32x16_bf16 v[144:159], v[208:211], v[136:139], v[144:159]
  v_mfma_f32_32x32x16_bf16 v[160:175], v[212:215], v[136:139], v[160:175]
  v_mfma_f32_32x32x16_bf16 v[144:159], v[216:219], v[140:143], v[144:159]
  s_waitcnt lgkmcnt(0)
  v_mfma_f32_32x32x16_bf16 v[160:175], v[220:223], v[140:143], v[160:175]
  v_mfma_f32_32x32x16_bf16 v[144:159], v[224:227], v[240:243], v[144:159]
  ds_read_b128 v[216:219], v1 offset:4608
  ds_read_b128 v[220:223], v1 offset:5632
  v_mfma_f32_32x32x16_bf16 v[160:175], v[228:231], v[240:243], v[160:175]
  s_nop 11
  s_branch L_body
L_final:
  v_lshrrev_b32 v248, 4, v1
  v_and_b32 v249, 31, v248
  v_lshrrev_b32 v250, 5, v248
  v_lshlrev_b32 v248, 10, v249
  v_lshl_add_u32 v248, v250, 5, v248
  s_lshl_b32 s44, s18, 15
  s_lshl_b32 s45, s19, 6
  s_add_u32 s44, s44, s45
  buffer_store_dwordx4 v[232:235], v248, s[8:11], s44 offen
  buffer_store_dwordx4 v[236:239], v248, s[8:11], s44 offen offset:16
  s_or_b32 s44, s2, s14
  s_cmp_lg_u32 s44, 0
  s_cbranch_scc1 L_noep
  v_mov_b32 v249, s3
  s_mov_b32 s45, 0x28000
  s_mov_b64 exec, 1
  buffer_store_dword v249, off, s[4:7], s45 sc1
  s_mov_b64 exec, -1
L_noep:
  s_endpgm
L_helper:
  s_sub_u32 s44, s14, 4
  s_and_b32 s45, s13, 7
  s_lshl_b32 s49, s44, 10
  v_lshrrev_b32 v9, 2, v0
  v_and_b32 v5, 3, v0
  v_lshlrev_b32 v5, 4, v5
  v_mul_u32_u24 v3, 3072, v9
  v_add_u32 v3, v3, v5
  s_mul_i32 s53, s44, 49152
  s_lshl_b32 s46, s13, 6
  s_add_u32 s53, s53, s46
  v_lshrrev_b32 v12, 4, v0
  v_mul_u32_u24 v12, 3072, v12
  v_and_b32 v13, 15, v0
  v_lshl_add_u32 v12, v13, 7, v12
  v_lshlrev_b32 v13, 7, v0
  s_lshr_b32 s48, s2, 3
  s_lshl_b32 s48, s48, 2
  s_add_u32 s48, s48, s44
  s_mul_i32 s48, s48, 12288
  s_lshl_b32 s47, s12, 4
  s_add_u32 s47, s47, s13
  s_lshl_b32 s47, s47, 13
  s_mov_b32 s98, 0x200000
  s_mov_b32 s99, 0x20000
  s_waitcnt lgkmcnt(0)
  s_mov_b64 s[20:21], s[74:75]
  s_mov_b64 s[40:41], s[76:77]
  s_mov_b64 s[24:25], s[78:79]
  s_mov_b64 s[28:29], s[82:83]
  s_mov_b64 s[32:33], s[84:85]
  s_mov_b64 s[36:37], s[86:87]
  s_mov_b64 s[96:97], s[72:73]
  s_load_dword s3, s[4:5], 0x28000
  s_mov_b32 s22, 0x180000
  s_mov_b32 s23, 0x20000
  s_mov_b32 s42, 0x4000
  s_mov_b32 s43, 0x20000
  s_mov_b32 s26, 0x80000
  s_mov_b32 s27, 0x20000
  s_mov_b32 s30, 0x158000
  s_mov_b32 s31, 0x20000
  s_mov_b32 s34, 0x158000
  s_mov_b32 s35, 0x20000
  s_mov_b32 s38, 0x158000
  s_mov_b32 s39, 0x20000
  s_cmp_lg_u32 s44, 1
  s_cbranch_scc1 L_h3
  s_lshr_b32 s46, s2, 3
  s_mul_i32 s46, s46, 49152
  s_lshr_b32 s47, s20, 7
  s_sub_u32 s47, 3, s47
  s_and_b32 s47, s47, 7
  s_lshl_b32 s47, s47, 7
  s_add_u32 s46, s46, s47
  v_and_b32 v26, 15, v0
  v_mul_u32_u24 v26, 3072, v26
  v_lshrrev_b32 v27, 4, v0
  v_add_u32 v27, 1, v27
  v_cmp_eq_u32 vcc, 3, v27
  s_nop 1
  v_cndmask_b32 v27, v27, 0, vcc
  v_lshl_add_u32 v26, v27, 10, v26
  s_mov_b32 exec_hi, 0
  buffer_load_dword v27, v26, s[20:23], s46 offen
  s_mov_b32 exec_hi, -1
L_h3:
  s_cmp_lg_u32 s44, 2
  s_cbranch_scc1 L_h4
  s_mul_i32 s46, s2, 6144
  s_mov_b32 exec_hi, 0xffff
  buffer_load_dword v26, v13, s[20:23], s46 offen
  s_mov_b32 exec_hi, -1
L_h4:
  s_add_u32 s57, s53, 1024
  s_add_u32 s54, s53, 2048
  v_lshlrev_b32 v1, 4, v0
  s_cmp_lg_u32 s14, 7
  s_nop 0
  s_cbranch_scc1 L_h00
  s_lshl_b32 s46, s13, 10
  s_mov_b32 m0, 159744
  s_nop 0
  buffer_load_dwordx4 v1, s[40:43], s46 offen lds
L_h00:
  s_xor_b32 s46, s100, 0
  s_mul_i32 s46, s46, 196608
  s_add_u32 s46, s46, s57
  buffer_load_dwordx4 v[32:35], v3, s[20:23], s46 offen
  s_xor_b32 s46, s100, 0
  s_mul_i32 s46, s46, 196608
  s_add_u32 s46, s46, s54
  buffer_load_dwordx4 v[64:67], v3, s[20:23], s46 offen
  s_xor_b32 s47, s100, 1
  s_mul_i32 s47, s47, 196608
  s_add_u32 s47, s47, s57
  buffer_load_dwordx4 v[36:39], v3, s[20:23], s47 offen
  s_xor_b32 s47, s100, 1
  s_mul_i32 s47, s47, 196608
  s_add_u32 s47, s47, s54
  buffer_load_dwordx4 v[68:71], v3, s[20:23], s47 offen
  s_xor_b32 s46, s100, 2
  s_mul_i32 s46, s46, 196608
  s_add_u32 s46, s46, s57
  buffer_load_dwordx4 v[40:43], v3, s[20:23], s46 offen
  s_xor_b32 s46, s100, 2
  s_mul_i32 s46, s46, 196608
  s_add_u32 s46, s46, s54
  buffer_load_dwordx4 v[72:75], v3, s[20:23], s46 offen
  s_xor_b32 s47, s100, 3
  s_mul_i32 s47, s47, 196608
  s_add_u32 s47, s47, s57
  buffer_load_dwordx4 v[44:47], v3, s[20:23], s47 offen
  s_xor_b32 s47, s100, 3
  s_mul_i32 s47, s47, 196608
  s_add_u32 s47, s47, s54
  buffer_load_dwordx4 v[76:79], v3, s[20:23], s47 offen
  s_barrier
  s_lshl_b32 s17, s12, 2
  s_add_u32 s17, s17, s44
  s_mul_i32 s18, s17, 86
  s_add_u32 s18, s18, s13
  s_lshl_b32 s18, s18, 10
  s_add_u32 s18, s18, 0x800000
  s_lshl_b32 s17, s17, 15
  s_lshl_b32 s46, s13, 11
  s_add_u32 s17, s17, s46
  s_add_u32 s17, s17, 0x600000
  s_lshr_b32 s46, s13, 3
  s_lshl_b32 s46, s46, 1
  s_and_b32 s47, s44, 1
  s_add_u32 s46, s46, s47
  s_lshl_b32 s47, s12, 2
  s_add_u32 s46, s46, s47
  s_lshl_b32 s47, s45, 1
  s_lshr_b32 s9, s44, 1
  s_add_u32 s47, s47, s9
  s_lshl_b32 s46, s46, 4
  s_add_u32 s46, s46, s47
  s_lshl_b32 s8, s46, 11
  s_add_u32 s8, s8, 0x400000
  s_lshl_b32 s9, s46, 8
  s_add_u32 s9, s9, 0x1c0000
  s_mov_b32 s68, s53
  s_mov_b32 s48, s54
  v_and_b32 v6, 7, v9
  v_lshlrev_b32 v30, 10, v6
  v_lshrrev_b32 v6, 5, v0
  v_lshl_add_u32 v30, v6, 6, v30
  v_add_u32 v30, v30, v5
  s_lshl_b32 s55, s44, 13
  s_lshl_b32 s46, s45, 7
  s_add_u32 s55, s55, s46
  v_mul_u32_u24 v28, 2752, v9
  v_add_u32 v28, v28, v5
  s_mul_i32 s53, s44, 44032
  s_lshl_b32 s46, s13, 6
  s_add_u32 s53, s53, s46
  v_lshrrev_b32 v6, 3, v0
  v_and_b32 v31, 31, v0
  v_lshlrev_b32 v31, 4, v31
  v_lshrrev_b32 v6, 5, v0
  v_lshl_add_u32 v31, v6, 11, v31
  s_lshl_b32 s46, s44, 9
  s_add_u32 s46, s46, 73728
  v_add_u32 v31, s46, v31
  v_bfe_u32 v31, v0, 2, 3
  v_lshlrev_b32 v31, 9, v31
  v_and_b32 v6, 1, v0
  v_lshl_or_b32 v31, v6, 6, v31
  v_bfe_u32 v6, v0, 1, 1
  v_lshl_or_b32 v31, v6, 5, v31
  v_lshrrev_b32 v6, 3, v0
  v_xor_b32 v6, v0, v6
  v_bfe_u32 v6, v6, 2, 1
  v_lshl_or_b32 v31, v6, 4, v31
  s_lshl_b32 s46, s44, 12
  s_add_u32 s46, s46, 73728
  v_add_u32 v31, s46, v31
  s_lshl_b32 s46, s13, 7
  s_add_u32 s46, s46, 1024
  s_lshl_b32 s47, s13, 6
  s_add_u32 s47, s47, 1728
  s_cmp_lt_u32 s13, 11
  s_cselect_b32 s46, s46, s47
  s_mul_i32 s54, s44, 176128
  s_add_u32 s54, s54, s46
  s_add_u32 s46, s49, 8192
  v_add_u32 v1, s46, v1
  v_add_u32 v2, 0x10000, v1
  v_bfe_u32 v5, v0, 4, 1
  v_and_b32 v6, 1, v0
  v_lshl_add_u32 v5, v5, 1, v6
  v_bfe_u32 v6, v0, 1, 1
  v_lshl_add_u32 v5, v5, 1, v6
  v_bfe_u32 v6, v0, 2, 2
  v_lshl_add_u32 v5, v6, 3, v5
  v_lshrrev_b32 v6, 5, v0
  v_lshl_add_u32 v5, v6, 7, v5
  v_lshlrev_b32 v8, 3, v5
  s_mov_b32 s51, 0x3f803f80
  v_and_b32 v10, 15, v0
  v_lshlrev_b32 v10, 2, v10
  v_and_b32 v11, 3, v0
  v_lshlrev_b32 v11, 4, v11
  s_lshl_b32 s46, s44, 2
  v_add_u32 v11, s46, v11
  s_waitcnt lgkmcnt(0)
  s_and_b32 s3, s3, 0x7ffffffe
  s_add_u32 s3, s3, 2
  v_mov_b32 v29, s3
  s_lshr_b32 s46, s13, 3
  s_lshl_b32 s46, s46, 1
  s_and_b32 s52, s12, 1
  s_add_u32 s52, s52, s46
  s_and_b32 s50, s12, 1
  s_lshl_b32 s50, s50, 1
  s_and_b32 s46, s13, 1
  s_or_b32 s50, s50, s46
  s_cmp_lg_u32 s14, 7
  s_cbranch_scc1 L_h2
  s_waitcnt vmcnt(8)
  v_bfe_u32 v5, v0, 1, 1
  v_bfe_u32 v6, v0, 4, 1
  v_lshl_add_u32 v5, v6, 1, v5
  v_bfe_u32 v6, v0, 2, 2
  v_lshl_add_u32 v5, v6, 2, v5
  v_lshrrev_b32 v6, 5, v0
  v_lshl_add_u32 v5, v6, 5, v5
  v_lshlrev_b32 v5, 3, v5
  v_add_u32 v5, 159744, v5
  ds_read_b64_tr_b16 v[20:21], v5 offset:0
  ds_read_b64_tr_b16 v[22:23], v5 offset:128
  ds_read_b64_tr_b16 v[24:25], v5 offset:512
  ds_read_b64_tr_b16 v[26:27], v5 offset:640
  v_bfe_u32 v6, v0, 2, 1
  v_mul_u32_u24 v6, 0x8000, v6
  v_lshl_or_b32 v6, v6, 16, v6
  v_lshlrev_b32 v9, 4, v0
  s_waitcnt lgkmcnt(3)
  v_xor_b32 v20, v20, v6
  v_xor_b32 v21, v21, v6
  s_waitcnt lgkmcnt(2)
  v_xor_b32 v22, v22, v6
  v_xor_b32 v23, v23, v6
  s_waitcnt lgkmcnt(1)
  v_xor_b32 v24, v24, v6
  v_xor_b32 v25, v25, v6
  s_waitcnt lgkmcnt(0)
  v_xor_b32 v26, v26, v6
  v_xor_b32 v27, v27, v6
  ds_write_b128 v9, v[20:23] offset:4608
  ds_write_b128 v9, v[24:27] offset:5632
  s_waitcnt lgkmcnt(0)
L_h2:
  s_waitcnt vmcnt(7)
  ds_write_b128 v1, v[32:35] offset:0
  s_waitcnt vmcnt(6)
  ds_write_b128 v1, v[64:67] offset:32768
  s_waitcnt vmcnt(5)
  ds_write_b128 v1, v[36:39] offset:4096
  s_waitcnt vmcnt(4)
  ds_write_b128 v1, v[68:71] offset:36864
  ds_write_b32 v11, v29 offset:2176
  s_xor_b32 s46, s100, 4
  s_mul_i32 s46, s46, 196608
  s_add_u32 s46, s46, s57
  buffer_load_dwordx4 v[48:51], v3, s[20:23], s46 offen
  s_xor_b32 s46, s100, 4
  s_mul_i32 s46, s46, 196608
  s_add_u32 s46, s46, s48
  buffer_load_dwordx4 v[80:83], v3, s[20:23], s46 offen
  s_xor_b32 s47, s100, 5
  s_mul_i32 s47, s47, 196608
  s_add_u32 s47, s47, s57
  buffer_load_dwordx4 v[52:55], v3, s[20:23], s47 offen
  s_xor_b32 s47, s100, 5
  s_mul_i32 s47, s47, 196608
  s_add_u32 s47, s47, s48
  buffer_load_dwordx4 v[84:87], v3, s[20:23], s47 offen
  v_lshlrev_b32 v5, 4, v0
  v_mov_b32 v16, -1
  v_mov_b32 v17, -1
  v_mov_b32 v18, -1
  v_mov_b32 v19, -1
  buffer_store_dwordx4 v[16:19], v5, s[4:7], s17 offen offset:0 sc1
  buffer_store_dwordx4 v[16:19], v5, s[4:7], s17 offen offset:1024 sc1
  s_lshl_b32 s46, s13, 1
  s_and_b32 s47, s44, 1
  s_add_u32 s46, s46, s47
  s_lshl_b32 s46, s46, 4
  s_add_u32 s46, s46, s12
  s_mul_i32 s46, s46, 4096
  s_add_u32 s46, s46, 0xe00000
  s_lshr_b32 s47, s44, 1
  s_lshl_b32 s47, s47, 10
  s_add_u32 s47, s47, s46
  buffer_store_dwordx4 v[16:19], v5, s[4:7], s47 offen sc1
  s_mov_b64 exec, 0xff
  buffer_store_dwordx4 v[16:19], v5, s[4:7], s46 offen offset:2048 sc1
  s_mov_b64 exec, -1
  s_waitcnt vmcnt(11)
  ds_write_b128 v1, v[40:43] offset:8192
  s_waitcnt vmcnt(10)
  ds_write_b128 v1, v[72:75] offset:40960
  s_waitcnt vmcnt(9)
  ds_write_b128 v1, v[44:47] offset:12288
  s_waitcnt vmcnt(8)
  ds_write_b128 v1, v[76:79] offset:45056
  ds_write_b32 v11, v29 offset:2240
  s_xor_b32 s46, s100, 6
  s_mul_i32 s46, s46, 196608
  s_add_u32 s46, s46, s57
  buffer_load_dwordx4 v[56:59], v3, s[20:23], s46 offen
  s_xor_b32 s46, s100, 6
  s_mul_i32 s46, s46, 196608
  s_add_u32 s46, s46, s48
  buffer_load_dwordx4 v[88:91], v3, s[20:23], s46 offen
  s_xor_b32 s47, s100, 7
  s_mul_i32 s47, s47, 196608
  s_add_u32 s47, s47, s57
  buffer_load_dwordx4 v[60:63], v3, s[20:23], s47 offen
  s_xor_b32 s47, s100, 7
  s_mul_i32 s47, s47, 196608
  s_add_u32 s47, s47, s48
  buffer_load_dwordx4 v[92:95], v3, s[20:23], s47 offen
  s_waitcnt vmcnt(11)
  ds_write_b128 v1, v[48:51] offset:16384
  s_waitcnt vmcnt(10)
  ds_write_b128 v1, v[80:83] offset:49152
  s_waitcnt vmcnt(9)
  ds_write_b128 v1, v[52:55] offset:20480
  s_waitcnt vmcnt(8)
  ds_write_b128 v1, v[84:87] offset:53248
  ds_write_b32 v11, v29 offset:1216
  s_waitcnt lgkmcnt(8)
  s_waitcnt vmcnt(3)
  ds_write_b128 v1, v[56:59] offset:24576
  s_waitcnt vmcnt(2)
  ds_write_b128 v1, v[88:91] offset:57344
  s_waitcnt vmcnt(1)
  ds_write_b128 v1, v[60:63] offset:28672
  s_waitcnt vmcnt(0)
  ds_write_b128 v1, v[92:95] offset:61440
  ds_write_b32 v11, v29 offset:1280
L_hw_306:
  ds_read_b32 v7, v10 offset:2752
  s_waitcnt lgkmcnt(0)
  v_cmp_gt_u32 vcc, v29, v7
  s_cbranch_vccz L_hwe_307
  s_sleep 1
  s_sub_u32 s56, s56, 1
  s_cbranch_scc0 L_hw_306
  s_mov_b32 s56, 0
L_hwe_307:
  s_lshl_b32 s46, s44, 1
  s_xor_b32 s46, s46, s100
  v_lshrrev_b32 v5, 5, v0
  v_xor_b32 v5, s46, v5
  v_bfe_u32 v6, v0, 4, 1
  v_lshl_or_b32 v5, v5, 1, v6
  v_bfe_u32 v6, v0, 2, 1
  v_lshl_or_b32 v5, v5, 1, v6
  v_bfe_u32 v6, v0, 3, 1
  v_lshl_or_b32 v5, v5, 1, v6
  v_mul_u32_u24 v5, 24576, v5
  v_and_b32 v6, 3, v0
  v_lshl_add_u32 v5, v6, 4, v5
  s_lshl_b32 s46, s13, 6
  s_add_u32 s47, s46, 12288
  buffer_load_dwordx4 v[96:99], v5, s[20:23], s46 offen offset:0
  buffer_load_dwordx4 v[100:103], v5, s[20:23], s46 offen offset:3072
  s_add_u32 s46, s46, 6144
  buffer_load_dwordx4 v[104:107], v5, s[20:23], s46 offen offset:0
  buffer_load_dwordx4 v[108:111], v5, s[20:23], s46 offen offset:3072
  buffer_load_dwordx4 v[112:115], v5, s[20:23], s47 offen offset:0
  buffer_load_dwordx4 v[116:119], v5, s[20:23], s47 offen offset:3072
  s_add_u32 s47, s47, 6144
  buffer_load_dwordx4 v[120:123], v5, s[20:23], s47 offen offset:0
  buffer_load_dwordx4 v[124:127], v5, s[20:23], s47 offen offset:3072
  v_lshlrev_b32 v13, 7, v0
  s_cmp_eq_u32 s44, 0
  s_cselect_b64 s[64:65], s[28:29], s[32:33]
  s_cmp_eq_u32 s44, 2
  s_cselect_b64 s[64:65], s[36:37], s[64:65]
  s_cmp_eq_u32 s44, 3
  s_cselect_b64 s[64:65], s[24:25], s[64:65]
  s_cselect_b32 s66, 0x80000, s30
  s_mov_b32 s67, 0x20000
  s_movk_i32 s46, 5504
  s_cselect_b32 s46, 2048, s46
  s_cselect_b32 s47, 16, 44
  s_mul_i32 s46, s46, s2
  v_cmp_gt_u32 vcc, s47, v0
  s_nop 0
  s_mov_b64 exec, vcc
  buffer_load_dword v228, v13, s[64:67], s46 offen
  s_mov_b64 exec, -1
  ds_write_b32 v11, v29 offset:2624
  s_cmp_lg_u32 s14, 7
  s_cbranch_scc1 L_h1
L_hw_308:
  ds_read_b32 v7, v10 offset:2624
  s_waitcnt lgkmcnt(0)
  v_cmp_gt_u32 vcc, v29, v7
  s_cbranch_vccz L_hwe_309
  s_sleep 1
  s_sub_u32 s56, s56, 1
  s_cbranch_scc0 L_hw_308
  s_mov_b32 s56, 0
L_hwe_309:
  s_getreg_b32 s46, hwreg(HW_REG_XCC_ID)
  s_and_b32 s46, s46, 15
  s_lshl_b32 s48, s3, 4
  s_or_b32 s10, s46, s48
  s_lshl_b32 s47, s12, 8
  s_lshl_b32 s48, s13, 2
  s_add_u32 s47, s47, s48
  s_add_u32 s47, s47, 0x20000
  v_mov_b32 v5, s10
  s_mov_b64 exec, 1
  buffer_store_dword v5, off, s[4:7], s47 sc1
  s_mov_b64 exec, -1
L_h1:
L_hw_311:
  ds_read_b32 v7, v10 offset:1280
  s_waitcnt lgkmcnt(0)
  v_cmp_gt_u32 vcc, v29, v7
  s_cbranch_vccz L_hwe_312
  s_sleep 1
  s_sub_u32 s56, s56, 1
  s_cbranch_scc0 L_hw_311
  s_mov_b32 s56, 0
L_hwe_312:
  s_setprio 3
  s_lshr_b32 s47, s44, 1
  s_lshl_b32 s47, s47, 3
  s_and_b32 s46, s44, 1
  s_add_u32 s47, s47, s46
  s_lshl_b32 s47, s47, 12
  s_add_u32 s47, s47, 8192
  v_add_u32 v9, s47, v8
  ds_read_b64_tr_b16 v[32:33], v9 offset:0
  ds_read_b64_tr_b16 v[34:35], v9 offset:256
  ds_read_b64_tr_b16 v[36:37], v9 offset:512
  ds_read_b64_tr_b16 v[38:39], v9 offset:768
  ds_read_b64_tr_b16 v[40:41], v9 offset:2048
  ds_read_b64_tr_b16 v[42:43], v9 offset:2304
  ds_read_b64_tr_b16 v[44:45], v9 offset:2560
  ds_read_b64_tr_b16 v[46:47], v9 offset:2816
  ds_read_b64_tr_b16 v[48:49], v9 offset:8192
  ds_read_b64_tr_b16 v[50:51], v9 offset:8448
  ds_read_b64_tr_b16 v[52:53], v9 offset:8704
  ds_read_b64_tr_b16 v[54:55], v9 offset:8960
  s_mov_b32 s46, 0xf0f00f0f
  s_mov_b32 s47, 0xf0f00f0f
  v_mov_b32 v4, s51
  v_cndmask_b32 v4, 0, v4, s[46:47]
  v_mov_b32 v5, v4
  v_mov_b32 v6, v4
  v_mov_b32 v7, v4
  s_waitcnt lgkmcnt(10)
  s_nop 0
  v_mfma_f32_16x16x32_bf16 v[24:27], v[4:7], v[32:35], 0
  ds_read_b64_tr_b16 v[56:57], v9 offset:10240
  ds_read_b64_tr_b16 v[58:59], v9 offset:10496
  s_waitcnt lgkmcnt(10)
  v_mfma_f32_16x16x32_bf16 v[24:27], v[4:7], v[36:39], v[24:27]
  ds_read_b64_tr_b16 v[60:61], v9 offset:10752
  ds_read_b64_tr_b16 v[62:63], v9 offset:11008
  s_waitcnt lgkmcnt(10)
  v_mfma_f32_16x16x32_bf16 v[24:27], v[4:7], v[40:43], v[24:27]
  ds_read_b64_tr_b16 v[64:65], v9 offset:16384
  ds_read_b64_tr_b16 v[66:67], v9 offset:16640
  s_waitcnt lgkmcnt(10)
  v_mfma_f32_16x16x32_bf16 v[24:27], v[4:7], v[44:47], v[24:27]
  ds_read_b64_tr_b16 v[68:69], v9 offset:16896
  ds_read_b64_tr_b16 v[70:71], v9 offset:17152
  s_waitcnt lgkmcnt(10)
  v_mfma_f32_16x16x32_bf16 v[24:27], v[4:7], v[48:51], v[24:27]
  ds_read_b64_tr_b16 v[72:73], v9 offset:18432
  ds_read_b64_tr_b16 v[74:75], v9 offset:18688
  s_waitcnt lgkmcnt(10)
  v_mfma_f32_16x16x32_bf16 v[24:27], v[4:7], v[52:55], v[24:27]
  ds_read_b64_tr_b16 v[76:77], v9 offset:18944
  ds_read_b64_tr_b16 v[78:79], v9 offset:19200
  s_waitcnt lgkmcnt(10)
  v_mfma_f32_16x16x32_bf16 v[24:27], v[4:7], v[56:59], v[24:27]
  ds_read_b64_tr_b16 v[80:81], v9 offset:24576
  ds_read_b64_tr_b16 v[82:83], v9 offset:24832
  s_waitcnt lgkmcnt(10)
  v_mfma_f32_16x16x32_bf16 v[24:27], v[4:7], v[60:63], v[24:27]
  ds_read_b64_tr_b16 v[84:85], v9 offset:25088
  ds_read_b64_tr_b16 v[86:87], v9 offset:25344
  s_waitcnt lgkmcnt(10)
  v_mfma_f32_16x16x32_bf16 v[24:27], v[4:7], v[64:67], v[24:27]
  ds_read_b64_tr_b16 v[88:89], v9 offset:26624
  ds_read_b64_tr_b16 v[90:91], v9 offset:26880
  s_waitcnt lgkmcnt(10)
  v_mfma_f32_16x16x32_bf16 v[24:27], v[4:7], v[68:71], v[24:27]
  ds_read_b64_tr_b16 v[92:93], v9 offset:27136
  ds_read_b64_tr_b16 v[94:95], v9 offset:27392
  s_waitcnt lgkmcnt(10)
  v_mfma_f32_16x16x32_bf16 v[24:27], v[4:7], v[72:75], v[24:27]
  s_waitcnt lgkmcnt(8)
  v_mfma_f32_16x16x32_bf16 v[24:27], v[4:7], v[76:79], v[24:27]
  s_waitcnt lgkmcnt(6)
  v_mfma_f32_16x16x32_bf16 v[24:27], v[4:7], v[80:83], v[24:27]
  s_waitcnt lgkmcnt(4)
  v_mfma_f32_16x16x32_bf16 v[24:27], v[4:7], v[84:87], v[24:27]
  s_waitcnt lgkmcnt(2)
  v_mfma_f32_16x16x32_bf16 v[24:27], v[4:7], v[88:91], v[24:27]
  s_waitcnt lgkmcnt(0)
  v_mfma_f32_16x16x32_bf16 v[24:27], v[4:7], v[92:95], v[24:27]
  v_and_b32 v9, 31, v0
  v_lshlrev_b32 v9, 3, v9
  s_lshr_b32 s47, s44, 1
  s_lshl_b32 s47, s47, 8
  s_and_b32 s46, s44, 1
  s_lshl_b32 s46, s46, 2
  s_add_u32 s47, s47, s46
  v_add_u32 v9, s47, v9
  v_cvt_pk_bf16_f32 v6, v24, v24
  v_and_b32 v6, 0xffff0000, v6
  v_sub_f32 v6, v24, v6
  v_cvt_pk_bf16_f32 v12, v24, v6
  ds_write_b32 v9, v12 offset:6656
  s_setprio 0
  s_waitcnt lgkmcnt(0)
L_cse_310:
  ds_write_b32 v11, v29 offset:2112
  v_bfe_u32 v6, v0, 4, 1
  v_bfe_u32 v4, v0, 2, 1
  v_lshl_or_b32 v4, v6, 1, v4
  v_bfe_u32 v6, v0, 3, 1
  v_lshl_or_b32 v4, v4, 1, v6
  v_mul_u32_u24 v4, 22016, v4
  v_and_b32 v6, 3, v0
  v_lshl_add_u32 v4, v6, 4, v4
  v_lshrrev_b32 v6, 5, v0
  v_lshl_add_u32 v4, v6, 6, v4
  buffer_load_dwordx4 v[128:131], v4, s[28:31], s54 offen
  buffer_load_dwordx4 v[192:195], v4, s[32:35], s54 offen
  s_add_u32 s46, s54, 2752
  buffer_load_dwordx4 v[132:135], v4, s[28:31], s46 offen
  buffer_load_dwordx4 v[196:199], v4, s[32:35], s46 offen
  s_add_u32 s46, s54, 5504
  buffer_load_dwordx4 v[136:139], v4, s[28:31], s46 offen
  buffer_load_dwordx4 v[200:203], v4, s[32:35], s46 offen
  s_add_u32 s46, s54, 8256
  buffer_load_dwordx4 v[140:143], v4, s[28:31], s46 offen
  buffer_load_dwordx4 v[204:207], v4, s[32:35], s46 offen
  s_add_u32 s46, s54, 11008
  buffer_load_dwordx4 v[144:147], v4, s[28:31], s46 offen
  buffer_load_dwordx4 v[208:211], v4, s[32:35], s46 offen
  s_add_u32 s46, s54, 13760
  buffer_load_dwordx4 v[148:151], v4, s[28:31], s46 offen
  buffer_load_dwordx4 v[212:215], v4, s[32:35], s46 offen
  s_mov_b32 s46, 0x05040100
  s_mov_b32 s47, 0x07060302
  s_waitcnt vmcnt(19)
  v_perm_b32 v12, v100, v96, s46
  v_perm_b32 v100, v100, v96, s47
  v_mov_b32 v96, v12
  v_perm_b32 v14, v101, v97, s46
  v_perm_b32 v15, v101, v97, s47
  s_waitcnt vmcnt(17)
  v_perm_b32 v97, v108, v104, s46
  v_perm_b32 v101, v108, v104, s47
  v_mov_b32 v104, v14
  v_mov_b32 v108, v15
  v_perm_b32 v12, v102, v98, s46
  v_perm_b32 v13, v102, v98, s47
  s_waitcnt vmcnt(15)
  v_perm_b32 v98, v116, v112, s46
  v_perm_b32 v102, v116, v112, s47
  v_mov_b32 v112, v12
  v_mov_b32 v116, v13
  v_perm_b32 v14, v103, v99, s46
  v_perm_b32 v15, v103, v99, s47
  s_waitcnt vmcnt(13)
  v_perm_b32 v99, v124, v120, s46
  v_perm_b32 v103, v124, v120, s47
  v_mov_b32 v120, v14
  v_mov_b32 v124, v15
  v_perm_b32 v12, v109, v105, s46
  v_perm_b32 v109, v109, v105, s47
  v_mov_b32 v105, v12
  v_perm_b32 v14, v110, v106, s46
  v_perm_b32 v15, v110, v106, s47
  v_perm_b32 v106, v117, v113, s46
  v_perm_b32 v110, v117, v113, s47
  v_mov_b32 v113, v14
  v_mov_b32 v117, v15
  v_perm_b32 v12, v111, v107, s46
  v_perm_b32 v13, v111, v107, s47
  v_perm_b32 v107, v125, v121, s46
  v_perm_b32 v111, v125, v121, s47
  v_mov_b32 v121, v12
  v_mov_b32 v125, v13
  v_perm_b32 v14, v118, v114, s46
  v_perm_b32 v118, v118, v114, s47
  v_mov_b32 v114, v14
  v_perm_b32 v12, v119, v115, s46
  v_perm_b32 v13, v119, v115, s47
  v_perm_b32 v115, v126, v122, s46
  v_perm_b32 v119, v126, v122, s47
  v_mov_b32 v122, v12
  v_mov_b32 v126, v13
  v_perm_b32 v14, v127, v123, s46
  v_perm_b32 v127, v127, v123, s47
  v_mov_b32 v123, v14
  v_lshrrev_b32 v6, 5, v0
  v_lshlrev_b32 v5, 4, v6
  v_xor_b32 v5, v5, v31
  v_add_u32 v6, s44, v6
  v_lshl_add_u32 v5, v6, 12, v5
  v_xor_b32 v6, 16, v5
  s_nop 1
L_hw_313:
  ds_read_b32 v7, v10 offset:64
  s_waitcnt lgkmcnt(0)
  v_cmp_gt_u32 vcc, v29, v7
  s_cbranch_vccz L_hwe_314
  s_sleep 1
  s_sub_u32 s56, s56, 1
  s_cbranch_scc0 L_hw_313
  s_mov_b32 s56, 0
L_hwe_314:
  ds_write_b128 v5, v[96:99] offset:0
  ds_write_b128 v6, v[100:103] offset:0
  ds_write_b128 v5, v[104:107] offset:128
  ds_write_b128 v6, v[108:111] offset:128
  ds_write_b128 v5, v[112:115] offset:256
  ds_write_b128 v6, v[116:119] offset:256
  ds_write_b128 v5, v[120:123] offset:384
  ds_write_b128 v6, v[124:127] offset:384
  ds_write_b32 v11, v29 offset:1920
  v_bfe_u32 v6, v0, 4, 1
  v_bfe_u32 v4, v0, 2, 1
  v_lshl_or_b32 v4, v6, 1, v4
  v_bfe_u32 v6, v0, 3, 1
  v_lshl_or_b32 v4, v4, 1, v6
  v_mul_u32_u24 v4, 22016, v4
  v_and_b32 v6, 3, v0
  v_lshl_add_u32 v4, v6, 4, v4
  v_lshrrev_b32 v6, 5, v0
  v_lshl_add_u32 v4, v6, 6, v4
  s_add_u32 s46, s54, 16512
  buffer_load_dwordx4 v[152:155], v4, s[28:31], s46 offen
  buffer_load_dwordx4 v[216:219], v4, s[32:35], s46 offen
  s_add_u32 s46, s54, 19264
  buffer_load_dwordx4 v[156:159], v4, s[28:31], s46 offen
  buffer_load_dwordx4 v[220:223], v4, s[32:35], s46 offen
  s_add_u32 s46, s54, 704512
  buffer_load_dwordx4 v[160:163], v4, s[28:31], s46 offen
  buffer_load_dwordx4 v[224:227], v4, s[32:35], s46 offen
  s_add_u32 s46, s54, 707264
  buffer_load_dwordx4 v[164:167], v4, s[28:31], s46 offen
  s_waitcnt vmcnt(19)
  buffer_load_dwordx4 v[228:231], v4, s[32:35], s46 offen
  s_cmp_ge_u32 s44, 2
  s_cbranch_scc1 L_cse_315
L_hw_316:
  ds_read_b32 v7, v10 offset:1920
  s_waitcnt lgkmcnt(0)
  v_cmp_gt_u32 vcc, v29, v7
  s_cbranch_vccz L_hwe_317
  s_sleep 1
  s_sub_u32 s56, s56, 1
  s_cbranch_scc0 L_hw_316
  s_mov_b32 s56, 0
L_hwe_317:
  s_setprio 3
  s_lshl_b32 s47, s44, 14
  s_add_u32 s47, s47, 73728
  v_lshlrev_b32 v5, 4, v0
  v_and_b32 v9, 0x250, v5
  v_bfe_u32 v6, v5, 7, 1
  v_lshl_or_b32 v9, v6, 8, v9
  v_bfe_u32 v6, v5, 5, 1
  v_lshl_or_b32 v9, v6, 7, v9
  v_bfe_u32 v6, v5, 8, 1
  v_lshl_or_b32 v9, v6, 5, v9
  v_lshrrev_b32 v6, 5, v5
  v_and_b32 v6, 16, v6
  v_xad_u32 v9, v9, v6, s47
  ds_read_b128 v[232:235], v9 offset:0
  ds_read_b128 v[236:239], v9 offset:1024
  ds_read_b128 v[240:243], v9 offset:2048
  ds_read_b128 v[244:247], v9 offset:3072
  ds_read_b128 v[248:251], v9 offset:4096
  ds_read_b128 v[252:255], v9 offset:5120
  s_mov_b32 s46, 0xf0f00f0f
  s_mov_b32 s47, 0xf0f00f0f
  v_mov_b32 v4, s51
  v_cndmask_b32 v4, 0, v4, s[46:47]
  v_mov_b32 v5, v4
  v_mov_b32 v6, v4
  v_mov_b32 v7, v4
  s_waitcnt lgkmcnt(5)
  s_nop 0
  v_mfma_f32_16x16x32_bf16 v[24:27], v[4:7], v[232:235], 0
  ds_read_b128 v[232:235], v9 offset:6144
  s_waitcnt lgkmcnt(5)
  v_mfma_f32_16x16x32_bf16 v[24:27], v[4:7], v[236:239], v[24:27]
  ds_read_b128 v[236:239], v9 offset:7168
  s_waitcnt lgkmcnt(5)
  v_mfma_f32_16x16x32_bf16 v[24:27], v[4:7], v[240:243], v[24:27]
  ds_read_b128 v[240:243], v9 offset:8192
  s_waitcnt lgkmcnt(5)
  v_mfma_f32_16x16x32_bf16 v[24:27], v[4:7], v[244:247], v[24:27]
  ds_read_b128 v[244:247], v9 offset:9216
  s_waitcnt lgkmcnt(5)
  v_mfma_f32_16x16x32_bf16 v[24:27], v[4:7], v[248:251], v[24:27]
  ds_read_b128 v[248:251], v9 offset:10240
  s_waitcnt lgkmcnt(5)
  v_mfma_f32_16x16x32_bf16 v[24:27], v[4:7], v[252:255], v[24:27]
  ds_read_b128 v[252:255], v9 offset:11264
  s_waitcnt lgkmcnt(5)
  v_mfma_f32_16x16x32_bf16 v[24:27], v[4:7], v[232:235], v[24:27]
  ds_read_b128 v[232:235], v9 offset:12288
  s_waitcnt lgkmcnt(5)
  v_mfma_f32_16x16x32_bf16 v[24:27], v[4:7], v[236:239], v[24:27]
  ds_read_b128 v[236:239], v9 offset:13312
  s_waitcnt lgkmcnt(5)
  v_mfma_f32_16x16x32_bf16 v[24:27], v[4:7], v[240:243], v[24:27]
  ds_read_b128 v[240:243], v9 offset:14336
  s_waitcnt lgkmcnt(5)
  v_mfma_f32_16x16x32_bf16 v[24:27], v[4:7], v[244:247], v[24:27]
  ds_read_b128 v[244:247], v9 offset:15360
  s_waitcnt lgkmcnt(5)
  v_mfma_f32_16x16x32_bf16 v[24:27], v[4:7], v[248:251], v[24:27]
  s_waitcnt lgkmcnt(4)
  v_mfma_f32_16x16x32_bf16 v[24:27], v[4:7], v[252:255], v[24:27]
  s_waitcnt lgkmcnt(3)
  v_mfma_f32_16x16x32_bf16 v[24:27], v[4:7], v[232:235], v[24:27]
  s_waitcnt lgkmcnt(2)
  v_mfma_f32_16x16x32_bf16 v[24:27], v[4:7], v[236:239], v[24:27]
  s_waitcnt lgkmcnt(1)
  v_mfma_f32_16x16x32_bf16 v[24:27], v[4:7], v[240:243], v[24:27]
  s_waitcnt lgkmcnt(0)
  v_mfma_f32_16x16x32_bf16 v[24:27], v[4:7], v[244:247], v[24:27]
  v_and_b32 v9, 31, v0
  v_lshlrev_b32 v9, 3, v9
  s_lshr_b32 s47, s44, 1
  s_lshl_b32 s47, s47, 8
  s_and_b32 s46, s44, 1
  s_lshl_b32 s46, s46, 2
  s_add_u32 s47, s47, s46
  v_add_u32 v9, s47, v9
  v_cvt_pk_bf16_f32 v6, v24, v24
  v_and_b32 v6, 0xffff0000, v6
  v_sub_f32 v6, v24, v6
  v_cvt_pk_bf16_f32 v12, v24, v6
  ds_write_b32 v9, v12 offset:7168
  s_setprio 0
  s_waitcnt lgkmcnt(0)
L_cse_315:
  ds_write_b32 v11, v29 offset:1344
  s_cmp_lg_u32 s14, 7
  s_cbranch_scc1 L_pe_318
  s_lshl_b32 s46, s12, 8
  s_lshl_b32 s47, s13, 2
  v_add_u32 v5, s46, v10
  v_lshlrev_b32 v6, 6, v10
  v_add_u32 v6, s47, v6
  s_mov_b32 vcc_lo, 0xffff0000
  s_mov_b32 vcc_hi, 0xffff0000
  v_cndmask_b32 v5, v5, v6, vcc
  s_mov_b32 s47, 0x20000
  s_nop 0
L_pl_319:
  buffer_load_dword v7, v5, s[4:7], s47 offen sc1
  s_waitcnt vmcnt(0)
  v_xor_b32 v6, s10, v7
  v_cmp_lt_u32 vcc, 15, v6
  s_nop 4
  s_cbranch_vccz L_pk_320
  s_sub_u32 s56, s56, 16
  s_cbranch_scc0 L_pl_319
  s_mov_b32 s56, 0
L_pk_320:
  v_cmp_ne_u32 vcc, s10, v7
  s_nop 0
  s_and_b32 vcc_lo, vcc_lo, 0xffff
  s_cselect_b32 s11, 1, 2
  v_mov_b32 v6, s11
  ds_write_b32 v10, v6 offset:1152
  s_waitcnt lgkmcnt(0)
L_pe_318:
L_hw_321:
  ds_read_b32 v7, v10 offset:128
  s_waitcnt lgkmcnt(0)
  v_cmp_gt_u32 vcc, v29, v7
  s_cbranch_vccz L_hwe_322
  s_sleep 1
  s_sub_u32 s56, s56, 1
  s_cbranch_scc0 L_hw_321
  s_mov_b32 s56, 0
L_hwe_322:
  s_add_u32 m0, s49, 8192
  s_nop 0
  buffer_load_dwordx4 v28, s[28:31], s53 offen lds
  s_add_u32 m0, s49, 40960
  s_nop 0
  buffer_load_dwordx4 v28, s[32:35], s53 offen lds
  s_add_u32 s47, s53, 176128
  s_add_u32 m0, s49, 12288
  s_nop 0
  buffer_load_dwordx4 v28, s[28:31], s47 offen lds
  s_add_u32 s47, s53, 176128
  s_add_u32 m0, s49, 45056
  s_nop 0
  buffer_load_dwordx4 v28, s[32:35], s47 offen lds
  s_add_u32 s46, s53, 352256
  s_add_u32 m0, s49, 16384
  s_nop 0
  buffer_load_dwordx4 v28, s[28:31], s46 offen lds
  s_add_u32 s46, s53, 352256
  s_add_u32 m0, s49, 49152
  s_nop 0
  buffer_load_dwordx4 v28, s[32:35], s46 offen lds
  s_add_u32 s47, s53, 528384
  s_add_u32 m0, s49, 20480
  s_nop 0
  buffer_load_dwordx4 v28, s[28:31], s47 offen lds
  s_add_u32 s47, s53, 528384
  s_add_u32 m0, s49, 53248
  s_nop 0
  buffer_load_dwordx4 v28, s[32:35], s47 offen lds
  s_add_u32 s46, s53, 704512
  s_add_u32 m0, s49, 24576
  s_nop 0
  buffer_load_dwordx4 v28, s[28:31], s46 offen lds
  s_add_u32 s46, s53, 704512
  s_add_u32 m0, s49, 57344
  s_nop 0
  buffer_load_dwordx4 v28, s[32:35], s46 offen lds
L_hw_323:
  ds_read_b32 v7, v10 offset:1152
  s_waitcnt lgkmcnt(0)
  v_cmp_eq_u32 vcc, 0, v7
  s_cbranch_vccz L_hwe_324
  s_sleep 1
  s_sub_u32 s56, s56, 1
  s_cbranch_scc0 L_hw_323
  s_mov_b32 s56, 0
L_hwe_324:
  v_readfirstlane_b32 s19, v7
  v_mov_b32 v16, -1
  v_mov_b32 v17, -1
  v_mov_b32 v18, -1
  v_mov_b32 v19, -1
  v_lshlrev_b32 v5, 4, v0
  v_lshlrev_b32 v6, 3, v0
  s_add_u32 s46, s8, 0x0
  s_add_u32 s47, s9, 0x0
  s_cmp_eq_u32 s19, 1
  s_cbranch_scc1 L_ms_325
  buffer_store_dwordx4 v[16:19], v5, s[4:7], s46 offen offset:0
  buffer_store_dwordx4 v[16:19], v5, s[4:7], s46 offen offset:1024
  s_mov_b32 exec_hi, 0
  buffer_store_dwordx2 v[16:17], v6, s[4:7], s47 offen
  s_mov_b32 exec_hi, -1
  s_branch L_me_326
L_ms_325:
  buffer_store_dwordx4 v[16:19], v5, s[4:7], s46 offen offset:0 sc1
  buffer_store_dwordx4 v[16:19], v5, s[4:7], s46 offen offset:1024 sc1
  s_mov_b32 exec_hi, 0
  buffer_store_dwordx2 v[16:17], v6, s[4:7], s47 offen sc1
  s_mov_b32 exec_hi, -1
L_me_326:
L_hw_327:
  ds_read_b32 v7, v10 offset:2496
  s_waitcnt lgkmcnt(0)
  v_cmp_gt_u32 vcc, v29, v7
  s_cbranch_vccz L_hwe_328
  s_sleep 1
  s_sub_u32 s56, s56, 1
  s_cbranch_scc0 L_hw_327
  s_mov_b32 s56, 0
L_hwe_328:
  s_add_u32 s46, s55, 262144
  s_add_u32 m0, s49, 106496
  s_nop 0
  buffer_load_dwordx4 v30, s[24:27], s46 offen lds
  s_add_u32 s47, s55, 294912
  s_add_u32 m0, s49, 110592
  s_nop 0
  buffer_load_dwordx4 v30, s[24:27], s47 offen lds
  s_add_u32 s46, s55, 327680
  s_add_u32 m0, s49, 114688
  s_nop 0
  buffer_load_dwordx4 v30, s[24:27], s46 offen lds
  s_add_u32 s47, s55, 360448
  s_add_u32 m0, s49, 118784
  s_nop 0
  buffer_load_dwordx4 v30, s[24:27], s47 offen lds
  s_add_u32 s46, s55, 393216
  s_add_u32 m0, s49, 122880
  s_nop 0
  buffer_load_dwordx4 v30, s[24:27], s46 offen lds
  s_add_u32 s47, s55, 425984
  s_add_u32 m0, s49, 126976
  s_nop 0
  buffer_load_dwordx4 v30, s[24:27], s47 offen lds
  s_add_u32 s46, s55, 458752
  s_add_u32 m0, s49, 131072
  s_nop 0
  buffer_load_dwordx4 v30, s[24:27], s46 offen lds
  s_add_u32 s47, s55, 491520
  s_add_u32 m0, s49, 135168
  s_nop 0
  buffer_load_dwordx4 v30, s[24:27], s47 offen lds
  s_waitcnt vmcnt(8)
  ds_write_b32 v11, v29 offset:2688
L_hw_329:
  ds_read_b32 v7, v10 offset:256
  s_waitcnt lgkmcnt(0)
  v_cmp_gt_u32 vcc, v29, v7
  s_cbranch_vccz L_hwe_330
  s_sleep 1
  s_sub_u32 s56, s56, 1
  s_cbranch_scc0 L_hw_329
  s_mov_b32 s56, 0
L_hwe_330:
  s_add_u32 m0, s49, 73728
  s_nop 0
  buffer_load_dwordx4 v30, s[24:27], s55 offen lds
  s_add_u32 s47, s55, 32768
  s_add_u32 m0, s49, 77824
  s_nop 0
  buffer_load_dwordx4 v30, s[24:27], s47 offen lds
  s_add_u32 s46, s55, 65536
  s_add_u32 m0, s49, 81920
  s_nop 0
  buffer_load_dwordx4 v30, s[24:27], s46 offen lds
  s_add_u32 s47, s55, 98304
  s_add_u32 m0, s49, 86016
  s_nop 0
  buffer_load_dwordx4 v30, s[24:27], s47 offen lds
  s_add_u32 s46, s55, 131072
  s_add_u32 m0, s49, 90112
  s_nop 0
  buffer_load_dwordx4 v30, s[24:27], s46 offen lds
  s_add_u32 s47, s55, 163840
  s_add_u32 m0, s49, 94208
  s_nop 0
  buffer_load_dwordx4 v30, s[24:27], s47 offen lds
  s_add_u32 s46, s55, 196608
  s_add_u32 m0, s49, 98304
  s_nop 0
  buffer_load_dwordx4 v30, s[24:27], s46 offen lds
  s_add_u32 s47, s55, 229376
  s_add_u32 m0, s49, 102400
  s_nop 0
  buffer_load_dwordx4 v30, s[24:27], s47 offen lds
  v_mov_b32 v16, -1
  v_mov_b32 v17, -1
  v_mov_b32 v18, -1
  v_mov_b32 v19, -1
  v_lshlrev_b32 v5, 4, v0
  v_lshlrev_b32 v6, 3, v0
  s_add_u32 s46, s8, 0xffe00000
  s_add_u32 s47, s9, 0xfffc0000
  s_cmp_eq_u32 s19, 1
  s_cbranch_scc1 L_ms_331
  buffer_store_dwordx4 v[16:19], v5, s[4:7], s46 offen offset:0
  buffer_store_dwordx4 v[16:19], v5, s[4:7], s46 offen offset:1024
  s_mov_b32 exec_hi, 0
  buffer_store_dwordx2 v[16:17], v6, s[4:7], s47 offen
  s_mov_b32 exec_hi, -1
  s_branch L_me_332
L_ms_331:
  buffer_store_dwordx4 v[16:19], v5, s[4:7], s46 offen offset:0 sc1
  buffer_store_dwordx4 v[16:19], v5, s[4:7], s46 offen offset:1024 sc1
  s_mov_b32 exec_hi, 0
  buffer_store_dwordx2 v[16:17], v6, s[4:7], s47 offen sc1
  s_mov_b32 exec_hi, -1
L_me_332:
  v_mov_b32 v16, -1
  v_mov_b32 v17, -1
  v_mov_b32 v18, -1
  v_mov_b32 v19, -1
  v_lshlrev_b32 v5, 4, v0
  s_cmp_eq_u32 s19, 1
  s_nop 0
  s_cbranch_scc1 L_ms_333
  s_add_u32 s46, s18, 0
  buffer_store_dwordx4 v[16:19], v5, s[4:7], s46 offen
  s_add_u32 s46, s18, 44032
  buffer_store_dwordx4 v[16:19], v5, s[4:7], s46 offen
  s_add_u32 s46, s18, 16384
  buffer_store_dwordx4 v[16:19], v5, s[4:7], s46 offen
  s_add_u32 s46, s18, 60416
  buffer_store_dwordx4 v[16:19], v5, s[4:7], s46 offen
  s_cmp_eq_u32 s15, 0
  s_nop 0
  s_cbranch_scc1 L_hc_335
  s_add_u32 s46, s18, 32768
  buffer_store_dwordx4 v[16:19], v5, s[4:7], s46 offen
  s_add_u32 s46, s18, 76800
  buffer_store_dwordx4 v[16:19], v5, s[4:7], s46 offen
  s_nop 1
L_hc_335:
  s_branch L_me_334
L_ms_333:
  s_add_u32 s46, s18, 0
  buffer_store_dwordx4 v[16:19], v5, s[4:7], s46 offen sc1
  s_add_u32 s46, s18, 44032
  buffer_store_dwordx4 v[16:19], v5, s[4:7], s46 offen sc1
  s_add_u32 s46, s18, 16384
  buffer_store_dwordx4 v[16:19], v5, s[4:7], s46 offen sc1
  s_add_u32 s46, s18, 60416
  buffer_store_dwordx4 v[16:19], v5, s[4:7], s46 offen sc1
  s_cmp_eq_u32 s15, 0
  s_nop 0
  s_cbranch_scc1 L_hc_336
  s_add_u32 s46, s18, 32768
  buffer_store_dwordx4 v[16:19], v5, s[4:7], s46 offen sc1
  s_add_u32 s46, s18, 76800
  buffer_store_dwordx4 v[16:19], v5, s[4:7], s46 offen sc1
  s_nop 1
L_hc_336:
L_me_334:
  s_waitcnt vmcnt(0)
  ds_write_b32 v11, v29 offset:1408
  s_add_u32 s47, s53, 880640
  s_add_u32 m0, s49, 28672
  s_nop 0
  buffer_load_dwordx4 v28, s[28:31], s47 offen lds
  s_add_u32 s47, s53, 880640
  s_add_u32 m0, s49, 61440
  s_nop 0
  buffer_load_dwordx4 v28, s[32:35], s47 offen lds
  s_add_u32 s46, s53, 1056768
  s_add_u32 m0, s49, 32768
  s_nop 0
  buffer_load_dwordx4 v28, s[28:31], s46 offen lds
  s_add_u32 s46, s53, 1056768
  s_add_u32 m0, s49, 65536
  s_nop 0
  buffer_load_dwordx4 v28, s[32:35], s46 offen lds
  s_add_u32 s47, s53, 1232896
  s_add_u32 m0, s49, 36864
  s_nop 0
  buffer_load_dwordx4 v28, s[28:31], s47 offen lds
  s_add_u32 s47, s53, 1232896
  s_add_u32 m0, s49, 69632
  s_nop 0
  buffer_load_dwordx4 v28, s[32:35], s47 offen lds
  s_mov_b32 s46, 0x05040100
  s_mov_b32 s47, 0x07060302
  v_perm_b32 v12, v132, v128, s46
  v_perm_b32 v132, v132, v128, s47
  v_mov_b32 v128, v12
  v_perm_b32 v14, v133, v129, s46
  v_perm_b32 v15, v133, v129, s47
  v_permlane32_swap_b32 v128, v132
  v_perm_b32 v129, v140, v136, s46
  v_perm_b32 v133, v140, v136, s47
  v_mov_b32 v136, v14
  v_mov_b32 v140, v15
  v_perm_b32 v12, v134, v130, s46
  v_perm_b32 v13, v134, v130, s47
  v_permlane32_swap_b32 v129, v133
  v_permlane32_swap_b32 v136, v140
  v_perm_b32 v130, v148, v144, s46
  v_perm_b32 v134, v148, v144, s47
  v_mov_b32 v144, v12
  v_mov_b32 v148, v13
  v_perm_b32 v14, v135, v131, s46
  v_perm_b32 v15, v135, v131, s47
  v_permlane32_swap_b32 v130, v134
  v_permlane32_swap_b32 v144, v148
  v_perm_b32 v131, v156, v152, s46
  v_perm_b32 v135, v156, v152, s47
  v_mov_b32 v152, v14
  v_mov_b32 v156, v15
  v_perm_b32 v12, v141, v137, s46
  v_perm_b32 v141, v141, v137, s47
  v_permlane32_swap_b32 v131, v135
  v_permlane32_swap_b32 v152, v156
  v_mov_b32 v137, v12
  v_perm_b32 v14, v142, v138, s46
  v_perm_b32 v15, v142, v138, s47
  v_permlane32_swap_b32 v137, v141
  v_perm_b32 v138, v149, v145, s46
  v_perm_b32 v142, v149, v145, s47
  v_mov_b32 v145, v14
  v_mov_b32 v149, v15
  v_perm_b32 v12, v143, v139, s46
  v_perm_b32 v13, v143, v139, s47
  v_permlane32_swap_b32 v138, v142
  v_permlane32_swap_b32 v145, v149
  v_perm_b32 v139, v157, v153, s46
  v_perm_b32 v143, v157, v153, s47
  v_mov_b32 v153, v12
  v_mov_b32 v157, v13
  v_perm_b32 v14, v150, v146, s46
  v_perm_b32 v150, v150, v146, s47
  v_permlane32_swap_b32 v139, v143
  v_permlane32_swap_b32 v153, v157
  v_mov_b32 v146, v14
  v_perm_b32 v12, v151, v147, s46
  v_perm_b32 v13, v151, v147, s47
  v_permlane32_swap_b32 v146, v150
  v_perm_b32 v147, v158, v154, s46
  v_perm_b32 v151, v158, v154, s47
  v_mov_b32 v154, v12
  v_mov_b32 v158, v13
  v_perm_b32 v14, v159, v155, s46
  v_perm_b32 v159, v159, v155, s47
  v_permlane32_swap_b32 v147, v151
  v_permlane32_swap_b32 v154, v158
  v_mov_b32 v155, v14
  s_nop 1
  v_permlane32_swap_b32 v155, v159
  s_mov_b32 s46, 0x05040100
  s_mov_b32 s47, 0x07060302
  v_perm_b32 v12, v196, v192, s46
  v_perm_b32 v196, v196, v192, s47
  v_mov_b32 v192, v12
  v_perm_b32 v14, v197, v193, s46
  v_perm_b32 v15, v197, v193, s47
  v_permlane32_swap_b32 v192, v196
  v_perm_b32 v193, v204, v200, s46
  v_perm_b32 v197, v204, v200, s47
  v_mov_b32 v200, v14
  v_mov_b32 v204, v15
  v_perm_b32 v12, v198, v194, s46
  v_perm_b32 v13, v198, v194, s47
  v_permlane32_swap_b32 v193, v197
  v_permlane32_swap_b32 v200, v204
  v_perm_b32 v194, v212, v208, s46
  v_perm_b32 v198, v212, v208, s47
  v_mov_b32 v208, v12
  v_mov_b32 v212, v13
  v_perm_b32 v14, v199, v195, s46
  v_perm_b32 v15, v199, v195, s47
  v_permlane32_swap_b32 v194, v198
  v_permlane32_swap_b32 v208, v212
  v_perm_b32 v195, v220, v216, s46
  v_perm_b32 v199, v220, v216, s47
  v_mov_b32 v216, v14
  v_mov_b32 v220, v15
  v_perm_b32 v12, v205, v201, s46
  v_perm_b32 v205, v205, v201, s47
  v_permlane32_swap_b32 v195, v199
  v_permlane32_swap_b32 v216, v220
  v_mov_b32 v201, v12
  v_perm_b32 v14, v206, v202, s46
  v_perm_b32 v15, v206, v202, s47
  v_permlane32_swap_b32 v201, v205
  v_perm_b32 v202, v213, v209, s46
  v_perm_b32 v206, v213, v209, s47
  v_mov_b32 v209, v14
  v_mov_b32 v213, v15
  v_perm_b32 v12, v207, v203, s46
  v_perm_b32 v13, v207, v203, s47
  v_permlane32_swap_b32 v202, v206
  v_permlane32_swap_b32 v209, v213
  v_perm_b32 v203, v221, v217, s46
  v_perm_b32 v207, v221, v217, s47
  v_mov_b32 v217, v12
  v_mov_b32 v221, v13
  v_perm_b32 v14, v214, v210, s46
  v_perm_b32 v214, v214, v210, s47
  v_permlane32_swap_b32 v203, v207
  v_permlane32_swap_b32 v217, v221
  v_mov_b32 v210, v14
  v_perm_b32 v12, v215, v211, s46
  v_perm_b32 v13, v215, v211, s47
  v_permlane32_swap_b32 v210, v214
  v_perm_b32 v211, v222, v218, s46
  v_perm_b32 v215, v222, v218, s47
  v_mov_b32 v218, v12
  v_mov_b32 v222, v13
  v_perm_b32 v14, v223, v219, s46
  v_perm_b32 v223, v223, v219, s47
  v_permlane32_swap_b32 v211, v215
  v_permlane32_swap_b32 v218, v222
  v_mov_b32 v219, v14
  s_nop 1
  v_permlane32_swap_b32 v219, v223
  s_waitcnt vmcnt(0)
  ds_write_b32 v11, v29 offset:2880
L_hw_337:
  ds_read_b32 v7, v10 offset:2560
  s_waitcnt lgkmcnt(0)
  v_cmp_gt_u32 vcc, v29, v7
  s_cbranch_vccz L_hwe_338
  s_sleep 1
  s_sub_u32 s56, s56, 1
  s_cbranch_scc0 L_hw_337
  s_mov_b32 s56, 0
L_hwe_338:
  v_bfe_u32 v6, v0, 4, 1
  v_bfe_u32 v4, v0, 2, 1
  v_lshl_or_b32 v4, v6, 1, v4
  v_bfe_u32 v6, v0, 3, 1
  v_lshl_or_b32 v4, v4, 1, v6
  v_mul_u32_u24 v4, 22016, v4
  v_and_b32 v6, 3, v0
  v_lshl_add_u32 v4, v6, 4, v4
  v_lshrrev_b32 v6, 5, v0
  v_lshl_add_u32 v4, v6, 6, v4
  s_add_u32 s46, s54, 710016
  buffer_load_dwordx4 v[168:171], v4, s[28:31], s46 offen
  buffer_load_dwordx4 v[232:235], v4, s[32:35], s46 offen
  s_add_u32 s46, s54, 712768
  buffer_load_dwordx4 v[172:175], v4, s[28:31], s46 offen
  buffer_load_dwordx4 v[236:239], v4, s[32:35], s46 offen
  s_add_u32 s46, s54, 715520
  buffer_load_dwordx4 v[176:179], v4, s[28:31], s46 offen
  buffer_load_dwordx4 v[240:243], v4, s[32:35], s46 offen
  s_add_u32 s46, s54, 718272
  buffer_load_dwordx4 v[180:183], v4, s[28:31], s46 offen
  buffer_load_dwordx4 v[244:247], v4, s[32:35], s46 offen
  s_add_u32 s46, s54, 721024
  buffer_load_dwordx4 v[184:187], v4, s[28:31], s46 offen
  buffer_load_dwordx4 v[248:251], v4, s[32:35], s46 offen
  s_add_u32 s46, s54, 723776
  buffer_load_dwordx4 v[188:191], v4, s[28:31], s46 offen
  buffer_load_dwordx4 v[252:255], v4, s[32:35], s46 offen
L_hw_340:
  ds_read_b32 v7, v10 offset:1408
  s_waitcnt lgkmcnt(0)
  v_cmp_gt_u32 vcc, v29, v7
  s_cbranch_vccz L_hwe_341
  s_sleep 1
  s_sub_u32 s56, s56, 1
  s_cbranch_scc0 L_hw_340
  s_mov_b32 s56, 0
L_hwe_341:
  s_setprio 3
  s_lshl_b32 s47, s44, 14
  s_add_u32 s47, s47, 8192
  v_add_u32 v9, s47, v8
  ds_read_b64_tr_b16 v[12:13], v9 offset:0
  ds_read_b64_tr_b16 v[14:15], v9 offset:256
  ds_read_b64_tr_b16 v[16:17], v9 offset:512
  ds_read_b64_tr_b16 v[18:19], v9 offset:768
  ds_read_b64_tr_b16 v[20:21], v9 offset:2048
  ds_read_b64_tr_b16 v[22:23], v9 offset:2304
  s_mov_b32 s46, 0xf0f00f0f
  s_mov_b32 s47, 0xf0f00f0f
  v_mov_b32 v4, s51
  v_cndmask_b32 v4, 0, v4, s[46:47]
  v_mov_b32 v5, v4
  v_mov_b32 v6, v4
  v_mov_b32 v7, v4
  s_waitcnt lgkmcnt(4)
  s_nop 0
  v_mfma_f32_16x16x32_bf16 v[24:27], v[4:7], v[12:15], 0
  ds_read_b64_tr_b16 v[12:13], v9 offset:2560
  ds_read_b64_tr_b16 v[14:15], v9 offset:2816
  s_waitcnt lgkmcnt(4)
  v_mfma_f32_16x16x32_bf16 v[24:27], v[4:7], v[16:19], v[24:27]
  ds_read_b64_tr_b16 v[16:17], v9 offset:4096
  ds_read_b64_tr_b16 v[18:19], v9 offset:4352
  s_waitcnt lgkmcnt(4)
  v_mfma_f32_16x16x32_bf16 v[24:27], v[4:7], v[20:23], v[24:27]
  ds_read_b64_tr_b16 v[20:21], v9 offset:4608
  ds_read_b64_tr_b16 v[22:23], v9 offset:4864
  s_waitcnt lgkmcnt(4)
  v_mfma_f32_16x16x32_bf16 v[24:27], v[4:7], v[12:15], v[24:27]
  ds_read_b64_tr_b16 v[12:13], v9 offset:6144
  ds_read_b64_tr_b16 v[14:15], v9 offset:6400
  s_waitcnt lgkmcnt(4)
  v_mfma_f32_16x16x32_bf16 v[24:27], v[4:7], v[16:19], v[24:27]
  ds_read_b64_tr_b16 v[16:17], v9 offset:6656
  ds_read_b64_tr_b16 v[18:19], v9 offset:6912
  s_waitcnt lgkmcnt(4)
  v_mfma_f32_16x16x32_bf16 v[24:27], v[4:7], v[20:23], v[24:27]
  ds_read_b64_tr_b16 v[20:21], v9 offset:8192
  ds_read_b64_tr_b16 v[22:23], v9 offset:8448
  s_waitcnt lgkmcnt(4)
  v_mfma_f32_16x16x32_bf16 v[24:27], v[4:7], v[12:15], v[24:27]
  ds_read_b64_tr_b16 v[12:13], v9 offset:8704
  ds_read_b64_tr_b16 v[14:15], v9 offset:8960
  s_waitcnt lgkmcnt(4)
  v_mfma_f32_16x16x32_bf16 v[24:27], v[4:7], v[16:19], v[24:27]
  ds_read_b64_tr_b16 v[16:17], v9 offset:10240
  ds_read_b64_tr_b16 v[18:19], v9 offset:10496
  s_waitcnt lgkmcnt(4)
  v_mfma_f32_16x16x32_bf16 v[24:27], v[4:7], v[20:23], v[24:27]
  ds_read_b64_tr_b16 v[20:21], v9 offset:10752
  ds_read_b64_tr_b16 v[22:23], v9 offset:11008
  s_waitcnt lgkmcnt(4)
  v_mfma_f32_16x16x32_bf16 v[24:27], v[4:7], v[12:15], v[24:27]
  ds_read_b64_tr_b16 v[12:13], v9 offset:12288
  ds_read_b64_tr_b16 v[14:15], v9 offset:12544
  s_waitcnt lgkmcnt(4)
  v_mfma_f32_16x16x32_bf16 v[24:27], v[4:7], v[16:19], v[24:27]
  ds_read_b64_tr_b16 v[16:17], v9 offset:12800
  ds_read_b64_tr_b16 v[18:19], v9 offset:13056
  s_waitcnt lgkmcnt(4)
  v_mfma_f32_16x16x32_bf16 v[24:27], v[4:7], v[20:23], v[24:27]
  ds_read_b64_tr_b16 v[20:21], v9 offset:14336
  ds_read_b64_tr_b16 v[22:23], v9 offset:14592
  s_waitcnt lgkmcnt(4)
  v_mfma_f32_16x16x32_bf16 v[24:27], v[4:7], v[12:15], v[24:27]
  ds_read_b64_tr_b16 v[12:13], v9 offset:14848
  ds_read_b64_tr_b16 v[14:15], v9 offset:15104
  s_waitcnt lgkmcnt(4)
  v_mfma_f32_16x16x32_bf16 v[24:27], v[4:7], v[16:19], v[24:27]
  s_waitcnt lgkmcnt(2)
  v_mfma_f32_16x16x32_bf16 v[24:27], v[4:7], v[20:23], v[24:27]
  s_waitcnt lgkmcnt(0)
  v_mfma_f32_16x16x32_bf16 v[24:27], v[4:7], v[12:15], v[24:27]
  v_and_b32 v9, 31, v0
  v_lshlrev_b32 v9, 3, v9
  s_lshr_b32 s47, s44, 1
  s_lshl_b32 s47, s47, 8
  s_and_b32 s46, s44, 1
  s_lshl_b32 s46, s46, 2
  s_add_u32 s47, s47, s46
  v_add_u32 v9, s47, v9
  v_cvt_pk_bf16_f32 v6, v24, v24
  v_and_b32 v6, 0xffff0000, v6
  v_sub_f32 v6, v24, v6
  v_cvt_pk_bf16_f32 v12, v24, v6
  ds_write_b32 v9, v12 offset:3072
  s_setprio 0
  s_waitcnt lgkmcnt(0)
L_cse_339:
L_hbody:
L_hw_342:
  ds_read_b32 v7, v10 offset:448
  s_waitcnt lgkmcnt(0)
  v_cmp_gt_u32 vcc, v29, v7
  s_cbranch_vccz L_hwe_343
  s_sleep 1
  s_sub_u32 s56, s56, 1
  s_cbranch_scc0 L_hw_342
  s_mov_b32 s56, 0
L_hwe_343:
  s_cmp_eq_u32 s16, 0
  s_cbranch_scc1 L_hp0
  s_waitcnt vmcnt(0)
  ds_write_b128 v31, v[128:131] offset:0
  ds_write_b128 v31, v[136:139] offset:128
  ds_write_b128 v31, v[144:147] offset:256
  ds_write_b128 v31, v[152:155] offset:384
  ds_write_b128 v31, v[192:195] offset:32768
  ds_write_b128 v31, v[200:203] offset:32896
  ds_write_b128 v31, v[208:211] offset:33024
  ds_write_b128 v31, v[216:219] offset:33152
  ds_write_b128 v31, v[160:163] offset:16384
  ds_write_b128 v31, v[168:171] offset:16512
  ds_write_b128 v31, v[176:179] offset:16640
  ds_write_b128 v31, v[184:187] offset:16768
  ds_write_b128 v31, v[224:227] offset:49152
  ds_write_b128 v31, v[232:235] offset:49280
  s_waitcnt lgkmcnt(8)
  ds_write_b128 v31, v[240:243] offset:49408
  ds_write_b128 v31, v[248:251] offset:49536
  s_branch L_hp1
L_hp0:
  ds_write_b128 v31, v[128:131] offset:0
  ds_write_b128 v31, v[136:139] offset:128
  ds_write_b128 v31, v[144:147] offset:256
  ds_write_b128 v31, v[152:155] offset:384
  ds_write_b128 v31, v[192:195] offset:32768
  ds_write_b128 v31, v[200:203] offset:32896
  ds_write_b128 v31, v[208:211] offset:33024
  ds_write_b128 v31, v[216:219] offset:33152
  s_waitcnt vmcnt(0)
  s_mov_b32 s46, 0x05040100
  s_mov_b32 s47, 0x07060302
  v_perm_b32 v12, v164, v160, s46
  v_perm_b32 v164, v164, v160, s47
  v_mov_b32 v160, v12
  v_perm_b32 v14, v165, v161, s46
  v_perm_b32 v15, v165, v161, s47
  v_permlane32_swap_b32 v160, v164
  v_perm_b32 v161, v172, v168, s46
  v_perm_b32 v165, v172, v168, s47
  v_mov_b32 v168, v14
  v_mov_b32 v172, v15
  v_perm_b32 v12, v166, v162, s46
  v_perm_b32 v13, v166, v162, s47
  v_permlane32_swap_b32 v161, v165
  v_permlane32_swap_b32 v168, v172
  v_perm_b32 v162, v180, v176, s46
  v_perm_b32 v166, v180, v176, s47
  v_mov_b32 v176, v12
  v_mov_b32 v180, v13
  v_perm_b32 v14, v167, v163, s46
  v_perm_b32 v15, v167, v163, s47
  v_permlane32_swap_b32 v162, v166
  v_permlane32_swap_b32 v176, v180
  v_perm_b32 v163, v188, v184, s46
  v_perm_b32 v167, v188, v184, s47
  v_mov_b32 v184, v14
  v_mov_b32 v188, v15
  v_perm_b32 v12, v173, v169, s46
  v_perm_b32 v173, v173, v169, s47
  v_permlane32_swap_b32 v163, v167
  v_permlane32_swap_b32 v184, v188
  v_mov_b32 v169, v12
  v_perm_b32 v14, v174, v170, s46
  v_perm_b32 v15, v174, v170, s47
  v_permlane32_swap_b32 v169, v173
  v_perm_b32 v170, v181, v177, s46
  v_perm_b32 v174, v181, v177, s47
  v_mov_b32 v177, v14
  v_mov_b32 v181, v15
  v_perm_b32 v12, v175, v171, s46
  v_perm_b32 v13, v175, v171, s47
  v_permlane32_swap_b32 v170, v174
  v_permlane32_swap_b32 v177, v181
  v_perm_b32 v171, v189, v185, s46
  v_perm_b32 v175, v189, v185, s47
  v_mov_b32 v185, v12
  v_mov_b32 v189, v13
  v_perm_b32 v14, v182, v178, s46
  v_perm_b32 v182, v182, v178, s47
  v_permlane32_swap_b32 v171, v175
  v_permlane32_swap_b32 v185, v189
  v_mov_b32 v178, v14
  v_perm_b32 v12, v183, v179, s46
  v_perm_b32 v13, v183, v179, s47
  v_permlane32_swap_b32 v178, v182
  v_perm_b32 v179, v190, v186, s46
  v_perm_b32 v183, v190, v186, s47
  v_mov_b32 v186, v12
  v_mov_b32 v190, v13
  v_perm_b32 v14, v191, v187, s46
  v_perm_b32 v191, v191, v187, s47
  v_permlane32_swap_b32 v179, v183
  v_permlane32_swap_b32 v186, v190
  v_mov_b32 v187, v14
  s_nop 1
  v_permlane32_swap_b32 v187, v191
  s_mov_b32 s46, 0x05040100
  s_mov_b32 s47, 0x07060302
  v_perm_b32 v12, v228, v224, s46
  v_perm_b32 v228, v228, v224, s47
  v_mov_b32 v224, v12
  v_perm_b32 v14, v229, v225, s46
  v_perm_b32 v15, v229, v225, s47
  v_permlane32_swap_b32 v224, v228
  v_perm_b32 v225, v236, v232, s46
  v_perm_b32 v229, v236, v232, s47
  v_mov_b32 v232, v14
  v_mov_b32 v236, v15
  v_perm_b32 v12, v230, v226, s46
  v_perm_b32 v13, v230, v226, s47
  v_permlane32_swap_b32 v225, v229
  v_permlane32_swap_b32 v232, v236
  v_perm_b32 v226, v244, v240, s46
  v_perm_b32 v230, v244, v240, s47
  v_mov_b32 v240, v12
  v_mov_b32 v244, v13
  v_perm_b32 v14, v231, v227, s46
  v_perm_b32 v15, v231, v227, s47
  v_permlane32_swap_b32 v226, v230
  v_permlane32_swap_b32 v240, v244
  v_perm_b32 v227, v252, v248, s46
  v_perm_b32 v231, v252, v248, s47
  v_mov_b32 v248, v14
  v_mov_b32 v252, v15
  v_perm_b32 v12, v237, v233, s46
  v_perm_b32 v237, v237, v233, s47
  v_permlane32_swap_b32 v227, v231
  v_permlane32_swap_b32 v248, v252
  v_mov_b32 v233, v12
  v_perm_b32 v14, v238, v234, s46
  v_perm_b32 v15, v238, v234, s47
  v_permlane32_swap_b32 v233, v237
  v_perm_b32 v234, v245, v241, s46
  v_perm_b32 v238, v245, v241, s47
  v_mov_b32 v241, v14
  v_mov_b32 v245, v15
  v_perm_b32 v12, v239, v235, s46
  v_perm_b32 v13, v239, v235, s47
  v_permlane32_swap_b32 v234, v238
  v_permlane32_swap_b32 v241, v245
  v_perm_b32 v235, v253, v249, s46
  v_perm_b32 v239, v253, v249, s47
  v_mov_b32 v249, v12
  v_mov_b32 v253, v13
  v_perm_b32 v14, v246, v242, s46
  v_perm_b32 v246, v246, v242, s47
  v_permlane32_swap_b32 v235, v239
  v_permlane32_swap_b32 v249, v253
  v_mov_b32 v242, v14
  v_perm_b32 v12, v247, v243, s46
  v_perm_b32 v13, v247, v243, s47
  v_permlane32_swap_b32 v242, v246
  v_perm_b32 v243, v254, v250, s46
  v_perm_b32 v247, v254, v250, s47
  v_mov_b32 v250, v12
  v_mov_b32 v254, v13
  v_perm_b32 v14, v255, v251, s46
  v_perm_b32 v255, v255, v251, s47
  v_permlane32_swap_b32 v243, v247
  v_permlane32_swap_b32 v250, v254
  v_mov_b32 v251, v14
  s_nop 1
  v_permlane32_swap_b32 v251, v255
  ds_write_b128 v31, v[160:163] offset:16384
  ds_write_b128 v31, v[168:171] offset:16512
  ds_write_b128 v31, v[176:179] offset:16640
  ds_write_b128 v31, v[184:187] offset:16768
  ds_write_b128 v31, v[224:227] offset:49152
  ds_write_b128 v31, v[232:235] offset:49280
  s_waitcnt lgkmcnt(8)
  ds_write_b128 v31, v[240:243] offset:49408
  ds_write_b128 v31, v[248:251] offset:49536
L_hp1:
  ds_write_b32 v11, v29 offset:1472
  s_cmp_lg_u32 s16, 0
  s_cbranch_scc1 L_ce_344
L_hw_346:
  ds_read_b32 v7, v10 offset:1472
  s_waitcnt lgkmcnt(0)
  v_cmp_gt_u32 vcc, v29, v7
  s_cbranch_vccz L_hwe_347
  s_sleep 1
  s_sub_u32 s56, s56, 1
  s_cbranch_scc0 L_hw_346
  s_mov_b32 s56, 0
L_hwe_347:
  s_setprio 3
  s_lshl_b32 s47, s44, 14
  s_add_u32 s47, s47, 73728
  v_lshlrev_b32 v5, 4, v0
  v_and_b32 v9, 0x250, v5
  v_bfe_u32 v6, v5, 7, 1
  v_lshl_or_b32 v9, v6, 8, v9
  v_bfe_u32 v6, v5, 5, 1
  v_lshl_or_b32 v9, v6, 7, v9
  v_bfe_u32 v6, v5, 8, 1
  v_lshl_or_b32 v9, v6, 5, v9
  v_lshrrev_b32 v6, 5, v5
  v_and_b32 v6, 16, v6
  v_xad_u32 v9, v9, v6, s47
  ds_read_b128 v[12:15], v9 offset:0
  ds_read_b128 v[16:19], v9 offset:1024
  ds_read_b128 v[20:23], v9 offset:2048
  s_mov_b32 s46, 0xf0f00f0f
  s_mov_b32 s47, 0xf0f00f0f
  v_mov_b32 v4, s51
  v_cndmask_b32 v4, 0, v4, s[46:47]
  v_mov_b32 v5, v4
  v_mov_b32 v6, v4
  v_mov_b32 v7, v4
  s_waitcnt lgkmcnt(2)
  s_nop 0
  v_mfma_f32_16x16x32_bf16 v[24:27], v[4:7], v[12:15], 0
  ds_read_b128 v[12:15], v9 offset:3072
  s_waitcnt lgkmcnt(2)
  v_mfma_f32_16x16x32_bf16 v[24:27], v[4:7], v[16:19], v[24:27]
  ds_read_b128 v[16:19], v9 offset:4096
  s_waitcnt lgkmcnt(2)
  v_mfma_f32_16x16x32_bf16 v[24:27], v[4:7], v[20:23], v[24:27]
  ds_read_b128 v[20:23], v9 offset:5120
  s_waitcnt lgkmcnt(2)
  v_mfma_f32_16x16x32_bf16 v[24:27], v[4:7], v[12:15], v[24:27]
  ds_read_b128 v[12:15], v9 offset:6144
  s_waitcnt lgkmcnt(2)
  v_mfma_f32_16x16x32_bf16 v[24:27], v[4:7], v[16:19], v[24:27]
  ds_read_b128 v[16:19], v9 offset:7168
  s_waitcnt lgkmcnt(2)
  v_mfma_f32_16x16x32_bf16 v[24:27], v[4:7], v[20:23], v[24:27]
  ds_read_b128 v[20:23], v9 offset:8192
  s_waitcnt lgkmcnt(2)
  v_mfma_f32_16x16x32_bf16 v[24:27], v[4:7], v[12:15], v[24:27]
  ds_read_b128 v[12:15], v9 offset:9216
  s_waitcnt lgkmcnt(2)
  v_mfma_f32_16x16x32_bf16 v[24:27], v[4:7], v[16:19], v[24:27]
  ds_read_b128 v[16:19], v9 offset:10240
  s_waitcnt lgkmcnt(2)
  v_mfma_f32_16x16x32_bf16 v[24:27], v[4:7], v[20:23], v[24:27]
  ds_read_b128 v[20:23], v9 offset:11264
  s_waitcnt lgkmcnt(2)
  v_mfma_f32_16x16x32_bf16 v[24:27], v[4:7], v[12:15], v[24:27]
  ds_read_b128 v[12:15], v9 offset:12288
  s_waitcnt lgkmcnt(2)
  v_mfma_f32_16x16x32_bf16 v[24:27], v[4:7], v[16:19], v[24:27]
  ds_read_b128 v[16:19], v9 offset:13312
  s_waitcnt lgkmcnt(2)
  v_mfma_f32_16x16x32_bf16 v[24:27], v[4:7], v[20:23], v[24:27]
  ds_read_b128 v[20:23], v9 offset:14336
  s_waitcnt lgkmcnt(2)
  v_mfma_f32_16x16x32_bf16 v[24:27], v[4:7], v[12:15], v[24:27]
  ds_read_b128 v[12:15], v9 offset:15360
  s_waitcnt lgkmcnt(2)
  v_mfma_f32_16x16x32_bf16 v[24:27], v[4:7], v[16:19], v[24:27]
  s_waitcnt lgkmcnt(1)
  v_mfma_f32_16x16x32_bf16 v[24:27], v[4:7], v[20:23], v[24:27]
  s_waitcnt lgkmcnt(0)
  v_mfma_f32_16x16x32_bf16 v[24:27], v[4:7], v[12:15], v[24:27]
  v_and_b32 v9, 31, v0
  v_lshlrev_b32 v9, 3, v9
  s_lshr_b32 s47, s44, 1
  s_lshl_b32 s47, s47, 8
  s_and_b32 s46, s44, 1
  s_lshl_b32 s46, s46, 2
  s_add_u32 s47, s47, s46
  v_add_u32 v9, s47, v9
  v_cvt_pk_bf16_f32 v6, v24, v24
  v_and_b32 v6, 0xffff0000, v6
  v_sub_f32 v6, v24, v6
  v_cvt_pk_bf16_f32 v12, v24, v6
  ds_write_b32 v9, v12 offset:3584
  s_setprio 0
  s_waitcnt lgkmcnt(0)
L_cse_345:
  ds_write_b32 v11, v29 offset:1984
L_ce_344:
L_hw_348:
  ds_read_b32 v7, v10 offset:2304
  s_waitcnt lgkmcnt(0)
  v_cmp_gt_u32 vcc, v29, v7
  s_cbranch_vccz L_hwe_349
  s_sleep 1
  s_sub_u32 s56, s56, 1
  s_cbranch_scc0 L_hw_348
  s_mov_b32 s56, 0
L_hwe_349:
  s_add_u32 m0, s49, 139264
  s_nop 0
  buffer_load_dwordx4 v30, s[36:39], s55 offen lds
  s_add_u32 s47, s55, 32768
  s_add_u32 m0, s49, 143360
  s_nop 0
  buffer_load_dwordx4 v30, s[36:39], s47 offen lds
  s_add_u32 s46, s55, 65536
  s_add_u32 m0, s49, 147456
  s_nop 0
  buffer_load_dwordx4 v30, s[36:39], s46 offen lds
  s_add_u32 s47, s55, 98304
  s_add_u32 m0, s49, 151552
  s_nop 0
  buffer_load_dwordx4 v30, s[36:39], s47 offen lds
  s_add_u32 s46, s55, 131072
  s_add_u32 m0, s49, 155648
  s_nop 0
  buffer_load_dwordx4 v30, s[36:39], s46 offen lds
  s_add_u32 s47, s55, 163840
  s_add_u32 m0, s49, 159744
  s_nop 0
  buffer_load_dwordx4 v30, s[36:39], s47 offen lds
L_hw_350:
  ds_read_b32 v7, v10 offset:512
  s_waitcnt lgkmcnt(0)
  v_cmp_gt_u32 vcc, v29, v7
  s_cbranch_vccz L_hwe_351
  s_sleep 1
  s_sub_u32 s56, s56, 1
  s_cbranch_scc0 L_hw_350
  s_mov_b32 s56, 0
L_hwe_351:
  s_cmp_lg_u32 s16, 0
  s_cbranch_scc1 L_ce_352
  v_lshlrev_b32 v5, 4, v0
  v_mov_b32 v16, -1
  v_mov_b32 v17, -1
  v_mov_b32 v18, -1
  v_mov_b32 v19, -1
  s_cmp_eq_u32 s19, 1
  s_nop 0
  s_cbranch_scc1 L_ms_353
  buffer_store_dwordx4 v[16:19], v5, s[4:7], s17 offen offset:0
  buffer_store_dwordx4 v[16:19], v5, s[4:7], s17 offen offset:1024
  s_nop 1
  s_branch L_me_354
L_ms_353:
  buffer_store_dwordx4 v[16:19], v5, s[4:7], s17 offen offset:0 sc1
  buffer_store_dwordx4 v[16:19], v5, s[4:7], s17 offen offset:1024 sc1
  s_nop 1
L_me_354:
L_ce_352:
  s_add_u32 s46, s55, 196608
  s_add_u32 m0, s49, 8192
  s_nop 0
  buffer_load_dwordx4 v30, s[36:39], s46 offen lds
  s_add_u32 s47, s55, 229376
  s_add_u32 m0, s49, 12288
  s_nop 0
  buffer_load_dwordx4 v30, s[36:39], s47 offen lds
  s_add_u32 s46, s55, 262144
  s_add_u32 m0, s49, 16384
  s_nop 0
  buffer_load_dwordx4 v30, s[36:39], s46 offen lds
  s_add_u32 s47, s55, 294912
  s_add_u32 m0, s49, 20480
  s_nop 0
  buffer_load_dwordx4 v30, s[36:39], s47 offen lds
  s_add_u32 s46, s55, 327680
  s_add_u32 m0, s49, 24576
  s_nop 0
  buffer_load_dwordx4 v30, s[36:39], s46 offen lds
  s_add_u32 s47, s55, 360448
  s_add_u32 m0, s49, 28672
  s_nop 0
  buffer_load_dwordx4 v30, s[36:39], s47 offen lds
  s_cmp_lg_u32 s16, 0
  s_cbranch_scc1 L_ce_355
L_hw_356:
  ds_read_b32 v7, v10 offset:1984
  s_waitcnt lgkmcnt(0)
  v_cmp_gt_u32 vcc, v29, v7
  s_cbranch_vccz L_hwe_357
  s_sleep 1
  s_sub_u32 s56, s56, 1
  s_cbranch_scc0 L_hw_356
  s_mov_b32 s56, 0
L_hwe_357:
L_ce_355:
L_hw_358:
  ds_read_b32 v7, v10 offset:576
  s_waitcnt lgkmcnt(0)
  v_cmp_gt_u32 vcc, v29, v7
  s_cbranch_vccz L_hwe_359
  s_sleep 1
  s_sub_u32 s56, s56, 1
  s_cbranch_scc0 L_hw_358
  s_mov_b32 s56, 0
L_hwe_359:
  s_cmp_eq_u32 s15, 0
  s_cbranch_scc1 L_hlight
  ds_write_b128 v31, v[132:135] offset:0
  ds_write_b128 v31, v[140:143] offset:128
  ds_write_b128 v31, v[148:151] offset:256
  ds_write_b128 v31, v[156:159] offset:384
  ds_write_b128 v31, v[196:199] offset:32768
  ds_write_b128 v31, v[204:207] offset:32896
  ds_write_b128 v31, v[212:215] offset:33024
  ds_write_b128 v31, v[220:223] offset:33152
  ds_write_b32 v11, v29 offset:1536
  s_add_u32 s46, s55, 393216
  s_add_u32 m0, s49, 32768
  s_nop 0
  buffer_load_dwordx4 v30, s[36:39], s46 offen lds
  s_add_u32 s47, s55, 425984
  s_add_u32 m0, s49, 36864
  s_nop 0
  buffer_load_dwordx4 v30, s[36:39], s47 offen lds
  s_add_u32 s46, s55, 458752
  s_add_u32 m0, s49, 40960
  s_nop 0
  buffer_load_dwordx4 v30, s[36:39], s46 offen lds
  s_add_u32 s47, s55, 491520
  s_add_u32 m0, s49, 45056
  s_nop 0
  buffer_load_dwordx4 v30, s[36:39], s47 offen lds
  s_add_u32 s46, s55, 524288
  s_add_u32 m0, s49, 49152
  s_nop 0
  buffer_load_dwordx4 v30, s[36:39], s46 offen lds
L_hw_360:
  ds_read_b32 v7, v10 offset:640
  s_waitcnt lgkmcnt(0)
  v_cmp_gt_u32 vcc, v29, v7
  s_cbranch_vccz L_hwe_361
  s_sleep 1
  s_sub_u32 s56, s56, 1
  s_cbranch_scc0 L_hw_360
  s_mov_b32 s56, 0
L_hwe_361:
  ds_write_b128 v31, v[164:167] offset:16384
  ds_write_b128 v31, v[172:175] offset:16512
  ds_write_b128 v31, v[180:183] offset:16640
  ds_write_b128 v31, v[188:191] offset:16768
  ds_write_b128 v31, v[228:231] offset:49152
  ds_write_b128 v31, v[236:239] offset:49280
  ds_write_b128 v31, v[244:247] offset:49408
  ds_write_b128 v31, v[252:255] offset:49536
  ds_write_b32 v11, v29 offset:1600
  s_add_u32 s47, s55, 589824
  s_add_u32 m0, s49, 53248
  s_nop 0
  buffer_load_dwordx4 v30, s[36:39], s47 offen lds
  s_add_u32 s46, s55, 655360
  s_add_u32 m0, s49, 57344
  s_nop 0
  buffer_load_dwordx4 v30, s[36:39], s46 offen lds
  s_add_u32 s47, s55, 720896
  s_add_u32 m0, s49, 61440
  s_nop 0
  buffer_load_dwordx4 v30, s[36:39], s47 offen lds
  s_add_u32 s46, s55, 786432
  s_add_u32 m0, s49, 65536
  s_nop 0
  buffer_load_dwordx4 v30, s[36:39], s46 offen lds
  s_add_u32 s47, s55, 851968
  s_add_u32 m0, s49, 69632
  s_nop 0
  buffer_load_dwordx4 v30, s[36:39], s47 offen lds
  s_cmp_lg_u32 s16, 0
  s_cbranch_scc1 L_ce_362
L_hw_364:
  ds_read_b32 v7, v10 offset:1600
  s_waitcnt lgkmcnt(0)
  v_cmp_gt_u32 vcc, v29, v7
  s_cbranch_vccz L_hwe_365
  s_sleep 1
  s_sub_u32 s56, s56, 1
  s_cbranch_scc0 L_hw_364
  s_mov_b32 s56, 0
L_hwe_365:
  s_setprio 3
  s_lshl_b32 s47, s44, 14
  s_add_u32 s47, s47, 73728
  v_lshlrev_b32 v5, 4, v0
  v_and_b32 v9, 0x250, v5
  v_bfe_u32 v6, v5, 7, 1
  v_lshl_or_b32 v9, v6, 8, v9
  v_bfe_u32 v6, v5, 5, 1
  v_lshl_or_b32 v9, v6, 7, v9
  v_bfe_u32 v6, v5, 8, 1
  v_lshl_or_b32 v9, v6, 5, v9
  v_lshrrev_b32 v6, 5, v5
  v_and_b32 v6, 16, v6
  v_xad_u32 v9, v9, v6, s47
  ds_read_b128 v[12:15], v9 offset:0
  ds_read_b128 v[16:19], v9 offset:1024
  ds_read_b128 v[20:23], v9 offset:2048
  s_mov_b32 s46, 0xf0f00f0f
  s_mov_b32 s47, 0xf0f00f0f
  v_mov_b32 v4, s51
  v_cndmask_b32 v4, 0, v4, s[46:47]
  v_mov_b32 v5, v4
  v_mov_b32 v6, v4
  v_mov_b32 v7, v4
  s_waitcnt lgkmcnt(2)
  s_nop 0
  v_mfma_f32_16x16x32_bf16 v[24:27], v[4:7], v[12:15], 0
  ds_read_b128 v[12:15], v9 offset:3072
  s_waitcnt lgkmcnt(2)
  v_mfma_f32_16x16x32_bf16 v[24:27], v[4:7], v[16:19], v[24:27]
  ds_read_b128 v[16:19], v9 offset:4096
  s_waitcnt lgkmcnt(2)
  v_mfma_f32_16x16x32_bf16 v[24:27], v[4:7], v[20:23], v[24:27]
  ds_read_b128 v[20:23], v9 offset:5120
  s_waitcnt lgkmcnt(2)
  v_mfma_f32_16x16x32_bf16 v[24:27], v[4:7], v[12:15], v[24:27]
  ds_read_b128 v[12:15], v9 offset:6144
  s_waitcnt lgkmcnt(2)
  v_mfma_f32_16x16x32_bf16 v[24:27], v[4:7], v[16:19], v[24:27]
  ds_read_b128 v[16:19], v9 offset:7168
  s_waitcnt lgkmcnt(2)
  v_mfma_f32_16x16x32_bf16 v[24:27], v[4:7], v[20:23], v[24:27]
  ds_read_b128 v[20:23], v9 offset:8192
  s_waitcnt lgkmcnt(2)
  v_mfma_f32_16x16x32_bf16 v[24:27], v[4:7], v[12:15], v[24:27]
  ds_read_b128 v[12:15], v9 offset:9216
  s_waitcnt lgkmcnt(2)
  v_mfma_f32_16x16x32_bf16 v[24:27], v[4:7], v[16:19], v[24:27]
  ds_read_b128 v[16:19], v9 offset:10240
  s_waitcnt lgkmcnt(2)
  v_mfma_f32_16x16x32_bf16 v[24:27], v[4:7], v[20:23], v[24:27]
  ds_read_b128 v[20:23], v9 offset:11264
  s_waitcnt lgkmcnt(2)
  v_mfma_f32_16x16x32_bf16 v[24:27], v[4:7], v[12:15], v[24:27]
  ds_read_b128 v[12:15], v9 offset:12288
  s_waitcnt lgkmcnt(2)
  v_mfma_f32_16x16x32_bf16 v[24:27], v[4:7], v[16:19], v[24:27]
  ds_read_b128 v[16:19], v9 offset:13312
  s_waitcnt lgkmcnt(2)
  v_mfma_f32_16x16x32_bf16 v[24:27], v[4:7], v[20:23], v[24:27]
  ds_read_b128 v[20:23], v9 offset:14336
  s_waitcnt lgkmcnt(2)
  v_mfma_f32_16x16x32_bf16 v[24:27], v[4:7], v[12:15], v[24:27]
  ds_read_b128 v[12:15], v9 offset:15360
  s_waitcnt lgkmcnt(2)
  v_mfma_f32_16x16x32_bf16 v[24:27], v[4:7], v[16:19], v[24:27]
  s_waitcnt lgkmcnt(1)
  v_mfma_f32_16x16x32_bf16 v[24:27], v[4:7], v[20:23], v[24:27]
  s_waitcnt lgkmcnt(0)
  v_mfma_f32_16x16x32_bf16 v[24:27], v[4:7], v[12:15], v[24:27]
  v_and_b32 v9, 31, v0
  v_lshlrev_b32 v9, 3, v9
  s_lshr_b32 s47, s44, 1
  s_lshl_b32 s47, s47, 8
  s_and_b32 s46, s44, 1
  s_lshl_b32 s46, s46, 2
  s_add_u32 s47, s47, s46
  v_add_u32 v9, s47, v9
  v_cvt_pk_bf16_f32 v6, v24, v24
  v_and_b32 v6, 0xffff0000, v6
  v_sub_f32 v6, v24, v6
  v_cvt_pk_bf16_f32 v12, v24, v6
  ds_write_b32 v9, v12 offset:4096
  s_setprio 0
  s_waitcnt lgkmcnt(0)
L_cse_363:
  ds_write_b32 v11, v29 offset:2048
L_ce_362:
  s_waitcnt vmcnt(0)
  ds_write_b32 v11, v29 offset:1664
  s_cmp_lg_u32 s16, 0
  s_cbranch_scc1 L_ce_366
L_hw_367:
  ds_read_b32 v7, v10 offset:2048
  s_waitcnt lgkmcnt(0)
  v_cmp_gt_u32 vcc, v29, v7
  s_cbranch_vccz L_hwe_368
  s_sleep 1
  s_sub_u32 s56, s56, 1
  s_cbranch_scc0 L_hw_367
  s_mov_b32 s56, 0
L_hwe_368:
L_ce_366:
L_hw_369:
  ds_read_b32 v7, v10 offset:704
  s_waitcnt lgkmcnt(0)
  v_cmp_gt_u32 vcc, v29, v7
  s_cbranch_vccz L_hwe_370
  s_sleep 1
  s_sub_u32 s56, s56, 1
  s_cbranch_scc0 L_hw_369
  s_mov_b32 s56, 0
L_hwe_370:
  s_add_u32 s46, s55, 917504
  s_add_u32 m0, s49, 73728
  s_nop 0
  buffer_load_dwordx4 v30, s[36:39], s46 offen lds
  s_add_u32 s47, s55, 983040
  s_add_u32 m0, s49, 77824
  s_nop 0
  buffer_load_dwordx4 v30, s[36:39], s47 offen lds
  s_add_u32 s46, s55, 1048576
  s_add_u32 m0, s49, 81920
  s_nop 0
  buffer_load_dwordx4 v30, s[36:39], s46 offen lds
  s_add_u32 s47, s55, 1114112
  s_add_u32 m0, s49, 86016
  s_nop 0
  buffer_load_dwordx4 v30, s[36:39], s47 offen lds
  s_add_u32 s46, s55, 1179648
  s_add_u32 m0, s49, 106496
  s_nop 0
  buffer_load_dwordx4 v30, s[36:39], s46 offen lds
  s_add_u32 s47, s55, 1245184
  s_add_u32 m0, s49, 110592
  s_nop 0
  buffer_load_dwordx4 v30, s[36:39], s47 offen lds
  s_add_u32 s46, s55, 1277952
  s_add_u32 m0, s49, 114688
  s_nop 0
  buffer_load_dwordx4 v30, s[36:39], s46 offen lds
  s_add_u32 s47, s55, 1310720
  s_add_u32 m0, s49, 118784
  s_nop 0
  buffer_load_dwordx4 v30, s[36:39], s47 offen lds
L_hw_371:
  ds_read_b32 v7, v10 offset:768
  s_waitcnt lgkmcnt(0)
  v_cmp_gt_u32 vcc, v29, v7
  s_cbranch_vccz L_hwe_372
  s_sleep 1
  s_sub_u32 s56, s56, 1
  s_cbranch_scc0 L_hw_371
  s_mov_b32 s56, 0
L_hwe_372:
  s_add_u32 s46, s55, 1343488
  s_add_u32 m0, s49, 90112
  s_nop 0
  buffer_load_dwordx4 v30, s[36:39], s46 offen lds
  s_add_u32 s47, s55, 1376256
  s_add_u32 m0, s49, 94208
  s_nop 0
  buffer_load_dwordx4 v30, s[36:39], s47 offen lds
  s_add_u32 s46, s55, 557056
  s_add_u32 m0, s49, 98304
  s_nop 0
  buffer_load_dwordx4 v30, s[36:39], s46 offen lds
  s_add_u32 s47, s55, 622592
  s_add_u32 m0, s49, 102400
  s_nop 0
  buffer_load_dwordx4 v30, s[36:39], s47 offen lds
  s_add_u32 s46, s55, 688128
  s_add_u32 m0, s49, 122880
  s_nop 0
  buffer_load_dwordx4 v30, s[36:39], s46 offen lds
  s_add_u32 s47, s55, 753664
  s_add_u32 m0, s49, 126976
  s_nop 0
  buffer_load_dwordx4 v30, s[36:39], s47 offen lds
  s_add_u32 s46, s55, 819200
  s_add_u32 m0, s49, 131072
  s_nop 0
  buffer_load_dwordx4 v30, s[36:39], s46 offen lds
  s_add_u32 s47, s55, 884736
  s_add_u32 m0, s49, 135168
  s_nop 0
  buffer_load_dwordx4 v30, s[36:39], s47 offen lds
  s_branch L_hj
L_hlight:
  ds_write_b32 v11, v29 offset:1536
  s_add_u32 s46, s55, 393216
  s_add_u32 m0, s49, 32768
  s_nop 0
  buffer_load_dwordx4 v30, s[36:39], s46 offen lds
  s_add_u32 s47, s55, 425984
  s_add_u32 m0, s49, 36864
  s_nop 0
  buffer_load_dwordx4 v30, s[36:39], s47 offen lds
  s_add_u32 s46, s55, 458752
  s_add_u32 m0, s49, 40960
  s_nop 0
  buffer_load_dwordx4 v30, s[36:39], s46 offen lds
  s_add_u32 s47, s55, 491520
  s_add_u32 m0, s49, 45056
  s_nop 0
  buffer_load_dwordx4 v30, s[36:39], s47 offen lds
  s_add_u32 s46, s55, 524288
  s_add_u32 m0, s49, 49152
  s_nop 0
  buffer_load_dwordx4 v30, s[36:39], s46 offen lds
  s_add_u32 s47, s55, 589824
  s_add_u32 m0, s49, 53248
  s_nop 0
  buffer_load_dwordx4 v30, s[36:39], s47 offen lds
  s_add_u32 s46, s55, 655360
  s_add_u32 m0, s49, 57344
  s_nop 0
  buffer_load_dwordx4 v30, s[36:39], s46 offen lds
  s_add_u32 s47, s55, 720896
  s_add_u32 m0, s49, 61440
  s_nop 0
  buffer_load_dwordx4 v30, s[36:39], s47 offen lds
  s_add_u32 s46, s55, 786432
  s_add_u32 m0, s49, 65536
  s_nop 0
  buffer_load_dwordx4 v30, s[36:39], s46 offen lds
  s_add_u32 s47, s55, 851968
  s_add_u32 m0, s49, 69632
  s_nop 0
  buffer_load_dwordx4 v30, s[36:39], s47 offen lds
  s_add_u32 s46, s55, 917504
  s_add_u32 m0, s49, 73728
  s_nop 0
  buffer_load_dwordx4 v30, s[36:39], s46 offen lds
  s_add_u32 s47, s55, 983040
  s_add_u32 m0, s49, 77824
  s_nop 0
  buffer_load_dwordx4 v30, s[36:39], s47 offen lds
  s_add_u32 s46, s55, 1048576
  s_add_u32 m0, s49, 81920
  s_nop 0
  buffer_load_dwordx4 v30, s[36:39], s46 offen lds
  s_add_u32 s47, s55, 1114112
  s_add_u32 m0, s49, 86016
  s_nop 0
  buffer_load_dwordx4 v30, s[36:39], s47 offen lds
  s_add_u32 s46, s55, 1179648
  s_add_u32 m0, s49, 106496
  s_nop 0
  buffer_load_dwordx4 v30, s[36:39], s46 offen lds
  s_add_u32 s47, s55, 1245184
  s_add_u32 m0, s49, 110592
  s_nop 0
  buffer_load_dwordx4 v30, s[36:39], s47 offen lds
  s_add_u32 s46, s55, 1277952
  s_add_u32 m0, s49, 114688
  s_nop 0
  buffer_load_dwordx4 v30, s[36:39], s46 offen lds
  s_add_u32 s47, s55, 1310720
  s_add_u32 m0, s49, 118784
  s_nop 0
  buffer_load_dwordx4 v30, s[36:39], s47 offen lds
L_hw_373:
  ds_read_b32 v7, v10 offset:640
  s_waitcnt lgkmcnt(0)
  v_cmp_gt_u32 vcc, v29, v7
  s_cbranch_vccz L_hwe_374
  s_sleep 1
  s_sub_u32 s56, s56, 1
  s_cbranch_scc0 L_hw_373
  s_mov_b32 s56, 0
L_hwe_374:
  s_add_u32 s46, s55, 1343488
  s_add_u32 m0, s49, 90112
  s_nop 0
  buffer_load_dwordx4 v30, s[36:39], s46 offen lds
  s_add_u32 s47, s55, 1376256
  s_add_u32 m0, s49, 94208
  s_nop 0
  buffer_load_dwordx4 v30, s[36:39], s47 offen lds
  s_add_u32 s46, s55, 557056
  s_add_u32 m0, s49, 98304
  s_nop 0
  buffer_load_dwordx4 v30, s[36:39], s46 offen lds
  s_add_u32 s47, s55, 622592
  s_add_u32 m0, s49, 102400
  s_nop 0
  buffer_load_dwordx4 v30, s[36:39], s47 offen lds
  s_add_u32 s46, s55, 688128
  s_add_u32 m0, s49, 122880
  s_nop 0
  buffer_load_dwordx4 v30, s[36:39], s46 offen lds
  s_add_u32 s47, s55, 753664
  s_add_u32 m0, s49, 126976
  s_nop 0
  buffer_load_dwordx4 v30, s[36:39], s47 offen lds
  s_add_u32 s46, s55, 819200
  s_add_u32 m0, s49, 131072
  s_nop 0
  buffer_load_dwordx4 v30, s[36:39], s46 offen lds
  s_add_u32 s47, s55, 884736
  s_add_u32 m0, s49, 135168
  s_nop 0
  buffer_load_dwordx4 v30, s[36:39], s47 offen lds
  s_waitcnt vmcnt(16)
  ds_write_b32 v11, v29 offset:1664
L_hj:
  s_waitcnt vmcnt(8)
  ds_write_b32 v11, v29 offset:1728
L_hw_375:
  ds_read_b32 v7, v10 offset:832
  s_waitcnt lgkmcnt(0)
  v_cmp_gt_u32 vcc, v29, v7
  s_cbranch_vccz L_hwe_376
  s_sleep 1
  s_sub_u32 s56, s56, 1
  s_cbranch_scc0 L_hw_375
  s_mov_b32 s56, 0
L_hwe_376:
  s_add_u32 s46, s55, 950272
  s_add_u32 m0, s49, 139264
  s_nop 0
  buffer_load_dwordx4 v30, s[36:39], s46 offen lds
  s_add_u32 s47, s55, 1015808
  s_add_u32 m0, s49, 143360
  s_nop 0
  buffer_load_dwordx4 v30, s[36:39], s47 offen lds
  s_add_u32 s46, s55, 1081344
  s_add_u32 m0, s49, 147456
  s_nop 0
  buffer_load_dwordx4 v30, s[36:39], s46 offen lds
  s_add_u32 s47, s55, 1146880
  s_add_u32 m0, s49, 151552
  s_nop 0
  buffer_load_dwordx4 v30, s[36:39], s47 offen lds
  s_add_u32 s46, s55, 1212416
  s_add_u32 m0, s49, 155648
  s_nop 0
  buffer_load_dwordx4 v30, s[36:39], s46 offen lds
  s_waitcnt vmcnt(5)
  ds_write_b32 v11, v29 offset:1792
  s_waitcnt vmcnt(0)
  ds_write_b32 v11, v29 offset:1856
  s_cmp_eq_u32 s16, 1
  s_cbranch_scc1 L_hend
L_hw_377:
  ds_read_b32 v7, v10 offset:896
  s_waitcnt lgkmcnt(0)
  v_cmp_gt_u32 vcc, v29, v7
  s_cbranch_vccz L_hwe_378
  s_sleep 1
  s_sub_u32 s56, s56, 1
  s_cbranch_scc0 L_hw_377
  s_mov_b32 s56, 0
L_hwe_378:
  v_mov_b32 v16, -1
  v_mov_b32 v17, -1
  v_mov_b32 v18, -1
  v_mov_b32 v19, -1
  v_lshlrev_b32 v5, 4, v0
  v_lshlrev_b32 v6, 3, v0
  s_add_u32 s46, s8, 0x0
  s_add_u32 s47, s9, 0x0
  s_cmp_eq_u32 s19, 1
  s_cbranch_scc1 L_ms_379
  buffer_store_dwordx4 v[16:19], v5, s[4:7], s46 offen offset:0
  buffer_store_dwordx4 v[16:19], v5, s[4:7], s46 offen offset:1024
  s_mov_b32 exec_hi, 0
  buffer_store_dwordx2 v[16:17], v6, s[4:7], s47 offen
  s_mov_b32 exec_hi, -1
  s_branch L_me_380
L_ms_379:
  buffer_store_dwordx4 v[16:19], v5, s[4:7], s46 offen offset:0 sc1
  buffer_store_dwordx4 v[16:19], v5, s[4:7], s46 offen offset:1024 sc1
  s_mov_b32 exec_hi, 0
  buffer_store_dwordx2 v[16:17], v6, s[4:7], s47 offen sc1
  s_mov_b32 exec_hi, -1
L_me_380:
  s_lshr_b32 s47, s44, 1
  s_lshl_b32 s47, s47, 3
  s_and_b32 s46, s44, 1
  s_add_u32 s47, s47, s46
  s_lshl_b32 s47, s47, 12
  s_add_u32 s47, s47, 8192
  v_lshl_add_u32 v4, v0, 4, s47
  v_lshrrev_b32 v6, 5, v0
  v_lshlrev_b32 v5, 4, v6
  v_xor_b32 v5, v5, v31
  v_add_u32 v6, s44, v6
  v_lshl_add_u32 v5, v6, 12, v5
  v_xor_b32 v6, 16, v5
  s_nop 1
L_hw_381:
  ds_read_b32 v7, v10 offset:1088
  s_waitcnt lgkmcnt(0)
  v_cmp_gt_u32 vcc, v29, v7
  s_cbranch_vccz L_hwe_382
  s_sleep 1
  s_sub_u32 s56, s56, 1
  s_cbranch_scc0 L_hw_381
  s_mov_b32 s56, 0
L_hwe_382:
  v_add_u32 v29, 1, v29
  ds_write_b128 v4, v[32:35] offset:0
  ds_write_b128 v4, v[36:39] offset:1024
  ds_write_b128 v4, v[40:43] offset:2048
  ds_write_b128 v4, v[44:47] offset:3072
  ds_write_b32 v11, v29 offset:2176
  ds_write_b128 v4, v[48:51] offset:8192
  ds_write_b128 v4, v[52:55] offset:9216
  ds_write_b128 v4, v[56:59] offset:10240
  ds_write_b128 v4, v[60:63] offset:11264
  ds_write_b32 v11, v29 offset:2240
  ds_write_b128 v4, v[64:67] offset:16384
  ds_write_b128 v4, v[68:71] offset:17408
  ds_write_b128 v4, v[72:75] offset:18432
  ds_write_b128 v4, v[76:79] offset:19456
  ds_write_b32 v11, v29 offset:1216
  s_waitcnt lgkmcnt(8)
  ds_write_b128 v4, v[80:83] offset:24576
  ds_write_b128 v4, v[84:87] offset:25600
  ds_write_b128 v4, v[88:91] offset:26624
  ds_write_b128 v4, v[92:95] offset:27648
  ds_write_b32 v11, v29 offset:1280
  ds_write_b128 v5, v[96:99] offset:0
  s_waitcnt lgkmcnt(8)
  ds_write_b128 v6, v[100:103] offset:0
  ds_write_b128 v5, v[104:107] offset:128
  ds_write_b128 v6, v[108:111] offset:128
  ds_write_b128 v5, v[112:115] offset:256
  ds_write_b128 v6, v[116:119] offset:256
  ds_write_b128 v5, v[120:123] offset:384
  s_waitcnt lgkmcnt(8)
  ds_write_b128 v6, v[124:127] offset:384
  s_waitcnt vmcnt(0)
  ds_write_b32 v11, v29 offset:1344
  ds_write_b32 v11, v29 offset:2688
  s_mov_b32 s16, 1
L_hw_383:
  ds_read_b32 v7, v10 offset:0
  s_waitcnt lgkmcnt(0)
  v_cmp_gt_u32 vcc, v29, v7
  s_cbranch_vccz L_hwe_384
  s_sleep 1
  s_sub_u32 s56, s56, 1
  s_cbranch_scc0 L_hw_383
  s_mov_b32 s56, 0
L_hwe_384:
  s_add_u32 m0, s49, 8192
  s_nop 0
  buffer_load_dwordx4 v28, s[28:31], s53 offen lds
  s_add_u32 m0, s49, 40960
  s_nop 0
  buffer_load_dwordx4 v28, s[32:35], s53 offen lds
  s_add_u32 s47, s53, 176128
  s_add_u32 m0, s49, 12288
  s_nop 0
  buffer_load_dwordx4 v28, s[28:31], s47 offen lds
  s_add_u32 s47, s53, 176128
  s_add_u32 m0, s49, 45056
  s_nop 0
  buffer_load_dwordx4 v28, s[32:35], s47 offen lds
  s_add_u32 s46, s53, 352256
  s_add_u32 m0, s49, 16384
  s_nop 0
  buffer_load_dwordx4 v28, s[28:31], s46 offen lds
  s_add_u32 s46, s53, 352256
  s_add_u32 m0, s49, 49152
  s_nop 0
  buffer_load_dwordx4 v28, s[32:35], s46 offen lds
  s_add_u32 s47, s53, 528384
  s_add_u32 m0, s49, 20480
  s_nop 0
  buffer_load_dwordx4 v28, s[28:31], s47 offen lds
  s_add_u32 s47, s53, 528384
  s_add_u32 m0, s49, 53248
  s_nop 0
  buffer_load_dwordx4 v28, s[32:35], s47 offen lds
  s_add_u32 s46, s53, 704512
  s_add_u32 m0, s49, 24576
  s_nop 0
  buffer_load_dwordx4 v28, s[28:31], s46 offen lds
  s_add_u32 s46, s53, 704512
  s_add_u32 m0, s49, 57344
  s_nop 0
  buffer_load_dwordx4 v28, s[32:35], s46 offen lds
L_hw_385:
  ds_read_b32 v7, v10 offset:128
  s_waitcnt lgkmcnt(0)
  v_cmp_gt_u32 vcc, v29, v7
  s_cbranch_vccz L_hwe_386
  s_sleep 1
  s_sub_u32 s56, s56, 1
  s_cbranch_scc0 L_hw_385
  s_mov_b32 s56, 0
L_hwe_386:
  s_add_u32 s47, s53, 880640
  s_add_u32 m0, s49, 28672
  s_nop 0
  buffer_load_dwordx4 v28, s[28:31], s47 offen lds
  s_add_u32 s47, s53, 880640
  s_add_u32 m0, s49, 61440
  s_nop 0
  buffer_load_dwordx4 v28, s[32:35], s47 offen lds
  s_add_u32 s46, s53, 1056768
  s_add_u32 m0, s49, 32768
  s_nop 0
  buffer_load_dwordx4 v28, s[28:31], s46 offen lds
  s_add_u32 s46, s53, 1056768
  s_add_u32 m0, s49, 65536
  s_nop 0
  buffer_load_dwordx4 v28, s[32:35], s46 offen lds
  s_add_u32 s47, s53, 1232896
  s_add_u32 m0, s49, 36864
  s_nop 0
  buffer_load_dwordx4 v28, s[28:31], s47 offen lds
  s_add_u32 s47, s53, 1232896
  s_add_u32 m0, s49, 69632
  s_nop 0
  buffer_load_dwordx4 v28, s[32:35], s47 offen lds
  v_mov_b32 v16, -1
  v_mov_b32 v17, -1
  v_mov_b32 v18, -1
  v_mov_b32 v19, -1
  v_lshlrev_b32 v5, 4, v0
  s_cmp_eq_u32 s19, 1
  s_nop 0
  s_cbranch_scc1 L_ms_387
  s_add_u32 s46, s18, 0
  buffer_store_dwordx4 v[16:19], v5, s[4:7], s46 offen
  s_add_u32 s46, s18, 44032
  buffer_store_dwordx4 v[16:19], v5, s[4:7], s46 offen
  s_add_u32 s46, s18, 16384
  buffer_store_dwordx4 v[16:19], v5, s[4:7], s46 offen
  s_add_u32 s46, s18, 60416
  buffer_store_dwordx4 v[16:19], v5, s[4:7], s46 offen
  s_cmp_eq_u32 s15, 0
  s_nop 0
  s_cbranch_scc1 L_hc_389
  s_add_u32 s46, s18, 32768
  buffer_store_dwordx4 v[16:19], v5, s[4:7], s46 offen
  s_add_u32 s46, s18, 76800
  buffer_store_dwordx4 v[16:19], v5, s[4:7], s46 offen
  s_nop 1
L_hc_389:
  s_branch L_me_388
L_ms_387:
  s_add_u32 s46, s18, 0
  buffer_store_dwordx4 v[16:19], v5, s[4:7], s46 offen sc1
  s_add_u32 s46, s18, 44032
  buffer_store_dwordx4 v[16:19], v5, s[4:7], s46 offen sc1
  s_add_u32 s46, s18, 16384
  buffer_store_dwordx4 v[16:19], v5, s[4:7], s46 offen sc1
  s_add_u32 s46, s18, 60416
  buffer_store_dwordx4 v[16:19], v5, s[4:7], s46 offen sc1
  s_cmp_eq_u32 s15, 0
  s_nop 0
  s_cbranch_scc1 L_hc_390
  s_add_u32 s46, s18, 32768
  buffer_store_dwordx4 v[16:19], v5, s[4:7], s46 offen sc1
  s_add_u32 s46, s18, 76800
  buffer_store_dwordx4 v[16:19], v5, s[4:7], s46 offen sc1
  s_nop 1
L_hc_390:
L_me_388:
L_hw_391:
  ds_read_b32 v7, v10 offset:256
  s_waitcnt lgkmcnt(0)
  v_cmp_gt_u32 vcc, v29, v7
  s_cbranch_vccz L_hwe_392
  s_sleep 1
  s_sub_u32 s56, s56, 1
  s_cbranch_scc0 L_hw_391
  s_mov_b32 s56, 0
L_hwe_392:
  s_add_u32 m0, s49, 73728
  s_nop 0
  buffer_load_dwordx4 v30, s[24:27], s55 offen lds
  s_add_u32 s47, s55, 32768
  s_add_u32 m0, s49, 77824
  s_nop 0
  buffer_load_dwordx4 v30, s[24:27], s47 offen lds
  s_add_u32 s46, s55, 65536
  s_add_u32 m0, s49, 81920
  s_nop 0
  buffer_load_dwordx4 v30, s[24:27], s46 offen lds
  s_add_u32 s47, s55, 98304
  s_add_u32 m0, s49, 86016
  s_nop 0
  buffer_load_dwordx4 v30, s[24:27], s47 offen lds
  s_add_u32 s46, s55, 131072
  s_add_u32 m0, s49, 90112
  s_nop 0
  buffer_load_dwordx4 v30, s[24:27], s46 offen lds
  s_add_u32 s47, s55, 163840
  s_add_u32 m0, s49, 94208
  s_nop 0
  buffer_load_dwordx4 v30, s[24:27], s47 offen lds
  s_add_u32 s46, s55, 196608
  s_add_u32 m0, s49, 98304
  s_nop 0
  buffer_load_dwordx4 v30, s[24:27], s46 offen lds
  s_add_u32 s47, s55, 229376
  s_add_u32 m0, s49, 102400
  s_nop 0
  buffer_load_dwordx4 v30, s[24:27], s47 offen lds
  s_add_u32 s46, s55, 262144
  s_add_u32 m0, s49, 106496
  s_nop 0
  buffer_load_dwordx4 v30, s[24:27], s46 offen lds
  s_add_u32 s47, s55, 294912
  s_add_u32 m0, s49, 110592
  s_nop 0
  buffer_load_dwordx4 v30, s[24:27], s47 offen lds
  s_add_u32 s46, s55, 327680
  s_add_u32 m0, s49, 114688
  s_nop 0
  buffer_load_dwordx4 v30, s[24:27], s46 offen lds
  s_add_u32 s47, s55, 360448
  s_add_u32 m0, s49, 118784
  s_nop 0
  buffer_load_dwordx4 v30, s[24:27], s47 offen lds
  s_add_u32 s46, s55, 393216
  s_add_u32 m0, s49, 122880
  s_nop 0
  buffer_load_dwordx4 v30, s[24:27], s46 offen lds
  s_add_u32 s47, s55, 425984
  s_add_u32 m0, s49, 126976
  s_nop 0
  buffer_load_dwordx4 v30, s[24:27], s47 offen lds
  s_add_u32 s46, s55, 458752
  s_add_u32 m0, s49, 131072
  s_nop 0
  buffer_load_dwordx4 v30, s[24:27], s46 offen lds
  s_add_u32 s47, s55, 491520
  s_add_u32 m0, s49, 135168
  s_nop 0
  buffer_load_dwordx4 v30, s[24:27], s47 offen lds
  s_waitcnt vmcnt(0)
  ds_write_b32 v11, v29 offset:1408
  s_waitcnt lgkmcnt(0)
  s_branch L_hbody
L_hend:
  s_lshr_b32 s46, s2, 3
  s_lshl_b32 s46, s46, 3
  s_add_u32 s46, s46, s44
  s_lshl_b32 s46, s46, 1
  s_add_u32 s46, s46, s16
  s_cmp_lg_u32 s46, 481
  s_cbranch_scc1 L_wb_393
L_hw_394:
  ds_read_b32 v7, v10 offset:2368
  s_waitcnt lgkmcnt(0)
  v_cmp_gt_u32 vcc, v29, v7
  s_cbranch_vccz L_hwe_395
  s_sleep 1
  s_sub_u32 s56, s56, 1
  s_cbranch_scc0 L_hw_394
  s_mov_b32 s56, 0
L_hwe_395:
  buffer_wbl2 sc1
L_wb_393:
L_end:
  s_endpgm
L_lsl_1:
  ds_read_b32 v7, v14 offset:2176
  s_waitcnt lgkmcnt(0)
  v_cmp_gt_u32 vcc, v247, v7
  s_cbranch_vccz L_lbk_2
  s_sub_u32 s56, s56, 1
  s_cbranch_scc0 L_lsl_1
  s_mov_b32 s56, 0
  s_branch L_lbk_2
L_lsl_3:
  ds_read_b32 v7, v14 offset:2240
  s_waitcnt lgkmcnt(0)
  v_cmp_gt_u32 vcc, v247, v7
  s_cbranch_vccz L_lbk_4
  s_sub_u32 s56, s56, 1
  s_cbranch_scc0 L_lsl_3
  s_mov_b32 s56, 0
  s_branch L_lbk_4
L_lsl_5:
  ds_read_b32 v7, v14 offset:1216
  s_waitcnt lgkmcnt(0)
  v_cmp_gt_u32 vcc, v247, v7
  s_cbranch_vccz L_lbk_6
  s_sub_u32 s56, s56, 1
  s_cbranch_scc0 L_lsl_5
  s_mov_b32 s56, 0
  s_branch L_lbk_6
L_lsl_7:
  ds_read_b32 v7, v14 offset:1280
  s_waitcnt lgkmcnt(0)
  v_cmp_gt_u32 vcc, v247, v7
  s_cbranch_vccz L_lbk_8
  s_sub_u32 s56, s56, 1
  s_cbranch_scc0 L_lsl_7
  s_mov_b32 s56, 0
  s_branch L_lbk_8
L_lsl_9:
  ds_read_b32 v7, v14 offset:2112
  s_waitcnt lgkmcnt(0)
  v_cmp_eq_u32 vcc, 0, v7
  s_cbranch_vccz L_lbk_10
  s_sub_u32 s56, s56, 1
  s_cbranch_scc0 L_lsl_9
  s_mov_b32 s56, 0
  s_branch L_lbk_10
L_lsl_11:
  ds_read_b32 v7, v14 offset:64
  s_waitcnt lgkmcnt(0)
  v_cmp_gt_u32 vcc, v247, v7
  s_cbranch_vccz L_lbk_12
  s_sub_u32 s56, s56, 1
  s_cbranch_scc0 L_lsl_11
  s_mov_b32 s56, 0
  s_branch L_lbk_12
L_lsl_13:
  ds_read_b32 v7, v14 offset:192
  ds_read_b64_tr_b16 v[144:145], v10 offset:0
  ds_read_b64_tr_b16 v[146:147], v11 offset:256
  ds_read_b64_tr_b16 v[176:177], v12 offset:16384
  ds_read_b64_tr_b16 v[178:179], v13 offset:16640
  ds_read_b64_tr_b16 v[148:149], v10 offset:2048
  ds_read_b64_tr_b16 v[150:151], v11 offset:2304
  ds_read_b64_tr_b16 v[180:181], v12 offset:18432
  ds_read_b64_tr_b16 v[182:183], v13 offset:18688
  ds_read_b64_tr_b16 v[152:153], v10 offset:4096
  ds_read_b64_tr_b16 v[154:155], v11 offset:4352
  ds_read_b64_tr_b16 v[184:185], v12 offset:20480
  ds_read_b64_tr_b16 v[186:187], v13 offset:20736
  s_waitcnt lgkmcnt(0)
  v_cmp_gt_u32 vcc, v247, v7
  s_cbranch_vccz L_lbk_14
  s_sub_u32 s56, s56, 1
  s_cbranch_scc0 L_lsl_13
  s_mov_b32 s56, 0
  s_branch L_lbk_14
L_lsl_15:
  ds_read_b32 v7, v14 offset:2624
  s_waitcnt lgkmcnt(0)
  v_cmp_eq_u32 vcc, 0, v7
  s_cbranch_vccz L_lbk_16
  s_sub_u32 s56, s56, 1
  s_cbranch_scc0 L_lsl_15
  s_mov_b32 s56, 0
  s_branch L_lbk_16
L_lsl_17:
  ds_read_b32 v7, v14 offset:1344
  s_waitcnt lgkmcnt(0)
  v_cmp_gt_u32 vcc, v247, v7
  s_cbranch_vccz L_lbk_18
  s_sub_u32 s56, s56, 1
  s_cbranch_scc0 L_lsl_17
  s_mov_b32 s56, 0
  s_branch L_lbk_18
L_lsl_19:
  ds_read_b32 v7, v14 offset:1152
  s_waitcnt lgkmcnt(0)
  v_cmp_eq_u32 vcc, 0, v7
  s_cbranch_vccz L_lbk_20
  s_sub_u32 s56, s56, 1
  s_cbranch_scc0 L_lsl_19
  s_mov_b32 s56, 0
  s_branch L_lbk_20
L_lsl_21:
  ds_read_b32 v7, v14 offset:1344
  s_waitcnt lgkmcnt(0)
  v_cmp_gt_u32 vcc, v247, v7
  s_cbranch_vccz L_lbk_22
  s_sub_u32 s56, s56, 1
  s_cbranch_scc0 L_lsl_21
  s_mov_b32 s56, 0
  s_branch L_lbk_22
L_lsl_23:
  ds_read_b32 v7, v14 offset:1152
  s_waitcnt lgkmcnt(0)
  v_cmp_eq_u32 vcc, 0, v7
  s_cbranch_vccz L_lbk_24
  s_sub_u32 s56, s56, 1
  s_cbranch_scc0 L_lsl_23
  s_mov_b32 s56, 0
  s_branch L_lbk_24
L_lsl_25:
  ds_read_b32 v7, v14 offset:2496
  s_mov_b32 exec_hi, 0
  ds_read_b128 v[48:51], v13
  s_cmp_eq_u32 s14, 0
  s_cselect_b32 exec_lo, 0xffff, 0
  ds_read_b128 v[44:47], v12
  s_mov_b64 exec, -1
  s_waitcnt lgkmcnt(0)
  v_cmp_gt_u32 vcc, v247, v7
  s_cbranch_vccz L_lbk_26
  s_sub_u32 s56, s56, 1
  s_cbranch_scc0 L_lsl_25
  s_mov_b32 s56, 0
  s_branch L_lbk_26
L_pl_27:
L_pl_27l:
  s_xor_b32 s57, s20, 57344
  buffer_load_dwordx4 v[16:19], v6, s[4:7], s57 offen offset:0 sc1
  s_xor_b32 s57, s20, 49152
  buffer_load_dwordx4 v[20:23], v6, s[4:7], s57 offen offset:0 sc1
  s_xor_b32 s57, s20, 40960
  buffer_load_dwordx4 v[24:27], v6, s[4:7], s57 offen offset:0 sc1
  s_xor_b32 s57, s20, 32768
  buffer_load_dwordx4 v[28:31], v6, s[4:7], s57 offen offset:0 sc1
  s_waitcnt vmcnt(4)
  v_max3_u32 v15, v32, v36, v40
  v_cmp_eq_u32 vcc, -1, v15
  s_cbranch_vccz L_pls_29
  s_xor_b32 s57, s20, 24576
  buffer_load_dwordx4 v[32:35], v6, s[4:7], s57 offen offset:0 sc1
  s_xor_b32 s57, s20, 16384
  buffer_load_dwordx4 v[36:39], v6, s[4:7], s57 offen offset:0 sc1
  s_xor_b32 s57, s20, 8192
  buffer_load_dwordx4 v[40:43], v6, s[4:7], s57 offen offset:0 sc1
L_pls_29:
  v_max_u32 v15, v44, v48
  v_cmp_eq_u32 vcc, -1, v15
  s_cbranch_vccz L_pls_30
  buffer_load_dwordx4 v[44:47], v11, s[4:7], s34 offen offset:0 sc1
  buffer_load_dwordx4 v[48:51], v6, s[4:7], s20 offen offset:0 sc1
L_pls_30:
  s_waitcnt vmcnt(0)
  v_max3_u32 v15, v16, v20, v24
  v_max_u32 v15, v15, v28
  v_cmp_eq_u32 vcc, -1, v15
  s_cbranch_vccz L_plb_28
  s_sub_u32 s56, s56, 4
  s_cbranch_scc0 L_pl_27l
  s_mov_b32 s56, 0
  s_branch L_plb_28
L_pl_31:
L_pl_31l:
  s_xor_b32 s57, s20, 24576
  buffer_load_dwordx4 v[32:35], v6, s[4:7], s57 offen offset:0 sc1
  s_xor_b32 s57, s20, 16384
  buffer_load_dwordx4 v[36:39], v6, s[4:7], s57 offen offset:0 sc1
  s_xor_b32 s57, s20, 8192
  buffer_load_dwordx4 v[40:43], v6, s[4:7], s57 offen offset:0 sc1
  s_waitcnt vmcnt(3)
  v_max_u32 v15, v44, v48
  v_cmp_eq_u32 vcc, -1, v15
  s_cbranch_vccz L_pls_33
  buffer_load_dwordx4 v[44:47], v11, s[4:7], s34 offen offset:0 sc1
  buffer_load_dwordx4 v[48:51], v6, s[4:7], s20 offen offset:0 sc1
L_pls_33:
  s_waitcnt vmcnt(0)
  v_max3_u32 v15, v32, v36, v40
  v_cmp_eq_u32 vcc, -1, v15
  s_cbranch_vccz L_plb_32
  s_sub_u32 s56, s56, 4
  s_cbranch_scc0 L_pl_31l
  s_mov_b32 s56, 0
  s_branch L_plb_32
L_pl_34:
L_pl_34l:
  buffer_load_dwordx4 v[44:47], v11, s[4:7], s34 offen offset:0 sc1
  buffer_load_dwordx4 v[48:51], v6, s[4:7], s20 offen offset:0 sc1
  s_waitcnt vmcnt(2)
  s_waitcnt vmcnt(0)
  v_max_u32 v15, v44, v48
  v_cmp_eq_u32 vcc, -1, v15
  s_cbranch_vccz L_plb_35
  s_sub_u32 s56, s56, 4
  s_cbranch_scc0 L_pl_34l
  s_mov_b32 s56, 0
  s_branch L_plb_35
L_lsl_36:
  ds_read_b32 v7, v14 offset:320
  ds_read_b128 v[208:211], v72 offset:0
  ds_read_b128 v[212:215], v72 offset:1024
  ds_read_b128 v[216:219], v72 offset:2048
  ds_read_b128 v[220:223], v72 offset:3072
  s_waitcnt lgkmcnt(0)
  v_cmp_gt_u32 vcc, v247, v7
  s_cbranch_vccz L_lbk_37
  s_sub_u32 s56, s56, 1
  s_cbranch_scc0 L_lsl_36
  s_mov_b32 s56, 0
  s_branch L_lbk_37
L_lsl_38:
  ds_read_b32 v7, v14 offset:2688
  s_waitcnt lgkmcnt(0)
  v_cmp_gt_u32 vcc, v247, v7
  s_cbranch_vccz L_lbk_39
  s_sub_u32 s56, s56, 1
  s_cbranch_scc0 L_lsl_38
  s_mov_b32 s56, 0
  s_branch L_lbk_39
L_lsl_40:
  ds_read_b32 v7, v14 offset:1408
  s_waitcnt lgkmcnt(0)
  v_cmp_gt_u32 vcc, v247, v7
  s_cbranch_vccz L_lbk_41
  s_sub_u32 s56, s56, 1
  s_cbranch_scc0 L_lsl_40
  s_mov_b32 s56, 0
  s_branch L_lbk_41
L_pl_42:
L_pl_42l:
  buffer_load_dwordx4 v[16:19], v1, s[4:7], s23 offen offset:0 sc1
  buffer_load_dwordx4 v[20:23], v1, s[4:7], s23 offen offset:1024 sc1
  s_waitcnt vmcnt(2)
  v_max_u32 v15, v24, v28
  v_cmp_eq_u32 vcc, -1, v15
  s_cbranch_vccz L_pls_44
  buffer_load_dwordx4 v[24:27], v1, s[4:7], s23 offen offset:2048 sc1
  buffer_load_dwordx4 v[28:31], v1, s[4:7], s23 offen offset:3072 sc1
L_pls_44:
  v_max3_u32 v15, v32, v36, v40
  v_max_u32 v15, v15, v44
  v_cmp_eq_u32 vcc, -1, v15
  s_cbranch_vccz L_pls_45
  s_add_u32 s57, s23, 4096
  buffer_load_dwordx4 v[32:35], v1, s[4:7], s57 offen offset:0 sc1
  buffer_load_dwordx4 v[36:39], v1, s[4:7], s57 offen offset:1024 sc1
  buffer_load_dwordx4 v[40:43], v1, s[4:7], s57 offen offset:2048 sc1
  buffer_load_dwordx4 v[44:47], v1, s[4:7], s57 offen offset:3072 sc1
L_pls_45:
  s_waitcnt vmcnt(0)
  v_max_u32 v15, v16, v20
  v_cmp_eq_u32 vcc, -1, v15
  s_cbranch_vccz L_plb_43
  s_sub_u32 s56, s56, 4
  s_cbranch_scc0 L_pl_42l
  s_mov_b32 s56, 0
  s_branch L_plb_43
L_pl_46:
L_pl_46l:
  buffer_load_dwordx4 v[24:27], v1, s[4:7], s23 offen offset:2048 sc1
  buffer_load_dwordx4 v[28:31], v1, s[4:7], s23 offen offset:3072 sc1
  s_waitcnt vmcnt(2)
  v_max3_u32 v15, v32, v36, v40
  v_max_u32 v15, v15, v44
  v_cmp_eq_u32 vcc, -1, v15
  s_cbranch_vccz L_pls_48
  s_add_u32 s57, s23, 4096
  buffer_load_dwordx4 v[32:35], v1, s[4:7], s57 offen offset:0 sc1
  buffer_load_dwordx4 v[36:39], v1, s[4:7], s57 offen offset:1024 sc1
  buffer_load_dwordx4 v[40:43], v1, s[4:7], s57 offen offset:2048 sc1
  buffer_load_dwordx4 v[44:47], v1, s[4:7], s57 offen offset:3072 sc1
L_pls_48:
  v_max3_u32 v15, v48, v52, v56
  v_max_u32 v15, v15, v60
  v_cmp_eq_u32 vcc, -1, v15
  s_cbranch_vccz L_pls_49
  s_add_u32 s57, s23, 8192
  buffer_load_dwordx4 v[48:51], v1, s[4:7], s57 offen offset:0 sc1
  buffer_load_dwordx4 v[52:55], v1, s[4:7], s57 offen offset:1024 sc1
  buffer_load_dwordx4 v[56:59], v1, s[4:7], s57 offen offset:2048 sc1
  buffer_load_dwordx4 v[60:63], v1, s[4:7], s57 offen offset:3072 sc1
L_pls_49:
  s_waitcnt vmcnt(0)
  v_max_u32 v15, v24, v28
  v_cmp_eq_u32 vcc, -1, v15
  s_cbranch_vccz L_plb_47
  s_sub_u32 s56, s56, 4
  s_cbranch_scc0 L_pl_46l
  s_mov_b32 s56, 0
  s_branch L_plb_47
L_pl_50:
L_pl_50l:
  s_add_u32 s57, s23, 4096
  buffer_load_dwordx4 v[32:35], v1, s[4:7], s57 offen offset:0 sc1
  buffer_load_dwordx4 v[36:39], v1, s[4:7], s57 offen offset:1024 sc1
  buffer_load_dwordx4 v[40:43], v1, s[4:7], s57 offen offset:2048 sc1
  buffer_load_dwordx4 v[44:47], v1, s[4:7], s57 offen offset:3072 sc1
  s_waitcnt vmcnt(4)
  v_max3_u32 v15, v48, v52, v56
  v_max_u32 v15, v15, v60
  v_cmp_eq_u32 vcc, -1, v15
  s_cbranch_vccz L_pls_52
  s_add_u32 s57, s23, 8192
  buffer_load_dwordx4 v[48:51], v1, s[4:7], s57 offen offset:0 sc1
  buffer_load_dwordx4 v[52:55], v1, s[4:7], s57 offen offset:1024 sc1
  buffer_load_dwordx4 v[56:59], v1, s[4:7], s57 offen offset:2048 sc1
  buffer_load_dwordx4 v[60:63], v1, s[4:7], s57 offen offset:3072 sc1
L_pls_52:
  v_max3_u32 v15, v64, v68, v72
  v_max_u32 v15, v15, v76
  v_cmp_eq_u32 vcc, -1, v15
  s_cbranch_vccz L_pls_53
  s_add_u32 s57, s23, 12288
  buffer_load_dwordx4 v[64:67], v1, s[4:7], s57 offen offset:0 sc1
  buffer_load_dwordx4 v[68:71], v1, s[4:7], s57 offen offset:1024 sc1
  buffer_load_dwordx4 v[72:75], v1, s[4:7], s57 offen offset:2048 sc1
  buffer_load_dwordx4 v[76:79], v1, s[4:7], s57 offen offset:3072 sc1
L_pls_53:
  s_waitcnt vmcnt(0)
  v_max3_u32 v15, v32, v36, v40
  v_max_u32 v15, v15, v44
  v_cmp_eq_u32 vcc, -1, v15
  s_cbranch_vccz L_plb_51
  s_sub_u32 s56, s56, 4
  s_cbranch_scc0 L_pl_50l
  s_mov_b32 s56, 0
  s_branch L_plb_51
L_pl_54:
L_pl_54l:
  s_add_u32 s57, s23, 8192
  buffer_load_dwordx4 v[48:51], v1, s[4:7], s57 offen offset:0 sc1
  buffer_load_dwordx4 v[52:55], v1, s[4:7], s57 offen offset:1024 sc1
  buffer_load_dwordx4 v[56:59], v1, s[4:7], s57 offen offset:2048 sc1
  buffer_load_dwordx4 v[60:63], v1, s[4:7], s57 offen offset:3072 sc1
  s_waitcnt vmcnt(4)
  v_max3_u32 v15, v64, v68, v72
  v_max_u32 v15, v15, v76
  v_cmp_eq_u32 vcc, -1, v15
  s_cbranch_vccz L_pls_56
  s_add_u32 s57, s23, 12288
  buffer_load_dwordx4 v[64:67], v1, s[4:7], s57 offen offset:0 sc1
  buffer_load_dwordx4 v[68:71], v1, s[4:7], s57 offen offset:1024 sc1
  buffer_load_dwordx4 v[72:75], v1, s[4:7], s57 offen offset:2048 sc1
  buffer_load_dwordx4 v[76:79], v1, s[4:7], s57 offen offset:3072 sc1
L_pls_56:
  s_waitcnt vmcnt(0)
  v_max3_u32 v15, v48, v52, v56
  v_max_u32 v15, v15, v60
  v_cmp_eq_u32 vcc, -1, v15
  s_cbranch_vccz L_plb_55
  s_sub_u32 s56, s56, 4
  s_cbranch_scc0 L_pl_54l
  s_mov_b32 s56, 0
  s_branch L_plb_55
L_pl_57:
L_pl_57l:
  s_add_u32 s57, s23, 12288
  buffer_load_dwordx4 v[64:67], v1, s[4:7], s57 offen offset:0 sc1
  buffer_load_dwordx4 v[68:71], v1, s[4:7], s57 offen offset:1024 sc1
  buffer_load_dwordx4 v[72:75], v1, s[4:7], s57 offen offset:2048 sc1
  buffer_load_dwordx4 v[76:79], v1, s[4:7], s57 offen offset:3072 sc1
  s_waitcnt vmcnt(4)
  s_waitcnt vmcnt(0)
  v_max3_u32 v15, v64, v68, v72
  v_max_u32 v15, v15, v76
  v_cmp_eq_u32 vcc, -1, v15
  s_cbranch_vccz L_plb_58
  s_sub_u32 s56, s56, 4
  s_cbranch_scc0 L_pl_57l
  s_mov_b32 s56, 0
  s_branch L_plb_58
L_lsl_59:
  ds_read_b32 v7, v14 offset:384
  ds_read_b128 v[144:147], v13 offset:0
  ds_read_b128 v[148:151], v13 offset:1024
  ds_read_b128 v[152:155], v13 offset:2048
  ds_read_b128 v[156:159], v13 offset:3072
  s_waitcnt lgkmcnt(0)
  v_cmp_gt_u32 vcc, v247, v7
  s_nop 0
  s_and_b64 vcc, vcc, s[36:37]
  s_cbranch_scc0 L_lbk_60
  s_sub_u32 s56, s56, 1
  s_cbranch_scc0 L_lsl_59
  s_mov_b32 s56, 0
  s_branch L_lbk_60
L_pl_61:
L_pl_61l:
  buffer_load_dwordx4 v[16:19], v1, s[4:7], s26 offen offset:0 sc1
  buffer_load_dwordx4 v[20:23], v1, s[4:7], s26 offen offset:1024 sc1
  s_waitcnt vmcnt(2)
  v_max_u32 v15, v24, v28
  v_cmp_eq_u32 vcc, -1, v15
  s_cbranch_vccz L_pls_63
  buffer_load_dwordx4 v[24:27], v1, s[4:7], s26 offen offset:2048 sc1
  buffer_load_dwordx4 v[28:31], v1, s[4:7], s26 offen offset:3072 sc1
L_pls_63:
  v_max3_u32 v15, v32, v36, v40
  v_max_u32 v15, v15, v44
  v_cmp_eq_u32 vcc, -1, v15
  s_cbranch_vccz L_pls_64
  s_add_u32 s57, s26, 4096
  buffer_load_dwordx4 v[32:35], v1, s[4:7], s57 offen offset:0 sc1
  buffer_load_dwordx4 v[36:39], v1, s[4:7], s57 offen offset:1024 sc1
  buffer_load_dwordx4 v[40:43], v1, s[4:7], s57 offen offset:2048 sc1
  buffer_load_dwordx4 v[44:47], v1, s[4:7], s57 offen offset:3072 sc1
L_pls_64:
  v_max_u32 v15, v48, v52
  v_cmp_eq_u32 vcc, -1, v15
  s_cbranch_vccz L_pls_65
  s_add_u32 s57, s26, 8192
  buffer_load_dwordx4 v[48:51], v1, s[4:7], s57 offen offset:0 sc1
  buffer_load_dwordx4 v[52:55], v1, s[4:7], s57 offen offset:1024 sc1
L_pls_65:
  s_waitcnt vmcnt(0)
  v_max_u32 v15, v16, v20
  v_cmp_eq_u32 vcc, -1, v15
  s_cbranch_vccz L_plb_62
  s_sub_u32 s56, s56, 4
  s_cbranch_scc0 L_pl_61l
  s_mov_b32 s56, 0
  s_branch L_plb_62
L_pl_66:
L_pl_66l:
  buffer_load_dwordx4 v[24:27], v1, s[4:7], s26 offen offset:2048 sc1
  buffer_load_dwordx4 v[28:31], v1, s[4:7], s26 offen offset:3072 sc1
  s_waitcnt vmcnt(2)
  v_max3_u32 v15, v32, v36, v40
  v_max_u32 v15, v15, v44
  v_cmp_eq_u32 vcc, -1, v15
  s_cbranch_vccz L_pls_68
  s_add_u32 s57, s26, 4096
  buffer_load_dwordx4 v[32:35], v1, s[4:7], s57 offen offset:0 sc1
  buffer_load_dwordx4 v[36:39], v1, s[4:7], s57 offen offset:1024 sc1
  buffer_load_dwordx4 v[40:43], v1, s[4:7], s57 offen offset:2048 sc1
  buffer_load_dwordx4 v[44:47], v1, s[4:7], s57 offen offset:3072 sc1
L_pls_68:
  v_max3_u32 v15, v48, v52, v56
  v_max_u32 v15, v15, v60
  v_cmp_eq_u32 vcc, -1, v15
  s_cbranch_vccz L_pls_69
  s_add_u32 s57, s26, 8192
  buffer_load_dwordx4 v[48:51], v1, s[4:7], s57 offen offset:0 sc1
  buffer_load_dwordx4 v[52:55], v1, s[4:7], s57 offen offset:1024 sc1
  buffer_load_dwordx4 v[56:59], v1, s[4:7], s57 offen offset:2048 sc1
  buffer_load_dwordx4 v[60:63], v1, s[4:7], s57 offen offset:3072 sc1
L_pls_69:
  v_max_u32 v15, v64, v68
  v_cmp_eq_u32 vcc, -1, v15
  s_cbranch_vccz L_pls_70
  s_add_u32 s57, s26, 12288
  buffer_load_dwordx4 v[64:67], v1, s[4:7], s57 offen offset:0 sc1
  buffer_load_dwordx4 v[68:71], v1, s[4:7], s57 offen offset:1024 sc1
L_pls_70:
  s_waitcnt vmcnt(0)
  v_max_u32 v15, v24, v28
  v_cmp_eq_u32 vcc, -1, v15
  s_cbranch_vccz L_plb_67
  s_sub_u32 s56, s56, 4
  s_cbranch_scc0 L_pl_66l
  s_mov_b32 s56, 0
  s_branch L_plb_67
L_pl_71:
L_pl_71l:
  s_add_u32 s57, s26, 4096
  buffer_load_dwordx4 v[32:35], v1, s[4:7], s57 offen offset:0 sc1
  buffer_load_dwordx4 v[36:39], v1, s[4:7], s57 offen offset:1024 sc1
  buffer_load_dwordx4 v[40:43], v1, s[4:7], s57 offen offset:2048 sc1
  buffer_load_dwordx4 v[44:47], v1, s[4:7], s57 offen offset:3072 sc1
  s_waitcnt vmcnt(4)
  v_max3_u32 v15, v48, v52, v56
  v_max_u32 v15, v15, v60
  v_cmp_eq_u32 vcc, -1, v15
  s_cbranch_vccz L_pls_73
  s_add_u32 s57, s26, 8192
  buffer_load_dwordx4 v[48:51], v1, s[4:7], s57 offen offset:0 sc1
  buffer_load_dwordx4 v[52:55], v1, s[4:7], s57 offen offset:1024 sc1
  buffer_load_dwordx4 v[56:59], v1, s[4:7], s57 offen offset:2048 sc1
  buffer_load_dwordx4 v[60:63], v1, s[4:7], s57 offen offset:3072 sc1
L_pls_73:
  v_max3_u32 v15, v64, v68, v72
  v_max_u32 v15, v15, v76
  v_cmp_eq_u32 vcc, -1, v15
  s_cbranch_vccz L_pls_74
  s_add_u32 s57, s26, 12288
  buffer_load_dwordx4 v[64:67], v1, s[4:7], s57 offen offset:0 sc1
  buffer_load_dwordx4 v[68:71], v1, s[4:7], s57 offen offset:1024 sc1
  buffer_load_dwordx4 v[72:75], v1, s[4:7], s57 offen offset:2048 sc1
  buffer_load_dwordx4 v[76:79], v1, s[4:7], s57 offen offset:3072 sc1
L_pls_74:
  s_waitcnt vmcnt(0)
  v_max3_u32 v15, v32, v36, v40
  v_max_u32 v15, v15, v44
  v_cmp_eq_u32 vcc, -1, v15
  s_cbranch_vccz L_plb_72
  s_sub_u32 s56, s56, 4
  s_cbranch_scc0 L_pl_71l
  s_mov_b32 s56, 0
  s_branch L_plb_72
L_pl_75:
L_pl_75l:
  s_add_u32 s57, s26, 8192
  buffer_load_dwordx4 v[48:51], v1, s[4:7], s57 offen offset:0 sc1
  buffer_load_dwordx4 v[52:55], v1, s[4:7], s57 offen offset:1024 sc1
  buffer_load_dwordx4 v[56:59], v1, s[4:7], s57 offen offset:2048 sc1
  buffer_load_dwordx4 v[60:63], v1, s[4:7], s57 offen offset:3072 sc1
  s_waitcnt vmcnt(4)
  v_max3_u32 v15, v64, v68, v72
  v_max_u32 v15, v15, v76
  v_cmp_eq_u32 vcc, -1, v15
  s_cbranch_vccz L_pls_77
  s_add_u32 s57, s26, 12288
  buffer_load_dwordx4 v[64:67], v1, s[4:7], s57 offen offset:0 sc1
  buffer_load_dwordx4 v[68:71], v1, s[4:7], s57 offen offset:1024 sc1
  buffer_load_dwordx4 v[72:75], v1, s[4:7], s57 offen offset:2048 sc1
  buffer_load_dwordx4 v[76:79], v1, s[4:7], s57 offen offset:3072 sc1
L_pls_77:
  v_max3_u32 v15, v80, v84, v88
  v_max_u32 v15, v15, v92
  v_cmp_eq_u32 vcc, -1, v15
  s_cbranch_vccz L_pls_78
  s_add_u32 s57, s26, 16384
  buffer_load_dwordx4 v[80:83], v1, s[4:7], s57 offen offset:0 sc1
  buffer_load_dwordx4 v[84:87], v1, s[4:7], s57 offen offset:1024 sc1
  buffer_load_dwordx4 v[88:91], v1, s[4:7], s57 offen offset:2048 sc1
  buffer_load_dwordx4 v[92:95], v1, s[4:7], s57 offen offset:3072 sc1
L_pls_78:
  v_max3_u32 v15, v192, v194, v196
  v_max_u32 v15, v15, v198
  v_cmp_eq_u32 vcc, -1, v15
  s_cbranch_vccz L_pls_79
  buffer_load_dwordx2 v[192:193], v4, s[4:7], s27 offen offset:0 sc1
  buffer_load_dwordx2 v[194:195], v4, s[4:7], s27 offen offset:512 sc1
  buffer_load_dwordx2 v[196:197], v4, s[4:7], s27 offen offset:1024 sc1
  buffer_load_dwordx2 v[198:199], v4, s[4:7], s27 offen offset:1536 sc1
L_pls_79:
  s_waitcnt vmcnt(0)
  v_max3_u32 v15, v48, v52, v56
  v_max_u32 v15, v15, v60
  v_cmp_eq_u32 vcc, -1, v15
  s_cbranch_vccz L_plb_76
  s_sub_u32 s56, s56, 4
  s_cbranch_scc0 L_pl_75l
  s_mov_b32 s56, 0
  s_branch L_plb_76
L_pl_80:
L_pl_80l:
  s_add_u32 s57, s26, 12288
  buffer_load_dwordx4 v[64:67], v1, s[4:7], s57 offen offset:0 sc1
  buffer_load_dwordx4 v[68:71], v1, s[4:7], s57 offen offset:1024 sc1
  buffer_load_dwordx4 v[72:75], v1, s[4:7], s57 offen offset:2048 sc1
  buffer_load_dwordx4 v[76:79], v1, s[4:7], s57 offen offset:3072 sc1
  s_waitcnt vmcnt(4)
  v_max3_u32 v15, v80, v84, v88
  v_max_u32 v15, v15, v92
  v_cmp_eq_u32 vcc, -1, v15
  s_cbranch_vccz L_pls_82
  s_add_u32 s57, s26, 16384
  buffer_load_dwordx4 v[80:83], v1, s[4:7], s57 offen offset:0 sc1
  buffer_load_dwordx4 v[84:87], v1, s[4:7], s57 offen offset:1024 sc1
  buffer_load_dwordx4 v[88:91], v1, s[4:7], s57 offen offset:2048 sc1
  buffer_load_dwordx4 v[92:95], v1, s[4:7], s57 offen offset:3072 sc1
L_pls_82:
  v_max3_u32 v15, v96, v100, v104
  v_max_u32 v15, v15, v108
  v_cmp_eq_u32 vcc, -1, v15
  s_cbranch_vccz L_pls_83
  s_add_u32 s57, s26, 20480
  buffer_load_dwordx4 v[96:99], v1, s[4:7], s57 offen offset:0 sc1
  buffer_load_dwordx4 v[100:103], v1, s[4:7], s57 offen offset:1024 sc1
  buffer_load_dwordx4 v[104:107], v1, s[4:7], s57 offen offset:2048 sc1
  buffer_load_dwordx4 v[108:111], v1, s[4:7], s57 offen offset:3072 sc1
L_pls_83:
  v_max3_u32 v15, v192, v194, v196
  v_max3_u32 v15, v15, v198, v200
  v_max3_u32 v15, v15, v202, v204
  v_max_u32 v15, v15, v206
  v_cmp_eq_u32 vcc, -1, v15
  s_cbranch_vccz L_pls_84
  buffer_load_dwordx2 v[192:193], v4, s[4:7], s27 offen offset:0 sc1
  buffer_load_dwordx2 v[194:195], v4, s[4:7], s27 offen offset:512 sc1
  buffer_load_dwordx2 v[196:197], v4, s[4:7], s27 offen offset:1024 sc1
  buffer_load_dwordx2 v[198:199], v4, s[4:7], s27 offen offset:1536 sc1
  buffer_load_dwordx2 v[200:201], v4, s[4:7], s27 offen offset:2048 sc1
  buffer_load_dwordx2 v[202:203], v4, s[4:7], s27 offen offset:2560 sc1
  buffer_load_dwordx2 v[204:205], v4, s[4:7], s27 offen offset:3072 sc1
  buffer_load_dwordx2 v[206:207], v4, s[4:7], s27 offen offset:3584 sc1
L_pls_84:
  s_waitcnt vmcnt(0)
  v_max3_u32 v15, v64, v68, v72
  v_max_u32 v15, v15, v76
  v_cmp_eq_u32 vcc, -1, v15
  s_cbranch_vccz L_plb_81
  s_sub_u32 s56, s56, 4
  s_cbranch_scc0 L_pl_80l
  s_mov_b32 s56, 0
  s_branch L_plb_81
L_pl_85:
L_pl_85l:
  s_add_u32 s57, s26, 16384
  buffer_load_dwordx4 v[80:83], v1, s[4:7], s57 offen offset:0 sc1
  buffer_load_dwordx4 v[84:87], v1, s[4:7], s57 offen offset:1024 sc1
  buffer_load_dwordx4 v[88:91], v1, s[4:7], s57 offen offset:2048 sc1
  buffer_load_dwordx4 v[92:95], v1, s[4:7], s57 offen offset:3072 sc1
  s_waitcnt vmcnt(4)
  v_max3_u32 v15, v96, v100, v104
  v_max_u32 v15, v15, v108
  v_cmp_eq_u32 vcc, -1, v15
  s_cbranch_vccz L_pls_87
  s_add_u32 s57, s26, 20480
  buffer_load_dwordx4 v[96:99], v1, s[4:7], s57 offen offset:0 sc1
  buffer_load_dwordx4 v[100:103], v1, s[4:7], s57 offen offset:1024 sc1
  buffer_load_dwordx4 v[104:107], v1, s[4:7], s57 offen offset:2048 sc1
  buffer_load_dwordx4 v[108:111], v1, s[4:7], s57 offen offset:3072 sc1
L_pls_87:
  v_max3_u32 v15, v112, v116, v120
  v_max_u32 v15, v15, v124
  v_cmp_eq_u32 vcc, -1, v15
  s_cbranch_vccz L_pls_88
  s_add_u32 s57, s26, 24576
  buffer_load_dwordx4 v[112:115], v1, s[4:7], s57 offen offset:0 sc1
  buffer_load_dwordx4 v[116:119], v1, s[4:7], s57 offen offset:1024 sc1
  buffer_load_dwordx4 v[120:123], v1, s[4:7], s57 offen offset:2048 sc1
  buffer_load_dwordx4 v[124:127], v1, s[4:7], s57 offen offset:3072 sc1
L_pls_88:
  v_max3_u32 v15, v192, v194, v196
  v_max3_u32 v15, v15, v198, v200
  v_max3_u32 v15, v15, v202, v204
  v_max_u32 v15, v15, v206
  v_cmp_eq_u32 vcc, -1, v15
  s_cbranch_vccz L_pls_89
  buffer_load_dwordx2 v[192:193], v4, s[4:7], s27 offen offset:0 sc1
  buffer_load_dwordx2 v[194:195], v4, s[4:7], s27 offen offset:512 sc1
  buffer_load_dwordx2 v[196:197], v4, s[4:7], s27 offen offset:1024 sc1
  buffer_load_dwordx2 v[198:199], v4, s[4:7], s27 offen offset:1536 sc1
  buffer_load_dwordx2 v[200:201], v4, s[4:7], s27 offen offset:2048 sc1
  buffer_load_dwordx2 v[202:203], v4, s[4:7], s27 offen offset:2560 sc1
  buffer_load_dwordx2 v[204:205], v4, s[4:7], s27 offen offset:3072 sc1
  buffer_load_dwordx2 v[206:207], v4, s[4:7], s27 offen offset:3584 sc1
L_pls_89:
  s_waitcnt vmcnt(0)
  v_max3_u32 v15, v80, v84, v88
  v_max_u32 v15, v15, v92
  v_cmp_eq_u32 vcc, -1, v15
  s_cbranch_vccz L_plb_86
  s_sub_u32 s56, s56, 4
  s_cbranch_scc0 L_pl_85l
  s_mov_b32 s56, 0
  s_branch L_plb_86
L_pl_90:
L_pl_90l:
  s_add_u32 s57, s26, 20480
  buffer_load_dwordx4 v[96:99], v1, s[4:7], s57 offen offset:0 sc1
  buffer_load_dwordx4 v[100:103], v1, s[4:7], s57 offen offset:1024 sc1
  buffer_load_dwordx4 v[104:107], v1, s[4:7], s57 offen offset:2048 sc1
  buffer_load_dwordx4 v[108:111], v1, s[4:7], s57 offen offset:3072 sc1
  s_waitcnt vmcnt(4)
  v_max3_u32 v15, v112, v116, v120
  v_max_u32 v15, v15, v124
  v_cmp_eq_u32 vcc, -1, v15
  s_cbranch_vccz L_pls_92
  s_add_u32 s57, s26, 24576
  buffer_load_dwordx4 v[112:115], v1, s[4:7], s57 offen offset:0 sc1
  buffer_load_dwordx4 v[116:119], v1, s[4:7], s57 offen offset:1024 sc1
  buffer_load_dwordx4 v[120:123], v1, s[4:7], s57 offen offset:2048 sc1
  buffer_load_dwordx4 v[124:127], v1, s[4:7], s57 offen offset:3072 sc1
L_pls_92:
  v_max_u32 v15, v128, v132
  v_cmp_eq_u32 vcc, -1, v15
  s_cbranch_vccz L_pls_93
  s_add_u32 s57, s26, 28672
  buffer_load_dwordx4 v[128:131], v1, s[4:7], s57 offen offset:0 sc1
  buffer_load_dwordx4 v[132:135], v1, s[4:7], s57 offen offset:1024 sc1
L_pls_93:
  v_max_u32 v15, v136, v140
  v_cmp_eq_u32 vcc, -1, v15
  s_cbranch_vccz L_pls_94
  s_add_u32 s57, s26, 28672
  buffer_load_dwordx4 v[136:139], v1, s[4:7], s57 offen offset:2048 sc1
  buffer_load_dwordx4 v[140:143], v1, s[4:7], s57 offen offset:3072 sc1
L_pls_94:
  v_max3_u32 v15, v192, v194, v196
  v_max3_u32 v15, v15, v198, v200
  v_max3_u32 v15, v15, v202, v204
  v_max_u32 v15, v15, v206
  v_cmp_eq_u32 vcc, -1, v15
  s_cbranch_vccz L_pls_95
  buffer_load_dwordx2 v[192:193], v4, s[4:7], s27 offen offset:0 sc1
  buffer_load_dwordx2 v[194:195], v4, s[4:7], s27 offen offset:512 sc1
  buffer_load_dwordx2 v[196:197], v4, s[4:7], s27 offen offset:1024 sc1
  buffer_load_dwordx2 v[198:199], v4, s[4:7], s27 offen offset:1536 sc1
  buffer_load_dwordx2 v[200:201], v4, s[4:7], s27 offen offset:2048 sc1
  buffer_load_dwordx2 v[202:203], v4, s[4:7], s27 offen offset:2560 sc1
  buffer_load_dwordx2 v[204:205], v4, s[4:7], s27 offen offset:3072 sc1
  buffer_load_dwordx2 v[206:207], v4, s[4:7], s27 offen offset:3584 sc1
L_pls_95:
  s_waitcnt vmcnt(0)
  v_max3_u32 v15, v96, v100, v104
  v_max_u32 v15, v15, v108
  v_cmp_eq_u32 vcc, -1, v15
  s_cbranch_vccz L_plb_91
  s_sub_u32 s56, s56, 4
  s_cbranch_scc0 L_pl_90l
  s_mov_b32 s56, 0
  s_branch L_plb_91
L_pl_96:
L_pl_96l:
  buffer_load_dwordx2 v[192:193], v4, s[4:7], s27 offen offset:0 sc1
  buffer_load_dwordx2 v[194:195], v4, s[4:7], s27 offen offset:512 sc1
  buffer_load_dwordx2 v[196:197], v4, s[4:7], s27 offen offset:1024 sc1
  buffer_load_dwordx2 v[198:199], v4, s[4:7], s27 offen offset:1536 sc1
  buffer_load_dwordx2 v[200:201], v4, s[4:7], s27 offen offset:2048 sc1
  buffer_load_dwordx2 v[202:203], v4, s[4:7], s27 offen offset:2560 sc1
  buffer_load_dwordx2 v[204:205], v4, s[4:7], s27 offen offset:3072 sc1
  buffer_load_dwordx2 v[206:207], v4, s[4:7], s27 offen offset:3584 sc1
  s_waitcnt vmcnt(8)
  v_max3_u32 v15, v112, v116, v120
  v_max_u32 v15, v15, v124
  v_cmp_eq_u32 vcc, -1, v15
  s_cbranch_vccz L_pls_98
  s_add_u32 s57, s26, 24576
  buffer_load_dwordx4 v[112:115], v1, s[4:7], s57 offen offset:0 sc1
  buffer_load_dwordx4 v[116:119], v1, s[4:7], s57 offen offset:1024 sc1
  buffer_load_dwordx4 v[120:123], v1, s[4:7], s57 offen offset:2048 sc1
  buffer_load_dwordx4 v[124:127], v1, s[4:7], s57 offen offset:3072 sc1
L_pls_98:
  v_max_u32 v15, v128, v132
  v_cmp_eq_u32 vcc, -1, v15
  s_cbranch_vccz L_pls_99
  s_add_u32 s57, s26, 28672
  buffer_load_dwordx4 v[128:131], v1, s[4:7], s57 offen offset:0 sc1
  buffer_load_dwordx4 v[132:135], v1, s[4:7], s57 offen offset:1024 sc1
L_pls_99:
  v_max_u32 v15, v136, v140
  v_cmp_eq_u32 vcc, -1, v15
  s_cbranch_vccz L_pls_100
  s_add_u32 s57, s26, 28672
  buffer_load_dwordx4 v[136:139], v1, s[4:7], s57 offen offset:2048 sc1
  buffer_load_dwordx4 v[140:143], v1, s[4:7], s57 offen offset:3072 sc1
L_pls_100:
  s_waitcnt vmcnt(0)
  v_max3_u32 v15, v192, v194, v196
  v_max3_u32 v15, v15, v198, v200
  v_max3_u32 v15, v15, v202, v204
  v_max_u32 v15, v15, v206
  v_cmp_eq_u32 vcc, -1, v15
  s_cbranch_vccz L_plb_97
  s_sub_u32 s56, s56, 4
  s_cbranch_scc0 L_pl_96l
  s_mov_b32 s56, 0
  s_branch L_plb_97
L_pl_101:
L_pl_101l:
  s_add_u32 s57, s26, 24576
  buffer_load_dwordx4 v[112:115], v1, s[4:7], s57 offen offset:0 sc1
  buffer_load_dwordx4 v[116:119], v1, s[4:7], s57 offen offset:1024 sc1
  buffer_load_dwordx4 v[120:123], v1, s[4:7], s57 offen offset:2048 sc1
  buffer_load_dwordx4 v[124:127], v1, s[4:7], s57 offen offset:3072 sc1
  s_waitcnt vmcnt(4)
  v_max_u32 v15, v128, v132
  v_cmp_eq_u32 vcc, -1, v15
  s_cbranch_vccz L_pls_103
  s_add_u32 s57, s26, 28672
  buffer_load_dwordx4 v[128:131], v1, s[4:7], s57 offen offset:0 sc1
  buffer_load_dwordx4 v[132:135], v1, s[4:7], s57 offen offset:1024 sc1
L_pls_103:
  v_max_u32 v15, v136, v140
  v_cmp_eq_u32 vcc, -1, v15
  s_cbranch_vccz L_pls_104
  s_add_u32 s57, s26, 28672
  buffer_load_dwordx4 v[136:139], v1, s[4:7], s57 offen offset:2048 sc1
  buffer_load_dwordx4 v[140:143], v1, s[4:7], s57 offen offset:3072 sc1
L_pls_104:
  s_waitcnt vmcnt(0)
  v_max3_u32 v15, v112, v116, v120
  v_max_u32 v15, v15, v124
  v_cmp_eq_u32 vcc, -1, v15
  s_cbranch_vccz L_plb_102
  s_sub_u32 s56, s56, 4
  s_cbranch_scc0 L_pl_101l
  s_mov_b32 s56, 0
  s_branch L_plb_102
L_pl_105:
L_pl_105l:
  s_add_u32 s57, s26, 28672
  buffer_load_dwordx4 v[128:131], v1, s[4:7], s57 offen offset:0 sc1
  buffer_load_dwordx4 v[132:135], v1, s[4:7], s57 offen offset:1024 sc1
  s_waitcnt vmcnt(2)
  v_max_u32 v15, v136, v140
  v_cmp_eq_u32 vcc, -1, v15
  s_cbranch_vccz L_pls_107
  s_add_u32 s57, s26, 28672
  buffer_load_dwordx4 v[136:139], v1, s[4:7], s57 offen offset:2048 sc1
  buffer_load_dwordx4 v[140:143], v1, s[4:7], s57 offen offset:3072 sc1
L_pls_107:
  s_waitcnt vmcnt(0)
  v_max_u32 v15, v128, v132
  v_cmp_eq_u32 vcc, -1, v15
  s_cbranch_vccz L_plb_106
  s_sub_u32 s56, s56, 4
  s_cbranch_scc0 L_pl_105l
  s_mov_b32 s56, 0
  s_branch L_plb_106
L_lsl_108:
  ds_read_b32 v7, v14 offset:1472
  s_waitcnt lgkmcnt(0)
  v_cmp_gt_u32 vcc, v247, v7
  s_cbranch_vccz L_lbk_109
  s_sub_u32 s56, s56, 1
  s_cbranch_scc0 L_lsl_108
  s_mov_b32 s56, 0
  s_branch L_lbk_109
L_pl_110:
L_pl_110l:
  s_add_u32 s57, s26, 28672
  buffer_load_dwordx4 v[136:139], v1, s[4:7], s57 offen offset:2048 sc1
  buffer_load_dwordx4 v[140:143], v1, s[4:7], s57 offen offset:3072 sc1
  s_waitcnt vmcnt(2)
  s_waitcnt vmcnt(0)
  v_max_u32 v15, v136, v140
  v_cmp_eq_u32 vcc, -1, v15
  s_cbranch_vccz L_plb_111
  s_sub_u32 s56, s56, 4
  s_cbranch_scc0 L_pl_110l
  s_mov_b32 s56, 0
  s_branch L_plb_111
L_lsl_112:
  ds_read_b32 v7, v14 offset:1536
  s_waitcnt lgkmcnt(0)
  v_cmp_gt_u32 vcc, v247, v7
  s_cbranch_vccz L_lbk_113
  s_sub_u32 s56, s56, 1
  s_cbranch_scc0 L_lsl_112
  s_mov_b32 s56, 0
  s_branch L_lbk_113
L_lsl_114:
  ds_read_b32 v7, v14 offset:1600
  s_waitcnt lgkmcnt(0)
  v_cmp_gt_u32 vcc, v247, v7
  s_cbranch_vccz L_lbk_115
  s_sub_u32 s56, s56, 1
  s_cbranch_scc0 L_lsl_114
  s_mov_b32 s56, 0
  s_branch L_lbk_115
L_lsl_116:
  ds_read_b32 v7, v14 offset:1664
  s_waitcnt lgkmcnt(0)
  v_cmp_gt_u32 vcc, v247, v7
  s_cbranch_vccz L_lbk_117
  s_sub_u32 s56, s56, 1
  s_cbranch_scc0 L_lsl_116
  s_mov_b32 s56, 0
  s_branch L_lbk_117
L_pl_118:
L_pl_118l:
  buffer_load_dwordx4 v[16:19], v1, s[4:7], s29 offen offset:0 sc1
  buffer_load_dwordx4 v[20:23], v1, s[4:7], s29 offen offset:1024 sc1
  s_waitcnt vmcnt(2)
  v_max_u32 v15, v24, v28
  v_cmp_eq_u32 vcc, -1, v15
  s_cbranch_vccz L_pls_120
  buffer_load_dwordx4 v[24:27], v1, s[4:7], s29 offen offset:2048 sc1
  buffer_load_dwordx4 v[28:31], v1, s[4:7], s29 offen offset:3072 sc1
L_pls_120:
  v_max3_u32 v15, v32, v36, v40
  v_max_u32 v15, v15, v44
  v_cmp_eq_u32 vcc, -1, v15
  s_cbranch_vccz L_pls_121
  s_add_u32 s57, s29, 4096
  buffer_load_dwordx4 v[32:35], v1, s[4:7], s57 offen offset:0 sc1
  buffer_load_dwordx4 v[36:39], v1, s[4:7], s57 offen offset:1024 sc1
  buffer_load_dwordx4 v[40:43], v1, s[4:7], s57 offen offset:2048 sc1
  buffer_load_dwordx4 v[44:47], v1, s[4:7], s57 offen offset:3072 sc1
L_pls_121:
  v_max3_u32 v15, v48, v52, v56
  v_max_u32 v15, v15, v60
  v_cmp_eq_u32 vcc, -1, v15
  s_cbranch_vccz L_pls_122
  s_add_u32 s57, s29, 8192
  buffer_load_dwordx4 v[48:51], v1, s[4:7], s57 offen offset:0 sc1
  buffer_load_dwordx4 v[52:55], v1, s[4:7], s57 offen offset:1024 sc1
  buffer_load_dwordx4 v[56:59], v1, s[4:7], s57 offen offset:2048 sc1
  buffer_load_dwordx4 v[60:63], v1, s[4:7], s57 offen offset:3072 sc1
L_pls_122:
  v_max3_u32 v15, v64, v68, v72
  v_max_u32 v15, v15, v76
  v_cmp_eq_u32 vcc, -1, v15
  s_cbranch_vccz L_pls_123
  s_add_u32 s57, s29, 12288
  buffer_load_dwordx4 v[64:67], v1, s[4:7], s57 offen offset:0 sc1
  buffer_load_dwordx4 v[68:71], v1, s[4:7], s57 offen offset:1024 sc1
  buffer_load_dwordx4 v[72:75], v1, s[4:7], s57 offen offset:2048 sc1
  buffer_load_dwordx4 v[76:79], v1, s[4:7], s57 offen offset:3072 sc1
L_pls_123:
  s_waitcnt vmcnt(0)
  v_max_u32 v15, v16, v20
  v_cmp_eq_u32 vcc, -1, v15
  s_cbranch_vccz L_plb_119
  s_sub_u32 s56, s56, 4
  s_cbranch_scc0 L_pl_118l
  s_mov_b32 s56, 0
  s_branch L_plb_119
L_pl_124:
L_pl_124l:
  buffer_load_dwordx4 v[24:27], v1, s[4:7], s29 offen offset:2048 sc1
  buffer_load_dwordx4 v[28:31], v1, s[4:7], s29 offen offset:3072 sc1
  s_waitcnt vmcnt(2)
  v_max3_u32 v15, v32, v36, v40
  v_max_u32 v15, v15, v44
  v_cmp_eq_u32 vcc, -1, v15
  s_cbranch_vccz L_pls_126
  s_add_u32 s57, s29, 4096
  buffer_load_dwordx4 v[32:35], v1, s[4:7], s57 offen offset:0 sc1
  buffer_load_dwordx4 v[36:39], v1, s[4:7], s57 offen offset:1024 sc1
  buffer_load_dwordx4 v[40:43], v1, s[4:7], s57 offen offset:2048 sc1
  buffer_load_dwordx4 v[44:47], v1, s[4:7], s57 offen offset:3072 sc1
L_pls_126:
  v_max3_u32 v15, v48, v52, v56
  v_max_u32 v15, v15, v60
  v_cmp_eq_u32 vcc, -1, v15
  s_cbranch_vccz L_pls_127
  s_add_u32 s57, s29, 8192
  buffer_load_dwordx4 v[48:51], v1, s[4:7], s57 offen offset:0 sc1
  buffer_load_dwordx4 v[52:55], v1, s[4:7], s57 offen offset:1024 sc1
  buffer_load_dwordx4 v[56:59], v1, s[4:7], s57 offen offset:2048 sc1
  buffer_load_dwordx4 v[60:63], v1, s[4:7], s57 offen offset:3072 sc1
L_pls_127:
  v_max3_u32 v15, v64, v68, v72
  v_max_u32 v15, v15, v76
  v_cmp_eq_u32 vcc, -1, v15
  s_cbranch_vccz L_pls_128
  s_add_u32 s57, s29, 12288
  buffer_load_dwordx4 v[64:67], v1, s[4:7], s57 offen offset:0 sc1
  buffer_load_dwordx4 v[68:71], v1, s[4:7], s57 offen offset:1024 sc1
  buffer_load_dwordx4 v[72:75], v1, s[4:7], s57 offen offset:2048 sc1
  buffer_load_dwordx4 v[76:79], v1, s[4:7], s57 offen offset:3072 sc1
L_pls_128:
  v_cmp_eq_u32 vcc, -1, v80
  s_cbranch_vccz L_pls_129
  s_add_u32 s57, s29, 16384
  buffer_load_dwordx4 v[80:83], v1, s[4:7], s57 offen offset:0 sc1
L_pls_129:
  s_waitcnt vmcnt(0)
  v_max_u32 v15, v24, v28
  v_cmp_eq_u32 vcc, -1, v15
  s_cbranch_vccz L_plb_125
  s_sub_u32 s56, s56, 4
  s_cbranch_scc0 L_pl_124l
  s_mov_b32 s56, 0
  s_branch L_plb_125
L_pl_130:
L_pl_130l:
  s_add_u32 s57, s29, 4096
  buffer_load_dwordx4 v[32:35], v1, s[4:7], s57 offen offset:0 sc1
  buffer_load_dwordx4 v[36:39], v1, s[4:7], s57 offen offset:1024 sc1
  buffer_load_dwordx4 v[40:43], v1, s[4:7], s57 offen offset:2048 sc1
  buffer_load_dwordx4 v[44:47], v1, s[4:7], s57 offen offset:3072 sc1
  s_waitcnt vmcnt(4)
  v_max3_u32 v15, v48, v52, v56
  v_max_u32 v15, v15, v60
  v_cmp_eq_u32 vcc, -1, v15
  s_cbranch_vccz L_pls_132
  s_add_u32 s57, s29, 8192
  buffer_load_dwordx4 v[48:51], v1, s[4:7], s57 offen offset:0 sc1
  buffer_load_dwordx4 v[52:55], v1, s[4:7], s57 offen offset:1024 sc1
  buffer_load_dwordx4 v[56:59], v1, s[4:7], s57 offen offset:2048 sc1
  buffer_load_dwordx4 v[60:63], v1, s[4:7], s57 offen offset:3072 sc1
L_pls_132:
  v_max3_u32 v15, v64, v68, v72
  v_max_u32 v15, v15, v76
  v_cmp_eq_u32 vcc, -1, v15
  s_cbranch_vccz L_pls_133
  s_add_u32 s57, s29, 12288
  buffer_load_dwordx4 v[64:67], v1, s[4:7], s57 offen offset:0 sc1
  buffer_load_dwordx4 v[68:71], v1, s[4:7], s57 offen offset:1024 sc1
  buffer_load_dwordx4 v[72:75], v1, s[4:7], s57 offen offset:2048 sc1
  buffer_load_dwordx4 v[76:79], v1, s[4:7], s57 offen offset:3072 sc1
L_pls_133:
  v_max3_u32 v15, v80, v84, v88
  v_cmp_eq_u32 vcc, -1, v15
  s_cbranch_vccz L_pls_134
  s_add_u32 s57, s29, 16384
  buffer_load_dwordx4 v[80:83], v1, s[4:7], s57 offen offset:0 sc1
  buffer_load_dwordx4 v[84:87], v1, s[4:7], s57 offen offset:1024 sc1
  buffer_load_dwordx4 v[88:91], v1, s[4:7], s57 offen offset:2048 sc1
L_pls_134:
  s_waitcnt vmcnt(0)
  v_max3_u32 v15, v32, v36, v40
  v_max_u32 v15, v15, v44
  v_cmp_eq_u32 vcc, -1, v15
  s_cbranch_vccz L_plb_131
  s_sub_u32 s56, s56, 4
  s_cbranch_scc0 L_pl_130l
  s_mov_b32 s56, 0
  s_branch L_plb_131
L_pl_135:
L_pl_135l:
  s_add_u32 s57, s29, 8192
  buffer_load_dwordx4 v[48:51], v1, s[4:7], s57 offen offset:0 sc1
  buffer_load_dwordx4 v[52:55], v1, s[4:7], s57 offen offset:1024 sc1
  buffer_load_dwordx4 v[56:59], v1, s[4:7], s57 offen offset:2048 sc1
  buffer_load_dwordx4 v[60:63], v1, s[4:7], s57 offen offset:3072 sc1
  s_waitcnt vmcnt(4)
  v_max3_u32 v15, v64, v68, v72
  v_max_u32 v15, v15, v76
  v_cmp_eq_u32 vcc, -1, v15
  s_cbranch_vccz L_pls_137
  s_add_u32 s57, s29, 12288
  buffer_load_dwordx4 v[64:67], v1, s[4:7], s57 offen offset:0 sc1
  buffer_load_dwordx4 v[68:71], v1, s[4:7], s57 offen offset:1024 sc1
  buffer_load_dwordx4 v[72:75], v1, s[4:7], s57 offen offset:2048 sc1
  buffer_load_dwordx4 v[76:79], v1, s[4:7], s57 offen offset:3072 sc1
L_pls_137:
  v_max3_u32 v15, v80, v84, v88
  v_max_u32 v15, v15, v92
  v_cmp_eq_u32 vcc, -1, v15
  s_cbranch_vccz L_pls_138
  s_add_u32 s57, s29, 16384
  buffer_load_dwordx4 v[80:83], v1, s[4:7], s57 offen offset:0 sc1
  buffer_load_dwordx4 v[84:87], v1, s[4:7], s57 offen offset:1024 sc1
  buffer_load_dwordx4 v[88:91], v1, s[4:7], s57 offen offset:2048 sc1
  buffer_load_dwordx4 v[92:95], v1, s[4:7], s57 offen offset:3072 sc1
L_pls_138:
  v_max3_u32 v15, v96, v100, v104
  v_cmp_eq_u32 vcc, -1, v15
  s_cbranch_vccz L_pls_139
  s_add_u32 s57, s29, 20480
  buffer_load_dwordx4 v[96:99], v1, s[4:7], s57 offen offset:0 sc1
  buffer_load_dwordx4 v[100:103], v1, s[4:7], s57 offen offset:1024 sc1
  buffer_load_dwordx4 v[104:107], v1, s[4:7], s57 offen offset:2048 sc1
L_pls_139:
  s_waitcnt vmcnt(0)
  v_max3_u32 v15, v48, v52, v56
  v_max_u32 v15, v15, v60
  v_cmp_eq_u32 vcc, -1, v15
  s_cbranch_vccz L_plb_136
  s_sub_u32 s56, s56, 4
  s_cbranch_scc0 L_pl_135l
  s_mov_b32 s56, 0
  s_branch L_plb_136
L_pl_140:
L_pl_140l:
  s_add_u32 s57, s29, 12288
  buffer_load_dwordx4 v[64:67], v1, s[4:7], s57 offen offset:0 sc1
  buffer_load_dwordx4 v[68:71], v1, s[4:7], s57 offen offset:1024 sc1
  buffer_load_dwordx4 v[72:75], v1, s[4:7], s57 offen offset:2048 sc1
  buffer_load_dwordx4 v[76:79], v1, s[4:7], s57 offen offset:3072 sc1
  s_waitcnt vmcnt(4)
  v_max3_u32 v15, v80, v84, v88
  v_max_u32 v15, v15, v92
  v_cmp_eq_u32 vcc, -1, v15
  s_cbranch_vccz L_pls_142
  s_add_u32 s57, s29, 16384
  buffer_load_dwordx4 v[80:83], v1, s[4:7], s57 offen offset:0 sc1
  buffer_load_dwordx4 v[84:87], v1, s[4:7], s57 offen offset:1024 sc1
  buffer_load_dwordx4 v[88:91], v1, s[4:7], s57 offen offset:2048 sc1
  buffer_load_dwordx4 v[92:95], v1, s[4:7], s57 offen offset:3072 sc1
L_pls_142:
  v_max3_u32 v15, v96, v100, v104
  v_max_u32 v15, v15, v108
  v_cmp_eq_u32 vcc, -1, v15
  s_cbranch_vccz L_pls_143
  s_add_u32 s57, s29, 20480
  buffer_load_dwordx4 v[96:99], v1, s[4:7], s57 offen offset:0 sc1
  buffer_load_dwordx4 v[100:103], v1, s[4:7], s57 offen offset:1024 sc1
  buffer_load_dwordx4 v[104:107], v1, s[4:7], s57 offen offset:2048 sc1
  buffer_load_dwordx4 v[108:111], v1, s[4:7], s57 offen offset:3072 sc1
L_pls_143:
  v_max3_u32 v15, v112, v116, v120
  v_cmp_eq_u32 vcc, -1, v15
  s_cbranch_vccz L_pls_144
  s_add_u32 s57, s29, 24576
  buffer_load_dwordx4 v[112:115], v1, s[4:7], s57 offen offset:0 sc1
  buffer_load_dwordx4 v[116:119], v1, s[4:7], s57 offen offset:1024 sc1
  buffer_load_dwordx4 v[120:123], v1, s[4:7], s57 offen offset:2048 sc1
L_pls_144:
  s_waitcnt vmcnt(0)
  v_max3_u32 v15, v64, v68, v72
  v_max_u32 v15, v15, v76
  v_cmp_eq_u32 vcc, -1, v15
  s_cbranch_vccz L_plb_141
  s_sub_u32 s56, s56, 4
  s_cbranch_scc0 L_pl_140l
  s_mov_b32 s56, 0
  s_branch L_plb_141
L_pl_145:
L_pl_145l:
  s_add_u32 s57, s29, 16384
  buffer_load_dwordx4 v[80:83], v1, s[4:7], s57 offen offset:0 sc1
  buffer_load_dwordx4 v[84:87], v1, s[4:7], s57 offen offset:1024 sc1
  buffer_load_dwordx4 v[88:91], v1, s[4:7], s57 offen offset:2048 sc1
  buffer_load_dwordx4 v[92:95], v1, s[4:7], s57 offen offset:3072 sc1
  s_waitcnt vmcnt(4)
  v_max3_u32 v15, v96, v100, v104
  v_max_u32 v15, v15, v108
  v_cmp_eq_u32 vcc, -1, v15
  s_cbranch_vccz L_pls_147
  s_add_u32 s57, s29, 20480
  buffer_load_dwordx4 v[96:99], v1, s[4:7], s57 offen offset:0 sc1
  buffer_load_dwordx4 v[100:103], v1, s[4:7], s57 offen offset:1024 sc1
  buffer_load_dwordx4 v[104:107], v1, s[4:7], s57 offen offset:2048 sc1
  buffer_load_dwordx4 v[108:111], v1, s[4:7], s57 offen offset:3072 sc1
L_pls_147:
  v_max3_u32 v15, v112, v116, v120
  v_max_u32 v15, v15, v124
  v_cmp_eq_u32 vcc, -1, v15
  s_cbranch_vccz L_pls_148
  s_add_u32 s57, s29, 24576
  buffer_load_dwordx4 v[112:115], v1, s[4:7], s57 offen offset:0 sc1
  buffer_load_dwordx4 v[116:119], v1, s[4:7], s57 offen offset:1024 sc1
  buffer_load_dwordx4 v[120:123], v1, s[4:7], s57 offen offset:2048 sc1
  buffer_load_dwordx4 v[124:127], v1, s[4:7], s57 offen offset:3072 sc1
L_pls_148:
  v_max3_u32 v15, v128, v132, v136
  v_cmp_eq_u32 vcc, -1, v15
  s_cbranch_vccz L_pls_149
  s_add_u32 s57, s29, 28672
  buffer_load_dwordx4 v[128:131], v1, s[4:7], s57 offen offset:0 sc1
  buffer_load_dwordx4 v[132:135], v1, s[4:7], s57 offen offset:1024 sc1
  buffer_load_dwordx4 v[136:139], v1, s[4:7], s57 offen offset:2048 sc1
L_pls_149:
  s_waitcnt vmcnt(0)
  v_max3_u32 v15, v80, v84, v88
  v_max_u32 v15, v15, v92
  v_cmp_eq_u32 vcc, -1, v15
  s_cbranch_vccz L_plb_146
  s_sub_u32 s56, s56, 4
  s_cbranch_scc0 L_pl_145l
  s_mov_b32 s56, 0
  s_branch L_plb_146
L_lsl_150:
  ds_read_b32 v7, v14 offset:1728
  s_waitcnt lgkmcnt(0)
  v_cmp_gt_u32 vcc, v247, v7
  s_cbranch_vccz L_lbk_151
  s_sub_u32 s56, s56, 1
  s_cbranch_scc0 L_lsl_150
  s_mov_b32 s56, 0
  s_branch L_lbk_151
L_pl_152:
L_pl_152l:
  s_add_u32 s57, s29, 20480
  buffer_load_dwordx4 v[96:99], v1, s[4:7], s57 offen offset:0 sc1
  buffer_load_dwordx4 v[100:103], v1, s[4:7], s57 offen offset:1024 sc1
  buffer_load_dwordx4 v[104:107], v1, s[4:7], s57 offen offset:2048 sc1
  buffer_load_dwordx4 v[108:111], v1, s[4:7], s57 offen offset:3072 sc1
  s_waitcnt vmcnt(4)
  v_max3_u32 v15, v112, v116, v120
  v_max_u32 v15, v15, v124
  v_cmp_eq_u32 vcc, -1, v15
  s_cbranch_vccz L_pls_154
  s_add_u32 s57, s29, 24576
  buffer_load_dwordx4 v[112:115], v1, s[4:7], s57 offen offset:0 sc1
  buffer_load_dwordx4 v[116:119], v1, s[4:7], s57 offen offset:1024 sc1
  buffer_load_dwordx4 v[120:123], v1, s[4:7], s57 offen offset:2048 sc1
  buffer_load_dwordx4 v[124:127], v1, s[4:7], s57 offen offset:3072 sc1
L_pls_154:
  v_max3_u32 v15, v128, v132, v136
  v_max_u32 v15, v15, v140
  v_cmp_eq_u32 vcc, -1, v15
  s_cbranch_vccz L_pls_155
  s_add_u32 s57, s29, 28672
  buffer_load_dwordx4 v[128:131], v1, s[4:7], s57 offen offset:0 sc1
  buffer_load_dwordx4 v[132:135], v1, s[4:7], s57 offen offset:1024 sc1
  buffer_load_dwordx4 v[136:139], v1, s[4:7], s57 offen offset:2048 sc1
  buffer_load_dwordx4 v[140:143], v1, s[4:7], s57 offen offset:3072 sc1
L_pls_155:
  v_max_u32 v15, v16, v20
  v_cmp_eq_u32 vcc, -1, v15
  s_cbranch_vccz L_pls_156
  s_add_u32 s57, s29, 32768
  buffer_load_dwordx4 v[16:19], v1, s[4:7], s57 offen offset:0 sc1
  buffer_load_dwordx4 v[20:23], v1, s[4:7], s57 offen offset:1024 sc1
L_pls_156:
  s_waitcnt vmcnt(0)
  v_max3_u32 v15, v96, v100, v104
  v_max_u32 v15, v15, v108
  v_cmp_eq_u32 vcc, -1, v15
  s_cbranch_vccz L_plb_153
  s_sub_u32 s56, s56, 4
  s_cbranch_scc0 L_pl_152l
  s_mov_b32 s56, 0
  s_branch L_plb_153
L_pl_157:
L_pl_157l:
  s_add_u32 s57, s29, 24576
  buffer_load_dwordx4 v[112:115], v1, s[4:7], s57 offen offset:0 sc1
  buffer_load_dwordx4 v[116:119], v1, s[4:7], s57 offen offset:1024 sc1
  buffer_load_dwordx4 v[120:123], v1, s[4:7], s57 offen offset:2048 sc1
  buffer_load_dwordx4 v[124:127], v1, s[4:7], s57 offen offset:3072 sc1
  s_waitcnt vmcnt(4)
  v_max3_u32 v15, v128, v132, v136
  v_max_u32 v15, v15, v140
  v_cmp_eq_u32 vcc, -1, v15
  s_cbranch_vccz L_pls_159
  s_add_u32 s57, s29, 28672
  buffer_load_dwordx4 v[128:131], v1, s[4:7], s57 offen offset:0 sc1
  buffer_load_dwordx4 v[132:135], v1, s[4:7], s57 offen offset:1024 sc1
  buffer_load_dwordx4 v[136:139], v1, s[4:7], s57 offen offset:2048 sc1
  buffer_load_dwordx4 v[140:143], v1, s[4:7], s57 offen offset:3072 sc1
L_pls_159:
  v_max3_u32 v15, v16, v20, v24
  v_cmp_eq_u32 vcc, -1, v15
  s_cbranch_vccz L_pls_160
  s_add_u32 s57, s29, 32768
  buffer_load_dwordx4 v[16:19], v1, s[4:7], s57 offen offset:0 sc1
  buffer_load_dwordx4 v[20:23], v1, s[4:7], s57 offen offset:1024 sc1
  buffer_load_dwordx4 v[24:27], v1, s[4:7], s57 offen offset:2048 sc1
L_pls_160:
  v_max3_u32 v15, v28, v32, v36
  v_cmp_eq_u32 vcc, -1, v15
  s_cbranch_vccz L_pls_161
  s_add_u32 s57, s29, 32768
  buffer_load_dwordx4 v[28:31], v1, s[4:7], s57 offen offset:3072 sc1
  s_add_u32 s57, s29, 36864
  buffer_load_dwordx4 v[32:35], v1, s[4:7], s57 offen offset:0 sc1
  buffer_load_dwordx4 v[36:39], v1, s[4:7], s57 offen offset:1024 sc1
L_pls_161:
  s_waitcnt vmcnt(0)
  v_max3_u32 v15, v112, v116, v120
  v_max_u32 v15, v15, v124
  v_cmp_eq_u32 vcc, -1, v15
  s_cbranch_vccz L_plb_158
  s_sub_u32 s56, s56, 4
  s_cbranch_scc0 L_pl_157l
  s_mov_b32 s56, 0
  s_branch L_plb_158
L_lsl_162:
  ds_read_b32 v7, v14 offset:1792
  s_waitcnt lgkmcnt(0)
  v_cmp_gt_u32 vcc, v247, v7
  s_cbranch_vccz L_lbk_163
  s_sub_u32 s56, s56, 1
  s_cbranch_scc0 L_lsl_162
  s_mov_b32 s56, 0
  s_branch L_lbk_163
L_pl_164:
L_pl_164l:
  s_add_u32 s57, s29, 28672
  buffer_load_dwordx4 v[128:131], v1, s[4:7], s57 offen offset:0 sc1
  buffer_load_dwordx4 v[132:135], v1, s[4:7], s57 offen offset:1024 sc1
  buffer_load_dwordx4 v[136:139], v1, s[4:7], s57 offen offset:2048 sc1
  buffer_load_dwordx4 v[140:143], v1, s[4:7], s57 offen offset:3072 sc1
  s_waitcnt vmcnt(4)
  v_max3_u32 v15, v16, v20, v24
  v_cmp_eq_u32 vcc, -1, v15
  s_cbranch_vccz L_pls_166
  s_add_u32 s57, s29, 32768
  buffer_load_dwordx4 v[16:19], v1, s[4:7], s57 offen offset:0 sc1
  buffer_load_dwordx4 v[20:23], v1, s[4:7], s57 offen offset:1024 sc1
  buffer_load_dwordx4 v[24:27], v1, s[4:7], s57 offen offset:2048 sc1
L_pls_166:
  v_max3_u32 v15, v28, v32, v36
  v_max_u32 v15, v15, v40
  v_cmp_eq_u32 vcc, -1, v15
  s_cbranch_vccz L_pls_167
  s_add_u32 s57, s29, 32768
  buffer_load_dwordx4 v[28:31], v1, s[4:7], s57 offen offset:3072 sc1
  s_add_u32 s57, s29, 36864
  buffer_load_dwordx4 v[32:35], v1, s[4:7], s57 offen offset:0 sc1
  buffer_load_dwordx4 v[36:39], v1, s[4:7], s57 offen offset:1024 sc1
  buffer_load_dwordx4 v[40:43], v1, s[4:7], s57 offen offset:2048 sc1
L_pls_167:
  v_max3_u32 v15, v44, v48, v52
  v_cmp_eq_u32 vcc, -1, v15
  s_cbranch_vccz L_pls_168
  s_add_u32 s57, s29, 36864
  buffer_load_dwordx4 v[44:47], v1, s[4:7], s57 offen offset:3072 sc1
  s_add_u32 s57, s29, 40960
  buffer_load_dwordx4 v[48:51], v1, s[4:7], s57 offen offset:0 sc1
  buffer_load_dwordx4 v[52:55], v1, s[4:7], s57 offen offset:1024 sc1
L_pls_168:
  s_waitcnt vmcnt(0)
  v_max3_u32 v15, v128, v132, v136
  v_max_u32 v15, v15, v140
  v_cmp_eq_u32 vcc, -1, v15
  s_cbranch_vccz L_plb_165
  s_sub_u32 s56, s56, 4
  s_cbranch_scc0 L_pl_164l
  s_mov_b32 s56, 0
  s_branch L_plb_165
L_pl_169:
L_pl_169l:
  s_add_u32 s57, s29, 32768
  buffer_load_dwordx4 v[16:19], v1, s[4:7], s57 offen offset:0 sc1
  buffer_load_dwordx4 v[20:23], v1, s[4:7], s57 offen offset:1024 sc1
  buffer_load_dwordx4 v[24:27], v1, s[4:7], s57 offen offset:2048 sc1
  s_waitcnt vmcnt(3)
  v_max3_u32 v15, v28, v32, v36
  v_max_u32 v15, v15, v40
  v_cmp_eq_u32 vcc, -1, v15
  s_cbranch_vccz L_pls_171
  s_add_u32 s57, s29, 32768
  buffer_load_dwordx4 v[28:31], v1, s[4:7], s57 offen offset:3072 sc1
  s_add_u32 s57, s29, 36864
  buffer_load_dwordx4 v[32:35], v1, s[4:7], s57 offen offset:0 sc1
  buffer_load_dwordx4 v[36:39], v1, s[4:7], s57 offen offset:1024 sc1
  buffer_load_dwordx4 v[40:43], v1, s[4:7], s57 offen offset:2048 sc1
L_pls_171:
  v_max3_u32 v15, v44, v48, v52
  v_max_u32 v15, v15, v56
  v_cmp_eq_u32 vcc, -1, v15
  s_cbranch_vccz L_pls_172
  s_add_u32 s57, s29, 36864
  buffer_load_dwordx4 v[44:47], v1, s[4:7], s57 offen offset:3072 sc1
  s_add_u32 s57, s29, 40960
  buffer_load_dwordx4 v[48:51], v1, s[4:7], s57 offen offset:0 sc1
  buffer_load_dwordx4 v[52:55], v1, s[4:7], s57 offen offset:1024 sc1
  buffer_load_dwordx4 v[56:59], v1, s[4:7], s57 offen offset:2048 sc1
L_pls_172:
  s_waitcnt vmcnt(0)
  v_max3_u32 v15, v16, v20, v24
  v_cmp_eq_u32 vcc, -1, v15
  s_cbranch_vccz L_plb_170
  s_sub_u32 s56, s56, 4
  s_cbranch_scc0 L_pl_169l
  s_mov_b32 s56, 0
  s_branch L_plb_170
L_lsl_173:
  ds_read_b32 v7, v14 offset:1856
  s_waitcnt lgkmcnt(0)
  v_cmp_gt_u32 vcc, v247, v7
  s_cbranch_vccz L_lbk_174
  s_sub_u32 s56, s56, 1
  s_cbranch_scc0 L_lsl_173
  s_mov_b32 s56, 0
  s_branch L_lbk_174
L_pl_175:
L_pl_175l:
  s_add_u32 s57, s29, 32768
  buffer_load_dwordx4 v[28:31], v1, s[4:7], s57 offen offset:3072 sc1
  s_add_u32 s57, s29, 36864
  buffer_load_dwordx4 v[32:35], v1, s[4:7], s57 offen offset:0 sc1
  buffer_load_dwordx4 v[36:39], v1, s[4:7], s57 offen offset:1024 sc1
  buffer_load_dwordx4 v[40:43], v1, s[4:7], s57 offen offset:2048 sc1
  s_waitcnt vmcnt(4)
  v_max3_u32 v15, v44, v48, v52
  v_max_u32 v15, v15, v56
  v_cmp_eq_u32 vcc, -1, v15
  s_cbranch_vccz L_pls_177
  s_add_u32 s57, s29, 36864
  buffer_load_dwordx4 v[44:47], v1, s[4:7], s57 offen offset:3072 sc1
  s_add_u32 s57, s29, 40960
  buffer_load_dwordx4 v[48:51], v1, s[4:7], s57 offen offset:0 sc1
  buffer_load_dwordx4 v[52:55], v1, s[4:7], s57 offen offset:1024 sc1
  buffer_load_dwordx4 v[56:59], v1, s[4:7], s57 offen offset:2048 sc1
L_pls_177:
  s_waitcnt vmcnt(0)
  v_max3_u32 v15, v28, v32, v36
  v_max_u32 v15, v15, v40
  v_cmp_eq_u32 vcc, -1, v15
  s_cbranch_vccz L_plb_176
  s_sub_u32 s56, s56, 4
  s_cbranch_scc0 L_pl_175l
  s_mov_b32 s56, 0
  s_branch L_plb_176
L_pl_178:
L_pl_178l:
  s_add_u32 s57, s29, 36864
  buffer_load_dwordx4 v[44:47], v1, s[4:7], s57 offen offset:3072 sc1
  s_add_u32 s57, s29, 40960
  buffer_load_dwordx4 v[48:51], v1, s[4:7], s57 offen offset:0 sc1
  buffer_load_dwordx4 v[52:55], v1, s[4:7], s57 offen offset:1024 sc1
  buffer_load_dwordx4 v[56:59], v1, s[4:7], s57 offen offset:2048 sc1
  s_waitcnt vmcnt(4)
  s_waitcnt vmcnt(0)
  v_max3_u32 v15, v44, v48, v52
  v_max_u32 v15, v15, v56
  v_cmp_eq_u32 vcc, -1, v15
  s_cbranch_vccz L_plb_179
  s_sub_u32 s56, s56, 4
  s_cbranch_scc0 L_pl_178l
  s_mov_b32 s56, 0
  s_branch L_plb_179
L_lsl_180:
  ds_read_b32 v7, v14 offset:960
  s_waitcnt lgkmcnt(0)
  v_cmp_gt_u32 vcc, v247, v7
  s_cbranch_vccz L_lbk_181
  s_sub_u32 s56, s56, 1
  s_cbranch_scc0 L_lsl_180
  s_mov_b32 s56, 0
  s_branch L_lbk_181
L_lsl_182:
  ds_read_b32 v7, v14 offset:1664
  s_waitcnt lgkmcnt(0)
  v_cmp_gt_u32 vcc, v247, v7
  s_cbranch_vccz L_lbk_183
  s_sub_u32 s56, s56, 1
  s_cbranch_scc0 L_lsl_182
  s_mov_b32 s56, 0
  s_branch L_lbk_183
L_pl_184:
L_pl_184l:
  buffer_load_dwordx4 v[16:19], v1, s[4:7], s29 offen offset:0 sc1
  buffer_load_dwordx4 v[20:23], v1, s[4:7], s29 offen offset:1024 sc1
  s_waitcnt vmcnt(2)
  v_max_u32 v15, v24, v28
  v_cmp_eq_u32 vcc, -1, v15
  s_cbranch_vccz L_pls_186
  buffer_load_dwordx4 v[24:27], v1, s[4:7], s29 offen offset:2048 sc1
  buffer_load_dwordx4 v[28:31], v1, s[4:7], s29 offen offset:3072 sc1
L_pls_186:
  v_max3_u32 v15, v32, v36, v40
  v_max_u32 v15, v15, v44
  v_cmp_eq_u32 vcc, -1, v15
  s_cbranch_vccz L_pls_187
  s_add_u32 s57, s29, 4096
  buffer_load_dwordx4 v[32:35], v1, s[4:7], s57 offen offset:0 sc1
  buffer_load_dwordx4 v[36:39], v1, s[4:7], s57 offen offset:1024 sc1
  buffer_load_dwordx4 v[40:43], v1, s[4:7], s57 offen offset:2048 sc1
  buffer_load_dwordx4 v[44:47], v1, s[4:7], s57 offen offset:3072 sc1
L_pls_187:
  v_max3_u32 v15, v48, v52, v56
  v_max_u32 v15, v15, v60
  v_cmp_eq_u32 vcc, -1, v15
  s_cbranch_vccz L_pls_188
  s_add_u32 s57, s29, 8192
  buffer_load_dwordx4 v[48:51], v1, s[4:7], s57 offen offset:0 sc1
  buffer_load_dwordx4 v[52:55], v1, s[4:7], s57 offen offset:1024 sc1
  buffer_load_dwordx4 v[56:59], v1, s[4:7], s57 offen offset:2048 sc1
  buffer_load_dwordx4 v[60:63], v1, s[4:7], s57 offen offset:3072 sc1
L_pls_188:
  v_max3_u32 v15, v64, v68, v72
  v_max_u32 v15, v15, v76
  v_cmp_eq_u32 vcc, -1, v15
  s_cbranch_vccz L_pls_189
  s_add_u32 s57, s29, 12288
  buffer_load_dwordx4 v[64:67], v1, s[4:7], s57 offen offset:0 sc1
  buffer_load_dwordx4 v[68:71], v1, s[4:7], s57 offen offset:1024 sc1
  buffer_load_dwordx4 v[72:75], v1, s[4:7], s57 offen offset:2048 sc1
  buffer_load_dwordx4 v[76:79], v1, s[4:7], s57 offen offset:3072 sc1
L_pls_189:
  s_waitcnt vmcnt(0)
  v_max_u32 v15, v16, v20
  v_cmp_eq_u32 vcc, -1, v15
  s_cbranch_vccz L_plb_185
  s_sub_u32 s56, s56, 4
  s_cbranch_scc0 L_pl_184l
  s_mov_b32 s56, 0
  s_branch L_plb_185
L_pl_190:
L_pl_190l:
  buffer_load_dwordx4 v[24:27], v1, s[4:7], s29 offen offset:2048 sc1
  buffer_load_dwordx4 v[28:31], v1, s[4:7], s29 offen offset:3072 sc1
  s_waitcnt vmcnt(2)
  v_max3_u32 v15, v32, v36, v40
  v_max_u32 v15, v15, v44
  v_cmp_eq_u32 vcc, -1, v15
  s_cbranch_vccz L_pls_192
  s_add_u32 s57, s29, 4096
  buffer_load_dwordx4 v[32:35], v1, s[4:7], s57 offen offset:0 sc1
  buffer_load_dwordx4 v[36:39], v1, s[4:7], s57 offen offset:1024 sc1
  buffer_load_dwordx4 v[40:43], v1, s[4:7], s57 offen offset:2048 sc1
  buffer_load_dwordx4 v[44:47], v1, s[4:7], s57 offen offset:3072 sc1
L_pls_192:
  v_max3_u32 v15, v48, v52, v56
  v_max_u32 v15, v15, v60
  v_cmp_eq_u32 vcc, -1, v15
  s_cbranch_vccz L_pls_193
  s_add_u32 s57, s29, 8192
  buffer_load_dwordx4 v[48:51], v1, s[4:7], s57 offen offset:0 sc1
  buffer_load_dwordx4 v[52:55], v1, s[4:7], s57 offen offset:1024 sc1
  buffer_load_dwordx4 v[56:59], v1, s[4:7], s57 offen offset:2048 sc1
  buffer_load_dwordx4 v[60:63], v1, s[4:7], s57 offen offset:3072 sc1
L_pls_193:
  v_max3_u32 v15, v64, v68, v72
  v_max_u32 v15, v15, v76
  v_cmp_eq_u32 vcc, -1, v15
  s_cbranch_vccz L_pls_194
  s_add_u32 s57, s29, 12288
  buffer_load_dwordx4 v[64:67], v1, s[4:7], s57 offen offset:0 sc1
  buffer_load_dwordx4 v[68:71], v1, s[4:7], s57 offen offset:1024 sc1
  buffer_load_dwordx4 v[72:75], v1, s[4:7], s57 offen offset:2048 sc1
  buffer_load_dwordx4 v[76:79], v1, s[4:7], s57 offen offset:3072 sc1
L_pls_194:
  v_cmp_eq_u32 vcc, -1, v80
  s_cbranch_vccz L_pls_195
  s_add_u32 s57, s29, 16384
  buffer_load_dwordx4 v[80:83], v1, s[4:7], s57 offen offset:0 sc1
L_pls_195:
  s_waitcnt vmcnt(0)
  v_max_u32 v15, v24, v28
  v_cmp_eq_u32 vcc, -1, v15
  s_cbranch_vccz L_plb_191
  s_sub_u32 s56, s56, 4
  s_cbranch_scc0 L_pl_190l
  s_mov_b32 s56, 0
  s_branch L_plb_191
L_pl_196:
L_pl_196l:
  s_add_u32 s57, s29, 4096
  buffer_load_dwordx4 v[32:35], v1, s[4:7], s57 offen offset:0 sc1
  buffer_load_dwordx4 v[36:39], v1, s[4:7], s57 offen offset:1024 sc1
  buffer_load_dwordx4 v[40:43], v1, s[4:7], s57 offen offset:2048 sc1
  buffer_load_dwordx4 v[44:47], v1, s[4:7], s57 offen offset:3072 sc1
  s_waitcnt vmcnt(4)
  v_max3_u32 v15, v48, v52, v56
  v_max_u32 v15, v15, v60
  v_cmp_eq_u32 vcc, -1, v15
  s_cbranch_vccz L_pls_198
  s_add_u32 s57, s29, 8192
  buffer_load_dwordx4 v[48:51], v1, s[4:7], s57 offen offset:0 sc1
  buffer_load_dwordx4 v[52:55], v1, s[4:7], s57 offen offset:1024 sc1
  buffer_load_dwordx4 v[56:59], v1, s[4:7], s57 offen offset:2048 sc1
  buffer_load_dwordx4 v[60:63], v1, s[4:7], s57 offen offset:3072 sc1
L_pls_198:
  v_max3_u32 v15, v64, v68, v72
  v_max_u32 v15, v15, v76
  v_cmp_eq_u32 vcc, -1, v15
  s_cbranch_vccz L_pls_199
  s_add_u32 s57, s29, 12288
  buffer_load_dwordx4 v[64:67], v1, s[4:7], s57 offen offset:0 sc1
  buffer_load_dwordx4 v[68:71], v1, s[4:7], s57 offen offset:1024 sc1
  buffer_load_dwordx4 v[72:75], v1, s[4:7], s57 offen offset:2048 sc1
  buffer_load_dwordx4 v[76:79], v1, s[4:7], s57 offen offset:3072 sc1
L_pls_199:
  v_max3_u32 v15, v80, v84, v88
  v_cmp_eq_u32 vcc, -1, v15
  s_cbranch_vccz L_pls_200
  s_add_u32 s57, s29, 16384
  buffer_load_dwordx4 v[80:83], v1, s[4:7], s57 offen offset:0 sc1
  buffer_load_dwordx4 v[84:87], v1, s[4:7], s57 offen offset:1024 sc1
  buffer_load_dwordx4 v[88:91], v1, s[4:7], s57 offen offset:2048 sc1
L_pls_200:
  s_waitcnt vmcnt(0)
  v_max3_u32 v15, v32, v36, v40
  v_max_u32 v15, v15, v44
  v_cmp_eq_u32 vcc, -1, v15
  s_cbranch_vccz L_plb_197
  s_sub_u32 s56, s56, 4
  s_cbranch_scc0 L_pl_196l
  s_mov_b32 s56, 0
  s_branch L_plb_197
L_pl_201:
L_pl_201l:
  s_add_u32 s57, s29, 8192
  buffer_load_dwordx4 v[48:51], v1, s[4:7], s57 offen offset:0 sc1
  buffer_load_dwordx4 v[52:55], v1, s[4:7], s57 offen offset:1024 sc1
  buffer_load_dwordx4 v[56:59], v1, s[4:7], s57 offen offset:2048 sc1
  buffer_load_dwordx4 v[60:63], v1, s[4:7], s57 offen offset:3072 sc1
  s_waitcnt vmcnt(4)
  v_max3_u32 v15, v64, v68, v72
  v_max_u32 v15, v15, v76
  v_cmp_eq_u32 vcc, -1, v15
  s_cbranch_vccz L_pls_203
  s_add_u32 s57, s29, 12288
  buffer_load_dwordx4 v[64:67], v1, s[4:7], s57 offen offset:0 sc1
  buffer_load_dwordx4 v[68:71], v1, s[4:7], s57 offen offset:1024 sc1
  buffer_load_dwordx4 v[72:75], v1, s[4:7], s57 offen offset:2048 sc1
  buffer_load_dwordx4 v[76:79], v1, s[4:7], s57 offen offset:3072 sc1
L_pls_203:
  v_max3_u32 v15, v80, v84, v88
  v_max_u32 v15, v15, v92
  v_cmp_eq_u32 vcc, -1, v15
  s_cbranch_vccz L_pls_204
  s_add_u32 s57, s29, 16384
  buffer_load_dwordx4 v[80:83], v1, s[4:7], s57 offen offset:0 sc1
  buffer_load_dwordx4 v[84:87], v1, s[4:7], s57 offen offset:1024 sc1
  buffer_load_dwordx4 v[88:91], v1, s[4:7], s57 offen offset:2048 sc1
  buffer_load_dwordx4 v[92:95], v1, s[4:7], s57 offen offset:3072 sc1
L_pls_204:
  v_max3_u32 v15, v96, v100, v104
  v_cmp_eq_u32 vcc, -1, v15
  s_cbranch_vccz L_pls_205
  s_add_u32 s57, s29, 20480
  buffer_load_dwordx4 v[96:99], v1, s[4:7], s57 offen offset:0 sc1
  buffer_load_dwordx4 v[100:103], v1, s[4:7], s57 offen offset:1024 sc1
  buffer_load_dwordx4 v[104:107], v1, s[4:7], s57 offen offset:2048 sc1
L_pls_205:
  s_waitcnt vmcnt(0)
  v_max3_u32 v15, v48, v52, v56
  v_max_u32 v15, v15, v60
  v_cmp_eq_u32 vcc, -1, v15
  s_cbranch_vccz L_plb_202
  s_sub_u32 s56, s56, 4
  s_cbranch_scc0 L_pl_201l
  s_mov_b32 s56, 0
  s_branch L_plb_202
L_pl_206:
L_pl_206l:
  s_add_u32 s57, s29, 12288
  buffer_load_dwordx4 v[64:67], v1, s[4:7], s57 offen offset:0 sc1
  buffer_load_dwordx4 v[68:71], v1, s[4:7], s57 offen offset:1024 sc1
  buffer_load_dwordx4 v[72:75], v1, s[4:7], s57 offen offset:2048 sc1
  buffer_load_dwordx4 v[76:79], v1, s[4:7], s57 offen offset:3072 sc1
  s_waitcnt vmcnt(4)
  v_max3_u32 v15, v80, v84, v88
  v_max_u32 v15, v15, v92
  v_cmp_eq_u32 vcc, -1, v15
  s_cbranch_vccz L_pls_208
  s_add_u32 s57, s29, 16384
  buffer_load_dwordx4 v[80:83], v1, s[4:7], s57 offen offset:0 sc1
  buffer_load_dwordx4 v[84:87], v1, s[4:7], s57 offen offset:1024 sc1
  buffer_load_dwordx4 v[88:91], v1, s[4:7], s57 offen offset:2048 sc1
  buffer_load_dwordx4 v[92:95], v1, s[4:7], s57 offen offset:3072 sc1
L_pls_208:
  v_max3_u32 v15, v96, v100, v104
  v_max_u32 v15, v15, v108
  v_cmp_eq_u32 vcc, -1, v15
  s_cbranch_vccz L_pls_209
  s_add_u32 s57, s29, 20480
  buffer_load_dwordx4 v[96:99], v1, s[4:7], s57 offen offset:0 sc1
  buffer_load_dwordx4 v[100:103], v1, s[4:7], s57 offen offset:1024 sc1
  buffer_load_dwordx4 v[104:107], v1, s[4:7], s57 offen offset:2048 sc1
  buffer_load_dwordx4 v[108:111], v1, s[4:7], s57 offen offset:3072 sc1
L_pls_209:
  v_max3_u32 v15, v112, v116, v120
  v_cmp_eq_u32 vcc, -1, v15
  s_cbranch_vccz L_pls_210
  s_add_u32 s57, s29, 24576
  buffer_load_dwordx4 v[112:115], v1, s[4:7], s57 offen offset:0 sc1
  buffer_load_dwordx4 v[116:119], v1, s[4:7], s57 offen offset:1024 sc1
  buffer_load_dwordx4 v[120:123], v1, s[4:7], s57 offen offset:2048 sc1
L_pls_210:
  s_waitcnt vmcnt(0)
  v_max3_u32 v15, v64, v68, v72
  v_max_u32 v15, v15, v76
  v_cmp_eq_u32 vcc, -1, v15
  s_cbranch_vccz L_plb_207
  s_sub_u32 s56, s56, 4
  s_cbranch_scc0 L_pl_206l
  s_mov_b32 s56, 0
  s_branch L_plb_207
L_pl_211:
L_pl_211l:
  s_add_u32 s57, s29, 16384
  buffer_load_dwordx4 v[80:83], v1, s[4:7], s57 offen offset:0 sc1
  buffer_load_dwordx4 v[84:87], v1, s[4:7], s57 offen offset:1024 sc1
  buffer_load_dwordx4 v[88:91], v1, s[4:7], s57 offen offset:2048 sc1
  buffer_load_dwordx4 v[92:95], v1, s[4:7], s57 offen offset:3072 sc1
  s_waitcnt vmcnt(4)
  v_max3_u32 v15, v96, v100, v104
  v_max_u32 v15, v15, v108
  v_cmp_eq_u32 vcc, -1, v15
  s_cbranch_vccz L_pls_213
  s_add_u32 s57, s29, 20480
  buffer_load_dwordx4 v[96:99], v1, s[4:7], s57 offen offset:0 sc1
  buffer_load_dwordx4 v[100:103], v1, s[4:7], s57 offen offset:1024 sc1
  buffer_load_dwordx4 v[104:107], v1, s[4:7], s57 offen offset:2048 sc1
  buffer_load_dwordx4 v[108:111], v1, s[4:7], s57 offen offset:3072 sc1
L_pls_213:
  v_max3_u32 v15, v112, v116, v120
  v_max_u32 v15, v15, v124
  v_cmp_eq_u32 vcc, -1, v15
  s_cbranch_vccz L_pls_214
  s_add_u32 s57, s29, 24576
  buffer_load_dwordx4 v[112:115], v1, s[4:7], s57 offen offset:0 sc1
  buffer_load_dwordx4 v[116:119], v1, s[4:7], s57 offen offset:1024 sc1
  buffer_load_dwordx4 v[120:123], v1, s[4:7], s57 offen offset:2048 sc1
  buffer_load_dwordx4 v[124:127], v1, s[4:7], s57 offen offset:3072 sc1
L_pls_214:
  v_max3_u32 v15, v128, v132, v136
  v_cmp_eq_u32 vcc, -1, v15
  s_cbranch_vccz L_pls_215
  s_add_u32 s57, s29, 28672
  buffer_load_dwordx4 v[128:131], v1, s[4:7], s57 offen offset:0 sc1
  buffer_load_dwordx4 v[132:135], v1, s[4:7], s57 offen offset:1024 sc1
  buffer_load_dwordx4 v[136:139], v1, s[4:7], s57 offen offset:2048 sc1
L_pls_215:
  s_waitcnt vmcnt(0)
  v_max3_u32 v15, v80, v84, v88
  v_max_u32 v15, v15, v92
  v_cmp_eq_u32 vcc, -1, v15
  s_cbranch_vccz L_plb_212
  s_sub_u32 s56, s56, 4
  s_cbranch_scc0 L_pl_211l
  s_mov_b32 s56, 0
  s_branch L_plb_212
L_lsl_216:
  ds_read_b32 v7, v14 offset:1728
  s_waitcnt lgkmcnt(0)
  v_cmp_gt_u32 vcc, v247, v7
  s_cbranch_vccz L_lbk_217
  s_sub_u32 s56, s56, 1
  s_cbranch_scc0 L_lsl_216
  s_mov_b32 s56, 0
  s_branch L_lbk_217
L_pl_218:
L_pl_218l:
  s_add_u32 s57, s29, 20480
  buffer_load_dwordx4 v[96:99], v1, s[4:7], s57 offen offset:0 sc1
  buffer_load_dwordx4 v[100:103], v1, s[4:7], s57 offen offset:1024 sc1
  buffer_load_dwordx4 v[104:107], v1, s[4:7], s57 offen offset:2048 sc1
  buffer_load_dwordx4 v[108:111], v1, s[4:7], s57 offen offset:3072 sc1
  s_waitcnt vmcnt(4)
  v_max3_u32 v15, v112, v116, v120
  v_max_u32 v15, v15, v124
  v_cmp_eq_u32 vcc, -1, v15
  s_cbranch_vccz L_pls_220
  s_add_u32 s57, s29, 24576
  buffer_load_dwordx4 v[112:115], v1, s[4:7], s57 offen offset:0 sc1
  buffer_load_dwordx4 v[116:119], v1, s[4:7], s57 offen offset:1024 sc1
  buffer_load_dwordx4 v[120:123], v1, s[4:7], s57 offen offset:2048 sc1
  buffer_load_dwordx4 v[124:127], v1, s[4:7], s57 offen offset:3072 sc1
L_pls_220:
  v_max3_u32 v15, v128, v132, v136
  v_max_u32 v15, v15, v140
  v_cmp_eq_u32 vcc, -1, v15
  s_cbranch_vccz L_pls_221
  s_add_u32 s57, s29, 28672
  buffer_load_dwordx4 v[128:131], v1, s[4:7], s57 offen offset:0 sc1
  buffer_load_dwordx4 v[132:135], v1, s[4:7], s57 offen offset:1024 sc1
  buffer_load_dwordx4 v[136:139], v1, s[4:7], s57 offen offset:2048 sc1
  buffer_load_dwordx4 v[140:143], v1, s[4:7], s57 offen offset:3072 sc1
L_pls_221:
  s_waitcnt vmcnt(0)
  v_max3_u32 v15, v96, v100, v104
  v_max_u32 v15, v15, v108
  v_cmp_eq_u32 vcc, -1, v15
  s_cbranch_vccz L_plb_219
  s_sub_u32 s56, s56, 4
  s_cbranch_scc0 L_pl_218l
  s_mov_b32 s56, 0
  s_branch L_plb_219
L_pl_222:
L_pl_222l:
  s_add_u32 s57, s29, 24576
  buffer_load_dwordx4 v[112:115], v1, s[4:7], s57 offen offset:0 sc1
  buffer_load_dwordx4 v[116:119], v1, s[4:7], s57 offen offset:1024 sc1
  buffer_load_dwordx4 v[120:123], v1, s[4:7], s57 offen offset:2048 sc1
  buffer_load_dwordx4 v[124:127], v1, s[4:7], s57 offen offset:3072 sc1
  s_waitcnt vmcnt(4)
  v_max3_u32 v15, v128, v132, v136
  v_max_u32 v15, v15, v140
  v_cmp_eq_u32 vcc, -1, v15
  s_cbranch_vccz L_pls_224
  s_add_u32 s57, s29, 28672
  buffer_load_dwordx4 v[128:131], v1, s[4:7], s57 offen offset:0 sc1
  buffer_load_dwordx4 v[132:135], v1, s[4:7], s57 offen offset:1024 sc1
  buffer_load_dwordx4 v[136:139], v1, s[4:7], s57 offen offset:2048 sc1
  buffer_load_dwordx4 v[140:143], v1, s[4:7], s57 offen offset:3072 sc1
L_pls_224:
  v_max_u32 v15, v16, v20
  v_cmp_eq_u32 vcc, -1, v15
  s_cbranch_vccz L_pls_225
  s_add_u32 s57, s29, 32768
  buffer_load_dwordx4 v[16:19], v1, s[4:7], s57 offen offset:0 sc1
  buffer_load_dwordx4 v[20:23], v1, s[4:7], s57 offen offset:1024 sc1
L_pls_225:
  s_waitcnt vmcnt(0)
  v_max3_u32 v15, v112, v116, v120
  v_max_u32 v15, v15, v124
  v_cmp_eq_u32 vcc, -1, v15
  s_cbranch_vccz L_plb_223
  s_sub_u32 s56, s56, 4
  s_cbranch_scc0 L_pl_222l
  s_mov_b32 s56, 0
  s_branch L_plb_223
L_lsl_226:
  ds_read_b32 v7, v14 offset:1792
  s_waitcnt lgkmcnt(0)
  v_cmp_gt_u32 vcc, v247, v7
  s_cbranch_vccz L_lbk_227
  s_sub_u32 s56, s56, 1
  s_cbranch_scc0 L_lsl_226
  s_mov_b32 s56, 0
  s_branch L_lbk_227
L_pl_228:
L_pl_228l:
  s_add_u32 s57, s29, 28672
  buffer_load_dwordx4 v[128:131], v1, s[4:7], s57 offen offset:0 sc1
  buffer_load_dwordx4 v[132:135], v1, s[4:7], s57 offen offset:1024 sc1
  buffer_load_dwordx4 v[136:139], v1, s[4:7], s57 offen offset:2048 sc1
  buffer_load_dwordx4 v[140:143], v1, s[4:7], s57 offen offset:3072 sc1
  s_waitcnt vmcnt(4)
  v_max3_u32 v15, v16, v20, v24
  v_cmp_eq_u32 vcc, -1, v15
  s_cbranch_vccz L_pls_230
  s_add_u32 s57, s29, 32768
  buffer_load_dwordx4 v[16:19], v1, s[4:7], s57 offen offset:0 sc1
  buffer_load_dwordx4 v[20:23], v1, s[4:7], s57 offen offset:1024 sc1
  buffer_load_dwordx4 v[24:27], v1, s[4:7], s57 offen offset:2048 sc1
L_pls_230:
  v_max3_u32 v15, v28, v32, v36
  v_cmp_eq_u32 vcc, -1, v15
  s_cbranch_vccz L_pls_231
  s_add_u32 s57, s29, 32768
  buffer_load_dwordx4 v[28:31], v1, s[4:7], s57 offen offset:3072 sc1
  s_add_u32 s57, s29, 36864
  buffer_load_dwordx4 v[32:35], v1, s[4:7], s57 offen offset:0 sc1
  buffer_load_dwordx4 v[36:39], v1, s[4:7], s57 offen offset:1024 sc1
L_pls_231:
  s_waitcnt vmcnt(0)
  v_max3_u32 v15, v128, v132, v136
  v_max_u32 v15, v15, v140
  v_cmp_eq_u32 vcc, -1, v15
  s_cbranch_vccz L_plb_229
  s_sub_u32 s56, s56, 4
  s_cbranch_scc0 L_pl_228l
  s_mov_b32 s56, 0
  s_branch L_plb_229
L_pl_232:
L_pl_232l:
  s_add_u32 s57, s29, 32768
  buffer_load_dwordx4 v[16:19], v1, s[4:7], s57 offen offset:0 sc1
  buffer_load_dwordx4 v[20:23], v1, s[4:7], s57 offen offset:1024 sc1
  buffer_load_dwordx4 v[24:27], v1, s[4:7], s57 offen offset:2048 sc1
  s_waitcnt vmcnt(3)
  v_max3_u32 v15, v28, v32, v36
  v_max_u32 v15, v15, v40
  v_cmp_eq_u32 vcc, -1, v15
  s_cbranch_vccz L_pls_234
  s_add_u32 s57, s29, 32768
  buffer_load_dwordx4 v[28:31], v1, s[4:7], s57 offen offset:3072 sc1
  s_add_u32 s57, s29, 36864
  buffer_load_dwordx4 v[32:35], v1, s[4:7], s57 offen offset:0 sc1
  buffer_load_dwordx4 v[36:39], v1, s[4:7], s57 offen offset:1024 sc1
  buffer_load_dwordx4 v[40:43], v1, s[4:7], s57 offen offset:2048 sc1
L_pls_234:
  v_max3_u32 v15, v44, v48, v52
  v_cmp_eq_u32 vcc, -1, v15
  s_cbranch_vccz L_pls_235
  s_add_u32 s57, s29, 36864
  buffer_load_dwordx4 v[44:47], v1, s[4:7], s57 offen offset:3072 sc1
  s_add_u32 s57, s29, 40960
  buffer_load_dwordx4 v[48:51], v1, s[4:7], s57 offen offset:0 sc1
  buffer_load_dwordx4 v[52:55], v1, s[4:7], s57 offen offset:1024 sc1
L_pls_235:
  s_waitcnt vmcnt(0)
  v_max3_u32 v15, v16, v20, v24
  v_cmp_eq_u32 vcc, -1, v15
  s_cbranch_vccz L_plb_233
  s_sub_u32 s56, s56, 4
  s_cbranch_scc0 L_pl_232l
  s_mov_b32 s56, 0
  s_branch L_plb_233
L_lsl_236:
  ds_read_b32 v7, v14 offset:1856
  s_waitcnt lgkmcnt(0)
  v_cmp_gt_u32 vcc, v247, v7
  s_cbranch_vccz L_lbk_237
  s_sub_u32 s56, s56, 1
  s_cbranch_scc0 L_lsl_236
  s_mov_b32 s56, 0
  s_branch L_lbk_237
L_pl_238:
L_pl_238l:
  s_add_u32 s57, s29, 32768
  buffer_load_dwordx4 v[28:31], v1, s[4:7], s57 offen offset:3072 sc1
  s_add_u32 s57, s29, 36864
  buffer_load_dwordx4 v[32:35], v1, s[4:7], s57 offen offset:0 sc1
  buffer_load_dwordx4 v[36:39], v1, s[4:7], s57 offen offset:1024 sc1
  buffer_load_dwordx4 v[40:43], v1, s[4:7], s57 offen offset:2048 sc1
  s_waitcnt vmcnt(4)
  v_max3_u32 v15, v44, v48, v52
  v_max_u32 v15, v15, v56
  v_cmp_eq_u32 vcc, -1, v15
  s_cbranch_vccz L_pls_240
  s_add_u32 s57, s29, 36864
  buffer_load_dwordx4 v[44:47], v1, s[4:7], s57 offen offset:3072 sc1
  s_add_u32 s57, s29, 40960
  buffer_load_dwordx4 v[48:51], v1, s[4:7], s57 offen offset:0 sc1
  buffer_load_dwordx4 v[52:55], v1, s[4:7], s57 offen offset:1024 sc1
  buffer_load_dwordx4 v[56:59], v1, s[4:7], s57 offen offset:2048 sc1
L_pls_240:
  s_waitcnt vmcnt(0)
  v_max3_u32 v15, v28, v32, v36
  v_max_u32 v15, v15, v40
  v_cmp_eq_u32 vcc, -1, v15
  s_cbranch_vccz L_plb_239
  s_sub_u32 s56, s56, 4
  s_cbranch_scc0 L_pl_238l
  s_mov_b32 s56, 0
  s_branch L_plb_239
L_pl_241:
L_pl_241l:
  s_add_u32 s57, s29, 36864
  buffer_load_dwordx4 v[44:47], v1, s[4:7], s57 offen offset:3072 sc1
  s_add_u32 s57, s29, 40960
  buffer_load_dwordx4 v[48:51], v1, s[4:7], s57 offen offset:0 sc1
  buffer_load_dwordx4 v[52:55], v1, s[4:7], s57 offen offset:1024 sc1
  buffer_load_dwordx4 v[56:59], v1, s[4:7], s57 offen offset:2048 sc1
  s_waitcnt vmcnt(4)
  s_waitcnt vmcnt(0)
  v_max3_u32 v15, v44, v48, v52
  v_max_u32 v15, v15, v56
  v_cmp_eq_u32 vcc, -1, v15
  s_cbranch_vccz L_plb_242
  s_sub_u32 s56, s56, 4
  s_cbranch_scc0 L_pl_241l
  s_mov_b32 s56, 0
  s_branch L_plb_242
L_lsl_243:
  ds_read_b32 v7, v14 offset:960
  s_waitcnt lgkmcnt(0)
  v_cmp_gt_u32 vcc, v247, v7
  s_cbranch_vccz L_lbk_244
  s_sub_u32 s56, s56, 1
  s_cbranch_scc0 L_lsl_243
  s_mov_b32 s56, 0
  s_branch L_lbk_244
L_lsl_245:
  ds_read_b32 v7, v14 offset:1024
  ds_read_b128 v[144:147], v13 offset:0
  ds_read_b128 v[148:151], v13 offset:1024
  ds_read_b128 v[152:155], v13 offset:2048
  ds_read_b128 v[156:159], v13 offset:3072
  s_waitcnt lgkmcnt(0)
  v_cmp_gt_u32 vcc, v247, v7
  s_nop 0
  s_and_b64 vcc, vcc, s[36:37]
  s_cbranch_scc0 L_lbk_246
  s_sub_u32 s56, s56, 1
  s_cbranch_scc0 L_lsl_245
  s_mov_b32 s56, 0
  s_branch L_lbk_246
L_lsl_247:
  ds_read_b32 v7, v14 offset:2176
  s_waitcnt lgkmcnt(0)
  v_cmp_gt_u32 vcc, v247, v7
  s_cbranch_vccz L_lbk_248
  s_sub_u32 s56, s56, 1
  s_cbranch_scc0 L_lsl_247
  s_mov_b32 s56, 0
  s_branch L_lbk_248
L_pl_249:
L_pl_249l:
  buffer_load_dwordx4 v[16:19], v1, s[4:7], s38 offen offset:0 sc1
  buffer_load_dwordx4 v[20:23], v1, s[4:7], s38 offen offset:1024 sc1
  s_waitcnt vmcnt(2)
  v_max_u32 v15, v24, v28
  v_cmp_eq_u32 vcc, -1, v15
  s_cbranch_vccz L_pls_251
  buffer_load_dwordx4 v[24:27], v1, s[4:7], s38 offen offset:2048 sc1
  buffer_load_dwordx4 v[28:31], v1, s[4:7], s38 offen offset:3072 sc1
L_pls_251:
  v_max3_u32 v15, v32, v36, v40
  v_max_u32 v15, v15, v44
  v_cmp_eq_u32 vcc, -1, v15
  s_cbranch_vccz L_pls_252
  s_xor_b32 s57, s38, 4096
  buffer_load_dwordx4 v[32:35], v1, s[4:7], s57 offen offset:0 sc1
  buffer_load_dwordx4 v[36:39], v1, s[4:7], s57 offen offset:1024 sc1
  buffer_load_dwordx4 v[40:43], v1, s[4:7], s57 offen offset:2048 sc1
  buffer_load_dwordx4 v[44:47], v1, s[4:7], s57 offen offset:3072 sc1
L_pls_252:
  v_max_u32 v15, v48, v52
  v_cmp_eq_u32 vcc, -1, v15
  s_cbranch_vccz L_pls_253
  s_xor_b32 s57, s38, 8192
  buffer_load_dwordx4 v[48:51], v1, s[4:7], s57 offen offset:0 sc1
  buffer_load_dwordx4 v[52:55], v1, s[4:7], s57 offen offset:1024 sc1
L_pls_253:
  s_waitcnt vmcnt(0)
  v_max_u32 v15, v16, v20
  v_cmp_eq_u32 vcc, -1, v15
  s_cbranch_vccz L_plb_250
  s_sub_u32 s56, s56, 4
  s_cbranch_scc0 L_pl_249l
  s_mov_b32 s56, 0
  s_branch L_plb_250
L_pl_254:
L_pl_254l:
  buffer_load_dwordx4 v[24:27], v1, s[4:7], s38 offen offset:2048 sc1
  buffer_load_dwordx4 v[28:31], v1, s[4:7], s38 offen offset:3072 sc1
  s_waitcnt vmcnt(2)
  v_max3_u32 v15, v32, v36, v40
  v_max_u32 v15, v15, v44
  v_cmp_eq_u32 vcc, -1, v15
  s_cbranch_vccz L_pls_256
  s_xor_b32 s57, s38, 4096
  buffer_load_dwordx4 v[32:35], v1, s[4:7], s57 offen offset:0 sc1
  buffer_load_dwordx4 v[36:39], v1, s[4:7], s57 offen offset:1024 sc1
  buffer_load_dwordx4 v[40:43], v1, s[4:7], s57 offen offset:2048 sc1
  buffer_load_dwordx4 v[44:47], v1, s[4:7], s57 offen offset:3072 sc1
L_pls_256:
  v_max3_u32 v15, v48, v52, v56
  v_max_u32 v15, v15, v60
  v_cmp_eq_u32 vcc, -1, v15
  s_cbranch_vccz L_pls_257
  s_xor_b32 s57, s38, 8192
  buffer_load_dwordx4 v[48:51], v1, s[4:7], s57 offen offset:0 sc1
  buffer_load_dwordx4 v[52:55], v1, s[4:7], s57 offen offset:1024 sc1
  buffer_load_dwordx4 v[56:59], v1, s[4:7], s57 offen offset:2048 sc1
  buffer_load_dwordx4 v[60:63], v1, s[4:7], s57 offen offset:3072 sc1
L_pls_257:
  v_max_u32 v15, v64, v68
  v_cmp_eq_u32 vcc, -1, v15
  s_cbranch_vccz L_pls_258
  s_xor_b32 s57, s38, 12288
  buffer_load_dwordx4 v[64:67], v1, s[4:7], s57 offen offset:0 sc1
  buffer_load_dwordx4 v[68:71], v1, s[4:7], s57 offen offset:1024 sc1
L_pls_258:
  s_waitcnt vmcnt(0)
  v_max_u32 v15, v24, v28
  v_cmp_eq_u32 vcc, -1, v15
  s_cbranch_vccz L_plb_255
  s_sub_u32 s56, s56, 4
  s_cbranch_scc0 L_pl_254l
  s_mov_b32 s56, 0
  s_branch L_plb_255
L_pl_259:
L_pl_259l:
  s_xor_b32 s57, s38, 4096
  buffer_load_dwordx4 v[32:35], v1, s[4:7], s57 offen offset:0 sc1
  buffer_load_dwordx4 v[36:39], v1, s[4:7], s57 offen offset:1024 sc1
  buffer_load_dwordx4 v[40:43], v1, s[4:7], s57 offen offset:2048 sc1
  buffer_load_dwordx4 v[44:47], v1, s[4:7], s57 offen offset:3072 sc1
  s_waitcnt vmcnt(4)
  v_max3_u32 v15, v48, v52, v56
  v_max_u32 v15, v15, v60
  v_cmp_eq_u32 vcc, -1, v15
  s_cbranch_vccz L_pls_261
  s_xor_b32 s57, s38, 8192
  buffer_load_dwordx4 v[48:51], v1, s[4:7], s57 offen offset:0 sc1
  buffer_load_dwordx4 v[52:55], v1, s[4:7], s57 offen offset:1024 sc1
  buffer_load_dwordx4 v[56:59], v1, s[4:7], s57 offen offset:2048 sc1
  buffer_load_dwordx4 v[60:63], v1, s[4:7], s57 offen offset:3072 sc1
L_pls_261:
  v_max3_u32 v15, v64, v68, v72
  v_max_u32 v15, v15, v76
  v_cmp_eq_u32 vcc, -1, v15
  s_cbranch_vccz L_pls_262
  s_xor_b32 s57, s38, 12288
  buffer_load_dwordx4 v[64:67], v1, s[4:7], s57 offen offset:0 sc1
  buffer_load_dwordx4 v[68:71], v1, s[4:7], s57 offen offset:1024 sc1
  buffer_load_dwordx4 v[72:75], v1, s[4:7], s57 offen offset:2048 sc1
  buffer_load_dwordx4 v[76:79], v1, s[4:7], s57 offen offset:3072 sc1
L_pls_262:
  s_waitcnt vmcnt(0)
  v_max3_u32 v15, v32, v36, v40
  v_max_u32 v15, v15, v44
  v_cmp_eq_u32 vcc, -1, v15
  s_cbranch_vccz L_plb_260
  s_sub_u32 s56, s56, 4
  s_cbranch_scc0 L_pl_259l
  s_mov_b32 s56, 0
  s_branch L_plb_260
L_lsl_263:
  ds_read_b32 v7, v14 offset:2240
  s_waitcnt lgkmcnt(0)
  v_cmp_gt_u32 vcc, v247, v7
  s_cbranch_vccz L_lbk_264
  s_sub_u32 s56, s56, 1
  s_cbranch_scc0 L_lsl_263
  s_mov_b32 s56, 0
  s_branch L_lbk_264
L_pl_265:
L_pl_265l:
  s_xor_b32 s57, s38, 8192
  buffer_load_dwordx4 v[48:51], v1, s[4:7], s57 offen offset:0 sc1
  buffer_load_dwordx4 v[52:55], v1, s[4:7], s57 offen offset:1024 sc1
  buffer_load_dwordx4 v[56:59], v1, s[4:7], s57 offen offset:2048 sc1
  buffer_load_dwordx4 v[60:63], v1, s[4:7], s57 offen offset:3072 sc1
  s_waitcnt vmcnt(4)
  v_max3_u32 v15, v64, v68, v72
  v_max_u32 v15, v15, v76
  v_cmp_eq_u32 vcc, -1, v15
  s_cbranch_vccz L_pls_267
  s_xor_b32 s57, s38, 12288
  buffer_load_dwordx4 v[64:67], v1, s[4:7], s57 offen offset:0 sc1
  buffer_load_dwordx4 v[68:71], v1, s[4:7], s57 offen offset:1024 sc1
  buffer_load_dwordx4 v[72:75], v1, s[4:7], s57 offen offset:2048 sc1
  buffer_load_dwordx4 v[76:79], v1, s[4:7], s57 offen offset:3072 sc1
L_pls_267:
  v_max3_u32 v15, v80, v84, v88
  v_max_u32 v15, v15, v92
  v_cmp_eq_u32 vcc, -1, v15
  s_cbranch_vccz L_pls_268
  s_xor_b32 s57, s38, 16384
  buffer_load_dwordx4 v[80:83], v1, s[4:7], s57 offen offset:0 sc1
  buffer_load_dwordx4 v[84:87], v1, s[4:7], s57 offen offset:1024 sc1
  buffer_load_dwordx4 v[88:91], v1, s[4:7], s57 offen offset:2048 sc1
  buffer_load_dwordx4 v[92:95], v1, s[4:7], s57 offen offset:3072 sc1
L_pls_268:
  v_max3_u32 v15, v192, v194, v196
  v_max_u32 v15, v15, v198
  v_cmp_eq_u32 vcc, -1, v15
  s_cbranch_vccz L_pls_269
  buffer_load_dwordx2 v[192:193], v4, s[4:7], s39 offen offset:0 sc1
  buffer_load_dwordx2 v[194:195], v4, s[4:7], s39 offen offset:512 sc1
  buffer_load_dwordx2 v[196:197], v4, s[4:7], s39 offen offset:1024 sc1
  buffer_load_dwordx2 v[198:199], v4, s[4:7], s39 offen offset:1536 sc1
L_pls_269:
  s_waitcnt vmcnt(0)
  v_max3_u32 v15, v48, v52, v56
  v_max_u32 v15, v15, v60
  v_cmp_eq_u32 vcc, -1, v15
  s_cbranch_vccz L_plb_266
  s_sub_u32 s56, s56, 4
  s_cbranch_scc0 L_pl_265l
  s_mov_b32 s56, 0
  s_branch L_plb_266
L_pl_270:
L_pl_270l:
  s_xor_b32 s57, s38, 12288
  buffer_load_dwordx4 v[64:67], v1, s[4:7], s57 offen offset:0 sc1
  buffer_load_dwordx4 v[68:71], v1, s[4:7], s57 offen offset:1024 sc1
  buffer_load_dwordx4 v[72:75], v1, s[4:7], s57 offen offset:2048 sc1
  buffer_load_dwordx4 v[76:79], v1, s[4:7], s57 offen offset:3072 sc1
  s_waitcnt vmcnt(4)
  v_max3_u32 v15, v80, v84, v88
  v_max_u32 v15, v15, v92
  v_cmp_eq_u32 vcc, -1, v15
  s_cbranch_vccz L_pls_272
  s_xor_b32 s57, s38, 16384
  buffer_load_dwordx4 v[80:83], v1, s[4:7], s57 offen offset:0 sc1
  buffer_load_dwordx4 v[84:87], v1, s[4:7], s57 offen offset:1024 sc1
  buffer_load_dwordx4 v[88:91], v1, s[4:7], s57 offen offset:2048 sc1
  buffer_load_dwordx4 v[92:95], v1, s[4:7], s57 offen offset:3072 sc1
L_pls_272:
  v_max3_u32 v15, v96, v100, v104
  v_max_u32 v15, v15, v108
  v_cmp_eq_u32 vcc, -1, v15
  s_cbranch_vccz L_pls_273
  s_xor_b32 s57, s38, 20480
  buffer_load_dwordx4 v[96:99], v1, s[4:7], s57 offen offset:0 sc1
  buffer_load_dwordx4 v[100:103], v1, s[4:7], s57 offen offset:1024 sc1
  buffer_load_dwordx4 v[104:107], v1, s[4:7], s57 offen offset:2048 sc1
  buffer_load_dwordx4 v[108:111], v1, s[4:7], s57 offen offset:3072 sc1
L_pls_273:
  v_max3_u32 v15, v192, v194, v196
  v_max3_u32 v15, v15, v198, v200
  v_max3_u32 v15, v15, v202, v204
  v_max_u32 v15, v15, v206
  v_cmp_eq_u32 vcc, -1, v15
  s_cbranch_vccz L_pls_274
  buffer_load_dwordx2 v[192:193], v4, s[4:7], s39 offen offset:0 sc1
  buffer_load_dwordx2 v[194:195], v4, s[4:7], s39 offen offset:512 sc1
  buffer_load_dwordx2 v[196:197], v4, s[4:7], s39 offen offset:1024 sc1
  buffer_load_dwordx2 v[198:199], v4, s[4:7], s39 offen offset:1536 sc1
  buffer_load_dwordx2 v[200:201], v4, s[4:7], s39 offen offset:2048 sc1
  buffer_load_dwordx2 v[202:203], v4, s[4:7], s39 offen offset:2560 sc1
  buffer_load_dwordx2 v[204:205], v4, s[4:7], s39 offen offset:3072 sc1
  buffer_load_dwordx2 v[206:207], v4, s[4:7], s39 offen offset:3584 sc1
L_pls_274:
  s_waitcnt vmcnt(0)
  v_max3_u32 v15, v64, v68, v72
  v_max_u32 v15, v15, v76
  v_cmp_eq_u32 vcc, -1, v15
  s_cbranch_vccz L_plb_271
  s_sub_u32 s56, s56, 4
  s_cbranch_scc0 L_pl_270l
  s_mov_b32 s56, 0
  s_branch L_plb_271
L_lsl_275:
  ds_read_b32 v7, v14 offset:1216
  s_waitcnt lgkmcnt(0)
  v_cmp_gt_u32 vcc, v247, v7
  s_cbranch_vccz L_lbk_276
  s_sub_u32 s56, s56, 1
  s_cbranch_scc0 L_lsl_275
  s_mov_b32 s56, 0
  s_branch L_lbk_276
L_pl_277:
L_pl_277l:
  s_xor_b32 s57, s38, 16384
  buffer_load_dwordx4 v[80:83], v1, s[4:7], s57 offen offset:0 sc1
  buffer_load_dwordx4 v[84:87], v1, s[4:7], s57 offen offset:1024 sc1
  buffer_load_dwordx4 v[88:91], v1, s[4:7], s57 offen offset:2048 sc1
  buffer_load_dwordx4 v[92:95], v1, s[4:7], s57 offen offset:3072 sc1
  s_waitcnt vmcnt(4)
  v_max3_u32 v15, v96, v100, v104
  v_max_u32 v15, v15, v108
  v_cmp_eq_u32 vcc, -1, v15
  s_cbranch_vccz L_pls_279
  s_xor_b32 s57, s38, 20480
  buffer_load_dwordx4 v[96:99], v1, s[4:7], s57 offen offset:0 sc1
  buffer_load_dwordx4 v[100:103], v1, s[4:7], s57 offen offset:1024 sc1
  buffer_load_dwordx4 v[104:107], v1, s[4:7], s57 offen offset:2048 sc1
  buffer_load_dwordx4 v[108:111], v1, s[4:7], s57 offen offset:3072 sc1
L_pls_279:
  v_max3_u32 v15, v112, v116, v120
  v_max_u32 v15, v15, v124
  v_cmp_eq_u32 vcc, -1, v15
  s_cbranch_vccz L_pls_280
  s_xor_b32 s57, s38, 24576
  buffer_load_dwordx4 v[112:115], v1, s[4:7], s57 offen offset:0 sc1
  buffer_load_dwordx4 v[116:119], v1, s[4:7], s57 offen offset:1024 sc1
  buffer_load_dwordx4 v[120:123], v1, s[4:7], s57 offen offset:2048 sc1
  buffer_load_dwordx4 v[124:127], v1, s[4:7], s57 offen offset:3072 sc1
L_pls_280:
  v_max3_u32 v15, v192, v194, v196
  v_max3_u32 v15, v15, v198, v200
  v_max3_u32 v15, v15, v202, v204
  v_max_u32 v15, v15, v206
  v_cmp_eq_u32 vcc, -1, v15
  s_cbranch_vccz L_pls_281
  buffer_load_dwordx2 v[192:193], v4, s[4:7], s39 offen offset:0 sc1
  buffer_load_dwordx2 v[194:195], v4, s[4:7], s39 offen offset:512 sc1
  buffer_load_dwordx2 v[196:197], v4, s[4:7], s39 offen offset:1024 sc1
  buffer_load_dwordx2 v[198:199], v4, s[4:7], s39 offen offset:1536 sc1
  buffer_load_dwordx2 v[200:201], v4, s[4:7], s39 offen offset:2048 sc1
  buffer_load_dwordx2 v[202:203], v4, s[4:7], s39 offen offset:2560 sc1
  buffer_load_dwordx2 v[204:205], v4, s[4:7], s39 offen offset:3072 sc1
  buffer_load_dwordx2 v[206:207], v4, s[4:7], s39 offen offset:3584 sc1
L_pls_281:
  s_waitcnt vmcnt(0)
  v_max3_u32 v15, v80, v84, v88
  v_max_u32 v15, v15, v92
  v_cmp_eq_u32 vcc, -1, v15
  s_cbranch_vccz L_plb_278
  s_sub_u32 s56, s56, 4
  s_cbranch_scc0 L_pl_277l
  s_mov_b32 s56, 0
  s_branch L_plb_278
L_pl_282:
L_pl_282l:
  s_xor_b32 s57, s38, 20480
  buffer_load_dwordx4 v[96:99], v1, s[4:7], s57 offen offset:0 sc1
  buffer_load_dwordx4 v[100:103], v1, s[4:7], s57 offen offset:1024 sc1
  buffer_load_dwordx4 v[104:107], v1, s[4:7], s57 offen offset:2048 sc1
  buffer_load_dwordx4 v[108:111], v1, s[4:7], s57 offen offset:3072 sc1
  s_waitcnt vmcnt(4)
  v_max3_u32 v15, v112, v116, v120
  v_max_u32 v15, v15, v124
  v_cmp_eq_u32 vcc, -1, v15
  s_cbranch_vccz L_pls_284
  s_xor_b32 s57, s38, 24576
  buffer_load_dwordx4 v[112:115], v1, s[4:7], s57 offen offset:0 sc1
  buffer_load_dwordx4 v[116:119], v1, s[4:7], s57 offen offset:1024 sc1
  buffer_load_dwordx4 v[120:123], v1, s[4:7], s57 offen offset:2048 sc1
  buffer_load_dwordx4 v[124:127], v1, s[4:7], s57 offen offset:3072 sc1
L_pls_284:
  v_max_u32 v15, v128, v132
  v_cmp_eq_u32 vcc, -1, v15
  s_cbranch_vccz L_pls_285
  s_xor_b32 s57, s38, 28672
  buffer_load_dwordx4 v[128:131], v1, s[4:7], s57 offen offset:0 sc1
  buffer_load_dwordx4 v[132:135], v1, s[4:7], s57 offen offset:1024 sc1
L_pls_285:
  v_max_u32 v15, v136, v140
  v_cmp_eq_u32 vcc, -1, v15
  s_cbranch_vccz L_pls_286
  s_xor_b32 s57, s38, 28672
  buffer_load_dwordx4 v[136:139], v1, s[4:7], s57 offen offset:2048 sc1
  buffer_load_dwordx4 v[140:143], v1, s[4:7], s57 offen offset:3072 sc1
L_pls_286:
  v_max3_u32 v15, v192, v194, v196
  v_max3_u32 v15, v15, v198, v200
  v_max3_u32 v15, v15, v202, v204
  v_max_u32 v15, v15, v206
  v_cmp_eq_u32 vcc, -1, v15
  s_cbranch_vccz L_pls_287
  buffer_load_dwordx2 v[192:193], v4, s[4:7], s39 offen offset:0 sc1
  buffer_load_dwordx2 v[194:195], v4, s[4:7], s39 offen offset:512 sc1
  buffer_load_dwordx2 v[196:197], v4, s[4:7], s39 offen offset:1024 sc1
  buffer_load_dwordx2 v[198:199], v4, s[4:7], s39 offen offset:1536 sc1
  buffer_load_dwordx2 v[200:201], v4, s[4:7], s39 offen offset:2048 sc1
  buffer_load_dwordx2 v[202:203], v4, s[4:7], s39 offen offset:2560 sc1
  buffer_load_dwordx2 v[204:205], v4, s[4:7], s39 offen offset:3072 sc1
  buffer_load_dwordx2 v[206:207], v4, s[4:7], s39 offen offset:3584 sc1
L_pls_287:
  s_waitcnt vmcnt(0)
  v_max3_u32 v15, v96, v100, v104
  v_max_u32 v15, v15, v108
  v_cmp_eq_u32 vcc, -1, v15
  s_cbranch_vccz L_plb_283
  s_sub_u32 s56, s56, 4
  s_cbranch_scc0 L_pl_282l
  s_mov_b32 s56, 0
  s_branch L_plb_283
L_pl_288:
L_pl_288l:
  buffer_load_dwordx2 v[192:193], v4, s[4:7], s39 offen offset:0 sc1
  buffer_load_dwordx2 v[194:195], v4, s[4:7], s39 offen offset:512 sc1
  buffer_load_dwordx2 v[196:197], v4, s[4:7], s39 offen offset:1024 sc1
  buffer_load_dwordx2 v[198:199], v4, s[4:7], s39 offen offset:1536 sc1
  buffer_load_dwordx2 v[200:201], v4, s[4:7], s39 offen offset:2048 sc1
  buffer_load_dwordx2 v[202:203], v4, s[4:7], s39 offen offset:2560 sc1
  buffer_load_dwordx2 v[204:205], v4, s[4:7], s39 offen offset:3072 sc1
  buffer_load_dwordx2 v[206:207], v4, s[4:7], s39 offen offset:3584 sc1
  s_waitcnt vmcnt(8)
  v_max3_u32 v15, v112, v116, v120
  v_max_u32 v15, v15, v124
  v_cmp_eq_u32 vcc, -1, v15
  s_cbranch_vccz L_pls_290
  s_xor_b32 s57, s38, 24576
  buffer_load_dwordx4 v[112:115], v1, s[4:7], s57 offen offset:0 sc1
  buffer_load_dwordx4 v[116:119], v1, s[4:7], s57 offen offset:1024 sc1
  buffer_load_dwordx4 v[120:123], v1, s[4:7], s57 offen offset:2048 sc1
  buffer_load_dwordx4 v[124:127], v1, s[4:7], s57 offen offset:3072 sc1
L_pls_290:
  v_max_u32 v15, v128, v132
  v_cmp_eq_u32 vcc, -1, v15
  s_cbranch_vccz L_pls_291
  s_xor_b32 s57, s38, 28672
  buffer_load_dwordx4 v[128:131], v1, s[4:7], s57 offen offset:0 sc1
  buffer_load_dwordx4 v[132:135], v1, s[4:7], s57 offen offset:1024 sc1
L_pls_291:
  v_max_u32 v15, v136, v140
  v_cmp_eq_u32 vcc, -1, v15
  s_cbranch_vccz L_pls_292
  s_xor_b32 s57, s38, 28672
  buffer_load_dwordx4 v[136:139], v1, s[4:7], s57 offen offset:2048 sc1
  buffer_load_dwordx4 v[140:143], v1, s[4:7], s57 offen offset:3072 sc1
L_pls_292:
  s_waitcnt vmcnt(0)
  v_max3_u32 v15, v192, v194, v196
  v_max3_u32 v15, v15, v198, v200
  v_max3_u32 v15, v15, v202, v204
  v_max_u32 v15, v15, v206
  v_cmp_eq_u32 vcc, -1, v15
  s_cbranch_vccz L_plb_289
  s_sub_u32 s56, s56, 4
  s_cbranch_scc0 L_pl_288l
  s_mov_b32 s56, 0
  s_branch L_plb_289
L_lsl_293:
  ds_read_b32 v7, v14 offset:1280
  s_waitcnt lgkmcnt(0)
  v_cmp_gt_u32 vcc, v247, v7
  s_cbranch_vccz L_lbk_294
  s_sub_u32 s56, s56, 1
  s_cbranch_scc0 L_lsl_293
  s_mov_b32 s56, 0
  s_branch L_lbk_294
L_pl_295:
L_pl_295l:
  s_xor_b32 s57, s38, 24576
  buffer_load_dwordx4 v[112:115], v1, s[4:7], s57 offen offset:0 sc1
  buffer_load_dwordx4 v[116:119], v1, s[4:7], s57 offen offset:1024 sc1
  buffer_load_dwordx4 v[120:123], v1, s[4:7], s57 offen offset:2048 sc1
  buffer_load_dwordx4 v[124:127], v1, s[4:7], s57 offen offset:3072 sc1
  s_waitcnt vmcnt(4)
  v_max_u32 v15, v128, v132
  v_cmp_eq_u32 vcc, -1, v15
  s_cbranch_vccz L_pls_297
  s_xor_b32 s57, s38, 28672
  buffer_load_dwordx4 v[128:131], v1, s[4:7], s57 offen offset:0 sc1
  buffer_load_dwordx4 v[132:135], v1, s[4:7], s57 offen offset:1024 sc1
L_pls_297:
  v_max_u32 v15, v136, v140
  v_cmp_eq_u32 vcc, -1, v15
  s_cbranch_vccz L_pls_298
  s_xor_b32 s57, s38, 28672
  buffer_load_dwordx4 v[136:139], v1, s[4:7], s57 offen offset:2048 sc1
  buffer_load_dwordx4 v[140:143], v1, s[4:7], s57 offen offset:3072 sc1
L_pls_298:
  s_waitcnt vmcnt(0)
  v_max3_u32 v15, v112, v116, v120
  v_max_u32 v15, v15, v124
  v_cmp_eq_u32 vcc, -1, v15
  s_cbranch_vccz L_plb_296
  s_sub_u32 s56, s56, 4
  s_cbranch_scc0 L_pl_295l
  s_mov_b32 s56, 0
  s_branch L_plb_296
L_pl_299:
L_pl_299l:
  s_xor_b32 s57, s38, 28672
  buffer_load_dwordx4 v[128:131], v1, s[4:7], s57 offen offset:0 sc1
  buffer_load_dwordx4 v[132:135], v1, s[4:7], s57 offen offset:1024 sc1
  s_waitcnt vmcnt(2)
  v_max_u32 v15, v136, v140
  v_cmp_eq_u32 vcc, -1, v15
  s_cbranch_vccz L_pls_301
  s_xor_b32 s57, s38, 28672
  buffer_load_dwordx4 v[136:139], v1, s[4:7], s57 offen offset:2048 sc1
  buffer_load_dwordx4 v[140:143], v1, s[4:7], s57 offen offset:3072 sc1
L_pls_301:
  s_waitcnt vmcnt(0)
  v_max_u32 v15, v128, v132
  v_cmp_eq_u32 vcc, -1, v15
  s_cbranch_vccz L_plb_300
  s_sub_u32 s56, s56, 4
  s_cbranch_scc0 L_pl_299l
  s_mov_b32 s56, 0
  s_branch L_plb_300
L_lsl_302:
  ds_read_b32 v7, v14 offset:2112
  s_waitcnt lgkmcnt(0)
  v_cmp_eq_u32 vcc, 0, v7
  s_cbranch_vccz L_lbk_303
  s_sub_u32 s56, s56, 1
  s_cbranch_scc0 L_lsl_302
  s_mov_b32 s56, 0
  s_branch L_lbk_303
L_pl_304:
L_pl_304l:
  s_xor_b32 s57, s38, 28672
  buffer_load_dwordx4 v[136:139], v1, s[4:7], s57 offen offset:2048 sc1
  buffer_load_dwordx4 v[140:143], v1, s[4:7], s57 offen offset:3072 sc1
  s_waitcnt vmcnt(2)
  s_waitcnt vmcnt(0)
  v_max_u32 v15, v136, v140
  v_cmp_eq_u32 vcc, -1, v15
  s_cbranch_vccz L_plb_305
  s_sub_u32 s56, s56, 4
  s_cbranch_scc0 L_pl_304l
  s_mov_b32 s56, 0
  s_branch L_plb_305
L_cpfend:
L_bodys:
  ds_write_b32 v5, v247 offset:128
  v_cvt_pk_bf16_f32 v144, v144, v145
  v_cvt_pk_bf16_f32 v145, v146, v147
  v_cvt_pk_bf16_f32 v146, v148, v149
  v_cvt_pk_bf16_f32 v147, v150, v151
  v_cvt_pk_bf16_f32 v148, v152, v153
  v_cvt_pk_bf16_f32 v149, v154, v155
  v_cvt_pk_bf16_f32 v150, v156, v157
  v_cvt_pk_bf16_f32 v151, v158, v159
  s_waitcnt lgkmcnt(2)
  v_mfma_f32_32x32x16_bf16 v[176:191], v[216:219], v[144:147], 0
  s_waitcnt lgkmcnt(1)
  v_mfma_f32_32x32x16_bf16 v[192:207], v[220:223], v[148:151], 0
  v_pk_mul_f32 v[160:161], v[160:161], v[246:247] op_sel_hi:[1,0]
  v_pk_mul_f32 v[162:163], v[162:163], v[246:247] op_sel_hi:[1,0]
  v_pk_mul_f32 v[164:165], v[164:165], v[246:247] op_sel_hi:[1,0]
  v_pk_mul_f32 v[166:167], v[166:167], v[246:247] op_sel_hi:[1,0]
  v_pk_mul_f32 v[168:169], v[168:169], v[246:247] op_sel_hi:[1,0]
  v_pk_mul_f32 v[170:171], v[170:171], v[246:247] op_sel_hi:[1,0]
  v_pk_mul_f32 v[172:173], v[172:173], v[246:247] op_sel_hi:[1,0]
  v_pk_mul_f32 v[174:175], v[174:175], v[246:247] op_sel_hi:[1,0]
  v_cvt_pk_bf16_f32 v160, v160, v161
  v_cvt_pk_bf16_f32 v161, v162, v163
  v_cvt_pk_bf16_f32 v162, v164, v165
  v_cvt_pk_bf16_f32 v163, v166, v167
  v_cvt_pk_bf16_f32 v164, v168, v169
  v_cvt_pk_bf16_f32 v165, v170, v171
  v_cvt_pk_bf16_f32 v166, v172, v173
  v_cvt_pk_bf16_f32 v167, v174, v175
  v_cndmask_b32 v172, 0, 48, s[42:43]
  v_xor_b32 v172, v172, v8
  v_xor_b32 v174, 16, v8
  ds_write_b128 v172, v[160:163] offset:16384
  ds_write_b128 v172, v[164:167] offset:24576
  v_max3_f32 v248, v176, v177, v178
  v_max3_f32 v250, v192, v193, v194
  v_max3_f32 v248, v248, v179, v180
  v_max3_f32 v250, v250, v195, v196
  v_max3_f32 v248, v248, v181, v182
  v_max3_f32 v250, v250, v197, v198
  v_max3_f32 v248, v248, v183, v184
  v_max3_f32 v250, v250, v199, v200
  v_max3_f32 v248, v248, v185, v186
  v_max3_f32 v250, v250, v201, v202
  v_max3_f32 v248, v248, v187, v188
  v_max3_f32 v250, v250, v203, v204
  v_max3_f32 v248, v248, v189, v190
  v_max3_f32 v250, v250, v205, v206
  v_max_f32 v248, v248, v191
  v_max_f32 v250, v250, v207
  v_mul_f32_e64 v248, -v244, v248
  v_mul_f32_e64 v250, -v244, v250
  v_pk_fma_f32 v[176:177], v[176:177], v[244:245], v[248:249] op_sel_hi:[1,0,0]
  v_pk_fma_f32 v[192:193], v[192:193], v[244:245], v[250:251] op_sel_hi:[1,0,0]
  v_pk_fma_f32 v[178:179], v[178:179], v[244:245], v[248:249] op_sel_hi:[1,0,0]
  v_pk_fma_f32 v[194:195], v[194:195], v[244:245], v[250:251] op_sel_hi:[1,0,0]
  v_pk_fma_f32 v[180:181], v[180:181], v[244:245], v[248:249] op_sel_hi:[1,0,0]
  v_pk_fma_f32 v[196:197], v[196:197], v[244:245], v[250:251] op_sel_hi:[1,0,0]
  v_pk_fma_f32 v[182:183], v[182:183], v[244:245], v[248:249] op_sel_hi:[1,0,0]
  v_pk_fma_f32 v[198:199], v[198:199], v[244:245], v[250:251] op_sel_hi:[1,0,0]
  v_pk_fma_f32 v[184:185], v[184:185], v[244:245], v[248:249] op_sel_hi:[1,0,0]
  v_pk_fma_f32 v[200:201], v[200:201], v[244:245], v[250:251] op_sel_hi:[1,0,0]
  v_pk_fma_f32 v[186:187], v[186:187], v[244:245], v[248:249] op_sel_hi:[1,0,0]
  v_pk_fma_f32 v[202:203], v[202:203], v[244:245], v[250:251] op_sel_hi:[1,0,0]
  v_pk_fma_f32 v[188:189], v[188:189], v[244:245], v[248:249] op_sel_hi:[1,0,0]
  v_pk_fma_f32 v[204:205], v[204:205], v[244:245], v[250:251] op_sel_hi:[1,0,0]
  v_pk_fma_f32 v[190:191], v[190:191], v[244:245], v[248:249] op_sel_hi:[1,0,0]
  v_pk_fma_f32 v[206:207], v[206:207], v[244:245], v[250:251] op_sel_hi:[1,0,0]
  v_exp_f32 v176, v176
  v_exp_f32 v192, v192
  v_exp_f32 v177, v177
  v_exp_f32 v193, v193
  v_exp_f32 v178, v178
  v_exp_f32 v194, v194
  v_exp_f32 v179, v179
  v_exp_f32 v195, v195
  v_exp_f32 v180, v180
  v_exp_f32 v196, v196
  v_exp_f32 v181, v181
  v_exp_f32 v197, v197
  v_exp_f32 v182, v182
  v_exp_f32 v198, v198
  v_exp_f32 v183, v183
  v_exp_f32 v199, v199
  v_exp_f32 v184, v184
  v_exp_f32 v200, v200
  v_exp_f32 v185, v185
  v_exp_f32 v201, v201
  v_exp_f32 v186, v186
  v_exp_f32 v202, v202
  v_exp_f32 v187, v187
  v_exp_f32 v203, v203
  v_exp_f32 v188, v188
  v_exp_f32 v204, v204
  v_exp_f32 v189, v189
  v_exp_f32 v205, v205
  v_exp_f32 v190, v190
  v_exp_f32 v206, v206
  v_exp_f32 v191, v191
  v_exp_f32 v207, v207
  v_pk_add_f32 v[252:253], v[176:177], v[178:179]
  v_pk_add_f32 v[254:255], v[192:193], v[194:195]
  v_pk_add_f32 v[252:253], v[252:253], v[180:181]
  v_pk_add_f32 v[254:255], v[254:255], v[196:197]
  v_pk_add_f32 v[252:253], v[252:253], v[182:183]
  v_pk_add_f32 v[254:255], v[254:255], v[198:199]
  v_pk_add_f32 v[252:253], v[252:253], v[184:185]
  v_pk_add_f32 v[254:255], v[254:255], v[200:201]
  v_pk_add_f32 v[252:253], v[252:253], v[186:187]
  v_pk_add_f32 v[254:255], v[254:255], v[202:203]
  v_pk_add_f32 v[252:253], v[252:253], v[188:189]
  v_pk_add_f32 v[254:255], v[254:255], v[204:205]
  v_pk_add_f32 v[252:253], v[252:253], v[190:191]
  v_pk_add_f32 v[254:255], v[254:255], v[206:207]
  v_add_f32 v252, v252, v253
  v_add_f32 v254, v254, v255
  v_rcp_f32 v252, v252
  v_rcp_f32 v254, v254
  v_pk_mul_f32 v[176:177], v[176:177], v[252:253] op_sel_hi:[1,0]
  v_pk_mul_f32 v[192:193], v[192:193], v[254:255] op_sel_hi:[1,0]
  v_pk_mul_f32 v[178:179], v[178:179], v[252:253] op_sel_hi:[1,0]
  v_pk_mul_f32 v[194:195], v[194:195], v[254:255] op_sel_hi:[1,0]
  v_pk_mul_f32 v[180:181], v[180:181], v[252:253] op_sel_hi:[1,0]
  v_pk_mul_f32 v[196:197], v[196:197], v[254:255] op_sel_hi:[1,0]
  v_pk_mul_f32 v[182:183], v[182:183], v[252:253] op_sel_hi:[1,0]
  v_pk_mul_f32 v[198:199], v[198:199], v[254:255] op_sel_hi:[1,0]
  v_pk_mul_f32 v[184:185], v[184:185], v[252:253] op_sel_hi:[1,0]
  v_pk_mul_f32 v[200:201], v[200:201], v[254:255] op_sel_hi:[1,0]
  v_pk_mul_f32 v[186:187], v[186:187], v[252:253] op_sel_hi:[1,0]
  v_pk_mul_f32 v[202:203], v[202:203], v[254:255] op_sel_hi:[1,0]
  v_pk_mul_f32 v[188:189], v[188:189], v[252:253] op_sel_hi:[1,0]
  v_pk_mul_f32 v[204:205], v[204:205], v[254:255] op_sel_hi:[1,0]
  v_pk_mul_f32 v[190:191], v[190:191], v[252:253] op_sel_hi:[1,0]
  v_pk_mul_f32 v[206:207], v[206:207], v[254:255] op_sel_hi:[1,0]
  v_cvt_pk_bf16_f32 v176, v176, v177
  v_cvt_pk_bf16_f32 v192, v192, v193
  v_cvt_pk_bf16_f32 v177, v178, v179
  v_cvt_pk_bf16_f32 v193, v194, v195
  v_cvt_pk_bf16_f32 v178, v180, v181
  v_cvt_pk_bf16_f32 v194, v196, v197
  v_cvt_pk_bf16_f32 v179, v182, v183
  v_cvt_pk_bf16_f32 v195, v198, v199
  v_cvt_pk_bf16_f32 v180, v184, v185
  v_cvt_pk_bf16_f32 v196, v200, v201
  v_cvt_pk_bf16_f32 v181, v186, v187
  v_cvt_pk_bf16_f32 v197, v202, v203
  v_cvt_pk_bf16_f32 v182, v188, v189
  v_cvt_pk_bf16_f32 v198, v204, v205
  v_cvt_pk_bf16_f32 v183, v190, v191
  v_cvt_pk_bf16_f32 v199, v206, v207
  ds_write_b128 v8, v[176:179]
  ds_write_b128 v174, v[180:183]
  ds_write_b128 v8, v[192:195] offset:8192
  ds_write_b128 v174, v[196:199] offset:8192
  ds_write_b32 v5, v247 offset:192
  s_waitcnt lgkmcnt(0)
  ds_read_b32 v7, v14 offset:192
  ds_read_b64_tr_b16 v[144:145], v10 offset:0
  ds_read_b64_tr_b16 v[146:147], v11 offset:256
  ds_read_b64_tr_b16 v[176:177], v12 offset:16384
  ds_read_b64_tr_b16 v[178:179], v13 offset:16640
  ds_read_b64_tr_b16 v[148:149], v10 offset:2048
  ds_read_b64_tr_b16 v[150:151], v11 offset:2304
  ds_read_b64_tr_b16 v[180:181], v12 offset:18432
  ds_read_b64_tr_b16 v[182:183], v13 offset:18688
  ds_read_b64_tr_b16 v[152:153], v10 offset:4096
  ds_read_b64_tr_b16 v[154:155], v11 offset:4352
  ds_read_b64_tr_b16 v[184:185], v12 offset:20480
  ds_read_b64_tr_b16 v[186:187], v13 offset:20736
  v_mov_b32 v216, s51
  v_mov_b32 v217, s51
  v_mov_b32 v218, s51
  v_mov_b32 v219, s51
  v_bfe_u32 v250, v1, 4, 5
  v_lshrrev_b32 v251, 9, v1
  s_and_b32 s46, s14, 1
  s_lshr_b32 s47, s14, 1
  s_lshl_b32 s44, s46, 2
  s_add_u32 s44, s44, s47
  s_lshl_b32 s45, s44, 4
  s_lshl_b32 s44, s44, 8
  s_add_u32 s45, s45, 2048
  v_lshlrev_b32 v248, 9, v251
  v_lshl_add_u32 v248, v250, 4, v248
  v_add_u32 v248, s44, v248
  v_lshl_add_u32 v251, v251, 5, s45
  v_cmp_eq_u32 vcc, 16, v250
  s_nop 1
  v_cndmask_b32 v248, v248, v251, vcc
  v_add_u32 v250, 143360, v248
  s_waitcnt lgkmcnt(12)
  v_cmp_gt_u32 vcc, v247, v7
  s_cbranch_vccnz L_lsl_396
L_lbk_397:
  s_waitcnt lgkmcnt(10)
  v_mfma_f32_16x16x32_bf16 v[212:215], v[144:147], v[216:219], 0
  ds_read_b64_tr_b16 v[156:157], v10 offset:6144
  ds_read_b64_tr_b16 v[158:159], v11 offset:6400
  ds_read_b64_tr_b16 v[188:189], v12 offset:22528
  ds_read_b64_tr_b16 v[190:191], v13 offset:22784
  ds_read_b32 v7, v14 offset:2624
  s_waitcnt lgkmcnt(13)
  v_mfma_f32_16x16x32_bf16 v[208:211], v[144:147], v[176:179], 0
  s_waitcnt lgkmcnt(11)
  v_mfma_f32_16x16x32_bf16 v[212:215], v[148:151], v[216:219], v[212:215]
  s_waitcnt lgkmcnt(9)
  v_mfma_f32_16x16x32_bf16 v[208:211], v[148:151], v[180:183], v[208:211]
  s_waitcnt lgkmcnt(7)
  v_mfma_f32_16x16x32_bf16 v[212:215], v[152:155], v[216:219], v[212:215]
  s_waitcnt lgkmcnt(5)
  v_mfma_f32_16x16x32_bf16 v[208:211], v[152:155], v[184:187], v[208:211]
  s_waitcnt lgkmcnt(3)
  v_mfma_f32_16x16x32_bf16 v[212:215], v[156:159], v[216:219], v[212:215]
  s_waitcnt lgkmcnt(1)
  v_mfma_f32_16x16x32_bf16 v[208:211], v[156:159], v[188:191], v[208:211]
  s_waitcnt lgkmcnt(0)
  v_cmp_eq_u32 vcc, 0, v7
  s_cbranch_vccnz L_lsl_398
L_lbk_399:
  s_nop 1
  v_cvt_pk_bf16_f32 v222, v212, v213
  v_cvt_pk_bf16_f32 v223, v214, v215
  s_nop 0
  v_cvt_pk_bf16_f32 v220, v208, v209
  v_cvt_pk_bf16_f32 v221, v210, v211
  s_nop 0
  v_permlane16_swap_b32 v220, v222
  v_permlane16_swap_b32 v221, v223
  s_mov_b32 exec_lo, 0x1ffff
  s_mov_b32 exec_hi, 0x1ffff
  buffer_store_dwordx4 v[220:223], v248, s[4:7], s21 offen sc1
  ds_write_b128 v250, v[220:223]
  s_mov_b64 exec, -1
  ds_write_b32 v5, v247 offset:2496
  s_cmp_ge_u32 s14, 2
  s_cbranch_scc1 L_nokvs
  ds_read_b32 v7, v14 offset:1344
  s_lshl_b32 s46, s14, 2
  s_xor_b32 s46, s46, s12
  s_and_b32 s34, s20, 0xffff0000
  v_lshrrev_b32 v11, 8, v1
  v_xor_b32 v11, s46, v11
  v_and_b32 v12, 0x70, v1
  v_add_u32 v12, 2048, v12
  v_lshl_add_u32 v11, v11, 12, v12
  s_waitcnt lgkmcnt(0)
  v_cmp_gt_u32 vcc, v247, v7
  s_cbranch_vccnz L_lsl_400
L_lbk_401:
  ds_read_b128 v[208:211], v3 offset:0
  ds_read_b128 v[212:215], v3 offset:1024
  ds_read_b128 v[216:219], v3 offset:2048
  ds_read_b128 v[220:223], v3 offset:3072
  ds_read_b128 v[224:227], v3 offset:4096
  s_waitcnt lgkmcnt(2)
  v_mfma_f32_32x32x16_bf16 v[144:159], v[208:211], v[16:19], 0
  ds_read_b128 v[228:231], v3 offset:5120
  v_mfma_f32_32x32x16_bf16 v[144:159], v[212:215], v[20:23], v[144:159]
  ds_read_b128 v[208:211], v3 offset:6144
  v_mfma_f32_32x32x16_bf16 v[144:159], v[216:219], v[24:27], v[144:159]
  ds_read_b128 v[212:215], v3 offset:7168
  s_waitcnt lgkmcnt(2)
  v_mfma_f32_32x32x16_bf16 v[144:159], v[220:223], v[28:31], v[144:159]
  ds_read_b128 v[216:219], v3 offset:8192
  v_mfma_f32_32x32x16_bf16 v[144:159], v[224:227], v[32:35], v[144:159]
  ds_read_b128 v[220:223], v3 offset:9216
  v_mfma_f32_32x32x16_bf16 v[144:159], v[228:231], v[36:39], v[144:159]
  ds_read_b128 v[224:227], v3 offset:10240
  s_waitcnt lgkmcnt(2)
  v_mfma_f32_32x32x16_bf16 v[144:159], v[208:211], v[40:43], v[144:159]
  ds_read_b128 v[228:231], v3 offset:11264
  v_mfma_f32_32x32x16_bf16 v[144:159], v[212:215], v[44:47], v[144:159]
  ds_read_b128 v[208:211], v3 offset:12288
  v_mfma_f32_32x32x16_bf16 v[144:159], v[216:219], v[48:51], v[144:159]
  ds_read_b128 v[212:215], v3 offset:13312
  s_waitcnt lgkmcnt(2)
  v_mfma_f32_32x32x16_bf16 v[144:159], v[220:223], v[52:55], v[144:159]
  ds_read_b128 v[216:219], v3 offset:14336
  v_mfma_f32_32x32x16_bf16 v[144:159], v[224:227], v[56:59], v[144:159]
  ds_read_b128 v[220:223], v3 offset:15360
  v_mfma_f32_32x32x16_bf16 v[144:159], v[228:231], v[60:63], v[144:159]
  ds_read_b128 v[224:227], v3 offset:16384
  s_waitcnt lgkmcnt(2)
  v_mfma_f32_32x32x16_bf16 v[144:159], v[208:211], v[64:67], v[144:159]
  ds_read_b128 v[228:231], v3 offset:17408
  v_mfma_f32_32x32x16_bf16 v[144:159], v[212:215], v[68:71], v[144:159]
  ds_read_b128 v[208:211], v3 offset:18432
  v_mfma_f32_32x32x16_bf16 v[144:159], v[216:219], v[72:75], v[144:159]
  ds_read_b128 v[212:215], v3 offset:19456
  s_waitcnt lgkmcnt(2)
  v_mfma_f32_32x32x16_bf16 v[144:159], v[220:223], v[76:79], v[144:159]
  ds_read_b128 v[216:219], v3 offset:20480
  v_bfe_u32 v68, v1, 4, 1
  v_lshlrev_b32 v68, 4, v68
  v_lshlrev_b32 v68, v68, s52
  v_mfma_f32_32x32x16_bf16 v[144:159], v[224:227], v[80:83], v[144:159]
  ds_read_b128 v[220:223], v3 offset:21504
  v_bfe_u32 v69, v1, 5, 2
  v_cmp_eq_u32 vcc, 0, v69
  s_nop 1
  v_cndmask_b32 v56, 0, v68, vcc
  v_mfma_f32_32x32x16_bf16 v[144:159], v[228:231], v[84:87], v[144:159]
  ds_read_b128 v[224:227], v3 offset:22528
  v_cmp_eq_u32 vcc, 1, v69
  s_nop 1
  v_cndmask_b32 v57, 0, v68, vcc
  v_cmp_eq_u32 vcc, 2, v69
  s_waitcnt lgkmcnt(2)
  v_mfma_f32_32x32x16_bf16 v[144:159], v[208:211], v[88:91], v[144:159]
  ds_read_b128 v[228:231], v3 offset:23552
  v_cndmask_b32 v58, 0, v68, vcc
  v_cmp_eq_u32 vcc, 3, v69
  s_nop 1
  v_cndmask_b32 v59, 0, v68, vcc
  v_mfma_f32_32x32x16_bf16 v[144:159], v[212:215], v[92:95], v[144:159]
  ds_read_b128 v[208:211], v3 offset:24576
  s_mov_b32 vcc_lo, 0xff0000ff
  s_mov_b32 vcc_hi, 0xff0000ff
  v_cndmask_b32 v52, 0, v56, vcc
  v_mfma_f32_32x32x16_bf16 v[144:159], v[216:219], v[96:99], v[144:159]
  ds_read_b128 v[212:215], v3 offset:25600
  v_cndmask_b32 v53, 0, v57, vcc
  v_cndmask_b32 v54, 0, v58, vcc
  v_cndmask_b32 v55, 0, v59, vcc
  s_waitcnt lgkmcnt(2)
  v_mfma_f32_32x32x16_bf16 v[144:159], v[220:223], v[100:103], v[144:159]
  ds_read_b128 v[216:219], v3 offset:26624
  v_bfe_u32 v68, v1, 8, 1
  v_lshlrev_b32 v68, 3, v68
  v_lshrrev_b32 v69, 9, v1
  v_mfma_f32_32x32x16_bf16 v[144:159], v[224:227], v[104:107], v[144:159]
  ds_read_b128 v[220:223], v3 offset:27648
  s_lshl_b32 s46, s14, 10
  s_add_u32 s46, s46, 139264
  s_lshl_b32 s47, s14, 4
  v_mfma_f32_32x32x16_bf16 v[144:159], v[228:231], v[108:111], v[144:159]
  ds_read_b128 v[224:227], v3 offset:28672
  s_add_u32 s47, s47, 139520
  v_and_b32 v70, 0xf0, v1
  v_lshl_add_u32 v70, v69, 9, v70
  s_xor_b32 s32, s20, 57344
  buffer_load_dwordx4 v[16:19], v6, s[4:7], s32 offen offset:0 sc1
  s_waitcnt lgkmcnt(2)
  v_mfma_f32_32x32x16_bf16 v[144:159], v[208:211], v[112:115], v[144:159]
  ds_read_b128 v[228:231], v3 offset:29696
  v_add3_u32 v70, v70, v68, s46
  v_and_b32 v71, 0x70, v1
  v_lshlrev_b32 v71, 5, v71
  s_xor_b32 s32, s20, 49152
  buffer_load_dwordx4 v[20:23], v6, s[4:7], s32 offen offset:0 sc1
  v_mfma_f32_32x32x16_bf16 v[144:159], v[212:215], v[116:119], v[144:159]
  ds_read_b128 v[208:211], v3 offset:30720
  v_lshl_add_u32 v71, v69, 6, v71
  v_add3_u32 v71, v71, v68, s47
  v_add_u32 v72, 139264, v1
  s_xor_b32 s32, s20, 40960
  buffer_load_dwordx4 v[24:27], v6, s[4:7], s32 offen offset:0 sc1
  v_mfma_f32_32x32x16_bf16 v[144:159], v[216:219], v[120:123], v[144:159]
  ds_read_b128 v[212:215], v3 offset:31744
  s_xor_b32 s32, s20, 32768
  buffer_load_dwordx4 v[28:31], v6, s[4:7], s32 offen offset:0 sc1
  ds_read_b64 v[216:217], v9 offset:7168
  s_waitcnt lgkmcnt(3)
  v_mfma_f32_32x32x16_bf16 v[144:159], v[220:223], v[124:127], v[144:159]
  s_xor_b32 s32, s20, 24576
  buffer_load_dwordx4 v[32:35], v6, s[4:7], s32 offen offset:0 sc1
  v_mfma_f32_32x32x16_bf16 v[144:159], v[224:227], v[128:131], v[144:159]
  s_xor_b32 s32, s20, 16384
  buffer_load_dwordx4 v[36:39], v6, s[4:7], s32 offen offset:0 sc1
  v_mfma_f32_32x32x16_bf16 v[144:159], v[228:231], v[132:135], v[144:159]
  s_xor_b32 s32, s20, 8192
  buffer_load_dwordx4 v[40:43], v6, s[4:7], s32 offen offset:0 sc1
  s_waitcnt lgkmcnt(0)
  v_mfma_f32_32x32x16_bf16 v[144:159], v[208:211], v[136:139], v[144:159]
  s_cmp_eq_u32 s14, 0
  s_cselect_b32 exec_lo, 0xffff0000, -1
  buffer_load_dwordx4 v[44:47], v11, s[4:7], s34 offen offset:0 sc1
  s_mov_b32 exec_lo, -1
  v_mfma_f32_32x32x16_bf16 v[144:159], v[212:215], v[140:143], v[144:159]
  ds_read_b128 v[220:223], v1 offset:4608
  ds_read_b128 v[224:227], v1 offset:5632
  s_mov_b32 exec_lo, 0
  buffer_load_dwordx4 v[48:51], v6, s[4:7], s20 offen offset:0 sc1
  s_mov_b32 exec_lo, -1
  v_mfma_f32_32x32x16_bf16 v[144:159], v[216:219], v[240:243], v[144:159]
  s_nop 11
  s_branch L_qds
L_nokvs:
  ds_read_b32 v7, v14 offset:1344
  s_lshl_b32 s46, s14, 2
  s_xor_b32 s46, s46, s12
  s_and_b32 s34, s20, 0xffff0000
  v_lshrrev_b32 v11, 8, v1
  v_xor_b32 v11, s46, v11
  v_and_b32 v12, 0x70, v1
  v_add_u32 v12, 2048, v12
  v_lshl_add_u32 v11, v11, 12, v12
  s_waitcnt lgkmcnt(0)
  v_cmp_gt_u32 vcc, v247, v7
  s_cbranch_vccnz L_lsl_402
L_lbk_403:
  ds_read_b128 v[208:211], v3 offset:0
  ds_read_b128 v[212:215], v3 offset:1024
  ds_read_b128 v[216:219], v3 offset:2048
  ds_read_b128 v[220:223], v3 offset:3072
  ds_read_b128 v[224:227], v3 offset:4096
  s_waitcnt lgkmcnt(2)
  v_mfma_f32_32x32x16_bf16 v[144:159], v[208:211], v[16:19], 0
  ds_read_b128 v[228:231], v3 offset:5120
  v_mfma_f32_32x32x16_bf16 v[144:159], v[212:215], v[20:23], v[144:159]
  ds_read_b128 v[208:211], v3 offset:6144
  v_mfma_f32_32x32x16_bf16 v[144:159], v[216:219], v[24:27], v[144:159]
  ds_read_b128 v[212:215], v3 offset:7168
  s_waitcnt lgkmcnt(2)
  v_mfma_f32_32x32x16_bf16 v[144:159], v[220:223], v[28:31], v[144:159]
  ds_read_b128 v[216:219], v3 offset:8192
  v_mfma_f32_32x32x16_bf16 v[144:159], v[224:227], v[32:35], v[144:159]
  ds_read_b128 v[220:223], v3 offset:9216
  v_mfma_f32_32x32x16_bf16 v[144:159], v[228:231], v[36:39], v[144:159]
  ds_read_b128 v[224:227], v3 offset:10240
  s_waitcnt lgkmcnt(2)
  v_mfma_f32_32x32x16_bf16 v[144:159], v[208:211], v[40:43], v[144:159]
  ds_read_b128 v[228:231], v3 offset:11264
  v_mfma_f32_32x32x16_bf16 v[144:159], v[212:215], v[44:47], v[144:159]
  ds_read_b128 v[208:211], v3 offset:12288
  v_mfma_f32_32x32x16_bf16 v[144:159], v[216:219], v[48:51], v[144:159]
  ds_read_b128 v[212:215], v3 offset:13312
  s_waitcnt lgkmcnt(2)
  v_mfma_f32_32x32x16_bf16 v[144:159], v[220:223], v[52:55], v[144:159]
  ds_read_b128 v[216:219], v3 offset:14336
  v_mfma_f32_32x32x16_bf16 v[144:159], v[224:227], v[56:59], v[144:159]
  ds_read_b128 v[220:223], v3 offset:15360
  v_mfma_f32_32x32x16_bf16 v[144:159], v[228:231], v[60:63], v[144:159]
  ds_read_b128 v[224:227], v3 offset:16384
  s_waitcnt lgkmcnt(2)
  v_mfma_f32_32x32x16_bf16 v[144:159], v[208:211], v[64:67], v[144:159]
  ds_read_b128 v[228:231], v3 offset:17408
  v_mfma_f32_32x32x16_bf16 v[144:159], v[212:215], v[68:71], v[144:159]
  ds_read_b128 v[208:211], v3 offset:18432
  v_mfma_f32_32x32x16_bf16 v[144:159], v[216:219], v[72:75], v[144:159]
  ds_read_b128 v[212:215], v3 offset:19456
  s_waitcnt lgkmcnt(2)
  v_mfma_f32_32x32x16_bf16 v[144:159], v[220:223], v[76:79], v[144:159]
  ds_read_b128 v[216:219], v3 offset:20480
  v_bfe_u32 v68, v1, 4, 1
  v_lshlrev_b32 v68, 4, v68
  v_lshlrev_b32 v68, v68, s52
  v_mfma_f32_32x32x16_bf16 v[144:159], v[224:227], v[80:83], v[144:159]
  ds_read_b128 v[220:223], v3 offset:21504
  v_bfe_u32 v69, v1, 5, 2
  v_cmp_eq_u32 vcc, 0, v69
  s_nop 1
  v_cndmask_b32 v56, 0, v68, vcc
  v_mfma_f32_32x32x16_bf16 v[144:159], v[228:231], v[84:87], v[144:159]
  ds_read_b128 v[224:227], v3 offset:22528
  v_cmp_eq_u32 vcc, 1, v69
  s_nop 1
  v_cndmask_b32 v57, 0, v68, vcc
  v_cmp_eq_u32 vcc, 2, v69
  s_waitcnt lgkmcnt(2)
  v_mfma_f32_32x32x16_bf16 v[144:159], v[208:211], v[88:91], v[144:159]
  ds_read_b128 v[228:231], v3 offset:23552
  v_cndmask_b32 v58, 0, v68, vcc
  v_cmp_eq_u32 vcc, 3, v69
  s_nop 1
  v_cndmask_b32 v59, 0, v68, vcc
  v_mfma_f32_32x32x16_bf16 v[144:159], v[212:215], v[92:95], v[144:159]
  ds_read_b128 v[208:211], v3 offset:24576
  s_mov_b32 vcc_lo, 0xff0000ff
  s_mov_b32 vcc_hi, 0xff0000ff
  v_cndmask_b32 v52, 0, v56, vcc
  v_mfma_f32_32x32x16_bf16 v[144:159], v[216:219], v[96:99], v[144:159]
  ds_read_b128 v[212:215], v3 offset:25600
  v_cndmask_b32 v53, 0, v57, vcc
  v_cndmask_b32 v54, 0, v58, vcc
  v_cndmask_b32 v55, 0, v59, vcc
  s_waitcnt lgkmcnt(2)
  v_mfma_f32_32x32x16_bf16 v[144:159], v[220:223], v[100:103], v[144:159]
  ds_read_b128 v[216:219], v3 offset:26624
  v_bfe_u32 v68, v1, 8, 1
  v_lshlrev_b32 v68, 3, v68
  v_lshrrev_b32 v69, 9, v1
  v_mfma_f32_32x32x16_bf16 v[144:159], v[224:227], v[104:107], v[144:159]
  ds_read_b128 v[220:223], v3 offset:27648
  s_lshl_b32 s46, s14, 10
  s_add_u32 s46, s46, 139264
  s_lshl_b32 s47, s14, 4
  v_mfma_f32_32x32x16_bf16 v[144:159], v[228:231], v[108:111], v[144:159]
  ds_read_b128 v[224:227], v3 offset:28672
  s_add_u32 s47, s47, 139520
  v_and_b32 v70, 0xf0, v1
  v_lshl_add_u32 v70, v69, 9, v70
  s_waitcnt lgkmcnt(2)
  v_mfma_f32_32x32x16_bf16 v[144:159], v[208:211], v[112:115], v[144:159]
  ds_read_b128 v[228:231], v3 offset:29696
  v_add3_u32 v70, v70, v68, s46
  v_and_b32 v71, 0x70, v1
  v_lshlrev_b32 v71, 5, v71
  v_mfma_f32_32x32x16_bf16 v[144:159], v[212:215], v[116:119], v[144:159]
  ds_read_b128 v[208:211], v3 offset:30720
  v_lshl_add_u32 v71, v69, 6, v71
  v_add3_u32 v71, v71, v68, s47
  v_add_u32 v72, 139264, v1
  v_mfma_f32_32x32x16_bf16 v[144:159], v[216:219], v[120:123], v[144:159]
  ds_read_b128 v[212:215], v3 offset:31744
  ds_read_b64 v[216:217], v9 offset:7168
  s_waitcnt lgkmcnt(3)
  v_mfma_f32_32x32x16_bf16 v[144:159], v[220:223], v[124:127], v[144:159]
  v_mfma_f32_32x32x16_bf16 v[144:159], v[224:227], v[128:131], v[144:159]
  v_mfma_f32_32x32x16_bf16 v[144:159], v[228:231], v[132:135], v[144:159]
  s_waitcnt lgkmcnt(0)
  v_mfma_f32_32x32x16_bf16 v[144:159], v[208:211], v[136:139], v[144:159]
  v_mfma_f32_32x32x16_bf16 v[144:159], v[212:215], v[140:143], v[144:159]
  ds_read_b128 v[220:223], v1 offset:4608
  ds_read_b128 v[224:227], v1 offset:5632
  v_mfma_f32_32x32x16_bf16 v[144:159], v[216:219], v[240:243], v[144:159]
  s_nop 11
L_qds:
  ds_write_b32 v5, v247 offset:256
  v_cvt_pk_bf16_f32 v144, v144, v145
  v_cvt_pk_bf16_f32 v145, v146, v147
  v_cvt_pk_bf16_f32 v146, v148, v149
  v_cvt_pk_bf16_f32 v147, v150, v151
  v_cvt_pk_bf16_f32 v148, v152, v153
  v_cvt_pk_bf16_f32 v149, v154, v155
  v_cvt_pk_bf16_f32 v150, v156, v157
  v_cvt_pk_bf16_f32 v151, v158, v159
  s_waitcnt lgkmcnt(2)
  v_mfma_f32_32x32x16_bf16 v[176:191], v[220:223], v[144:147], 0
  s_waitcnt lgkmcnt(1)
  v_mfma_f32_32x32x16_bf16 v[192:207], v[224:227], v[148:151], 0
  s_waitcnt lgkmcnt(0)
L_j1s:
  v_and_b32 v13, 0x1ff, v1
  s_lshl_b32 s46, s14, 9
  s_add_u32 s46, s46, 143360
  v_add_u32 v13, s46, v13
  v_add_u32 v12, 143360, v12
  ds_read_b32 v7, v14 offset:2496
  s_mov_b32 exec_hi, 0
  ds_read_b128 v[48:51], v13
  s_cmp_eq_u32 s14, 0
  s_cselect_b32 exec_lo, 0xffff, 0
  ds_read_b128 v[44:47], v12
  s_mov_b64 exec, -1
  v_max3_f32 v248, v176, v177, v178
  v_max3_f32 v250, v192, v193, v194
  v_max3_f32 v248, v248, v179, v180
  v_max3_f32 v250, v250, v195, v196
  v_max3_f32 v248, v248, v181, v182
  v_max3_f32 v250, v250, v197, v198
  v_max3_f32 v248, v248, v183, v184
  v_max3_f32 v250, v250, v199, v200
  v_max3_f32 v248, v248, v185, v186
  v_max3_f32 v250, v250, v201, v202
  v_max3_f32 v248, v248, v187, v188
  v_max3_f32 v250, v250, v203, v204
  v_max3_f32 v248, v248, v189, v190
  v_max3_f32 v250, v250, v205, v206
  v_max_f32 v248, v248, v191
  v_max_f32 v250, v250, v207
  v_mul_f32_e64 v248, -v244, v248
  v_mul_f32_e64 v250, -v244, v250
  v_pk_fma_f32 v[176:177], v[176:177], v[244:245], v[248:249] op_sel_hi:[1,0,0]
  v_pk_fma_f32 v[192:193], v[192:193], v[244:245], v[250:251] op_sel_hi:[1,0,0]
  v_pk_fma_f32 v[178:179], v[178:179], v[244:245], v[248:249] op_sel_hi:[1,0,0]
  v_pk_fma_f32 v[194:195], v[194:195], v[244:245], v[250:251] op_sel_hi:[1,0,0]
  v_pk_fma_f32 v[180:181], v[180:181], v[244:245], v[248:249] op_sel_hi:[1,0,0]
  v_pk_fma_f32 v[196:197], v[196:197], v[244:245], v[250:251] op_sel_hi:[1,0,0]
  v_pk_fma_f32 v[182:183], v[182:183], v[244:245], v[248:249] op_sel_hi:[1,0,0]
  v_pk_fma_f32 v[198:199], v[198:199], v[244:245], v[250:251] op_sel_hi:[1,0,0]
  v_pk_fma_f32 v[184:185], v[184:185], v[244:245], v[248:249] op_sel_hi:[1,0,0]
  v_pk_fma_f32 v[200:201], v[200:201], v[244:245], v[250:251] op_sel_hi:[1,0,0]
  v_pk_fma_f32 v[186:187], v[186:187], v[244:245], v[248:249] op_sel_hi:[1,0,0]
  v_pk_fma_f32 v[202:203], v[202:203], v[244:245], v[250:251] op_sel_hi:[1,0,0]
  v_pk_fma_f32 v[188:189], v[188:189], v[244:245], v[248:249] op_sel_hi:[1,0,0]
  v_pk_fma_f32 v[204:205], v[204:205], v[244:245], v[250:251] op_sel_hi:[1,0,0]
  v_pk_fma_f32 v[190:191], v[190:191], v[244:245], v[248:249] op_sel_hi:[1,0,0]
  v_pk_fma_f32 v[206:207], v[206:207], v[244:245], v[250:251] op_sel_hi:[1,0,0]
  v_exp_f32 v176, v176
  v_exp_f32 v192, v192
  v_exp_f32 v177, v177
  v_exp_f32 v193, v193
  v_exp_f32 v178, v178
  v_exp_f32 v194, v194
  v_exp_f32 v179, v179
  v_exp_f32 v195, v195
  v_exp_f32 v180, v180
  v_exp_f32 v196, v196
  v_exp_f32 v181, v181
  v_exp_f32 v197, v197
  v_exp_f32 v182, v182
  v_exp_f32 v198, v198
  v_exp_f32 v183, v183
  v_exp_f32 v199, v199
  v_exp_f32 v184, v184
  v_exp_f32 v200, v200
  v_exp_f32 v185, v185
  v_exp_f32 v201, v201
  v_exp_f32 v186, v186
  v_exp_f32 v202, v202
  v_exp_f32 v187, v187
  v_exp_f32 v203, v203
  v_exp_f32 v188, v188
  v_exp_f32 v204, v204
  v_exp_f32 v189, v189
  v_exp_f32 v205, v205
  v_exp_f32 v190, v190
  v_exp_f32 v206, v206
  v_exp_f32 v191, v191
  v_exp_f32 v207, v207
  v_pk_add_f32 v[252:253], v[176:177], v[178:179]
  v_pk_add_f32 v[254:255], v[192:193], v[194:195]
  v_pk_add_f32 v[252:253], v[252:253], v[180:181]
  v_pk_add_f32 v[254:255], v[254:255], v[196:197]
  v_pk_add_f32 v[252:253], v[252:253], v[182:183]
  v_pk_add_f32 v[254:255], v[254:255], v[198:199]
  v_pk_add_f32 v[252:253], v[252:253], v[184:185]
  v_pk_add_f32 v[254:255], v[254:255], v[200:201]
  v_pk_add_f32 v[252:253], v[252:253], v[186:187]
  v_pk_add_f32 v[254:255], v[254:255], v[202:203]
  v_pk_add_f32 v[252:253], v[252:253], v[188:189]
  v_pk_add_f32 v[254:255], v[254:255], v[204:205]
  v_pk_add_f32 v[252:253], v[252:253], v[190:191]
  v_pk_add_f32 v[254:255], v[254:255], v[206:207]
  v_add_f32 v252, v252, v253
  v_add_f32 v254, v254, v255
  v_rcp_f32 v252, v252
  v_rcp_f32 v254, v254
  v_pk_mul_f32 v[176:177], v[176:177], v[252:253] op_sel_hi:[1,0]
  v_pk_mul_f32 v[192:193], v[192:193], v[254:255] op_sel_hi:[1,0]
  v_pk_mul_f32 v[178:179], v[178:179], v[252:253] op_sel_hi:[1,0]
  v_pk_mul_f32 v[194:195], v[194:195], v[254:255] op_sel_hi:[1,0]
  v_pk_mul_f32 v[180:181], v[180:181], v[252:253] op_sel_hi:[1,0]
  v_pk_mul_f32 v[196:197], v[196:197], v[254:255] op_sel_hi:[1,0]
  v_pk_mul_f32 v[182:183], v[182:183], v[252:253] op_sel_hi:[1,0]
  v_pk_mul_f32 v[198:199], v[198:199], v[254:255] op_sel_hi:[1,0]
  v_pk_mul_f32 v[184:185], v[184:185], v[252:253] op_sel_hi:[1,0]
  v_pk_mul_f32 v[200:201], v[200:201], v[254:255] op_sel_hi:[1,0]
  v_pk_mul_f32 v[186:187], v[186:187], v[252:253] op_sel_hi:[1,0]
  v_pk_mul_f32 v[202:203], v[202:203], v[254:255] op_sel_hi:[1,0]
  v_pk_mul_f32 v[188:189], v[188:189], v[252:253] op_sel_hi:[1,0]
  v_pk_mul_f32 v[204:205], v[204:205], v[254:255] op_sel_hi:[1,0]
  v_pk_mul_f32 v[190:191], v[190:191], v[252:253] op_sel_hi:[1,0]
  v_pk_mul_f32 v[206:207], v[206:207], v[254:255] op_sel_hi:[1,0]
  v_cvt_pk_bf16_f32 v176, v176, v177
  v_cvt_pk_bf16_f32 v192, v192, v193
  v_cvt_pk_bf16_f32 v177, v178, v179
  v_cvt_pk_bf16_f32 v193, v194, v195
  v_cvt_pk_bf16_f32 v178, v180, v181
  v_cvt_pk_bf16_f32 v194, v196, v197
  v_cvt_pk_bf16_f32 v179, v182, v183
  v_cvt_pk_bf16_f32 v195, v198, v199
  v_cvt_pk_bf16_f32 v180, v184, v185
  v_cvt_pk_bf16_f32 v196, v200, v201
  v_cvt_pk_bf16_f32 v181, v186, v187
  v_cvt_pk_bf16_f32 v197, v202, v203
  v_cvt_pk_bf16_f32 v182, v188, v189
  v_cvt_pk_bf16_f32 v198, v204, v205
  v_cvt_pk_bf16_f32 v183, v190, v191
  v_cvt_pk_bf16_f32 v199, v206, v207
  s_cmp_lt_u32 s14, 2
  s_nop 0
  s_cbranch_scc1 L_gls
  s_xor_b32 s32, s20, 57344
  buffer_load_dwordx4 v[16:19], v6, s[4:7], s32 offen offset:0 sc1
  s_xor_b32 s32, s20, 49152
  buffer_load_dwordx4 v[20:23], v6, s[4:7], s32 offen offset:0 sc1
  s_xor_b32 s32, s20, 40960
  buffer_load_dwordx4 v[24:27], v6, s[4:7], s32 offen offset:0 sc1
  s_xor_b32 s32, s20, 32768
  buffer_load_dwordx4 v[28:31], v6, s[4:7], s32 offen offset:0 sc1
  s_xor_b32 s32, s20, 24576
  buffer_load_dwordx4 v[32:35], v6, s[4:7], s32 offen offset:0 sc1
  s_xor_b32 s32, s20, 16384
  buffer_load_dwordx4 v[36:39], v6, s[4:7], s32 offen offset:0 sc1
  s_xor_b32 s32, s20, 8192
  buffer_load_dwordx4 v[40:43], v6, s[4:7], s32 offen offset:0 sc1
  s_cmp_eq_u32 s14, 0
  s_cselect_b32 exec_lo, 0xffff0000, -1
  buffer_load_dwordx4 v[44:47], v11, s[4:7], s34 offen offset:0 sc1
  s_mov_b32 exec_lo, -1
  s_mov_b32 exec_lo, 0
  buffer_load_dwordx4 v[48:51], v6, s[4:7], s20 offen offset:0 sc1
  s_mov_b32 exec_lo, -1
L_gls:
  s_waitcnt lgkmcnt(2)
  v_cmp_gt_u32 vcc, v247, v7
  s_cbranch_vccnz L_lsl_404
L_lbk_405:
  s_waitcnt lgkmcnt(0)
  s_waitcnt vmcnt(6)
  v_max3_u32 v15, v16, v20, v24
  s_waitcnt vmcnt(5)
  v_max_u32 v15, v15, v28
  v_cmp_eq_u32 vcc, -1, v15
  s_cbranch_vccnz L_pl_406
L_plb_407:
  v_mfma_f32_16x16x32_bf16 v[60:63], v[52:55], v[16:19], 0
  v_mfma_f32_16x16x32_bf16 v[60:63], v[52:55], v[20:23], v[60:63]
  v_mfma_f32_16x16x32_bf16 v[60:63], v[52:55], v[24:27], v[60:63]
  v_mfma_f32_16x16x32_bf16 v[60:63], v[52:55], v[28:31], v[60:63]
  s_waitcnt vmcnt(2)
  v_max3_u32 v15, v32, v36, v40
  v_cmp_eq_u32 vcc, -1, v15
  s_cbranch_vccnz L_pl_410
L_plb_411:
  v_mfma_f32_16x16x32_bf16 v[60:63], v[52:55], v[32:35], v[60:63]
  v_mfma_f32_16x16x32_bf16 v[60:63], v[52:55], v[36:39], v[60:63]
  v_mfma_f32_16x16x32_bf16 v[60:63], v[52:55], v[40:43], v[60:63]
  s_waitcnt vmcnt(0)
  v_max_u32 v15, v44, v48
  v_cmp_eq_u32 vcc, -1, v15
  s_cbranch_vccnz L_pl_413
L_plb_414:
  v_mfma_f32_16x16x32_bf16 v[64:67], v[56:59], v[44:47], 0
  v_mfma_f32_16x16x32_bf16 v[60:63], v[52:55], v[48:51], v[60:63]
  s_nop 4
  v_cvt_pk_bf16_f32 v64, v64, v65
  v_cvt_pk_bf16_f32 v65, v66, v67
  ds_write_b64 v71, v[64:65]
  v_cvt_pk_bf16_f32 v60, v60, v61
  v_cvt_pk_bf16_f32 v61, v62, v63
  ds_write_b64 v70, v[60:61]
  ds_write_b32 v5, v247 offset:320
  ds_read_b32 v7, v14 offset:320
  ds_read_b128 v[208:211], v72 offset:0
  ds_read_b128 v[212:215], v72 offset:1024
  ds_read_b128 v[216:219], v72 offset:2048
  ds_read_b128 v[220:223], v72 offset:3072
  s_lshr_b32 s46, s14, 1
  s_mul_i32 s47, s46, 33280
  s_add_u32 s47, s47, 73728
  s_xor_b32 s48, s47, 512
  v_add_u32 v10, s47, v0
  v_add_u32 v11, s48, v0
  s_waitcnt lgkmcnt(4)
  v_cmp_gt_u32 vcc, v247, v7
  s_cbranch_vccnz L_lsl_415
L_lbk_416:
  ds_read_b32 v7, v14 offset:2688
  s_waitcnt lgkmcnt(4)
  v_mfma_f32_32x32x16_bf16 v[144:159], v[208:211], v[176:179], 0
  s_waitcnt lgkmcnt(3)
  v_mfma_f32_32x32x16_bf16 v[144:159], v[212:215], v[180:183], v[144:159]
  s_waitcnt lgkmcnt(2)
  v_mfma_f32_32x32x16_bf16 v[160:175], v[216:219], v[192:195], 0
  s_waitcnt lgkmcnt(1)
  v_mfma_f32_32x32x16_bf16 v[160:175], v[220:223], v[196:199], v[160:175]
  s_lshl_b32 s47, s14, 12
  s_xor_b32 s48, s47, 8192
  s_add_u32 s47, s47, 143360
  s_add_u32 s48, s48, 143360
  v_add_u32 v12, s47, v1
  v_add_u32 v13, s48, v1
  s_waitcnt lgkmcnt(0)
  v_cmp_gt_u32 vcc, v247, v7
  s_cbranch_vccnz L_lsl_417
L_lbk_418:
  v_pk_add_f32 v[152:153], v[152:153], v[154:155]
  v_add_f32 v152, v152, v153
  v_add_f32 v152, 0x358637bd, v152
  v_rcp_f32 v152, v152
  s_nop 0
  v_pk_mul_f32 v[144:145], v[144:145], v[152:153] op_sel_hi:[1,0]
  v_pk_mul_f32 v[146:147], v[146:147], v[152:153] op_sel_hi:[1,0]
  v_pk_mul_f32 v[148:149], v[148:149], v[152:153] op_sel_hi:[1,0]
  v_pk_mul_f32 v[150:151], v[150:151], v[152:153] op_sel_hi:[1,0]
  v_cvt_pk_bf16_f32 v144, v144, v145
  v_cvt_pk_bf16_f32 v145, v146, v147
  v_cvt_pk_bf16_f32 v146, v148, v149
  v_cvt_pk_bf16_f32 v147, v150, v151
  buffer_store_dwordx4 v[144:147], v1, s[4:7], s22 offen offset:0 sc1
  v_pk_add_f32 v[168:169], v[168:169], v[170:171]
  v_add_f32 v168, v168, v169
  v_add_f32 v168, 0x358637bd, v168
  v_rcp_f32 v168, v168
  s_nop 0
  v_pk_mul_f32 v[160:161], v[160:161], v[168:169] op_sel_hi:[1,0]
  v_pk_mul_f32 v[162:163], v[162:163], v[168:169] op_sel_hi:[1,0]
  v_pk_mul_f32 v[164:165], v[164:165], v[168:169] op_sel_hi:[1,0]
  v_pk_mul_f32 v[166:167], v[166:167], v[168:169] op_sel_hi:[1,0]
  v_cvt_pk_bf16_f32 v160, v160, v161
  v_cvt_pk_bf16_f32 v161, v162, v163
  v_cvt_pk_bf16_f32 v162, v164, v165
  v_cvt_pk_bf16_f32 v163, v166, v167
  buffer_store_dwordx4 v[160:163], v1, s[4:7], s22 offen offset:1024 sc1
  ds_read_b32 v7, v14 offset:1408
  v_lshlrev_b32 v176, 16, v232
  v_and_b32 v177, s54, v232
  v_lshlrev_b32 v178, 16, v233
  v_and_b32 v179, s54, v233
  v_lshlrev_b32 v180, 16, v234
  v_and_b32 v181, s54, v234
  v_lshlrev_b32 v182, 16, v235
  v_and_b32 v183, s54, v235
  v_lshlrev_b32 v184, 16, v236
  v_and_b32 v185, s54, v236
  v_lshlrev_b32 v186, 16, v237
  v_and_b32 v187, s54, v237
  v_lshlrev_b32 v188, 16, v238
  v_and_b32 v189, s54, v238
  v_lshlrev_b32 v190, 16, v239
  v_and_b32 v191, s54, v239
  s_waitcnt lgkmcnt(0)
  v_cmp_gt_u32 vcc, v247, v7
  s_cbranch_vccnz L_lsl_419
L_lbk_420:
  ds_read_b64_tr_b16 v[208:209], v10 offset:0
  ds_read_b64_tr_b16 v[210:211], v10 offset:256
  ds_read_b64_tr_b16 v[212:213], v11 offset:0
  ds_read_b64_tr_b16 v[214:215], v11 offset:256
  ds_read_b64_tr_b16 v[216:217], v10 offset:2048
  ds_read_b64_tr_b16 v[218:219], v10 offset:2304
  ds_read_b64_tr_b16 v[220:221], v11 offset:2048
  ds_read_b64_tr_b16 v[222:223], v11 offset:2304
  ds_read_b64_tr_b16 v[224:225], v10 offset:4096
  ds_read_b64_tr_b16 v[226:227], v10 offset:4352
  buffer_load_dwordx4 v[16:19], v1, s[4:7], s23 offen offset:0 sc1
  buffer_load_dwordx4 v[20:23], v1, s[4:7], s23 offen offset:1024 sc1
  buffer_load_dwordx4 v[24:27], v1, s[4:7], s23 offen offset:2048 sc1
  buffer_load_dwordx4 v[28:31], v1, s[4:7], s23 offen offset:3072 sc1
  s_add_u32 s44, s23, 4096
  buffer_load_dwordx4 v[32:35], v1, s[4:7], s44 offen offset:0 sc1
  buffer_load_dwordx4 v[36:39], v1, s[4:7], s44 offen offset:1024 sc1
  buffer_load_dwordx4 v[40:43], v1, s[4:7], s44 offen offset:2048 sc1
  buffer_load_dwordx4 v[44:47], v1, s[4:7], s44 offen offset:3072 sc1
  s_waitcnt vmcnt(6)
  v_max_u32 v15, v16, v20
  v_cmp_eq_u32 vcc, -1, v15
  s_cbranch_vccnz L_pl_421
L_plb_422:
  s_waitcnt lgkmcnt(4)
  v_mfma_f32_32x32x16_bf16 v[176:191], v[208:211], v[16:19], v[176:191]
  s_add_u32 s32, s23, 8192
  buffer_load_dwordx4 v[48:51], v1, s[4:7], s32 offen offset:0 sc1
  ds_read_b64_tr_b16 v[228:229], v11 offset:4096
  ds_read_b64_tr_b16 v[230:231], v11 offset:4352
  v_mfma_f32_32x32x16_bf16 v[192:207], v[212:215], v[16:19], 0
  buffer_load_dwordx4 v[52:55], v1, s[4:7], s32 offen offset:1024 sc1
  ds_read_b64_tr_b16 v[208:209], v10 offset:6144
  ds_read_b64_tr_b16 v[210:211], v10 offset:6400
  s_waitcnt vmcnt(6)
  v_max_u32 v15, v24, v28
  v_mfma_f32_32x32x16_bf16 v[176:191], v[216:219], v[20:23], v[176:191]
  buffer_load_dwordx4 v[56:59], v1, s[4:7], s32 offen offset:2048 sc1
  ds_read_b64_tr_b16 v[212:213], v11 offset:6144
  ds_read_b64_tr_b16 v[214:215], v11 offset:6400
  v_cmp_eq_u32 vcc, -1, v15
  s_waitcnt lgkmcnt(4)
  v_mfma_f32_32x32x16_bf16 v[192:207], v[220:223], v[20:23], v[192:207]
  buffer_load_dwordx4 v[60:63], v1, s[4:7], s32 offen offset:3072 sc1
  ds_read_b64_tr_b16 v[216:217], v10 offset:8192
  ds_read_b64_tr_b16 v[218:219], v10 offset:8448
  s_cbranch_vccnz L_pl_425
L_plb_426:
  v_mfma_f32_32x32x16_bf16 v[176:191], v[224:227], v[24:27], v[176:191]
  s_add_u32 s32, s23, 12288
  buffer_load_dwordx4 v[64:67], v1, s[4:7], s32 offen offset:0 sc1
  ds_read_b64_tr_b16 v[220:221], v11 offset:8192
  ds_read_b64_tr_b16 v[222:223], v11 offset:8448
  v_mfma_f32_32x32x16_bf16 v[192:207], v[228:231], v[24:27], v[192:207]
  buffer_load_dwordx4 v[68:71], v1, s[4:7], s32 offen offset:1024 sc1
  ds_read_b64_tr_b16 v[224:225], v10 offset:10240
  ds_read_b64_tr_b16 v[226:227], v10 offset:10496
  s_waitcnt vmcnt(6)
  v_max3_u32 v15, v32, v36, v40
  v_max_u32 v15, v15, v44
  s_waitcnt lgkmcnt(4)
  v_mfma_f32_32x32x16_bf16 v[176:191], v[208:211], v[28:31], v[176:191]
  buffer_load_dwordx4 v[72:75], v1, s[4:7], s32 offen offset:2048 sc1
  ds_read_b64_tr_b16 v[228:229], v11 offset:10240
  ds_read_b64_tr_b16 v[230:231], v11 offset:10496
  v_cmp_eq_u32 vcc, -1, v15
  v_mfma_f32_32x32x16_bf16 v[192:207], v[212:215], v[28:31], v[192:207]
  buffer_load_dwordx4 v[76:79], v1, s[4:7], s32 offen offset:3072 sc1
  ds_read_b64_tr_b16 v[208:209], v10 offset:12288
  ds_read_b64_tr_b16 v[210:211], v10 offset:12544
  ds_write_b32 v5, v247 offset:2560
  s_cbranch_vccnz L_pl_429
L_plb_430:
  v_mfma_f32_32x32x16_bf16 v[176:191], v[216:219], v[32:35], v[176:191]
  ds_read_b64_tr_b16 v[212:213], v11 offset:12288
  ds_read_b64_tr_b16 v[214:215], v11 offset:12544
  s_waitcnt lgkmcnt(5)
  v_mfma_f32_32x32x16_bf16 v[192:207], v[220:223], v[32:35], v[192:207]
  ds_read_b64_tr_b16 v[216:217], v10 offset:14336
  ds_read_b64_tr_b16 v[218:219], v10 offset:14592
  v_mfma_f32_32x32x16_bf16 v[176:191], v[224:227], v[36:39], v[176:191]
  ds_read_b64_tr_b16 v[220:221], v11 offset:14336
  ds_read_b64_tr_b16 v[222:223], v11 offset:14592
  v_mfma_f32_32x32x16_bf16 v[192:207], v[228:231], v[36:39], v[192:207]
  ds_read_b64_tr_b16 v[224:225], v11 offset:16384
  ds_read_b64_tr_b16 v[226:227], v11 offset:16640
  s_waitcnt lgkmcnt(4)
  v_mfma_f32_32x32x16_bf16 v[176:191], v[208:211], v[40:43], v[176:191]
  ds_read_b64_tr_b16 v[228:229], v11 offset:18432
  ds_read_b64_tr_b16 v[230:231], v11 offset:18688
  v_mfma_f32_32x32x16_bf16 v[192:207], v[212:215], v[40:43], v[192:207]
  ds_read_b64_tr_b16 v[208:209], v11 offset:20480
  ds_read_b64_tr_b16 v[210:211], v11 offset:20736
  s_waitcnt vmcnt(4)
  v_max3_u32 v15, v48, v52, v56
  v_max_u32 v15, v15, v60
  v_mfma_f32_32x32x16_bf16 v[176:191], v[216:219], v[44:47], v[176:191]
  ds_read_b64_tr_b16 v[212:213], v11 offset:22528
  ds_read_b64_tr_b16 v[214:215], v11 offset:22784
  v_cmp_eq_u32 vcc, -1, v15
  s_waitcnt lgkmcnt(4)
  v_mfma_f32_32x32x16_bf16 v[192:207], v[220:223], v[44:47], v[192:207]
  ds_read_b64_tr_b16 v[216:217], v11 offset:24576
  ds_read_b64_tr_b16 v[218:219], v11 offset:24832
  s_cbranch_vccnz L_pl_433
L_plb_434:
  v_mfma_f32_32x32x16_bf16 v[192:207], v[224:227], v[48:51], v[192:207]
  ds_read_b64_tr_b16 v[220:221], v11 offset:26624
  ds_read_b64_tr_b16 v[222:223], v11 offset:26880
  v_mfma_f32_32x32x16_bf16 v[192:207], v[228:231], v[52:55], v[192:207]
  ds_read_b64_tr_b16 v[224:225], v11 offset:28672
  ds_read_b64_tr_b16 v[226:227], v11 offset:28928
  s_waitcnt vmcnt(0)
  v_max3_u32 v15, v64, v68, v72
  v_max_u32 v15, v15, v76
  s_waitcnt lgkmcnt(4)
  v_mfma_f32_32x32x16_bf16 v[192:207], v[208:211], v[56:59], v[192:207]
  ds_read_b64_tr_b16 v[228:229], v11 offset:30720
  ds_read_b64_tr_b16 v[230:231], v11 offset:30976
  v_cmp_eq_u32 vcc, -1, v15
  v_mfma_f32_32x32x16_bf16 v[192:207], v[212:215], v[60:63], v[192:207]
  ds_read_b64_tr_b16 v[208:209], v10 offset:16384
  ds_read_b64_tr_b16 v[210:211], v10 offset:16640
  s_cbranch_vccnz L_pl_436
L_plb_437:
  v_mfma_f32_32x32x16_bf16 v[192:207], v[216:219], v[64:67], v[192:207]
  ds_read_b64_tr_b16 v[212:213], v10 offset:18432
  ds_read_b64_tr_b16 v[214:215], v10 offset:18688
  s_waitcnt lgkmcnt(4)
  v_mfma_f32_32x32x16_bf16 v[192:207], v[220:223], v[68:71], v[192:207]
  ds_read_b64_tr_b16 v[216:217], v10 offset:20480
  ds_read_b64_tr_b16 v[218:219], v10 offset:20736
  v_mfma_f32_32x32x16_bf16 v[192:207], v[224:227], v[72:75], v[192:207]
  ds_read_b64_tr_b16 v[220:221], v10 offset:22528
  ds_read_b64_tr_b16 v[222:223], v10 offset:22784
  v_mfma_f32_32x32x16_bf16 v[192:207], v[228:231], v[76:79], v[192:207]
  ds_read_b64_tr_b16 v[224:225], v10 offset:24576
  ds_read_b64_tr_b16 v[226:227], v10 offset:24832
  s_waitcnt lgkmcnt(4)
  v_mfma_f32_32x32x16_bf16 v[176:191], v[208:211], v[48:51], v[176:191]
  ds_read_b64_tr_b16 v[228:229], v10 offset:26624
  ds_read_b64_tr_b16 v[230:231], v10 offset:26880
  v_mfma_f32_32x32x16_bf16 v[176:191], v[212:215], v[52:55], v[176:191]
  ds_read_b64_tr_b16 v[208:209], v10 offset:28672
  ds_read_b64_tr_b16 v[210:211], v10 offset:28928
  ds_write_b128 v12, v[192:195] offset:0
  ds_write_b128 v12, v[196:199] offset:1024
  ds_write_b128 v12, v[200:203] offset:2048
  ds_write_b128 v12, v[204:207] offset:3072
  ds_write_b32 v5, v247 offset:384
  v_mfma_f32_32x32x16_bf16 v[176:191], v[216:219], v[56:59], v[176:191]
  ds_read_b64_tr_b16 v[212:213], v10 offset:30720
  ds_read_b64_tr_b16 v[214:215], v10 offset:30976
  s_waitcnt lgkmcnt(9)
  v_mfma_f32_32x32x16_bf16 v[176:191], v[220:223], v[60:63], v[176:191]
  v_mfma_f32_32x32x16_bf16 v[176:191], v[224:227], v[64:67], v[176:191]
  v_mfma_f32_32x32x16_bf16 v[176:191], v[228:231], v[68:71], v[176:191]
  ds_read_b32 v7, v14 offset:384
  ds_read_b128 v[144:147], v13 offset:0
  ds_read_b128 v[148:151], v13 offset:1024
  ds_read_b128 v[152:155], v13 offset:2048
  ds_read_b128 v[156:159], v13 offset:3072
  s_waitcnt lgkmcnt(5)
  v_mfma_f32_32x32x16_bf16 v[176:191], v[208:211], v[72:75], v[176:191]
  v_mfma_f32_32x32x16_bf16 v[176:191], v[212:215], v[76:79], v[176:191]
  s_waitcnt lgkmcnt(4)
  v_cmp_gt_u32 vcc, v247, v7
  s_nop 0
  s_and_b64 vcc, vcc, s[36:37]
  s_cbranch_scc1 L_lsl_438
L_lbk_439:
  s_waitcnt lgkmcnt(0)
  ds_write_b32 v5, v247 offset:448
  s_nop 4
  v_pk_add_f32 v[176:177], v[176:177], v[144:145]
  v_pk_add_f32 v[178:179], v[178:179], v[146:147]
  v_cvt_pk_bf16_f32 v232, v176, v177
  v_cvt_pk_bf16_f32 v233, v178, v179
  v_pk_add_f32 v[180:181], v[180:181], v[148:149]
  v_pk_add_f32 v[182:183], v[182:183], v[150:151]
  v_cvt_pk_bf16_f32 v234, v180, v181
  v_cvt_pk_bf16_f32 v235, v182, v183
  v_pk_add_f32 v[184:185], v[184:185], v[152:153]
  v_pk_add_f32 v[186:187], v[186:187], v[154:155]
  v_cvt_pk_bf16_f32 v236, v184, v185
  v_cvt_pk_bf16_f32 v237, v186, v187
  v_pk_add_f32 v[188:189], v[188:189], v[156:157]
  v_pk_add_f32 v[190:191], v[190:191], v[158:159]
  v_cvt_pk_bf16_f32 v238, v188, v189
  v_cvt_pk_bf16_f32 v239, v190, v191
  buffer_store_dwordx4 v[232:235], v1, s[4:7], s24 offen sc1
  buffer_store_dwordx4 v[236:239], v1, s[4:7], s24 offen offset:1024 sc1
  buffer_load_dwordx4 v[16:19], v1, s[4:7], s26 offen offset:0 sc1
  buffer_load_dwordx4 v[20:23], v1, s[4:7], s26 offen offset:1024 sc1
  v_mov_b32 v248, 0
  v_mov_b32 v249, 0
  v_mov_b32 v250, 0
  v_mov_b32 v251, 0
  v_dot2c_f32_bf16 v248, s51, v232
  v_dot2c_f32_bf16 v249, v232, v232
  v_dot2c_f32_bf16 v250, s51, v233
  v_dot2c_f32_bf16 v251, v233, v233
  v_dot2c_f32_bf16 v248, s51, v234
  v_dot2c_f32_bf16 v249, v234, v234
  v_dot2c_f32_bf16 v250, s51, v235
  v_dot2c_f32_bf16 v251, v235, v235
  v_dot2c_f32_bf16 v248, s51, v236
  v_dot2c_f32_bf16 v249, v236, v236
  v_dot2c_f32_bf16 v250, s51, v237
  v_dot2c_f32_bf16 v251, v237, v237
  v_dot2c_f32_bf16 v248, s51, v238
  v_dot2c_f32_bf16 v249, v238, v238
  v_dot2c_f32_bf16 v250, s51, v239
  v_dot2c_f32_bf16 v251, v239, v239
  s_nop 2
  v_pk_add_f32 v[248:249], v[248:249], v[250:251]
  v_mov_b32 v250, v248
  v_mov_b32 v251, v249
  s_nop 0
  v_permlane32_swap_b32 v250, v248
  v_permlane32_swap_b32 v251, v249
  v_pk_add_f32 v[248:249], v[248:249], v[250:251]
  s_mov_b32 exec_hi, 0
  buffer_store_dwordx2 v[248:249], v4, s[4:7], s25 offen sc1
  s_mov_b32 exec_hi, -1
  buffer_load_dwordx4 v[24:27], v1, s[4:7], s26 offen offset:2048 sc1
  buffer_load_dwordx4 v[28:31], v1, s[4:7], s26 offen offset:3072 sc1
  s_add_u32 s44, s26, 4096
  buffer_load_dwordx4 v[32:35], v1, s[4:7], s44 offen offset:0 sc1
  buffer_load_dwordx4 v[36:39], v1, s[4:7], s44 offen offset:1024 sc1
  buffer_load_dwordx4 v[40:43], v1, s[4:7], s44 offen offset:2048 sc1
  buffer_load_dwordx4 v[44:47], v1, s[4:7], s44 offen offset:3072 sc1
  s_add_u32 s45, s26, 8192
  buffer_load_dwordx4 v[48:51], v1, s[4:7], s45 offen offset:0 sc1
  buffer_load_dwordx4 v[52:55], v1, s[4:7], s45 offen offset:1024 sc1
  ds_read_b64_tr_b16 v[208:209], v2 offset:0
  ds_read_b64_tr_b16 v[210:211], v2 offset:256
  ds_read_b64_tr_b16 v[212:213], v2 offset:32768
  ds_read_b64_tr_b16 v[214:215], v2 offset:33024
  ds_read_b64_tr_b16 v[216:217], v2 offset:512
  ds_read_b64_tr_b16 v[218:219], v2 offset:768
  ds_read_b64_tr_b16 v[220:221], v2 offset:33280
  ds_read_b64_tr_b16 v[222:223], v2 offset:33536
  ds_read_b64_tr_b16 v[224:225], v2 offset:2048
  ds_read_b64_tr_b16 v[226:227], v2 offset:2304
  s_waitcnt vmcnt(9)
  v_max_u32 v15, v16, v20
  v_cmp_eq_u32 vcc, -1, v15
  s_cbranch_vccnz L_pl_440
L_plb_441:
  s_waitcnt lgkmcnt(4)
  v_mfma_f32_32x32x16_bf16 v[144:159], v[208:211], v[16:19], 0
  s_add_u32 s32, s26, 8192
  buffer_load_dwordx4 v[56:59], v1, s[4:7], s32 offen offset:2048 sc1
  ds_read_b64_tr_b16 v[228:229], v2 offset:34816
  ds_read_b64_tr_b16 v[230:231], v2 offset:35072
  v_mfma_f32_32x32x16_bf16 v[160:175], v[212:215], v[16:19], 0
  buffer_load_dwordx4 v[60:63], v1, s[4:7], s32 offen offset:3072 sc1
  ds_read_b64_tr_b16 v[208:209], v2 offset:2560
  ds_read_b64_tr_b16 v[210:211], v2 offset:2816
  s_waitcnt vmcnt(8)
  v_max_u32 v15, v24, v28
  v_mfma_f32_32x32x16_bf16 v[144:159], v[216:219], v[20:23], v[144:159]
  s_add_u32 s32, s26, 12288
  buffer_load_dwordx4 v[64:67], v1, s[4:7], s32 offen offset:0 sc1
  ds_read_b64_tr_b16 v[212:213], v2 offset:35328
  ds_read_b64_tr_b16 v[214:215], v2 offset:35584
  v_cmp_eq_u32 vcc, -1, v15
  s_waitcnt lgkmcnt(4)
  v_mfma_f32_32x32x16_bf16 v[160:175], v[220:223], v[20:23], v[160:175]
  buffer_load_dwordx4 v[68:71], v1, s[4:7], s32 offen offset:1024 sc1
  ds_read_b64_tr_b16 v[216:217], v2 offset:4096
  ds_read_b64_tr_b16 v[218:219], v2 offset:4352
  s_cbranch_vccnz L_pl_445
L_plb_446:
  v_mfma_f32_32x32x16_bf16 v[144:159], v[224:227], v[24:27], v[144:159]
  buffer_load_dwordx4 v[72:75], v1, s[4:7], s32 offen offset:2048 sc1
  ds_read_b64_tr_b16 v[220:221], v2 offset:36864
  ds_read_b64_tr_b16 v[222:223], v2 offset:37120
  v_mfma_f32_32x32x16_bf16 v[160:175], v[228:231], v[24:27], v[160:175]
  ds_read_b64_tr_b16 v[224:225], v2 offset:4608
  ds_read_b64_tr_b16 v[226:227], v2 offset:4864
  s_waitcnt vmcnt(7)
  v_max3_u32 v15, v32, v36, v40
  v_max_u32 v15, v15, v44
  s_waitcnt lgkmcnt(4)
  v_mfma_f32_32x32x16_bf16 v[144:159], v[208:211], v[28:31], v[144:159]
  buffer_load_dwordx4 v[76:79], v1, s[4:7], s32 offen offset:3072 sc1
  ds_read_b64_tr_b16 v[228:229], v2 offset:37376
  ds_read_b64_tr_b16 v[230:231], v2 offset:37632
  v_cmp_eq_u32 vcc, -1, v15
  v_mfma_f32_32x32x16_bf16 v[160:175], v[212:215], v[28:31], v[160:175]
  ds_read_b64_tr_b16 v[208:209], v2 offset:6144
  ds_read_b64_tr_b16 v[210:211], v2 offset:6400
  s_cbranch_vccnz L_pl_450
L_plb_451:
  v_mfma_f32_32x32x16_bf16 v[144:159], v[216:219], v[32:35], v[144:159]
  buffer_load_dwordx2 v[192:193], v4, s[4:7], s27 offen offset:0 sc1
  s_add_u32 s32, s26, 16384
  buffer_load_dwordx4 v[80:83], v1, s[4:7], s32 offen offset:0 sc1
  ds_read_b64_tr_b16 v[212:213], v2 offset:38912
  ds_read_b64_tr_b16 v[214:215], v2 offset:39168
  s_waitcnt lgkmcnt(4)
  v_mfma_f32_32x32x16_bf16 v[160:175], v[220:223], v[32:35], v[160:175]
  ds_read_b64_tr_b16 v[216:217], v2 offset:6656
  ds_read_b64_tr_b16 v[218:219], v2 offset:6912
  v_mfma_f32_32x32x16_bf16 v[144:159], v[224:227], v[36:39], v[144:159]
  buffer_load_dwordx2 v[194:195], v4, s[4:7], s27 offen offset:512 sc1
  buffer_load_dwordx4 v[84:87], v1, s[4:7], s32 offen offset:1024 sc1
  ds_read_b64_tr_b16 v[220:221], v2 offset:39424
  ds_read_b64_tr_b16 v[222:223], v2 offset:39680
  v_mfma_f32_32x32x16_bf16 v[160:175], v[228:231], v[36:39], v[160:175]
  ds_read_b64_tr_b16 v[224:225], v2 offset:8192
  ds_read_b64_tr_b16 v[226:227], v2 offset:8448
  s_waitcnt lgkmcnt(4)
  v_mfma_f32_32x32x16_bf16 v[144:159], v[208:211], v[40:43], v[144:159]
  buffer_load_dwordx2 v[196:197], v4, s[4:7], s27 offen offset:1024 sc1
  buffer_load_dwordx4 v[88:91], v1, s[4:7], s32 offen offset:2048 sc1
  ds_read_b64_tr_b16 v[228:229], v2 offset:40960
  ds_read_b64_tr_b16 v[230:231], v2 offset:41216
  v_mfma_f32_32x32x16_bf16 v[160:175], v[212:215], v[40:43], v[160:175]
  ds_read_b64_tr_b16 v[208:209], v2 offset:8704
  ds_read_b64_tr_b16 v[210:211], v2 offset:8960
  s_waitcnt vmcnt(10)
  v_max3_u32 v15, v48, v52, v56
  v_max_u32 v15, v15, v60
  v_mfma_f32_32x32x16_bf16 v[144:159], v[216:219], v[44:47], v[144:159]
  buffer_load_dwordx2 v[198:199], v4, s[4:7], s27 offen offset:1536 sc1
  buffer_load_dwordx4 v[92:95], v1, s[4:7], s32 offen offset:3072 sc1
  ds_read_b64_tr_b16 v[212:213], v2 offset:41472
  ds_read_b64_tr_b16 v[214:215], v2 offset:41728
  v_cmp_eq_u32 vcc, -1, v15
  s_waitcnt lgkmcnt(4)
  v_mfma_f32_32x32x16_bf16 v[160:175], v[220:223], v[44:47], v[160:175]
  ds_read_b64_tr_b16 v[216:217], v2 offset:10240
  ds_read_b64_tr_b16 v[218:219], v2 offset:10496
  s_cbranch_vccnz L_pl_454
L_plb_455:
  v_mfma_f32_32x32x16_bf16 v[144:159], v[224:227], v[48:51], v[144:159]
  buffer_load_dwordx2 v[200:201], v4, s[4:7], s27 offen offset:2048 sc1
  s_add_u32 s32, s26, 20480
  buffer_load_dwordx4 v[96:99], v1, s[4:7], s32 offen offset:0 sc1
  ds_read_b64_tr_b16 v[220:221], v2 offset:43008
  ds_read_b64_tr_b16 v[222:223], v2 offset:43264
  v_mfma_f32_32x32x16_bf16 v[160:175], v[228:231], v[48:51], v[160:175]
  ds_read_b64_tr_b16 v[224:225], v2 offset:10752
  ds_read_b64_tr_b16 v[226:227], v2 offset:11008
  s_waitcnt lgkmcnt(4)
  v_mfma_f32_32x32x16_bf16 v[144:159], v[208:211], v[52:55], v[144:159]
  buffer_load_dwordx2 v[202:203], v4, s[4:7], s27 offen offset:2560 sc1
  buffer_load_dwordx4 v[100:103], v1, s[4:7], s32 offen offset:1024 sc1
  ds_read_b64_tr_b16 v[228:229], v2 offset:43520
  ds_read_b64_tr_b16 v[230:231], v2 offset:43776
  v_mfma_f32_32x32x16_bf16 v[160:175], v[212:215], v[52:55], v[160:175]
  ds_read_b64_tr_b16 v[208:209], v2 offset:12288
  ds_read_b64_tr_b16 v[210:211], v2 offset:12544
  v_mfma_f32_32x32x16_bf16 v[144:159], v[216:219], v[56:59], v[144:159]
  buffer_load_dwordx2 v[204:205], v4, s[4:7], s27 offen offset:3072 sc1
  buffer_load_dwordx4 v[104:107], v1, s[4:7], s32 offen offset:2048 sc1
  ds_read_b64_tr_b16 v[212:213], v2 offset:45056
  ds_read_b64_tr_b16 v[214:215], v2 offset:45312
  s_waitcnt lgkmcnt(4)
  v_mfma_f32_32x32x16_bf16 v[160:175], v[220:223], v[56:59], v[160:175]
  ds_read_b64_tr_b16 v[216:217], v2 offset:12800
  ds_read_b64_tr_b16 v[218:219], v2 offset:13056
  s_waitcnt vmcnt(14)
  v_max3_u32 v15, v64, v68, v72
  v_max_u32 v15, v15, v76
  v_mfma_f32_32x32x16_bf16 v[144:159], v[224:227], v[60:63], v[144:159]
  buffer_load_dwordx2 v[206:207], v4, s[4:7], s27 offen offset:3584 sc1
  buffer_load_dwordx4 v[108:111], v1, s[4:7], s32 offen offset:3072 sc1
  ds_read_b64_tr_b16 v[220:221], v2 offset:45568
  ds_read_b64_tr_b16 v[222:223], v2 offset:45824
  v_cmp_eq_u32 vcc, -1, v15
  v_mfma_f32_32x32x16_bf16 v[160:175], v[228:231], v[60:63], v[160:175]
  ds_read_b64_tr_b16 v[224:225], v2 offset:14336
  ds_read_b64_tr_b16 v[226:227], v2 offset:14592
  s_cbranch_vccnz L_pl_459
L_plb_460:
  s_waitcnt lgkmcnt(4)
  v_mfma_f32_32x32x16_bf16 v[144:159], v[208:211], v[64:67], v[144:159]
  s_add_u32 s32, s26, 24576
  buffer_load_dwordx4 v[112:115], v1, s[4:7], s32 offen offset:0 sc1
  ds_read_b64_tr_b16 v[228:229], v2 offset:47104
  ds_read_b64_tr_b16 v[230:231], v2 offset:47360
  v_mfma_f32_32x32x16_bf16 v[160:175], v[212:215], v[64:67], v[160:175]
  ds_read_b64_tr_b16 v[208:209], v2 offset:14848
  ds_read_b64_tr_b16 v[210:211], v2 offset:15104
  v_mfma_f32_32x32x16_bf16 v[144:159], v[216:219], v[68:71], v[144:159]
  buffer_load_dwordx4 v[116:119], v1, s[4:7], s32 offen offset:1024 sc1
  ds_read_b64_tr_b16 v[212:213], v2 offset:47616
  ds_read_b64_tr_b16 v[214:215], v2 offset:47872
  s_waitcnt lgkmcnt(4)
  v_mfma_f32_32x32x16_bf16 v[160:175], v[220:223], v[68:71], v[160:175]
  ds_read_b64_tr_b16 v[216:217], v2 offset:16384
  ds_read_b64_tr_b16 v[218:219], v2 offset:16640
  v_mfma_f32_32x32x16_bf16 v[144:159], v[224:227], v[72:75], v[144:159]
  buffer_load_dwordx4 v[120:123], v1, s[4:7], s32 offen offset:2048 sc1
  ds_read_b64_tr_b16 v[220:221], v2 offset:49152
  ds_read_b64_tr_b16 v[222:223], v2 offset:49408
  v_mfma_f32_32x32x16_bf16 v[160:175], v[228:231], v[72:75], v[160:175]
  ds_read_b64_tr_b16 v[224:225], v2 offset:16896
  ds_read_b64_tr_b16 v[226:227], v2 offset:17152
  s_waitcnt vmcnt(11)
  v_max3_u32 v15, v80, v84, v88
  v_max_u32 v15, v15, v92
  s_waitcnt lgkmcnt(4)
  v_mfma_f32_32x32x16_bf16 v[144:159], v[208:211], v[76:79], v[144:159]
  buffer_load_dwordx4 v[124:127], v1, s[4:7], s32 offen offset:3072 sc1
  ds_read_b64_tr_b16 v[228:229], v2 offset:49664
  ds_read_b64_tr_b16 v[230:231], v2 offset:49920
  v_cmp_eq_u32 vcc, -1, v15
  v_mfma_f32_32x32x16_bf16 v[160:175], v[212:215], v[76:79], v[160:175]
  ds_read_b64_tr_b16 v[208:209], v2 offset:18432
  ds_read_b64_tr_b16 v[210:211], v2 offset:18688
  s_cbranch_vccnz L_pl_464
L_plb_465:
  v_mfma_f32_32x32x16_bf16 v[144:159], v[216:219], v[80:83], v[144:159]
  s_add_u32 s32, s26, 28672
  buffer_load_dwordx4 v[128:131], v1, s[4:7], s32 offen offset:0 sc1
  ds_read_b64_tr_b16 v[212:213], v2 offset:51200
  ds_read_b64_tr_b16 v[214:215], v2 offset:51456
  s_waitcnt lgkmcnt(4)
  v_mfma_f32_32x32x16_bf16 v[160:175], v[220:223], v[80:83], v[160:175]
  ds_read_b64_tr_b16 v[216:217], v2 offset:18944
  ds_read_b64_tr_b16 v[218:219], v2 offset:19200
  v_mfma_f32_32x32x16_bf16 v[144:159], v[224:227], v[84:87], v[144:159]
  buffer_load_dwordx4 v[132:135], v1, s[4:7], s32 offen offset:1024 sc1
  ds_read_b64_tr_b16 v[220:221], v2 offset:51712
  ds_read_b64_tr_b16 v[222:223], v2 offset:51968
  v_mfma_f32_32x32x16_bf16 v[160:175], v[228:231], v[84:87], v[160:175]
  ds_read_b64_tr_b16 v[224:225], v2 offset:20480
  ds_read_b64_tr_b16 v[226:227], v2 offset:20736
  s_waitcnt lgkmcnt(4)
  v_mfma_f32_32x32x16_bf16 v[144:159], v[208:211], v[88:91], v[144:159]
  buffer_load_dwordx4 v[136:139], v1, s[4:7], s32 offen offset:2048 sc1
  ds_read_b64_tr_b16 v[228:229], v2 offset:53248
  ds_read_b64_tr_b16 v[230:231], v2 offset:53504
  v_mfma_f32_32x32x16_bf16 v[160:175], v[212:215], v[88:91], v[160:175]
  ds_read_b64_tr_b16 v[208:209], v2 offset:20992
  ds_read_b64_tr_b16 v[210:211], v2 offset:21248
  s_waitcnt vmcnt(7)
  v_max3_u32 v15, v96, v100, v104
  v_max_u32 v15, v15, v108
  v_mfma_f32_32x32x16_bf16 v[144:159], v[216:219], v[92:95], v[144:159]
  buffer_load_dwordx4 v[140:143], v1, s[4:7], s32 offen offset:3072 sc1
  ds_read_b64_tr_b16 v[212:213], v2 offset:53760
  ds_read_b64_tr_b16 v[214:215], v2 offset:54016
  v_cmp_eq_u32 vcc, -1, v15
  s_waitcnt lgkmcnt(4)
  v_mfma_f32_32x32x16_bf16 v[160:175], v[220:223], v[92:95], v[160:175]
  ds_read_b64_tr_b16 v[216:217], v2 offset:22528
  ds_read_b64_tr_b16 v[218:219], v2 offset:22784
  s_cbranch_vccnz L_pl_469
L_plb_470:
  v_max3_u32 v15, v192, v194, v196
  v_max3_u32 v15, v15, v198, v200
  v_mfma_f32_32x32x16_bf16 v[144:159], v[224:227], v[96:99], v[144:159]
  ds_read_b64_tr_b16 v[220:221], v2 offset:55296
  ds_read_b64_tr_b16 v[222:223], v2 offset:55552
  v_max3_u32 v15, v15, v202, v204
  v_max_u32 v15, v15, v206
  v_mfma_f32_32x32x16_bf16 v[160:175], v[228:231], v[96:99], v[160:175]
  ds_read_b64_tr_b16 v[224:225], v2 offset:23040
  ds_read_b64_tr_b16 v[226:227], v2 offset:23296
  v_cmp_eq_u32 vcc, -1, v15
  s_waitcnt lgkmcnt(4)
  v_mfma_f32_32x32x16_bf16 v[144:159], v[208:211], v[100:103], v[144:159]
  ds_read_b64_tr_b16 v[228:229], v2 offset:55808
  ds_read_b64_tr_b16 v[230:231], v2 offset:56064
  s_cbranch_vccnz L_pl_475
L_plb_476:
  v_mfma_f32_32x32x16_bf16 v[160:175], v[212:215], v[100:103], v[160:175]
  ds_read_b64_tr_b16 v[208:209], v2 offset:24576
  ds_read_b64_tr_b16 v[210:211], v2 offset:24832
  v_add_f32 v192, v192, v194
  v_add_f32 v193, v193, v195
  v_mfma_f32_32x32x16_bf16 v[144:159], v[216:219], v[104:107], v[144:159]
  ds_read_b64_tr_b16 v[212:213], v2 offset:57344
  ds_read_b64_tr_b16 v[214:215], v2 offset:57600
  v_add_f32 v192, v192, v196
  v_add_f32 v193, v193, v197
  s_waitcnt lgkmcnt(4)
  v_mfma_f32_32x32x16_bf16 v[160:175], v[220:223], v[104:107], v[160:175]
  ds_read_b64_tr_b16 v[216:217], v2 offset:25088
  ds_read_b64_tr_b16 v[218:219], v2 offset:25344
  v_add_f32 v192, v192, v198
  v_add_f32 v193, v193, v199
  s_waitcnt vmcnt(4)
  v_max3_u32 v15, v112, v116, v120
  v_max_u32 v15, v15, v124
  ds_write_b32 v5, v247 offset:2304
  v_mfma_f32_32x32x16_bf16 v[144:159], v[224:227], v[108:111], v[144:159]
  ds_read_b64_tr_b16 v[220:221], v2 offset:57856
  ds_read_b64_tr_b16 v[222:223], v2 offset:58112
  v_add_f32 v192, v192, v200
  v_add_f32 v193, v193, v201
  v_cmp_eq_u32 vcc, -1, v15
  v_mfma_f32_32x32x16_bf16 v[160:175], v[228:231], v[108:111], v[160:175]
  ds_read_b64_tr_b16 v[224:225], v2 offset:26624
  ds_read_b64_tr_b16 v[226:227], v2 offset:26880
  v_add_f32 v192, v192, v202
  v_add_f32 v193, v193, v203
  s_cbranch_vccnz L_pl_480
L_plb_481:
  s_waitcnt lgkmcnt(5)
  v_mfma_f32_32x32x16_bf16 v[144:159], v[208:211], v[112:115], v[144:159]
  ds_read_b64_tr_b16 v[228:229], v2 offset:59392
  ds_read_b64_tr_b16 v[230:231], v2 offset:59648
  v_add_f32 v192, v192, v204
  v_add_f32 v193, v193, v205
  v_mfma_f32_32x32x16_bf16 v[160:175], v[212:215], v[112:115], v[160:175]
  ds_read_b64_tr_b16 v[208:209], v2 offset:27136
  ds_read_b64_tr_b16 v[210:211], v2 offset:27392
  v_add_f32 v192, v192, v206
  v_add_f32 v193, v193, v207
  v_mfma_f32_32x32x16_bf16 v[144:159], v[216:219], v[116:119], v[144:159]
  ds_read_b64_tr_b16 v[212:213], v2 offset:59904
  ds_read_b64_tr_b16 v[214:215], v2 offset:60160
  v_mov_b32 v194, v192
  v_mov_b32 v195, v193
  s_waitcnt lgkmcnt(4)
  v_mfma_f32_32x32x16_bf16 v[160:175], v[220:223], v[116:119], v[160:175]
  ds_read_b64_tr_b16 v[216:217], v2 offset:28672
  ds_read_b64_tr_b16 v[218:219], v2 offset:28928
  v_permlane32_swap_b32 v194, v192
  v_permlane32_swap_b32 v195, v193
  ds_read_b32 v7, v14 offset:1472
  v_mfma_f32_32x32x16_bf16 v[144:159], v[224:227], v[120:123], v[144:159]
  ds_read_b64_tr_b16 v[220:221], v2 offset:61440
  ds_read_b64_tr_b16 v[222:223], v2 offset:61696
  v_add_f32 v192, v192, v194
  v_add_f32 v193, v193, v195
  v_mfma_f32_32x32x16_bf16 v[160:175], v[228:231], v[120:123], v[160:175]
  ds_read_b64_tr_b16 v[224:225], v2 offset:29184
  ds_read_b64_tr_b16 v[226:227], v2 offset:29440
  v_mul_f32 v192, 0xbb000000, v192
  v_mul_f32 v193, 0x3b000000, v193
  s_waitcnt vmcnt(2)
  v_max_u32 v15, v128, v132
  s_waitcnt lgkmcnt(5)
  v_mfma_f32_32x32x16_bf16 v[144:159], v[208:211], v[124:127], v[144:159]
  ds_read_b64_tr_b16 v[228:229], v2 offset:61952
  ds_read_b64_tr_b16 v[230:231], v2 offset:62208
  v_fma_f32 v193, -v192, v192, v193
  v_cvt_pk_bf16_f32 v240, v192, v192
  v_cmp_eq_u32 vcc, -1, v15
  v_mfma_f32_32x32x16_bf16 v[160:175], v[212:215], v[124:127], v[160:175]
  ds_read_b64_tr_b16 v[208:209], v2 offset:30720
  ds_read_b64_tr_b16 v[210:211], v2 offset:30976
  v_max_f32 v193, 0, v193
  v_add_f32 v193, 0x3727c5ac, v193
  s_cbranch_vccnz L_pl_484
L_plb_485:
  v_mfma_f32_32x32x16_bf16 v[144:159], v[216:219], v[128:131], v[144:159]
  ds_read_b64_tr_b16 v[212:213], v2 offset:63488
  ds_read_b64_tr_b16 v[214:215], v2 offset:63744
  v_and_b32 v194, s54, v240
  v_rsq_f32 v195, v193
  s_waitcnt lgkmcnt(4)
  v_mfma_f32_32x32x16_bf16 v[160:175], v[220:223], v[128:131], v[160:175]
  ds_read_b64_tr_b16 v[216:217], v2 offset:31232
  ds_read_b64_tr_b16 v[218:219], v2 offset:31488
  v_sub_f32 v194, v192, v194
  v_cvt_pk_bf16_f32 v241, v194, v194
  s_waitcnt vmcnt(0)
  v_max_u32 v15, v136, v140
  v_mfma_f32_32x32x16_bf16 v[144:159], v[224:227], v[132:135], v[144:159]
  ds_read_b64_tr_b16 v[220:221], v2 offset:64000
  ds_read_b64_tr_b16 v[222:223], v2 offset:64256
  v_cndmask_b32 v240, v240, v241, s[42:43]
  v_mov_b32 v241, v240
  v_cmp_eq_u32 s[30:31], -1, v15
  v_cmp_gt_u32 vcc, v247, v7
  s_cbranch_vccnz L_lsl_487
L_lbk_488:
  ds_read_b64 v[224:225], v9 offset:3072
  v_mfma_f32_32x32x16_bf16 v[160:175], v[228:231], v[132:135], v[160:175]
  v_mul_f32 v244, 0xc0135761, v195
  v_mul_f32 v194, v195, v195
  s_cmp_lg_u64 s[30:31], 0
  s_cbranch_scc1 L_pl_489
L_plb_490:
  ds_read_b64 v[228:229], v9 offset:3328
  s_waitcnt lgkmcnt(4)
  v_mfma_f32_32x32x16_bf16 v[144:159], v[208:211], v[136:139], v[144:159]
  v_mul_f32 v194, 0x3d372713, v194
  v_mul_f32 v245, v244, v194
  v_mfma_f32_32x32x16_bf16 v[160:175], v[212:215], v[136:139], v[160:175]
  ds_read_b128 v[208:211], v3 offset:0
  v_mov_b32 v246, v193
  v_mfma_f32_32x32x16_bf16 v[144:159], v[216:219], v[140:143], v[144:159]
  ds_read_b128 v[212:215], v3 offset:32768
  s_waitcnt lgkmcnt(2)
  v_mfma_f32_32x32x16_bf16 v[160:175], v[220:223], v[140:143], v[160:175]
  ds_read_b128 v[216:219], v3 offset:1024
  v_mfma_f32_32x32x16_bf16 v[144:159], v[224:227], v[240:243], v[144:159]
  ds_read_b128 v[220:223], v3 offset:33792
  v_mfma_f32_32x32x16_bf16 v[160:175], v[228:231], v[240:243], v[160:175]
  ds_read_b128 v[224:227], v3 offset:2048
  s_waitcnt lgkmcnt(2)
  v_mfma_f32_32x32x16_bf16 v[176:191], v[208:211], v[16:19], 0
  ds_read_b128 v[228:231], v3 offset:34816
  ds_write_b32 v5, v247 offset:512
  v_mfma_f32_32x32x16_bf16 v[192:207], v[212:215], v[16:19], 0
  ds_read_b128 v[208:211], v3 offset:3072
  v_mul_f32 v248, v144, v144
  v_mul_f32 v249, v145, v145
  v_fma_f32 v248, v248, v245, v244
  v_mfma_f32_32x32x16_bf16 v[176:191], v[216:219], v[20:23], v[176:191]
  ds_read_b128 v[212:215], v3 offset:35840
  v_fma_f32 v249, v249, v245, v244
  v_mul_f32 v248, v248, v144
  v_mul_f32 v249, v249, v145
  s_waitcnt lgkmcnt(3)
  v_mfma_f32_32x32x16_bf16 v[192:207], v[220:223], v[20:23], v[192:207]
  ds_read_b128 v[216:219], v3 offset:4096
  v_exp_f32 v248, v248
  v_exp_f32 v249, v249
  v_mfma_f32_32x32x16_bf16 v[176:191], v[224:227], v[24:27], v[176:191]
  ds_read_b128 v[220:223], v3 offset:36864
  v_mul_f32 v160, v160, v144
  v_mul_f32 v161, v161, v145
  v_fma_f32 v248, v248, v246, v246
  v_mfma_f32_32x32x16_bf16 v[192:207], v[228:231], v[24:27], v[192:207]
  ds_read_b128 v[224:227], v3 offset:5120
  v_fma_f32 v249, v249, v246, v246
  v_rcp_f32 v248, v248
  s_waitcnt lgkmcnt(2)
  v_mfma_f32_32x32x16_bf16 v[176:191], v[208:211], v[28:31], v[176:191]
  ds_read_b128 v[228:231], v3 offset:37888
  v_rcp_f32 v249, v249
  v_nop
  v_mfma_f32_32x32x16_bf16 v[192:207], v[212:215], v[28:31], v[192:207]
  ds_read_b128 v[208:211], v3 offset:6144
  v_mul_f32 v160, v160, v248
  v_mul_f32 v161, v161, v249
  v_mul_f32 v250, v146, v146
  v_mfma_f32_32x32x16_bf16 v[176:191], v[216:219], v[32:35], v[176:191]
  ds_read_b128 v[212:215], v3 offset:38912
  v_mul_f32 v251, v147, v147
  v_fma_f32 v250, v250, v245, v244
  v_fma_f32 v251, v251, v245, v244
  s_waitcnt lgkmcnt(2)
  v_mfma_f32_32x32x16_bf16 v[192:207], v[220:223], v[32:35], v[192:207]
  ds_read_b128 v[216:219], v3 offset:7168
  v_mul_f32 v250, v250, v146
  v_mul_f32 v251, v251, v147
  v_exp_f32 v250, v250
  v_mfma_f32_32x32x16_bf16 v[176:191], v[224:227], v[36:39], v[176:191]
  ds_read_b128 v[220:223], v3 offset:39936
  v_exp_f32 v251, v251
  v_mul_f32 v162, v162, v146
  v_mfma_f32_32x32x16_bf16 v[192:207], v[228:231], v[36:39], v[192:207]
  ds_read_b128 v[224:227], v3 offset:8192
  v_mul_f32 v163, v163, v147
  v_fma_f32 v250, v250, v246, v246
  v_fma_f32 v251, v251, v246, v246
  s_waitcnt lgkmcnt(2)
  v_mfma_f32_32x32x16_bf16 v[176:191], v[208:211], v[40:43], v[176:191]
  ds_read_b128 v[228:231], v3 offset:40960
  v_rcp_f32 v250, v250
  v_rcp_f32 v251, v251
  v_mfma_f32_32x32x16_bf16 v[192:207], v[212:215], v[40:43], v[192:207]
  ds_read_b128 v[208:211], v3 offset:9216
  v_cvt_pk_bf16_f32 v144, v160, v161
  v_mul_f32 v162, v162, v250
  v_mul_f32 v163, v163, v251
  v_mfma_f32_32x32x16_bf16 v[176:191], v[216:219], v[44:47], v[176:191]
  ds_read_b128 v[212:215], v3 offset:41984
  v_mul_f32 v252, v148, v148
  v_mul_f32 v253, v149, v149
  v_fma_f32 v252, v252, v245, v244
  s_waitcnt lgkmcnt(2)
  v_mfma_f32_32x32x16_bf16 v[192:207], v[220:223], v[44:47], v[192:207]
  ds_read_b128 v[216:219], v3 offset:10240
  v_fma_f32 v253, v253, v245, v244
  v_mul_f32 v252, v252, v148
  v_mul_f32 v253, v253, v149
  v_mfma_f32_32x32x16_bf16 v[176:191], v[224:227], v[48:51], v[176:191]
  ds_read_b128 v[220:223], v3 offset:43008
  v_exp_f32 v252, v252
  v_exp_f32 v253, v253
  v_mfma_f32_32x32x16_bf16 v[192:207], v[228:231], v[48:51], v[192:207]
  ds_read_b128 v[224:227], v3 offset:11264
  v_mul_f32 v164, v164, v148
  v_mul_f32 v165, v165, v149
  v_fma_f32 v252, v252, v246, v246
  s_waitcnt lgkmcnt(2)
  v_mfma_f32_32x32x16_bf16 v[176:191], v[208:211], v[52:55], v[176:191]
  ds_read_b128 v[228:231], v3 offset:44032
  v_fma_f32 v253, v253, v246, v246
  v_rcp_f32 v252, v252
  v_mfma_f32_32x32x16_bf16 v[192:207], v[212:215], v[52:55], v[192:207]
  ds_read_b128 v[208:211], v3 offset:12288
  v_rcp_f32 v253, v253
  v_cvt_pk_bf16_f32 v145, v162, v163
  v_mfma_f32_32x32x16_bf16 v[176:191], v[216:219], v[56:59], v[176:191]
  ds_read_b128 v[212:215], v3 offset:45056
  v_mul_f32 v164, v164, v252
  v_mul_f32 v165, v165, v253
  v_mul_f32 v254, v150, v150
  s_waitcnt lgkmcnt(2)
  v_mfma_f32_32x32x16_bf16 v[192:207], v[220:223], v[56:59], v[192:207]
  ds_read_b128 v[216:219], v3 offset:13312
  v_mul_f32 v255, v151, v151
  v_fma_f32 v254, v254, v245, v244
  v_fma_f32 v255, v255, v245, v244
  v_mfma_f32_32x32x16_bf16 v[176:191], v[224:227], v[60:63], v[176:191]
  ds_read_b128 v[220:223], v3 offset:46080
  v_mul_f32 v254, v254, v150
  v_mul_f32 v255, v255, v151
  v_exp_f32 v254, v254
  v_mfma_f32_32x32x16_bf16 v[192:207], v[228:231], v[60:63], v[192:207]
  ds_read_b128 v[224:227], v3 offset:14336
  v_exp_f32 v255, v255
  v_mul_f32 v166, v166, v150
  s_waitcnt lgkmcnt(2)
  v_mfma_f32_32x32x16_bf16 v[176:191], v[208:211], v[64:67], v[176:191]
  ds_read_b128 v[228:231], v3 offset:47104
  v_mul_f32 v167, v167, v151
  v_fma_f32 v254, v254, v246, v246
  v_fma_f32 v255, v255, v246, v246
  v_mfma_f32_32x32x16_bf16 v[192:207], v[212:215], v[64:67], v[192:207]
  ds_read_b128 v[208:211], v3 offset:15360
  v_rcp_f32 v254, v254
  v_rcp_f32 v255, v255
  v_mfma_f32_32x32x16_bf16 v[176:191], v[216:219], v[68:71], v[176:191]
  ds_read_b128 v[212:215], v3 offset:48128
  v_cvt_pk_bf16_f32 v146, v164, v165
  v_mul_f32 v166, v166, v254
  v_mul_f32 v167, v167, v255
  ds_write_b32 v5, v247 offset:576
  s_waitcnt lgkmcnt(3)
  v_mfma_f32_32x32x16_bf16 v[192:207], v[220:223], v[68:71], v[192:207]
  ds_read_b128 v[216:219], v3 offset:16384
  v_mul_f32 v248, v152, v152
  v_mul_f32 v249, v153, v153
  v_fma_f32 v248, v248, v245, v244
  v_mfma_f32_32x32x16_bf16 v[176:191], v[224:227], v[72:75], v[176:191]
  ds_read_b128 v[220:223], v3 offset:49152
  v_fma_f32 v249, v249, v245, v244
  v_mul_f32 v248, v248, v152
  v_mul_f32 v249, v249, v153
  v_mfma_f32_32x32x16_bf16 v[192:207], v[228:231], v[72:75], v[192:207]
  ds_read_b128 v[224:227], v3 offset:17408
  v_exp_f32 v248, v248
  v_exp_f32 v249, v249
  s_waitcnt lgkmcnt(2)
  v_mfma_f32_32x32x16_bf16 v[176:191], v[208:211], v[76:79], v[176:191]
  ds_read_b128 v[228:231], v3 offset:50176
  v_mul_f32 v168, v168, v152
  v_mul_f32 v169, v169, v153
  v_fma_f32 v248, v248, v246, v246
  v_mfma_f32_32x32x16_bf16 v[192:207], v[212:215], v[76:79], v[192:207]
  ds_read_b128 v[208:211], v3 offset:18432
  v_fma_f32 v249, v249, v246, v246
  v_rcp_f32 v248, v248
  v_mfma_f32_32x32x16_bf16 v[176:191], v[216:219], v[80:83], v[176:191]
  ds_read_b128 v[212:215], v3 offset:51200
  v_rcp_f32 v249, v249
  v_cvt_pk_bf16_f32 v147, v166, v167
  s_waitcnt lgkmcnt(2)
  v_mfma_f32_32x32x16_bf16 v[192:207], v[220:223], v[80:83], v[192:207]
  ds_read_b128 v[216:219], v3 offset:19456
  v_mul_f32 v168, v168, v248
  v_mul_f32 v169, v169, v249
  v_mul_f32 v250, v154, v154
  v_mfma_f32_32x32x16_bf16 v[176:191], v[224:227], v[84:87], v[176:191]
  ds_read_b128 v[220:223], v3 offset:52224
  v_mul_f32 v251, v155, v155
  v_fma_f32 v250, v250, v245, v244
  v_fma_f32 v251, v251, v245, v244
  v_mfma_f32_32x32x16_bf16 v[192:207], v[228:231], v[84:87], v[192:207]
  ds_read_b128 v[224:227], v3 offset:20480
  v_mul_f32 v250, v250, v154
  v_mul_f32 v251, v251, v155
  v_exp_f32 v250, v250
  s_waitcnt lgkmcnt(2)
  v_mfma_f32_32x32x16_bf16 v[176:191], v[208:211], v[88:91], v[176:191]
  ds_read_b128 v[228:231], v3 offset:53248
  v_exp_f32 v251, v251
  v_mul_f32 v170, v170, v154
  v_mfma_f32_32x32x16_bf16 v[192:207], v[212:215], v[88:91], v[192:207]
  ds_read_b128 v[208:211], v3 offset:21504
  v_mul_f32 v171, v171, v155
  v_fma_f32 v250, v250, v246, v246
  v_fma_f32 v251, v251, v246, v246
  v_mfma_f32_32x32x16_bf16 v[176:191], v[216:219], v[92:95], v[176:191]
  ds_read_b128 v[212:215], v3 offset:54272
  v_rcp_f32 v250, v250
  v_rcp_f32 v251, v251
  s_waitcnt lgkmcnt(2)
  v_mfma_f32_32x32x16_bf16 v[192:207], v[220:223], v[92:95], v[192:207]
  ds_read_b128 v[216:219], v3 offset:22528
  v_cvt_pk_bf16_f32 v148, v168, v169
  v_mul_f32 v170, v170, v250
  v_mul_f32 v171, v171, v251
  v_mfma_f32_32x32x16_bf16 v[176:191], v[224:227], v[96:99], v[176:191]
  ds_read_b128 v[220:223], v3 offset:55296
  v_mul_f32 v252, v156, v156
  v_mul_f32 v253, v157, v157
  v_fma_f32 v252, v252, v245, v244
  v_mfma_f32_32x32x16_bf16 v[192:207], v[228:231], v[96:99], v[192:207]
  ds_read_b128 v[224:227], v3 offset:23552
  v_fma_f32 v253, v253, v245, v244
  v_mul_f32 v252, v252, v156
  v_mul_f32 v253, v253, v157
  s_waitcnt lgkmcnt(2)
  v_mfma_f32_32x32x16_bf16 v[176:191], v[208:211], v[100:103], v[176:191]
  ds_read_b128 v[228:231], v3 offset:56320
  v_exp_f32 v252, v252
  v_exp_f32 v253, v253
  v_mfma_f32_32x32x16_bf16 v[192:207], v[212:215], v[100:103], v[192:207]
  ds_read_b128 v[208:211], v3 offset:24576
  v_mul_f32 v172, v172, v156
  v_mul_f32 v173, v173, v157
  v_fma_f32 v252, v252, v246, v246
  v_mfma_f32_32x32x16_bf16 v[176:191], v[216:219], v[104:107], v[176:191]
  ds_read_b128 v[212:215], v3 offset:57344
  v_fma_f32 v253, v253, v246, v246
  v_rcp_f32 v252, v252
  s_waitcnt lgkmcnt(2)
  v_mfma_f32_32x32x16_bf16 v[192:207], v[220:223], v[104:107], v[192:207]
  ds_read_b128 v[216:219], v3 offset:25600
  v_rcp_f32 v253, v253
  v_cvt_pk_bf16_f32 v149, v170, v171
  v_mfma_f32_32x32x16_bf16 v[176:191], v[224:227], v[108:111], v[176:191]
  ds_read_b128 v[220:223], v3 offset:58368
  v_mul_f32 v172, v172, v252
  v_mul_f32 v173, v173, v253
  v_mul_f32 v254, v158, v158
  v_mfma_f32_32x32x16_bf16 v[192:207], v[228:231], v[108:111], v[192:207]
  ds_read_b128 v[224:227], v3 offset:26624
  v_mul_f32 v255, v159, v159
  v_fma_f32 v254, v254, v245, v244
  v_fma_f32 v255, v255, v245, v244
  s_waitcnt lgkmcnt(2)
  v_mfma_f32_32x32x16_bf16 v[176:191], v[208:211], v[112:115], v[176:191]
  ds_read_b128 v[228:231], v3 offset:59392
  v_mul_f32 v254, v254, v158
  v_mul_f32 v255, v255, v159
  v_exp_f32 v254, v254
  v_mfma_f32_32x32x16_bf16 v[192:207], v[212:215], v[112:115], v[192:207]
  ds_read_b128 v[208:211], v3 offset:27648
  v_exp_f32 v255, v255
  v_mul_f32 v174, v174, v158
  v_mfma_f32_32x32x16_bf16 v[176:191], v[216:219], v[116:119], v[176:191]
  ds_read_b128 v[212:215], v3 offset:60416
  v_mul_f32 v175, v175, v159
  v_fma_f32 v254, v254, v246, v246
  v_fma_f32 v255, v255, v246, v246
  s_waitcnt lgkmcnt(2)
  v_mfma_f32_32x32x16_bf16 v[192:207], v[220:223], v[116:119], v[192:207]
  ds_read_b128 v[216:219], v3 offset:28672
  v_rcp_f32 v254, v254
  v_rcp_f32 v255, v255
  ds_read_b32 v7, v14 offset:1536
  v_mfma_f32_32x32x16_bf16 v[176:191], v[224:227], v[120:123], v[176:191]
  ds_read_b128 v[220:223], v3 offset:61440
  v_cvt_pk_bf16_f32 v150, v172, v173
  v_mul_f32 v174, v174, v254
  v_mul_f32 v175, v175, v255
  v_mfma_f32_32x32x16_bf16 v[192:207], v[228:231], v[120:123], v[192:207]
  ds_read_b128 v[224:227], v3 offset:29696
  v_cvt_pk_bf16_f32 v151, v174, v175
  s_add_u32 s46, s28, 0
  s_add_u32 s47, s28, 44032
  buffer_store_dwordx4 v[144:147], v1, s[4:7], s46 offen sc1
  buffer_store_dwordx4 v[148:151], v1, s[4:7], s47 offen sc1
  s_waitcnt lgkmcnt(3)
  v_mfma_f32_32x32x16_bf16 v[176:191], v[208:211], v[124:127], v[176:191]
  ds_read_b128 v[228:231], v3 offset:62464
  v_mfma_f32_32x32x16_bf16 v[192:207], v[212:215], v[124:127], v[192:207]
  ds_read_b128 v[208:211], v3 offset:30720
  v_mfma_f32_32x32x16_bf16 v[176:191], v[216:219], v[128:131], v[176:191]
  ds_read_b128 v[212:215], v3 offset:63488
  s_waitcnt lgkmcnt(2)
  v_mfma_f32_32x32x16_bf16 v[192:207], v[220:223], v[128:131], v[192:207]
  ds_read_b128 v[216:219], v3 offset:31744
  v_mfma_f32_32x32x16_bf16 v[176:191], v[224:227], v[132:135], v[176:191]
  ds_read_b128 v[220:223], v3 offset:64512
  ds_write_b32 v5, v247 offset:640
  v_cmp_gt_u32 vcc, v247, v7
  s_cbranch_vccnz L_lsl_491
L_lbk_492:
  ds_read_b64 v[224:225], v9 offset:3584
  v_mfma_f32_32x32x16_bf16 v[192:207], v[228:231], v[132:135], v[192:207]
  ds_read_b64 v[228:229], v9 offset:3840
  s_waitcnt lgkmcnt(4)
  v_mfma_f32_32x32x16_bf16 v[176:191], v[208:211], v[136:139], v[176:191]
  v_mfma_f32_32x32x16_bf16 v[192:207], v[212:215], v[136:139], v[192:207]
  ds_read_b128 v[208:211], v3 offset:0
  v_mfma_f32_32x32x16_bf16 v[176:191], v[216:219], v[140:143], v[176:191]
  ds_read_b128 v[212:215], v3 offset:32768
  s_waitcnt lgkmcnt(2)
  v_mfma_f32_32x32x16_bf16 v[192:207], v[220:223], v[140:143], v[192:207]
  ds_read_b128 v[216:219], v3 offset:1024
  v_mfma_f32_32x32x16_bf16 v[176:191], v[224:227], v[240:243], v[176:191]
  ds_read_b128 v[220:223], v3 offset:33792
  v_mfma_f32_32x32x16_bf16 v[192:207], v[228:231], v[240:243], v[192:207]
  ds_read_b128 v[224:227], v3 offset:2048
  s_cmp_eq_u32 s15, 0
  s_nop 9
  s_cbranch_scc1 L_lights
  s_waitcnt lgkmcnt(2)
  v_mfma_f32_32x32x16_bf16 v[144:159], v[208:211], v[16:19], 0
  ds_read_b128 v[228:231], v3 offset:34816
  v_mfma_f32_32x32x16_bf16 v[160:175], v[212:215], v[16:19], 0
  buffer_load_dwordx4 v[16:19], v1, s[4:7], s29 offen offset:0 sc1
  ds_read_b128 v[208:211], v3 offset:3072
  v_mul_f32 v248, v176, v176
  v_mul_f32 v249, v177, v177
  v_fma_f32 v248, v248, v245, v244
  v_mfma_f32_32x32x16_bf16 v[144:159], v[216:219], v[20:23], v[144:159]
  ds_read_b128 v[212:215], v3 offset:35840
  v_fma_f32 v249, v249, v245, v244
  v_mul_f32 v248, v248, v176
  v_mul_f32 v249, v249, v177
  s_waitcnt lgkmcnt(2)
  v_mfma_f32_32x32x16_bf16 v[160:175], v[220:223], v[20:23], v[160:175]
  buffer_load_dwordx4 v[20:23], v1, s[4:7], s29 offen offset:1024 sc1
  ds_read_b128 v[216:219], v3 offset:4096
  v_exp_f32 v248, v248
  v_exp_f32 v249, v249
  v_mfma_f32_32x32x16_bf16 v[144:159], v[224:227], v[24:27], v[144:159]
  ds_read_b128 v[220:223], v3 offset:36864
  v_mul_f32 v192, v192, v176
  v_mul_f32 v193, v193, v177
  v_fma_f32 v248, v248, v246, v246
  v_mfma_f32_32x32x16_bf16 v[160:175], v[228:231], v[24:27], v[160:175]
  buffer_load_dwordx4 v[24:27], v1, s[4:7], s29 offen offset:2048 sc1
  ds_read_b128 v[224:227], v3 offset:5120
  v_fma_f32 v249, v249, v246, v246
  v_rcp_f32 v248, v248
  s_waitcnt lgkmcnt(2)
  v_mfma_f32_32x32x16_bf16 v[144:159], v[208:211], v[28:31], v[144:159]
  ds_read_b128 v[228:231], v3 offset:37888
  v_rcp_f32 v249, v249
  v_nop
  v_mfma_f32_32x32x16_bf16 v[160:175], v[212:215], v[28:31], v[160:175]
  buffer_load_dwordx4 v[28:31], v1, s[4:7], s29 offen offset:3072 sc1
  ds_read_b128 v[208:211], v3 offset:6144
  v_mul_f32 v192, v192, v248
  v_mul_f32 v193, v193, v249
  v_mul_f32 v250, v178, v178
  v_mfma_f32_32x32x16_bf16 v[144:159], v[216:219], v[32:35], v[144:159]
  ds_read_b128 v[212:215], v3 offset:38912
  v_mul_f32 v251, v179, v179
  v_fma_f32 v250, v250, v245, v244
  v_fma_f32 v251, v251, v245, v244
  s_waitcnt lgkmcnt(2)
  v_mfma_f32_32x32x16_bf16 v[160:175], v[220:223], v[32:35], v[160:175]
  s_add_u32 s32, s29, 4096
  buffer_load_dwordx4 v[32:35], v1, s[4:7], s32 offen offset:0 sc1
  ds_read_b128 v[216:219], v3 offset:7168
  v_mul_f32 v250, v250, v178
  v_mul_f32 v251, v251, v179
  v_exp_f32 v250, v250
  v_mfma_f32_32x32x16_bf16 v[144:159], v[224:227], v[36:39], v[144:159]
  ds_read_b128 v[220:223], v3 offset:39936
  v_exp_f32 v251, v251
  v_mul_f32 v194, v194, v178
  v_mfma_f32_32x32x16_bf16 v[160:175], v[228:231], v[36:39], v[160:175]
  buffer_load_dwordx4 v[36:39], v1, s[4:7], s32 offen offset:1024 sc1
  ds_read_b128 v[224:227], v3 offset:8192
  v_mul_f32 v195, v195, v179
  v_fma_f32 v250, v250, v246, v246
  v_fma_f32 v251, v251, v246, v246
  s_waitcnt lgkmcnt(2)
  v_mfma_f32_32x32x16_bf16 v[144:159], v[208:211], v[40:43], v[144:159]
  ds_read_b128 v[228:231], v3 offset:40960
  v_rcp_f32 v250, v250
  v_rcp_f32 v251, v251
  v_mfma_f32_32x32x16_bf16 v[160:175], v[212:215], v[40:43], v[160:175]
  buffer_load_dwordx4 v[40:43], v1, s[4:7], s32 offen offset:2048 sc1
  ds_read_b128 v[208:211], v3 offset:9216
  v_cvt_pk_bf16_f32 v176, v192, v193
  v_mul_f32 v194, v194, v250
  v_mul_f32 v195, v195, v251
  v_mfma_f32_32x32x16_bf16 v[144:159], v[216:219], v[44:47], v[144:159]
  ds_read_b128 v[212:215], v3 offset:41984
  v_mul_f32 v252, v180, v180
  v_mul_f32 v253, v181, v181
  v_fma_f32 v252, v252, v245, v244
  s_waitcnt lgkmcnt(2)
  v_mfma_f32_32x32x16_bf16 v[160:175], v[220:223], v[44:47], v[160:175]
  buffer_load_dwordx4 v[44:47], v1, s[4:7], s32 offen offset:3072 sc1
  ds_read_b128 v[216:219], v3 offset:10240
  v_fma_f32 v253, v253, v245, v244
  v_mul_f32 v252, v252, v180
  v_mul_f32 v253, v253, v181
  ds_read_b32 v7, v14 offset:1600
  v_mfma_f32_32x32x16_bf16 v[144:159], v[224:227], v[48:51], v[144:159]
  ds_read_b128 v[220:223], v3 offset:43008
  v_exp_f32 v252, v252
  v_exp_f32 v253, v253
  v_mfma_f32_32x32x16_bf16 v[160:175], v[228:231], v[48:51], v[160:175]
  s_add_u32 s32, s29, 8192
  buffer_load_dwordx4 v[48:51], v1, s[4:7], s32 offen offset:0 sc1
  ds_read_b128 v[224:227], v3 offset:11264
  v_mul_f32 v196, v196, v180
  v_mul_f32 v197, v197, v181
  v_fma_f32 v252, v252, v246, v246
  s_waitcnt lgkmcnt(3)
  v_mfma_f32_32x32x16_bf16 v[144:159], v[208:211], v[52:55], v[144:159]
  ds_read_b128 v[228:231], v3 offset:44032
  v_fma_f32 v253, v253, v246, v246
  v_rcp_f32 v252, v252
  v_mfma_f32_32x32x16_bf16 v[160:175], v[212:215], v[52:55], v[160:175]
  buffer_load_dwordx4 v[52:55], v1, s[4:7], s32 offen offset:1024 sc1
  ds_read_b128 v[208:211], v3 offset:12288
  v_rcp_f32 v253, v253
  v_cvt_pk_bf16_f32 v177, v194, v195
  v_mfma_f32_32x32x16_bf16 v[144:159], v[216:219], v[56:59], v[144:159]
  ds_read_b128 v[212:215], v3 offset:45056
  v_mul_f32 v196, v196, v252
  v_mul_f32 v197, v197, v253
  v_mul_f32 v254, v182, v182
  s_waitcnt lgkmcnt(2)
  v_mfma_f32_32x32x16_bf16 v[160:175], v[220:223], v[56:59], v[160:175]
  buffer_load_dwordx4 v[56:59], v1, s[4:7], s32 offen offset:2048 sc1
  ds_read_b128 v[216:219], v3 offset:13312
  v_mul_f32 v255, v183, v183
  v_fma_f32 v254, v254, v245, v244
  v_fma_f32 v255, v255, v245, v244
  v_mfma_f32_32x32x16_bf16 v[144:159], v[224:227], v[60:63], v[144:159]
  ds_read_b128 v[220:223], v3 offset:46080
  v_mul_f32 v254, v254, v182
  v_mul_f32 v255, v255, v183
  v_exp_f32 v254, v254
  v_mfma_f32_32x32x16_bf16 v[160:175], v[228:231], v[60:63], v[160:175]
  buffer_load_dwordx4 v[60:63], v1, s[4:7], s32 offen offset:3072 sc1
  ds_read_b128 v[224:227], v3 offset:14336
  v_exp_f32 v255, v255
  v_mul_f32 v198, v198, v182
  s_waitcnt lgkmcnt(2)
  v_mfma_f32_32x32x16_bf16 v[144:159], v[208:211], v[64:67], v[144:159]
  ds_read_b128 v[228:231], v3 offset:47104
  v_mul_f32 v199, v199, v183
  v_fma_f32 v254, v254, v246, v246
  v_fma_f32 v255, v255, v246, v246
  v_mfma_f32_32x32x16_bf16 v[160:175], v[212:215], v[64:67], v[160:175]
  s_add_u32 s32, s29, 12288
  buffer_load_dwordx4 v[64:67], v1, s[4:7], s32 offen offset:0 sc1
  ds_read_b128 v[208:211], v3 offset:15360
  v_rcp_f32 v254, v254
  v_rcp_f32 v255, v255
  v_mfma_f32_32x32x16_bf16 v[144:159], v[216:219], v[68:71], v[144:159]
  ds_read_b128 v[212:215], v3 offset:48128
  v_cvt_pk_bf16_f32 v178, v196, v197
  v_mul_f32 v198, v198, v254
  v_mul_f32 v199, v199, v255
  v_cmp_gt_u32 vcc, v247, v7
  s_cbranch_vccnz L_lsl_493
L_lbk_494:
  ds_write_b32 v5, v247 offset:704
  s_waitcnt lgkmcnt(3)
  v_mfma_f32_32x32x16_bf16 v[160:175], v[220:223], v[68:71], v[160:175]
  buffer_load_dwordx4 v[68:71], v1, s[4:7], s32 offen offset:1024 sc1
  ds_read_b128 v[216:219], v3 offset:16384
  v_mul_f32 v248, v184, v184
  v_mul_f32 v249, v185, v185
  v_fma_f32 v248, v248, v245, v244
  v_mfma_f32_32x32x16_bf16 v[144:159], v[224:227], v[72:75], v[144:159]
  ds_read_b128 v[220:223], v3 offset:49152
  v_fma_f32 v249, v249, v245, v244
  v_mul_f32 v248, v248, v184
  v_mul_f32 v249, v249, v185
  v_mfma_f32_32x32x16_bf16 v[160:175], v[228:231], v[72:75], v[160:175]
  buffer_load_dwordx4 v[72:75], v1, s[4:7], s32 offen offset:2048 sc1
  ds_read_b128 v[224:227], v3 offset:17408
  v_exp_f32 v248, v248
  v_exp_f32 v249, v249
  s_waitcnt lgkmcnt(2)
  v_mfma_f32_32x32x16_bf16 v[144:159], v[208:211], v[76:79], v[144:159]
  ds_read_b128 v[228:231], v3 offset:50176
  v_mul_f32 v200, v200, v184
  v_mul_f32 v201, v201, v185
  v_fma_f32 v248, v248, v246, v246
  v_mfma_f32_32x32x16_bf16 v[160:175], v[212:215], v[76:79], v[160:175]
  buffer_load_dwordx4 v[76:79], v1, s[4:7], s32 offen offset:3072 sc1
  ds_read_b128 v[208:211], v3 offset:18432
  v_fma_f32 v249, v249, v246, v246
  v_rcp_f32 v248, v248
  v_mfma_f32_32x32x16_bf16 v[144:159], v[216:219], v[80:83], v[144:159]
  ds_read_b128 v[212:215], v3 offset:51200
  v_rcp_f32 v249, v249
  v_cvt_pk_bf16_f32 v179, v198, v199
  s_waitcnt lgkmcnt(2)
  v_mfma_f32_32x32x16_bf16 v[160:175], v[220:223], v[80:83], v[160:175]
  ds_read_b128 v[216:219], v3 offset:19456
  v_mul_f32 v200, v200, v248
  v_mul_f32 v201, v201, v249
  v_mul_f32 v250, v186, v186
  v_mfma_f32_32x32x16_bf16 v[144:159], v[224:227], v[84:87], v[144:159]
  ds_read_b128 v[220:223], v3 offset:52224
  v_mul_f32 v251, v187, v187
  v_fma_f32 v250, v250, v245, v244
  v_fma_f32 v251, v251, v245, v244
  v_mfma_f32_32x32x16_bf16 v[160:175], v[228:231], v[84:87], v[160:175]
  ds_read_b128 v[224:227], v3 offset:20480
  v_mul_f32 v250, v250, v186
  v_mul_f32 v251, v251, v187
  v_exp_f32 v250, v250
  s_waitcnt lgkmcnt(2)
  v_mfma_f32_32x32x16_bf16 v[144:159], v[208:211], v[88:91], v[144:159]
  ds_read_b128 v[228:231], v3 offset:53248
  v_exp_f32 v251, v251
  v_mul_f32 v202, v202, v186
  v_mfma_f32_32x32x16_bf16 v[160:175], v[212:215], v[88:91], v[160:175]
  ds_read_b128 v[208:211], v3 offset:21504
  v_mul_f32 v203, v203, v187
  v_fma_f32 v250, v250, v246, v246
  v_fma_f32 v251, v251, v246, v246
  v_mfma_f32_32x32x16_bf16 v[144:159], v[216:219], v[92:95], v[144:159]
  ds_read_b128 v[212:215], v3 offset:54272
  v_rcp_f32 v250, v250
  v_rcp_f32 v251, v251
  s_waitcnt lgkmcnt(2)
  v_mfma_f32_32x32x16_bf16 v[160:175], v[220:223], v[92:95], v[160:175]
  ds_read_b128 v[216:219], v3 offset:22528
  v_cvt_pk_bf16_f32 v180, v200, v201
  v_mul_f32 v202, v202, v250
  v_mul_f32 v203, v203, v251
  v_mfma_f32_32x32x16_bf16 v[144:159], v[224:227], v[96:99], v[144:159]
  ds_read_b128 v[220:223], v3 offset:55296
  v_mul_f32 v252, v188, v188
  v_mul_f32 v253, v189, v189
  v_fma_f32 v252, v252, v245, v244
  v_mfma_f32_32x32x16_bf16 v[160:175], v[228:231], v[96:99], v[160:175]
  ds_read_b128 v[224:227], v3 offset:23552
  v_fma_f32 v253, v253, v245, v244
  v_mul_f32 v252, v252, v188
  v_mul_f32 v253, v253, v189
  s_waitcnt lgkmcnt(2)
  v_mfma_f32_32x32x16_bf16 v[144:159], v[208:211], v[100:103], v[144:159]
  ds_read_b128 v[228:231], v3 offset:56320
  v_exp_f32 v252, v252
  v_exp_f32 v253, v253
  v_mfma_f32_32x32x16_bf16 v[160:175], v[212:215], v[100:103], v[160:175]
  ds_read_b128 v[208:211], v3 offset:24576
  v_mul_f32 v204, v204, v188
  v_mul_f32 v205, v205, v189
  v_fma_f32 v252, v252, v246, v246
  v_mfma_f32_32x32x16_bf16 v[144:159], v[216:219], v[104:107], v[144:159]
  ds_read_b128 v[212:215], v3 offset:57344
  v_fma_f32 v253, v253, v246, v246
  v_rcp_f32 v252, v252
  s_waitcnt lgkmcnt(2)
  v_mfma_f32_32x32x16_bf16 v[160:175], v[220:223], v[104:107], v[160:175]
  ds_read_b128 v[216:219], v3 offset:25600
  v_rcp_f32 v253, v253
  v_cvt_pk_bf16_f32 v181, v202, v203
  v_mfma_f32_32x32x16_bf16 v[144:159], v[224:227], v[108:111], v[144:159]
  ds_read_b128 v[220:223], v3 offset:58368
  v_mul_f32 v204, v204, v252
  v_mul_f32 v205, v205, v253
  v_mul_f32 v254, v190, v190
  v_mfma_f32_32x32x16_bf16 v[160:175], v[228:231], v[108:111], v[160:175]
  ds_read_b128 v[224:227], v3 offset:26624
  v_mul_f32 v255, v191, v191
  v_fma_f32 v254, v254, v245, v244
  v_fma_f32 v255, v255, v245, v244
  s_waitcnt lgkmcnt(2)
  v_mfma_f32_32x32x16_bf16 v[144:159], v[208:211], v[112:115], v[144:159]
  ds_read_b128 v[228:231], v3 offset:59392
  v_mul_f32 v254, v254, v190
  v_mul_f32 v255, v255, v191
  v_exp_f32 v254, v254
  v_mfma_f32_32x32x16_bf16 v[160:175], v[212:215], v[112:115], v[160:175]
  ds_read_b128 v[208:211], v3 offset:27648
  v_exp_f32 v255, v255
  v_mul_f32 v206, v206, v190
  v_mfma_f32_32x32x16_bf16 v[144:159], v[216:219], v[116:119], v[144:159]
  ds_read_b128 v[212:215], v3 offset:60416
  v_mul_f32 v207, v207, v191
  v_fma_f32 v254, v254, v246, v246
  v_fma_f32 v255, v255, v246, v246
  s_waitcnt lgkmcnt(2)
  v_mfma_f32_32x32x16_bf16 v[160:175], v[220:223], v[116:119], v[160:175]
  ds_read_b128 v[216:219], v3 offset:28672
  v_rcp_f32 v254, v254
  v_rcp_f32 v255, v255
  ds_read_b32 v7, v14 offset:1664
  v_mfma_f32_32x32x16_bf16 v[144:159], v[224:227], v[120:123], v[144:159]
  ds_read_b128 v[220:223], v3 offset:61440
  v_cvt_pk_bf16_f32 v182, v204, v205
  v_mul_f32 v206, v206, v254
  v_mul_f32 v207, v207, v255
  v_mfma_f32_32x32x16_bf16 v[160:175], v[228:231], v[120:123], v[160:175]
  ds_read_b128 v[224:227], v3 offset:29696
  v_cvt_pk_bf16_f32 v183, v206, v207
  s_add_u32 s46, s28, 16384
  s_add_u32 s47, s28, 60416
  buffer_store_dwordx4 v[176:179], v1, s[4:7], s46 offen sc1
  buffer_store_dwordx4 v[180:183], v1, s[4:7], s47 offen sc1
  s_lshl_b32 s47, s14, 12
  s_waitcnt lgkmcnt(3)
  v_mfma_f32_32x32x16_bf16 v[144:159], v[208:211], v[124:127], v[144:159]
  ds_read_b128 v[228:231], v3 offset:62464
  s_xor_b32 s48, s47, 8192
  s_add_u32 s47, s47, 73728
  s_add_u32 s48, s48, 73728
  v_mfma_f32_32x32x16_bf16 v[160:175], v[212:215], v[124:127], v[160:175]
  ds_read_b128 v[208:211], v3 offset:30720
  v_add_u32 v12, s47, v1
  v_add_u32 v13, s48, v1
  v_lshlrev_b32 v176, 16, v232
  v_mfma_f32_32x32x16_bf16 v[144:159], v[216:219], v[128:131], v[144:159]
  ds_read_b128 v[212:215], v3 offset:63488
  v_and_b32 v177, s54, v232
  v_lshlrev_b32 v178, 16, v233
  v_and_b32 v179, s54, v233
  s_waitcnt lgkmcnt(2)
  v_mfma_f32_32x32x16_bf16 v[160:175], v[220:223], v[128:131], v[160:175]
  ds_read_b128 v[216:219], v3 offset:31744
  v_lshlrev_b32 v180, 16, v234
  v_and_b32 v181, s54, v234
  v_lshlrev_b32 v182, 16, v235
  v_mfma_f32_32x32x16_bf16 v[144:159], v[224:227], v[132:135], v[144:159]
  ds_read_b128 v[220:223], v3 offset:64512
  v_and_b32 v183, s54, v235
  v_lshlrev_b32 v184, 16, v236
  v_and_b32 v185, s54, v236
  ds_write_b32 v5, v247 offset:768
  v_cmp_gt_u32 vcc, v247, v7
  s_cbranch_vccnz L_lsl_495
L_lbk_496:
  ds_read_b64 v[224:225], v9 offset:4096
  v_mfma_f32_32x32x16_bf16 v[160:175], v[228:231], v[132:135], v[160:175]
  v_lshlrev_b32 v186, 16, v237
  v_and_b32 v187, s54, v237
  v_lshlrev_b32 v188, 16, v238
  ds_read_b64 v[228:229], v9 offset:4352
  s_waitcnt lgkmcnt(4)
  v_mfma_f32_32x32x16_bf16 v[144:159], v[208:211], v[136:139], v[144:159]
  v_and_b32 v189, s54, v238
  v_lshlrev_b32 v190, 16, v239
  v_and_b32 v191, s54, v239
  s_lshr_b32 s46, s14, 1
  s_mul_i32 s47, s46, 2560
  s_add_u32 s47, s47, 98304
  s_xor_b32 s48, s47, 512
  v_add_u32 v10, s47, v0
  v_add_u32 v11, s48, v0
  v_mfma_f32_32x32x16_bf16 v[160:175], v[212:215], v[136:139], v[160:175]
  ds_read_b64_tr_b16 v[208:209], v10 offset:40960
  ds_read_b64_tr_b16 v[210:211], v10 offset:41216
  v_mfma_f32_32x32x16_bf16 v[144:159], v[216:219], v[140:143], v[144:159]
  ds_read_b64_tr_b16 v[212:213], v11 offset:40960
  ds_read_b64_tr_b16 v[214:215], v11 offset:41216
  s_waitcnt lgkmcnt(4)
  v_mfma_f32_32x32x16_bf16 v[160:175], v[220:223], v[140:143], v[160:175]
  ds_read_b64_tr_b16 v[216:217], v10 offset:45056
  ds_read_b64_tr_b16 v[218:219], v10 offset:45312
  v_mfma_f32_32x32x16_bf16 v[144:159], v[224:227], v[240:243], v[144:159]
  ds_read_b64_tr_b16 v[220:221], v11 offset:45056
  ds_read_b64_tr_b16 v[222:223], v11 offset:45312
  v_mfma_f32_32x32x16_bf16 v[160:175], v[228:231], v[240:243], v[160:175]
  ds_read_b64_tr_b16 v[224:225], v10 offset:49152
  ds_read_b64_tr_b16 v[226:227], v10 offset:49408
  s_nop 3
  v_pk_mul_f32 v[248:249], v[144:145], v[144:145]
  v_pk_mul_f32 v[250:251], v[146:147], v[146:147]
  v_pk_mul_f32 v[252:253], v[148:149], v[148:149]
  v_pk_mul_f32 v[254:255], v[150:151], v[150:151]
  v_pk_fma_f32 v[248:249], v[248:249], v[244:245], v[244:245] op_sel:[0,1,0] op_sel_hi:[1,1,0]
  v_pk_fma_f32 v[250:251], v[250:251], v[244:245], v[244:245] op_sel:[0,1,0] op_sel_hi:[1,1,0]
  v_pk_fma_f32 v[252:253], v[252:253], v[244:245], v[244:245] op_sel:[0,1,0] op_sel_hi:[1,1,0]
  v_pk_fma_f32 v[254:255], v[254:255], v[244:245], v[244:245] op_sel:[0,1,0] op_sel_hi:[1,1,0]
  v_pk_mul_f32 v[248:249], v[248:249], v[144:145]
  v_pk_mul_f32 v[250:251], v[250:251], v[146:147]
  v_pk_mul_f32 v[252:253], v[252:253], v[148:149]
  v_pk_mul_f32 v[254:255], v[254:255], v[150:151]
  v_exp_f32 v248, v248
  v_exp_f32 v249, v249
  v_exp_f32 v250, v250
  v_exp_f32 v251, v251
  v_exp_f32 v252, v252
  v_exp_f32 v253, v253
  v_exp_f32 v254, v254
  v_exp_f32 v255, v255
  v_pk_mul_f32 v[160:161], v[160:161], v[144:145]
  v_pk_mul_f32 v[162:163], v[162:163], v[146:147]
  v_pk_mul_f32 v[164:165], v[164:165], v[148:149]
  v_pk_mul_f32 v[166:167], v[166:167], v[150:151]
  v_pk_fma_f32 v[248:249], v[248:249], v[246:247], v[246:247] op_sel_hi:[1,0,0]
  v_pk_fma_f32 v[250:251], v[250:251], v[246:247], v[246:247] op_sel_hi:[1,0,0]
  v_pk_fma_f32 v[252:253], v[252:253], v[246:247], v[246:247] op_sel_hi:[1,0,0]
  v_pk_fma_f32 v[254:255], v[254:255], v[246:247], v[246:247] op_sel_hi:[1,0,0]
  v_rcp_f32 v248, v248
  v_rcp_f32 v249, v249
  v_rcp_f32 v250, v250
  v_rcp_f32 v251, v251
  v_rcp_f32 v252, v252
  v_rcp_f32 v253, v253
  v_rcp_f32 v254, v254
  v_rcp_f32 v255, v255
  v_pk_mul_f32 v[160:161], v[160:161], v[248:249]
  v_pk_mul_f32 v[162:163], v[162:163], v[250:251]
  v_pk_mul_f32 v[164:165], v[164:165], v[252:253]
  v_pk_mul_f32 v[166:167], v[166:167], v[254:255]
  v_cvt_pk_bf16_f32 v144, v160, v161
  v_cvt_pk_bf16_f32 v145, v162, v163
  v_cvt_pk_bf16_f32 v146, v164, v165
  v_cvt_pk_bf16_f32 v147, v166, v167
  v_pk_mul_f32 v[248:249], v[152:153], v[152:153]
  v_pk_mul_f32 v[250:251], v[154:155], v[154:155]
  v_pk_mul_f32 v[252:253], v[156:157], v[156:157]
  v_pk_mul_f32 v[254:255], v[158:159], v[158:159]
  v_pk_fma_f32 v[248:249], v[248:249], v[244:245], v[244:245] op_sel:[0,1,0] op_sel_hi:[1,1,0]
  v_pk_fma_f32 v[250:251], v[250:251], v[244:245], v[244:245] op_sel:[0,1,0] op_sel_hi:[1,1,0]
  v_pk_fma_f32 v[252:253], v[252:253], v[244:245], v[244:245] op_sel:[0,1,0] op_sel_hi:[1,1,0]
  v_pk_fma_f32 v[254:255], v[254:255], v[244:245], v[244:245] op_sel:[0,1,0] op_sel_hi:[1,1,0]
  v_pk_mul_f32 v[248:249], v[248:249], v[152:153]
  v_pk_mul_f32 v[250:251], v[250:251], v[154:155]
  v_pk_mul_f32 v[252:253], v[252:253], v[156:157]
  v_pk_mul_f32 v[254:255], v[254:255], v[158:159]
  v_exp_f32 v248, v248
  v_exp_f32 v249, v249
  v_exp_f32 v250, v250
  v_exp_f32 v251, v251
  v_exp_f32 v252, v252
  v_exp_f32 v253, v253
  v_exp_f32 v254, v254
  v_exp_f32 v255, v255
  v_pk_mul_f32 v[168:169], v[168:169], v[152:153]
  v_pk_mul_f32 v[170:171], v[170:171], v[154:155]
  v_pk_mul_f32 v[172:173], v[172:173], v[156:157]
  v_pk_mul_f32 v[174:175], v[174:175], v[158:159]
  v_pk_fma_f32 v[248:249], v[248:249], v[246:247], v[246:247] op_sel_hi:[1,0,0]
  v_pk_fma_f32 v[250:251], v[250:251], v[246:247], v[246:247] op_sel_hi:[1,0,0]
  v_pk_fma_f32 v[252:253], v[252:253], v[246:247], v[246:247] op_sel_hi:[1,0,0]
  v_pk_fma_f32 v[254:255], v[254:255], v[246:247], v[246:247] op_sel_hi:[1,0,0]
  v_rcp_f32 v248, v248
  v_rcp_f32 v249, v249
  v_rcp_f32 v250, v250
  v_rcp_f32 v251, v251
  v_rcp_f32 v252, v252
  v_rcp_f32 v253, v253
  v_rcp_f32 v254, v254
  v_rcp_f32 v255, v255
  v_pk_mul_f32 v[168:169], v[168:169], v[248:249]
  v_pk_mul_f32 v[170:171], v[170:171], v[250:251]
  v_pk_mul_f32 v[172:173], v[172:173], v[252:253]
  v_pk_mul_f32 v[174:175], v[174:175], v[254:255]
  v_cvt_pk_bf16_f32 v148, v168, v169
  v_cvt_pk_bf16_f32 v149, v170, v171
  v_cvt_pk_bf16_f32 v150, v172, v173
  v_cvt_pk_bf16_f32 v151, v174, v175
  s_add_u32 s46, s28, 32768
  s_add_u32 s47, s28, 76800
  buffer_store_dwordx4 v[144:147], v1, s[4:7], s46 offen sc1
  buffer_store_dwordx4 v[148:151], v1, s[4:7], s47 offen sc1
  s_waitcnt vmcnt(18)
  v_max_u32 v15, v16, v20
  v_cmp_eq_u32 vcc, -1, v15
  s_cbranch_vccnz L_pl_497
L_plb_498:
  s_waitcnt lgkmcnt(4)
  v_mfma_f32_32x32x16_bf16 v[176:191], v[208:211], v[16:19], v[176:191]
  ds_read_b64_tr_b16 v[228:229], v11 offset:49152
  ds_read_b64_tr_b16 v[230:231], v11 offset:49408
  v_mfma_f32_32x32x16_bf16 v[192:207], v[212:215], v[16:19], 0
  ds_read_b64_tr_b16 v[208:209], v10 offset:53248
  ds_read_b64_tr_b16 v[210:211], v10 offset:53504
  s_waitcnt vmcnt(16)
  v_max_u32 v15, v24, v28
  v_mfma_f32_32x32x16_bf16 v[176:191], v[216:219], v[20:23], v[176:191]
  ds_read_b64_tr_b16 v[212:213], v11 offset:53248
  ds_read_b64_tr_b16 v[214:215], v11 offset:53504
  v_cmp_eq_u32 vcc, -1, v15
  s_waitcnt lgkmcnt(4)
  v_mfma_f32_32x32x16_bf16 v[192:207], v[220:223], v[20:23], v[192:207]
  s_add_u32 s32, s29, 16384
  buffer_load_dwordx4 v[80:83], v1, s[4:7], s32 offen offset:0 sc1
  ds_read_b64_tr_b16 v[216:217], v10 offset:57344
  ds_read_b64_tr_b16 v[218:219], v10 offset:57600
  s_cbranch_vccnz L_pl_503
L_plb_504:
  v_mfma_f32_32x32x16_bf16 v[176:191], v[224:227], v[24:27], v[176:191]
  ds_read_b64_tr_b16 v[220:221], v11 offset:57344
  ds_read_b64_tr_b16 v[222:223], v11 offset:57600
  v_mfma_f32_32x32x16_bf16 v[192:207], v[228:231], v[24:27], v[192:207]
  buffer_load_dwordx4 v[84:87], v1, s[4:7], s32 offen offset:1024 sc1
  ds_read_b64_tr_b16 v[224:225], v10 offset:61440
  ds_read_b64_tr_b16 v[226:227], v10 offset:61696
  s_waitcnt vmcnt(14)
  v_max3_u32 v15, v32, v36, v40
  v_max_u32 v15, v15, v44
  s_waitcnt lgkmcnt(4)
  v_mfma_f32_32x32x16_bf16 v[176:191], v[208:211], v[28:31], v[176:191]
  ds_read_b64_tr_b16 v[228:229], v11 offset:61440
  ds_read_b64_tr_b16 v[230:231], v11 offset:61696
  v_cmp_eq_u32 vcc, -1, v15
  ds_write_b32 v5, v247 offset:832
  v_add_u32 v10, 0xfffea000, v10
  v_add_u32 v11, 0xfffea000, v11
  v_mfma_f32_32x32x16_bf16 v[192:207], v[212:215], v[28:31], v[192:207]
  buffer_load_dwordx4 v[88:91], v1, s[4:7], s32 offen offset:2048 sc1
  ds_read_b64_tr_b16 v[208:209], v10 offset:0
  ds_read_b64_tr_b16 v[210:211], v10 offset:256
  s_cbranch_vccnz L_pl_509
L_plb_510:
  v_mfma_f32_32x32x16_bf16 v[176:191], v[216:219], v[32:35], v[176:191]
  ds_read_b64_tr_b16 v[212:213], v11 offset:0
  ds_read_b64_tr_b16 v[214:215], v11 offset:256
  s_waitcnt lgkmcnt(5)
  v_mfma_f32_32x32x16_bf16 v[192:207], v[220:223], v[32:35], v[192:207]
  buffer_load_dwordx4 v[92:95], v1, s[4:7], s32 offen offset:3072 sc1
  ds_read_b64_tr_b16 v[216:217], v10 offset:4096
  ds_read_b64_tr_b16 v[218:219], v10 offset:4352
  v_mfma_f32_32x32x16_bf16 v[176:191], v[224:227], v[36:39], v[176:191]
  ds_read_b64_tr_b16 v[220:221], v11 offset:4096
  ds_read_b64_tr_b16 v[222:223], v11 offset:4352
  v_mfma_f32_32x32x16_bf16 v[192:207], v[228:231], v[36:39], v[192:207]
  s_add_u32 s32, s29, 20480
  buffer_load_dwordx4 v[96:99], v1, s[4:7], s32 offen offset:0 sc1
  ds_read_b64_tr_b16 v[224:225], v10 offset:8192
  ds_read_b64_tr_b16 v[226:227], v10 offset:8448
  s_waitcnt lgkmcnt(4)
  v_mfma_f32_32x32x16_bf16 v[176:191], v[208:211], v[40:43], v[176:191]
  ds_read_b64_tr_b16 v[228:229], v11 offset:8192
  ds_read_b64_tr_b16 v[230:231], v11 offset:8448
  v_mfma_f32_32x32x16_bf16 v[192:207], v[212:215], v[40:43], v[192:207]
  buffer_load_dwordx4 v[100:103], v1, s[4:7], s32 offen offset:1024 sc1
  ds_read_b64_tr_b16 v[208:209], v10 offset:12288
  ds_read_b64_tr_b16 v[210:211], v10 offset:12544
  s_waitcnt vmcnt(14)
  v_max3_u32 v15, v48, v52, v56
  v_max_u32 v15, v15, v60
  v_mfma_f32_32x32x16_bf16 v[176:191], v[216:219], v[44:47], v[176:191]
  ds_read_b64_tr_b16 v[212:213], v11 offset:12288
  ds_read_b64_tr_b16 v[214:215], v11 offset:12544
  v_cmp_eq_u32 vcc, -1, v15
  s_waitcnt lgkmcnt(4)
  v_mfma_f32_32x32x16_bf16 v[192:207], v[220:223], v[44:47], v[192:207]
  buffer_load_dwordx4 v[104:107], v1, s[4:7], s32 offen offset:2048 sc1
  ds_read_b64_tr_b16 v[216:217], v10 offset:16384
  ds_read_b64_tr_b16 v[218:219], v10 offset:16640
  s_cbranch_vccnz L_pl_514
L_plb_515:
  v_mfma_f32_32x32x16_bf16 v[176:191], v[224:227], v[48:51], v[176:191]
  ds_read_b64_tr_b16 v[220:221], v11 offset:16384
  ds_read_b64_tr_b16 v[222:223], v11 offset:16640
  v_mfma_f32_32x32x16_bf16 v[192:207], v[228:231], v[48:51], v[192:207]
  buffer_load_dwordx4 v[108:111], v1, s[4:7], s32 offen offset:3072 sc1
  ds_read_b64_tr_b16 v[224:225], v10 offset:20480
  ds_read_b64_tr_b16 v[226:227], v10 offset:20736
  s_waitcnt lgkmcnt(4)
  v_mfma_f32_32x32x16_bf16 v[176:191], v[208:211], v[52:55], v[176:191]
  ds_read_b64_tr_b16 v[228:229], v11 offset:20480
  ds_read_b64_tr_b16 v[230:231], v11 offset:20736
  v_mfma_f32_32x32x16_bf16 v[192:207], v[212:215], v[52:55], v[192:207]
  s_add_u32 s32, s29, 24576
  buffer_load_dwordx4 v[112:115], v1, s[4:7], s32 offen offset:0 sc1
  ds_read_b64_tr_b16 v[208:209], v10 offset:24576
  ds_read_b64_tr_b16 v[210:211], v10 offset:24832
  v_mfma_f32_32x32x16_bf16 v[176:191], v[216:219], v[56:59], v[176:191]
  ds_read_b64_tr_b16 v[212:213], v11 offset:24576
  ds_read_b64_tr_b16 v[214:215], v11 offset:24832
  s_waitcnt lgkmcnt(4)
  v_mfma_f32_32x32x16_bf16 v[192:207], v[220:223], v[56:59], v[192:207]
  buffer_load_dwordx4 v[116:119], v1, s[4:7], s32 offen offset:1024 sc1
  ds_read_b64_tr_b16 v[216:217], v10 offset:28672
  ds_read_b64_tr_b16 v[218:219], v10 offset:28928
  s_waitcnt vmcnt(14)
  v_max3_u32 v15, v64, v68, v72
  v_max_u32 v15, v15, v76
  v_mfma_f32_32x32x16_bf16 v[176:191], v[224:227], v[60:63], v[176:191]
  ds_read_b64_tr_b16 v[220:221], v11 offset:28672
  ds_read_b64_tr_b16 v[222:223], v11 offset:28928
  v_cmp_eq_u32 vcc, -1, v15
  v_mfma_f32_32x32x16_bf16 v[192:207], v[228:231], v[60:63], v[192:207]
  buffer_load_dwordx4 v[120:123], v1, s[4:7], s32 offen offset:2048 sc1
  ds_read_b64_tr_b16 v[224:225], v10 offset:32768
  ds_read_b64_tr_b16 v[226:227], v10 offset:33024
  s_cbranch_vccnz L_pl_519
L_plb_520:
  s_waitcnt lgkmcnt(4)
  v_mfma_f32_32x32x16_bf16 v[176:191], v[208:211], v[64:67], v[176:191]
  ds_read_b64_tr_b16 v[228:229], v11 offset:32768
  ds_read_b64_tr_b16 v[230:231], v11 offset:33024
  v_mfma_f32_32x32x16_bf16 v[192:207], v[212:215], v[64:67], v[192:207]
  buffer_load_dwordx4 v[124:127], v1, s[4:7], s32 offen offset:3072 sc1
  ds_read_b64_tr_b16 v[208:209], v10 offset:36864
  ds_read_b64_tr_b16 v[210:211], v10 offset:37120
  v_mfma_f32_32x32x16_bf16 v[176:191], v[216:219], v[68:71], v[176:191]
  ds_read_b64_tr_b16 v[212:213], v11 offset:36864
  ds_read_b64_tr_b16 v[214:215], v11 offset:37120
  s_waitcnt lgkmcnt(4)
  v_mfma_f32_32x32x16_bf16 v[192:207], v[220:223], v[68:71], v[192:207]
  s_add_u32 s32, s29, 28672
  buffer_load_dwordx4 v[128:131], v1, s[4:7], s32 offen offset:0 sc1
  ds_read_b64_tr_b16 v[216:217], v10 offset:40960
  ds_read_b64_tr_b16 v[218:219], v10 offset:41216
  v_mfma_f32_32x32x16_bf16 v[176:191], v[224:227], v[72:75], v[176:191]
  ds_read_b64_tr_b16 v[220:221], v11 offset:40960
  ds_read_b64_tr_b16 v[222:223], v11 offset:41216
  v_mfma_f32_32x32x16_bf16 v[192:207], v[228:231], v[72:75], v[192:207]
  buffer_load_dwordx4 v[132:135], v1, s[4:7], s32 offen offset:1024 sc1
  ds_read_b64_tr_b16 v[224:225], v10 offset:45056
  ds_read_b64_tr_b16 v[226:227], v10 offset:45312
  s_waitcnt vmcnt(10)
  v_max3_u32 v15, v80, v84, v88
  v_max_u32 v15, v15, v92
  s_waitcnt lgkmcnt(4)
  v_mfma_f32_32x32x16_bf16 v[176:191], v[208:211], v[76:79], v[176:191]
  ds_read_b64_tr_b16 v[228:229], v11 offset:45056
  ds_read_b64_tr_b16 v[230:231], v11 offset:45312
  v_cmp_eq_u32 vcc, -1, v15
  v_mfma_f32_32x32x16_bf16 v[192:207], v[212:215], v[76:79], v[192:207]
  buffer_load_dwordx4 v[136:139], v1, s[4:7], s32 offen offset:2048 sc1
  ds_read_b64_tr_b16 v[208:209], v10 offset:49152
  ds_read_b64_tr_b16 v[210:211], v10 offset:49408
  s_cbranch_vccnz L_pl_524
L_plb_525:
  v_mfma_f32_32x32x16_bf16 v[176:191], v[216:219], v[80:83], v[176:191]
  ds_read_b64_tr_b16 v[212:213], v11 offset:49152
  ds_read_b64_tr_b16 v[214:215], v11 offset:49408
  ds_read_b32 v7, v14 offset:1728
  s_waitcnt lgkmcnt(5)
  v_mfma_f32_32x32x16_bf16 v[192:207], v[220:223], v[80:83], v[192:207]
  buffer_load_dwordx4 v[140:143], v1, s[4:7], s32 offen offset:3072 sc1
  ds_read_b64_tr_b16 v[216:217], v10 offset:53248
  ds_read_b64_tr_b16 v[218:219], v10 offset:53504
  v_mfma_f32_32x32x16_bf16 v[176:191], v[224:227], v[84:87], v[176:191]
  ds_read_b64_tr_b16 v[220:221], v11 offset:53248
  ds_read_b64_tr_b16 v[222:223], v11 offset:53504
  v_mfma_f32_32x32x16_bf16 v[192:207], v[228:231], v[84:87], v[192:207]
  ds_read_b64_tr_b16 v[224:225], v10 offset:57344
  ds_read_b64_tr_b16 v[226:227], v10 offset:57600
  s_waitcnt lgkmcnt(4)
  v_mfma_f32_32x32x16_bf16 v[176:191], v[208:211], v[88:91], v[176:191]
  s_add_u32 s32, s29, 32768
  buffer_load_dwordx4 v[16:19], v1, s[4:7], s32 offen offset:0 sc1
  ds_read_b64_tr_b16 v[228:229], v11 offset:57344
  ds_read_b64_tr_b16 v[230:231], v11 offset:57600
  v_mfma_f32_32x32x16_bf16 v[192:207], v[212:215], v[88:91], v[192:207]
  ds_read_b64_tr_b16 v[208:209], v10 offset:61440
  ds_read_b64_tr_b16 v[210:211], v10 offset:61696
  s_waitcnt vmcnt(9)
  v_max3_u32 v15, v96, v100, v104
  v_max_u32 v15, v15, v108
  v_mfma_f32_32x32x16_bf16 v[176:191], v[216:219], v[92:95], v[176:191]
  buffer_load_dwordx4 v[20:23], v1, s[4:7], s32 offen offset:1024 sc1
  ds_read_b64_tr_b16 v[212:213], v11 offset:61440
  ds_read_b64_tr_b16 v[214:215], v11 offset:61696
  v_cmp_eq_u32 s[30:31], -1, v15
  ds_write_b32 v5, v247 offset:896
  v_cmp_gt_u32 vcc, v247, v7
  s_cbranch_vccnz L_lsl_529
L_lbk_530:
  v_add_u32 v10, 0x10000, v10
  v_add_u32 v11, 0x10000, v11
  s_waitcnt lgkmcnt(5)
  v_mfma_f32_32x32x16_bf16 v[192:207], v[220:223], v[92:95], v[192:207]
  ds_read_b64_tr_b16 v[216:217], v10 offset:0
  ds_read_b64_tr_b16 v[218:219], v10 offset:256
  s_cmp_lg_u64 s[30:31], 0
  s_cbranch_scc1 L_pl_531
L_plb_532:
  v_mfma_f32_32x32x16_bf16 v[176:191], v[224:227], v[96:99], v[176:191]
  buffer_load_dwordx4 v[24:27], v1, s[4:7], s32 offen offset:2048 sc1
  ds_read_b64_tr_b16 v[220:221], v11 offset:0
  ds_read_b64_tr_b16 v[222:223], v11 offset:256
  v_mfma_f32_32x32x16_bf16 v[192:207], v[228:231], v[96:99], v[192:207]
  ds_read_b64_tr_b16 v[224:225], v10 offset:4096
  ds_read_b64_tr_b16 v[226:227], v10 offset:4352
  s_waitcnt lgkmcnt(4)
  v_mfma_f32_32x32x16_bf16 v[176:191], v[208:211], v[100:103], v[176:191]
  buffer_load_dwordx4 v[28:31], v1, s[4:7], s32 offen offset:3072 sc1
  ds_read_b64_tr_b16 v[228:229], v11 offset:4096
  ds_read_b64_tr_b16 v[230:231], v11 offset:4352
  v_mfma_f32_32x32x16_bf16 v[192:207], v[212:215], v[100:103], v[192:207]
  ds_read_b64_tr_b16 v[208:209], v10 offset:8192
  ds_read_b64_tr_b16 v[210:211], v10 offset:8448
  v_mfma_f32_32x32x16_bf16 v[176:191], v[216:219], v[104:107], v[176:191]
  s_add_u32 s32, s29, 36864
  buffer_load_dwordx4 v[32:35], v1, s[4:7], s32 offen offset:0 sc1
  ds_read_b64_tr_b16 v[212:213], v11 offset:8192
  ds_read_b64_tr_b16 v[214:215], v11 offset:8448
  s_waitcnt lgkmcnt(4)
  v_mfma_f32_32x32x16_bf16 v[192:207], v[220:223], v[104:107], v[192:207]
  ds_read_b64_tr_b16 v[216:217], v10 offset:12288
  ds_read_b64_tr_b16 v[218:219], v10 offset:12544
  s_waitcnt vmcnt(9)
  v_max3_u32 v15, v112, v116, v120
  v_max_u32 v15, v15, v124
  v_mfma_f32_32x32x16_bf16 v[176:191], v[224:227], v[108:111], v[176:191]
  buffer_load_dwordx4 v[36:39], v1, s[4:7], s32 offen offset:1024 sc1
  ds_read_b64_tr_b16 v[220:221], v11 offset:12288
  ds_read_b64_tr_b16 v[222:223], v11 offset:12544
  v_cmp_eq_u32 vcc, -1, v15
  ds_write_b32 v5, v247 offset:960
  v_mfma_f32_32x32x16_bf16 v[192:207], v[228:231], v[108:111], v[192:207]
  ds_read_b64_tr_b16 v[224:225], v10 offset:32768
  ds_read_b64_tr_b16 v[226:227], v10 offset:33024
  s_cbranch_vccnz L_pl_536
L_plb_537:
  s_waitcnt lgkmcnt(5)
  v_mfma_f32_32x32x16_bf16 v[176:191], v[208:211], v[112:115], v[176:191]
  buffer_load_dwordx4 v[40:43], v1, s[4:7], s32 offen offset:2048 sc1
  ds_read_b64_tr_b16 v[228:229], v11 offset:32768
  ds_read_b64_tr_b16 v[230:231], v11 offset:33024
  ds_read_b32 v7, v14 offset:1792
  v_mfma_f32_32x32x16_bf16 v[192:207], v[212:215], v[112:115], v[192:207]
  ds_read_b64_tr_b16 v[208:209], v10 offset:36864
  ds_read_b64_tr_b16 v[210:211], v10 offset:37120
  v_mfma_f32_32x32x16_bf16 v[176:191], v[216:219], v[116:119], v[176:191]
  buffer_load_dwordx4 v[44:47], v1, s[4:7], s32 offen offset:3072 sc1
  ds_read_b64_tr_b16 v[212:213], v11 offset:36864
  ds_read_b64_tr_b16 v[214:215], v11 offset:37120
  s_waitcnt lgkmcnt(5)
  v_mfma_f32_32x32x16_bf16 v[192:207], v[220:223], v[116:119], v[192:207]
  ds_read_b64_tr_b16 v[216:217], v10 offset:40960
  ds_read_b64_tr_b16 v[218:219], v10 offset:41216
  v_mfma_f32_32x32x16_bf16 v[176:191], v[224:227], v[120:123], v[176:191]
  s_add_u32 s32, s29, 40960
  buffer_load_dwordx4 v[48:51], v1, s[4:7], s32 offen offset:0 sc1
  ds_read_b64_tr_b16 v[220:221], v11 offset:40960
  ds_read_b64_tr_b16 v[222:223], v11 offset:41216
  v_mfma_f32_32x32x16_bf16 v[192:207], v[228:231], v[120:123], v[192:207]
  ds_read_b64_tr_b16 v[224:225], v10 offset:45056
  ds_read_b64_tr_b16 v[226:227], v10 offset:45312
  s_waitcnt vmcnt(9)
  v_max3_u32 v15, v128, v132, v136
  v_max_u32 v15, v15, v140
  s_waitcnt lgkmcnt(4)
  v_mfma_f32_32x32x16_bf16 v[176:191], v[208:211], v[124:127], v[176:191]
  buffer_load_dwordx4 v[52:55], v1, s[4:7], s32 offen offset:1024 sc1
  ds_read_b64_tr_b16 v[228:229], v11 offset:45056
  ds_read_b64_tr_b16 v[230:231], v11 offset:45312
  v_cmp_eq_u32 s[30:31], -1, v15
  v_cmp_gt_u32 vcc, v247, v7
  s_cbranch_vccnz L_lsl_541
L_lbk_542:
  v_mfma_f32_32x32x16_bf16 v[192:207], v[212:215], v[124:127], v[192:207]
  ds_read_b64_tr_b16 v[208:209], v10 offset:16384
  ds_read_b64_tr_b16 v[210:211], v10 offset:16640
  s_cmp_lg_u64 s[30:31], 0
  s_cbranch_scc1 L_pl_543
L_plb_544:
  v_mfma_f32_32x32x16_bf16 v[176:191], v[216:219], v[128:131], v[176:191]
  buffer_load_dwordx4 v[56:59], v1, s[4:7], s32 offen offset:2048 sc1
  ds_read_b64_tr_b16 v[212:213], v11 offset:16384
  ds_read_b64_tr_b16 v[214:215], v11 offset:16640
  s_waitcnt lgkmcnt(4)
  v_mfma_f32_32x32x16_bf16 v[192:207], v[220:223], v[128:131], v[192:207]
  ds_read_b64_tr_b16 v[216:217], v10 offset:20480
  ds_read_b64_tr_b16 v[218:219], v10 offset:20736
  v_mfma_f32_32x32x16_bf16 v[176:191], v[224:227], v[132:135], v[176:191]
  ds_read_b64_tr_b16 v[220:221], v11 offset:20480
  ds_read_b64_tr_b16 v[222:223], v11 offset:20736
  v_mfma_f32_32x32x16_bf16 v[192:207], v[228:231], v[132:135], v[192:207]
  ds_read_b64_tr_b16 v[224:225], v10 offset:24576
  ds_read_b64_tr_b16 v[226:227], v10 offset:24832
  s_waitcnt lgkmcnt(4)
  v_mfma_f32_32x32x16_bf16 v[176:191], v[208:211], v[136:139], v[176:191]
  ds_read_b64_tr_b16 v[228:229], v11 offset:24576
  ds_read_b64_tr_b16 v[230:231], v11 offset:24832
  v_mfma_f32_32x32x16_bf16 v[192:207], v[212:215], v[136:139], v[192:207]
  ds_read_b64_tr_b16 v[208:209], v10 offset:28672
  ds_read_b64_tr_b16 v[210:211], v10 offset:28928
  ds_read_b32 v7, v14 offset:1856
  s_waitcnt vmcnt(8)
  v_max3_u32 v15, v16, v20, v24
  v_mfma_f32_32x32x16_bf16 v[176:191], v[216:219], v[140:143], v[176:191]
  ds_read_b64_tr_b16 v[212:213], v11 offset:28672
  ds_read_b64_tr_b16 v[214:215], v11 offset:28928
  v_cmp_eq_u32 vcc, -1, v15
  v_add_u32 v10, 0x6000, v10
  v_add_u32 v11, 0x6000, v11
  s_waitcnt lgkmcnt(5)
  v_mfma_f32_32x32x16_bf16 v[192:207], v[220:223], v[140:143], v[192:207]
  ds_read_b64_tr_b16 v[216:217], v10 offset:24576
  ds_read_b64_tr_b16 v[218:219], v10 offset:24832
  ds_write_b32 v5, v247 offset:2368
  s_cbranch_vccnz L_pl_548
L_plb_549:
  v_mfma_f32_32x32x16_bf16 v[176:191], v[224:227], v[16:19], v[176:191]
  ds_read_b64_tr_b16 v[220:221], v11 offset:24576
  ds_read_b64_tr_b16 v[222:223], v11 offset:24832
  v_mfma_f32_32x32x16_bf16 v[192:207], v[228:231], v[16:19], v[192:207]
  ds_read_b64_tr_b16 v[224:225], v11 offset:28672
  ds_read_b64_tr_b16 v[226:227], v11 offset:28928
  s_waitcnt lgkmcnt(5)
  v_mfma_f32_32x32x16_bf16 v[176:191], v[208:211], v[20:23], v[176:191]
  ds_read_b64_tr_b16 v[228:229], v11 offset:32768
  ds_read_b64_tr_b16 v[230:231], v11 offset:33024
  v_mfma_f32_32x32x16_bf16 v[192:207], v[212:215], v[20:23], v[192:207]
  ds_read_b64_tr_b16 v[208:209], v11 offset:36864
  ds_read_b64_tr_b16 v[210:211], v11 offset:37120
  s_waitcnt vmcnt(4)
  v_max3_u32 v15, v28, v32, v36
  v_max_u32 v15, v15, v40
  v_cmp_gt_u32 vcc, v247, v7
  s_cbranch_vccnz L_lsl_552
L_lbk_553:
  v_mfma_f32_32x32x16_bf16 v[176:191], v[216:219], v[24:27], v[176:191]
  ds_read_b64_tr_b16 v[212:213], v11 offset:40960
  ds_read_b64_tr_b16 v[214:215], v11 offset:41216
  v_cmp_eq_u32 vcc, -1, v15
  s_waitcnt lgkmcnt(4)
  v_mfma_f32_32x32x16_bf16 v[192:207], v[220:223], v[24:27], v[192:207]
  ds_read_b64_tr_b16 v[216:217], v11 offset:45056
  ds_read_b64_tr_b16 v[218:219], v11 offset:45312
  s_cbranch_vccnz L_pl_554
L_plb_555:
  v_mfma_f32_32x32x16_bf16 v[192:207], v[224:227], v[28:31], v[192:207]
  ds_read_b64_tr_b16 v[220:221], v11 offset:49152
  ds_read_b64_tr_b16 v[222:223], v11 offset:49408
  v_mfma_f32_32x32x16_bf16 v[192:207], v[228:231], v[32:35], v[192:207]
  ds_read_b64_tr_b16 v[224:225], v11 offset:53248
  ds_read_b64_tr_b16 v[226:227], v11 offset:53504
  s_waitcnt vmcnt(0)
  v_max3_u32 v15, v44, v48, v52
  v_max_u32 v15, v15, v56
  s_waitcnt lgkmcnt(4)
  v_mfma_f32_32x32x16_bf16 v[192:207], v[208:211], v[36:39], v[192:207]
  ds_read_b64_tr_b16 v[228:229], v11 offset:57344
  ds_read_b64_tr_b16 v[230:231], v11 offset:57600
  v_cmp_eq_u32 vcc, -1, v15
  v_mfma_f32_32x32x16_bf16 v[192:207], v[212:215], v[40:43], v[192:207]
  ds_read_b64_tr_b16 v[208:209], v10 offset:28672
  ds_read_b64_tr_b16 v[210:211], v10 offset:28928
  s_cbranch_vccnz L_pl_557
L_plb_558:
  v_mfma_f32_32x32x16_bf16 v[192:207], v[216:219], v[44:47], v[192:207]
  ds_read_b64_tr_b16 v[212:213], v10 offset:32768
  ds_read_b64_tr_b16 v[214:215], v10 offset:33024
  ds_read_b32 v7, v14 offset:960
  s_waitcnt lgkmcnt(5)
  v_mfma_f32_32x32x16_bf16 v[192:207], v[220:223], v[48:51], v[192:207]
  ds_read_b64_tr_b16 v[216:217], v10 offset:36864
  ds_read_b64_tr_b16 v[218:219], v10 offset:37120
  v_mfma_f32_32x32x16_bf16 v[192:207], v[224:227], v[52:55], v[192:207]
  ds_read_b64_tr_b16 v[220:221], v10 offset:40960
  ds_read_b64_tr_b16 v[222:223], v10 offset:41216
  v_mfma_f32_32x32x16_bf16 v[192:207], v[228:231], v[56:59], v[192:207]
  ds_read_b64_tr_b16 v[224:225], v10 offset:45056
  ds_read_b64_tr_b16 v[226:227], v10 offset:45312
  s_waitcnt lgkmcnt(4)
  v_mfma_f32_32x32x16_bf16 v[176:191], v[208:211], v[28:31], v[176:191]
  ds_read_b64_tr_b16 v[228:229], v10 offset:49152
  ds_read_b64_tr_b16 v[230:231], v10 offset:49408
  v_mfma_f32_32x32x16_bf16 v[176:191], v[212:215], v[32:35], v[176:191]
  ds_read_b64_tr_b16 v[208:209], v10 offset:53248
  ds_read_b64_tr_b16 v[210:211], v10 offset:53504
  v_cmp_gt_u32 vcc, v247, v7
  s_cbranch_vccnz L_lsl_559
L_lbk_560:
  ds_write_b128 v12, v[192:195] offset:0
  ds_write_b128 v12, v[196:199] offset:1024
  ds_write_b128 v12, v[200:203] offset:2048
  ds_write_b128 v12, v[204:207] offset:3072
  ds_write_b32 v5, v247 offset:1024
  v_mfma_f32_32x32x16_bf16 v[176:191], v[216:219], v[36:39], v[176:191]
  ds_read_b64_tr_b16 v[212:213], v10 offset:57344
  ds_read_b64_tr_b16 v[214:215], v10 offset:57600
  s_waitcnt lgkmcnt(9)
  v_mfma_f32_32x32x16_bf16 v[176:191], v[220:223], v[40:43], v[176:191]
  v_mfma_f32_32x32x16_bf16 v[176:191], v[224:227], v[44:47], v[176:191]
  v_mfma_f32_32x32x16_bf16 v[176:191], v[228:231], v[48:51], v[176:191]
  ds_read_b32 v7, v14 offset:1024
  ds_read_b128 v[144:147], v13 offset:0
  ds_read_b128 v[148:151], v13 offset:1024
  ds_read_b128 v[152:155], v13 offset:2048
  ds_read_b128 v[156:159], v13 offset:3072
  s_waitcnt lgkmcnt(5)
  v_mfma_f32_32x32x16_bf16 v[176:191], v[208:211], v[52:55], v[176:191]
  v_mfma_f32_32x32x16_bf16 v[176:191], v[212:215], v[56:59], v[176:191]
  s_nop 11
  s_branch L_p4dones
L_lights:
  s_waitcnt lgkmcnt(0)
  v_pk_mul_f32 v[248:249], v[176:177], v[176:177]
  v_pk_mul_f32 v[250:251], v[178:179], v[178:179]
  v_pk_mul_f32 v[252:253], v[180:181], v[180:181]
  v_pk_mul_f32 v[254:255], v[182:183], v[182:183]
  v_pk_fma_f32 v[248:249], v[248:249], v[244:245], v[244:245] op_sel:[0,1,0] op_sel_hi:[1,1,0]
  v_pk_fma_f32 v[250:251], v[250:251], v[244:245], v[244:245] op_sel:[0,1,0] op_sel_hi:[1,1,0]
  v_pk_fma_f32 v[252:253], v[252:253], v[244:245], v[244:245] op_sel:[0,1,0] op_sel_hi:[1,1,0]
  v_pk_fma_f32 v[254:255], v[254:255], v[244:245], v[244:245] op_sel:[0,1,0] op_sel_hi:[1,1,0]
  v_pk_mul_f32 v[248:249], v[248:249], v[176:177]
  v_pk_mul_f32 v[250:251], v[250:251], v[178:179]
  v_pk_mul_f32 v[252:253], v[252:253], v[180:181]
  v_pk_mul_f32 v[254:255], v[254:255], v[182:183]
  v_exp_f32 v248, v248
  v_exp_f32 v249, v249
  v_exp_f32 v250, v250
  v_exp_f32 v251, v251
  v_exp_f32 v252, v252
  v_exp_f32 v253, v253
  v_exp_f32 v254, v254
  v_exp_f32 v255, v255
  v_pk_mul_f32 v[192:193], v[192:193], v[176:177]
  v_pk_mul_f32 v[194:195], v[194:195], v[178:179]
  v_pk_mul_f32 v[196:197], v[196:197], v[180:181]
  v_pk_mul_f32 v[198:199], v[198:199], v[182:183]
  v_pk_fma_f32 v[248:249], v[248:249], v[246:247], v[246:247] op_sel_hi:[1,0,0]
  v_pk_fma_f32 v[250:251], v[250:251], v[246:247], v[246:247] op_sel_hi:[1,0,0]
  v_pk_fma_f32 v[252:253], v[252:253], v[246:247], v[246:247] op_sel_hi:[1,0,0]
  v_pk_fma_f32 v[254:255], v[254:255], v[246:247], v[246:247] op_sel_hi:[1,0,0]
  v_rcp_f32 v248, v248
  v_rcp_f32 v249, v249
  v_rcp_f32 v250, v250
  v_rcp_f32 v251, v251
  v_rcp_f32 v252, v252
  v_rcp_f32 v253, v253
  v_rcp_f32 v254, v254
  v_rcp_f32 v255, v255
  v_pk_mul_f32 v[192:193], v[192:193], v[248:249]
  v_pk_mul_f32 v[194:195], v[194:195], v[250:251]
  v_pk_mul_f32 v[196:197], v[196:197], v[252:253]
  v_pk_mul_f32 v[198:199], v[198:199], v[254:255]
  v_cvt_pk_bf16_f32 v176, v192, v193
  v_cvt_pk_bf16_f32 v177, v194, v195
  v_cvt_pk_bf16_f32 v178, v196, v197
  v_cvt_pk_bf16_f32 v179, v198, v199
  v_pk_mul_f32 v[248:249], v[184:185], v[184:185]
  v_pk_mul_f32 v[250:251], v[186:187], v[186:187]
  v_pk_mul_f32 v[252:253], v[188:189], v[188:189]
  v_pk_mul_f32 v[254:255], v[190:191], v[190:191]
  v_pk_fma_f32 v[248:249], v[248:249], v[244:245], v[244:245] op_sel:[0,1,0] op_sel_hi:[1,1,0]
  v_pk_fma_f32 v[250:251], v[250:251], v[244:245], v[244:245] op_sel:[0,1,0] op_sel_hi:[1,1,0]
  v_pk_fma_f32 v[252:253], v[252:253], v[244:245], v[244:245] op_sel:[0,1,0] op_sel_hi:[1,1,0]
  v_pk_fma_f32 v[254:255], v[254:255], v[244:245], v[244:245] op_sel:[0,1,0] op_sel_hi:[1,1,0]
  v_pk_mul_f32 v[248:249], v[248:249], v[184:185]
  v_pk_mul_f32 v[250:251], v[250:251], v[186:187]
  v_pk_mul_f32 v[252:253], v[252:253], v[188:189]
  v_pk_mul_f32 v[254:255], v[254:255], v[190:191]
  v_exp_f32 v248, v248
  v_exp_f32 v249, v249
  v_exp_f32 v250, v250
  v_exp_f32 v251, v251
  v_exp_f32 v252, v252
  v_exp_f32 v253, v253
  v_exp_f32 v254, v254
  v_exp_f32 v255, v255
  v_pk_mul_f32 v[200:201], v[200:201], v[184:185]
  v_pk_mul_f32 v[202:203], v[202:203], v[186:187]
  v_pk_mul_f32 v[204:205], v[204:205], v[188:189]
  v_pk_mul_f32 v[206:207], v[206:207], v[190:191]
  v_pk_fma_f32 v[248:249], v[248:249], v[246:247], v[246:247] op_sel_hi:[1,0,0]
  v_pk_fma_f32 v[250:251], v[250:251], v[246:247], v[246:247] op_sel_hi:[1,0,0]
  v_pk_fma_f32 v[252:253], v[252:253], v[246:247], v[246:247] op_sel_hi:[1,0,0]
  v_pk_fma_f32 v[254:255], v[254:255], v[246:247], v[246:247] op_sel_hi:[1,0,0]
  v_rcp_f32 v248, v248
  v_rcp_f32 v249, v249
  v_rcp_f32 v250, v250
  v_rcp_f32 v251, v251
  v_rcp_f32 v252, v252
  v_rcp_f32 v253, v253
  v_rcp_f32 v254, v254
  v_rcp_f32 v255, v255
  v_pk_mul_f32 v[200:201], v[200:201], v[248:249]
  v_pk_mul_f32 v[202:203], v[202:203], v[250:251]
  v_pk_mul_f32 v[204:205], v[204:205], v[252:253]
  v_pk_mul_f32 v[206:207], v[206:207], v[254:255]
  v_cvt_pk_bf16_f32 v180, v200, v201
  v_cvt_pk_bf16_f32 v181, v202, v203
  v_cvt_pk_bf16_f32 v182, v204, v205
  v_cvt_pk_bf16_f32 v183, v206, v207
  s_add_u32 s46, s28, 16384
  s_add_u32 s47, s28, 60416
  buffer_store_dwordx4 v[176:179], v1, s[4:7], s46 offen sc1
  buffer_store_dwordx4 v[180:183], v1, s[4:7], s47 offen sc1
  ds_read_b32 v7, v14 offset:1664
  s_lshl_b32 s47, s14, 12
  s_xor_b32 s48, s47, 8192
  s_add_u32 s47, s47, 73728
  s_add_u32 s48, s48, 73728
  v_add_u32 v12, s47, v1
  v_add_u32 v13, s48, v1
  v_lshlrev_b32 v176, 16, v232
  v_and_b32 v177, s54, v232
  v_lshlrev_b32 v178, 16, v233
  v_and_b32 v179, s54, v233
  v_lshlrev_b32 v180, 16, v234
  v_and_b32 v181, s54, v234
  v_lshlrev_b32 v182, 16, v235
  v_and_b32 v183, s54, v235
  v_lshlrev_b32 v184, 16, v236
  v_and_b32 v185, s54, v236
  v_lshlrev_b32 v186, 16, v237
  v_and_b32 v187, s54, v237
  v_lshlrev_b32 v188, 16, v238
  v_and_b32 v189, s54, v238
  v_lshlrev_b32 v190, 16, v239
  v_and_b32 v191, s54, v239
  buffer_load_dwordx4 v[16:19], v1, s[4:7], s29 offen offset:0 sc1
  buffer_load_dwordx4 v[20:23], v1, s[4:7], s29 offen offset:1024 sc1
  buffer_load_dwordx4 v[24:27], v1, s[4:7], s29 offen offset:2048 sc1
  buffer_load_dwordx4 v[28:31], v1, s[4:7], s29 offen offset:3072 sc1
  s_add_u32 s44, s29, 4096
  buffer_load_dwordx4 v[32:35], v1, s[4:7], s44 offen offset:0 sc1
  buffer_load_dwordx4 v[36:39], v1, s[4:7], s44 offen offset:1024 sc1
  buffer_load_dwordx4 v[40:43], v1, s[4:7], s44 offen offset:2048 sc1
  buffer_load_dwordx4 v[44:47], v1, s[4:7], s44 offen offset:3072 sc1
  s_add_u32 s45, s29, 8192
  buffer_load_dwordx4 v[48:51], v1, s[4:7], s45 offen offset:0 sc1
  buffer_load_dwordx4 v[52:55], v1, s[4:7], s45 offen offset:1024 sc1
  buffer_load_dwordx4 v[56:59], v1, s[4:7], s45 offen offset:2048 sc1
  buffer_load_dwordx4 v[60:63], v1, s[4:7], s45 offen offset:3072 sc1
  s_add_u32 s44, s29, 12288
  buffer_load_dwordx4 v[64:67], v1, s[4:7], s44 offen offset:0 sc1
  buffer_load_dwordx4 v[68:71], v1, s[4:7], s44 offen offset:1024 sc1
  buffer_load_dwordx4 v[72:75], v1, s[4:7], s44 offen offset:2048 sc1
  buffer_load_dwordx4 v[76:79], v1, s[4:7], s44 offen offset:3072 sc1
  s_waitcnt lgkmcnt(0)
  v_cmp_gt_u32 vcc, v247, v7
  s_cbranch_vccnz L_lsl_561
L_lbk_562:
  s_lshr_b32 s46, s14, 1
  s_mul_i32 s47, s46, 2560
  s_add_u32 s47, s47, 98304
  s_xor_b32 s48, s47, 512
  v_add_u32 v10, s47, v0
  v_add_u32 v11, s48, v0
  ds_read_b64_tr_b16 v[208:209], v10 offset:40960
  ds_read_b64_tr_b16 v[210:211], v10 offset:41216
  ds_read_b64_tr_b16 v[212:213], v11 offset:40960
  ds_read_b64_tr_b16 v[214:215], v11 offset:41216
  ds_read_b64_tr_b16 v[216:217], v10 offset:45056
  ds_read_b64_tr_b16 v[218:219], v10 offset:45312
  ds_read_b64_tr_b16 v[220:221], v11 offset:45056
  ds_read_b64_tr_b16 v[222:223], v11 offset:45312
  ds_read_b64_tr_b16 v[224:225], v10 offset:49152
  ds_read_b64_tr_b16 v[226:227], v10 offset:49408
  s_waitcnt vmcnt(14)
  v_max_u32 v15, v16, v20
  v_cmp_eq_u32 vcc, -1, v15
  s_cbranch_vccnz L_pl_563
L_plb_564:
  s_waitcnt lgkmcnt(4)
  v_mfma_f32_32x32x16_bf16 v[176:191], v[208:211], v[16:19], v[176:191]
  ds_read_b64_tr_b16 v[228:229], v11 offset:49152
  ds_read_b64_tr_b16 v[230:231], v11 offset:49408
  v_mfma_f32_32x32x16_bf16 v[192:207], v[212:215], v[16:19], 0
  ds_read_b64_tr_b16 v[208:209], v10 offset:53248
  ds_read_b64_tr_b16 v[210:211], v10 offset:53504
  s_waitcnt vmcnt(12)
  v_max_u32 v15, v24, v28
  v_mfma_f32_32x32x16_bf16 v[176:191], v[216:219], v[20:23], v[176:191]
  ds_read_b64_tr_b16 v[212:213], v11 offset:53248
  ds_read_b64_tr_b16 v[214:215], v11 offset:53504
  v_cmp_eq_u32 vcc, -1, v15
  s_waitcnt lgkmcnt(4)
  v_mfma_f32_32x32x16_bf16 v[192:207], v[220:223], v[20:23], v[192:207]
  s_add_u32 s32, s29, 16384
  buffer_load_dwordx4 v[80:83], v1, s[4:7], s32 offen offset:0 sc1
  ds_read_b64_tr_b16 v[216:217], v10 offset:57344
  ds_read_b64_tr_b16 v[218:219], v10 offset:57600
  s_cbranch_vccnz L_pl_569
L_plb_570:
  v_mfma_f32_32x32x16_bf16 v[176:191], v[224:227], v[24:27], v[176:191]
  ds_read_b64_tr_b16 v[220:221], v11 offset:57344
  ds_read_b64_tr_b16 v[222:223], v11 offset:57600
  v_mfma_f32_32x32x16_bf16 v[192:207], v[228:231], v[24:27], v[192:207]
  buffer_load_dwordx4 v[84:87], v1, s[4:7], s32 offen offset:1024 sc1
  ds_read_b64_tr_b16 v[224:225], v10 offset:61440
  ds_read_b64_tr_b16 v[226:227], v10 offset:61696
  s_waitcnt vmcnt(10)
  v_max3_u32 v15, v32, v36, v40
  v_max_u32 v15, v15, v44
  s_waitcnt lgkmcnt(4)
  v_mfma_f32_32x32x16_bf16 v[176:191], v[208:211], v[28:31], v[176:191]
  ds_read_b64_tr_b16 v[228:229], v11 offset:61440
  ds_read_b64_tr_b16 v[230:231], v11 offset:61696
  v_cmp_eq_u32 vcc, -1, v15
  ds_write_b32 v5, v247 offset:832
  v_add_u32 v10, 0xfffea000, v10
  v_add_u32 v11, 0xfffea000, v11
  v_mfma_f32_32x32x16_bf16 v[192:207], v[212:215], v[28:31], v[192:207]
  buffer_load_dwordx4 v[88:91], v1, s[4:7], s32 offen offset:2048 sc1
  ds_read_b64_tr_b16 v[208:209], v10 offset:0
  ds_read_b64_tr_b16 v[210:211], v10 offset:256
  s_cbranch_vccnz L_pl_575
L_plb_576:
  v_mfma_f32_32x32x16_bf16 v[176:191], v[216:219], v[32:35], v[176:191]
  ds_read_b64_tr_b16 v[212:213], v11 offset:0
  ds_read_b64_tr_b16 v[214:215], v11 offset:256
  s_waitcnt lgkmcnt(5)
  v_mfma_f32_32x32x16_bf16 v[192:207], v[220:223], v[32:35], v[192:207]
  buffer_load_dwordx4 v[92:95], v1, s[4:7], s32 offen offset:3072 sc1
  ds_read_b64_tr_b16 v[216:217], v10 offset:4096
  ds_read_b64_tr_b16 v[218:219], v10 offset:4352
  v_mfma_f32_32x32x16_bf16 v[176:191], v[224:227], v[36:39], v[176:191]
  ds_read_b64_tr_b16 v[220:221], v11 offset:4096
  ds_read_b64_tr_b16 v[222:223], v11 offset:4352
  v_mfma_f32_32x32x16_bf16 v[192:207], v[228:231], v[36:39], v[192:207]
  s_add_u32 s32, s29, 20480
  buffer_load_dwordx4 v[96:99], v1, s[4:7], s32 offen offset:0 sc1
  ds_read_b64_tr_b16 v[224:225], v10 offset:8192
  ds_read_b64_tr_b16 v[226:227], v10 offset:8448
  s_waitcnt lgkmcnt(4)
  v_mfma_f32_32x32x16_bf16 v[176:191], v[208:211], v[40:43], v[176:191]
  ds_read_b64_tr_b16 v[228:229], v11 offset:8192
  ds_read_b64_tr_b16 v[230:231], v11 offset:8448
  v_mfma_f32_32x32x16_bf16 v[192:207], v[212:215], v[40:43], v[192:207]
  buffer_load_dwordx4 v[100:103], v1, s[4:7], s32 offen offset:1024 sc1
  ds_read_b64_tr_b16 v[208:209], v10 offset:12288
  ds_read_b64_tr_b16 v[210:211], v10 offset:12544
  s_waitcnt vmcnt(10)
  v_max3_u32 v15, v48, v52, v56
  v_max_u32 v15, v15, v60
  v_mfma_f32_32x32x16_bf16 v[176:191], v[216:219], v[44:47], v[176:191]
  ds_read_b64_tr_b16 v[212:213], v11 offset:12288
  ds_read_b64_tr_b16 v[214:215], v11 offset:12544
  v_cmp_eq_u32 vcc, -1, v15
  s_waitcnt lgkmcnt(4)
  v_mfma_f32_32x32x16_bf16 v[192:207], v[220:223], v[44:47], v[192:207]
  buffer_load_dwordx4 v[104:107], v1, s[4:7], s32 offen offset:2048 sc1
  ds_read_b64_tr_b16 v[216:217], v10 offset:16384
  ds_read_b64_tr_b16 v[218:219], v10 offset:16640
  s_cbranch_vccnz L_pl_580
L_plb_581:
  v_mfma_f32_32x32x16_bf16 v[176:191], v[224:227], v[48:51], v[176:191]
  ds_read_b64_tr_b16 v[220:221], v11 offset:16384
  ds_read_b64_tr_b16 v[222:223], v11 offset:16640
  v_mfma_f32_32x32x16_bf16 v[192:207], v[228:231], v[48:51], v[192:207]
  buffer_load_dwordx4 v[108:111], v1, s[4:7], s32 offen offset:3072 sc1
  ds_read_b64_tr_b16 v[224:225], v10 offset:20480
  ds_read_b64_tr_b16 v[226:227], v10 offset:20736
  s_waitcnt lgkmcnt(4)
  v_mfma_f32_32x32x16_bf16 v[176:191], v[208:211], v[52:55], v[176:191]
  ds_read_b64_tr_b16 v[228:229], v11 offset:20480
  ds_read_b64_tr_b16 v[230:231], v11 offset:20736
  v_mfma_f32_32x32x16_bf16 v[192:207], v[212:215], v[52:55], v[192:207]
  s_add_u32 s32, s29, 24576
  buffer_load_dwordx4 v[112:115], v1, s[4:7], s32 offen offset:0 sc1
  ds_read_b64_tr_b16 v[208:209], v10 offset:24576
  ds_read_b64_tr_b16 v[210:211], v10 offset:24832
  v_mfma_f32_32x32x16_bf16 v[176:191], v[216:219], v[56:59], v[176:191]
  ds_read_b64_tr_b16 v[212:213], v11 offset:24576
  ds_read_b64_tr_b16 v[214:215], v11 offset:24832
  s_waitcnt lgkmcnt(4)
  v_mfma_f32_32x32x16_bf16 v[192:207], v[220:223], v[56:59], v[192:207]
  buffer_load_dwordx4 v[116:119], v1, s[4:7], s32 offen offset:1024 sc1
  ds_read_b64_tr_b16 v[216:217], v10 offset:28672
  ds_read_b64_tr_b16 v[218:219], v10 offset:28928
  s_waitcnt vmcnt(10)
  v_max3_u32 v15, v64, v68, v72
  v_max_u32 v15, v15, v76
  v_mfma_f32_32x32x16_bf16 v[176:191], v[224:227], v[60:63], v[176:191]
  ds_read_b64_tr_b16 v[220:221], v11 offset:28672
  ds_read_b64_tr_b16 v[222:223], v11 offset:28928
  v_cmp_eq_u32 vcc, -1, v15
  v_mfma_f32_32x32x16_bf16 v[192:207], v[228:231], v[60:63], v[192:207]
  buffer_load_dwordx4 v[120:123], v1, s[4:7], s32 offen offset:2048 sc1
  ds_read_b64_tr_b16 v[224:225], v10 offset:32768
  ds_read_b64_tr_b16 v[226:227], v10 offset:33024
  s_cbranch_vccnz L_pl_585
L_plb_586:
  s_waitcnt lgkmcnt(4)
  v_mfma_f32_32x32x16_bf16 v[176:191], v[208:211], v[64:67], v[176:191]
  ds_read_b64_tr_b16 v[228:229], v11 offset:32768
  ds_read_b64_tr_b16 v[230:231], v11 offset:33024
  v_mfma_f32_32x32x16_bf16 v[192:207], v[212:215], v[64:67], v[192:207]
  buffer_load_dwordx4 v[124:127], v1, s[4:7], s32 offen offset:3072 sc1
  ds_read_b64_tr_b16 v[208:209], v10 offset:36864
  ds_read_b64_tr_b16 v[210:211], v10 offset:37120
  v_mfma_f32_32x32x16_bf16 v[176:191], v[216:219], v[68:71], v[176:191]
  ds_read_b64_tr_b16 v[212:213], v11 offset:36864
  ds_read_b64_tr_b16 v[214:215], v11 offset:37120
  s_waitcnt lgkmcnt(4)
  v_mfma_f32_32x32x16_bf16 v[192:207], v[220:223], v[68:71], v[192:207]
  s_add_u32 s32, s29, 28672
  buffer_load_dwordx4 v[128:131], v1, s[4:7], s32 offen offset:0 sc1
  ds_read_b64_tr_b16 v[216:217], v10 offset:40960
  ds_read_b64_tr_b16 v[218:219], v10 offset:41216
  v_mfma_f32_32x32x16_bf16 v[176:191], v[224:227], v[72:75], v[176:191]
  ds_read_b64_tr_b16 v[220:221], v11 offset:40960
  ds_read_b64_tr_b16 v[222:223], v11 offset:41216
  v_mfma_f32_32x32x16_bf16 v[192:207], v[228:231], v[72:75], v[192:207]
  buffer_load_dwordx4 v[132:135], v1, s[4:7], s32 offen offset:1024 sc1
  ds_read_b64_tr_b16 v[224:225], v10 offset:45056
  ds_read_b64_tr_b16 v[226:227], v10 offset:45312
  s_waitcnt vmcnt(10)
  v_max3_u32 v15, v80, v84, v88
  v_max_u32 v15, v15, v92
  s_waitcnt lgkmcnt(4)
  v_mfma_f32_32x32x16_bf16 v[176:191], v[208:211], v[76:79], v[176:191]
  ds_read_b64_tr_b16 v[228:229], v11 offset:45056
  ds_read_b64_tr_b16 v[230:231], v11 offset:45312
  v_cmp_eq_u32 vcc, -1, v15
  v_mfma_f32_32x32x16_bf16 v[192:207], v[212:215], v[76:79], v[192:207]
  buffer_load_dwordx4 v[136:139], v1, s[4:7], s32 offen offset:2048 sc1
  ds_read_b64_tr_b16 v[208:209], v10 offset:49152
  ds_read_b64_tr_b16 v[210:211], v10 offset:49408
  s_cbranch_vccnz L_pl_590
L_plb_591:
  v_mfma_f32_32x32x16_bf16 v[176:191], v[216:219], v[80:83], v[176:191]
  ds_read_b64_tr_b16 v[212:213], v11 offset:49152
  ds_read_b64_tr_b16 v[214:215], v11 offset:49408
  ds_read_b32 v7, v14 offset:1728
  s_waitcnt lgkmcnt(5)
  v_mfma_f32_32x32x16_bf16 v[192:207], v[220:223], v[80:83], v[192:207]
  buffer_load_dwordx4 v[140:143], v1, s[4:7], s32 offen offset:3072 sc1
  ds_read_b64_tr_b16 v[216:217], v10 offset:53248
  ds_read_b64_tr_b16 v[218:219], v10 offset:53504
  v_mfma_f32_32x32x16_bf16 v[176:191], v[224:227], v[84:87], v[176:191]
  ds_read_b64_tr_b16 v[220:221], v11 offset:53248
  ds_read_b64_tr_b16 v[222:223], v11 offset:53504
  v_mfma_f32_32x32x16_bf16 v[192:207], v[228:231], v[84:87], v[192:207]
  ds_read_b64_tr_b16 v[224:225], v10 offset:57344
  ds_read_b64_tr_b16 v[226:227], v10 offset:57600
  s_waitcnt lgkmcnt(4)
  v_mfma_f32_32x32x16_bf16 v[176:191], v[208:211], v[88:91], v[176:191]
  ds_read_b64_tr_b16 v[228:229], v11 offset:57344
  ds_read_b64_tr_b16 v[230:231], v11 offset:57600
  v_mfma_f32_32x32x16_bf16 v[192:207], v[212:215], v[88:91], v[192:207]
  ds_read_b64_tr_b16 v[208:209], v10 offset:61440
  ds_read_b64_tr_b16 v[210:211], v10 offset:61696
  s_waitcnt vmcnt(8)
  v_max3_u32 v15, v96, v100, v104
  v_max_u32 v15, v15, v108
  v_mfma_f32_32x32x16_bf16 v[176:191], v[216:219], v[92:95], v[176:191]
  ds_read_b64_tr_b16 v[212:213], v11 offset:61440
  ds_read_b64_tr_b16 v[214:215], v11 offset:61696
  v_cmp_eq_u32 s[30:31], -1, v15
  ds_write_b32 v5, v247 offset:896
  v_cmp_gt_u32 vcc, v247, v7
  s_cbranch_vccnz L_lsl_595
L_lbk_596:
  v_add_u32 v10, 0x10000, v10
  v_add_u32 v11, 0x10000, v11
  s_waitcnt lgkmcnt(5)
  v_mfma_f32_32x32x16_bf16 v[192:207], v[220:223], v[92:95], v[192:207]
  ds_read_b64_tr_b16 v[216:217], v10 offset:0
  ds_read_b64_tr_b16 v[218:219], v10 offset:256
  s_cmp_lg_u64 s[30:31], 0
  s_cbranch_scc1 L_pl_597
L_plb_598:
  v_mfma_f32_32x32x16_bf16 v[176:191], v[224:227], v[96:99], v[176:191]
  ds_read_b64_tr_b16 v[220:221], v11 offset:0
  ds_read_b64_tr_b16 v[222:223], v11 offset:256
  v_mfma_f32_32x32x16_bf16 v[192:207], v[228:231], v[96:99], v[192:207]
  ds_read_b64_tr_b16 v[224:225], v10 offset:4096
  ds_read_b64_tr_b16 v[226:227], v10 offset:4352
  s_waitcnt lgkmcnt(4)
  v_mfma_f32_32x32x16_bf16 v[176:191], v[208:211], v[100:103], v[176:191]
  ds_read_b64_tr_b16 v[228:229], v11 offset:4096
  ds_read_b64_tr_b16 v[230:231], v11 offset:4352
  v_mfma_f32_32x32x16_bf16 v[192:207], v[212:215], v[100:103], v[192:207]
  ds_read_b64_tr_b16 v[208:209], v10 offset:8192
  ds_read_b64_tr_b16 v[210:211], v10 offset:8448
  v_mfma_f32_32x32x16_bf16 v[176:191], v[216:219], v[104:107], v[176:191]
  s_add_u32 s32, s29, 32768
  buffer_load_dwordx4 v[16:19], v1, s[4:7], s32 offen offset:0 sc1
  ds_read_b64_tr_b16 v[212:213], v11 offset:8192
  ds_read_b64_tr_b16 v[214:215], v11 offset:8448
  s_waitcnt lgkmcnt(4)
  v_mfma_f32_32x32x16_bf16 v[192:207], v[220:223], v[104:107], v[192:207]
  ds_read_b64_tr_b16 v[216:217], v10 offset:12288
  ds_read_b64_tr_b16 v[218:219], v10 offset:12544
  s_waitcnt vmcnt(5)
  v_max3_u32 v15, v112, v116, v120
  v_max_u32 v15, v15, v124
  v_mfma_f32_32x32x16_bf16 v[176:191], v[224:227], v[108:111], v[176:191]
  buffer_load_dwordx4 v[20:23], v1, s[4:7], s32 offen offset:1024 sc1
  ds_read_b64_tr_b16 v[220:221], v11 offset:12288
  ds_read_b64_tr_b16 v[222:223], v11 offset:12544
  v_cmp_eq_u32 vcc, -1, v15
  ds_write_b32 v5, v247 offset:960
  v_mfma_f32_32x32x16_bf16 v[192:207], v[228:231], v[108:111], v[192:207]
  ds_read_b64_tr_b16 v[224:225], v10 offset:32768
  ds_read_b64_tr_b16 v[226:227], v10 offset:33024
  s_cbranch_vccnz L_pl_601
L_plb_602:
  s_waitcnt lgkmcnt(5)
  v_mfma_f32_32x32x16_bf16 v[176:191], v[208:211], v[112:115], v[176:191]
  buffer_load_dwordx4 v[24:27], v1, s[4:7], s32 offen offset:2048 sc1
  ds_read_b64_tr_b16 v[228:229], v11 offset:32768
  ds_read_b64_tr_b16 v[230:231], v11 offset:33024
  ds_read_b32 v7, v14 offset:1792
  v_mfma_f32_32x32x16_bf16 v[192:207], v[212:215], v[112:115], v[192:207]
  ds_read_b64_tr_b16 v[208:209], v10 offset:36864
  ds_read_b64_tr_b16 v[210:211], v10 offset:37120
  v_mfma_f32_32x32x16_bf16 v[176:191], v[216:219], v[116:119], v[176:191]
  buffer_load_dwordx4 v[28:31], v1, s[4:7], s32 offen offset:3072 sc1
  ds_read_b64_tr_b16 v[212:213], v11 offset:36864
  ds_read_b64_tr_b16 v[214:215], v11 offset:37120
  s_waitcnt lgkmcnt(5)
  v_mfma_f32_32x32x16_bf16 v[192:207], v[220:223], v[116:119], v[192:207]
  ds_read_b64_tr_b16 v[216:217], v10 offset:40960
  ds_read_b64_tr_b16 v[218:219], v10 offset:41216
  v_mfma_f32_32x32x16_bf16 v[176:191], v[224:227], v[120:123], v[176:191]
  s_add_u32 s32, s29, 36864
  buffer_load_dwordx4 v[32:35], v1, s[4:7], s32 offen offset:0 sc1
  ds_read_b64_tr_b16 v[220:221], v11 offset:40960
  ds_read_b64_tr_b16 v[222:223], v11 offset:41216
  v_mfma_f32_32x32x16_bf16 v[192:207], v[228:231], v[120:123], v[192:207]
  ds_read_b64_tr_b16 v[224:225], v10 offset:45056
  ds_read_b64_tr_b16 v[226:227], v10 offset:45312
  s_waitcnt vmcnt(5)
  v_max3_u32 v15, v128, v132, v136
  v_max_u32 v15, v15, v140
  s_waitcnt lgkmcnt(4)
  v_mfma_f32_32x32x16_bf16 v[176:191], v[208:211], v[124:127], v[176:191]
  buffer_load_dwordx4 v[36:39], v1, s[4:7], s32 offen offset:1024 sc1
  ds_read_b64_tr_b16 v[228:229], v11 offset:45056
  ds_read_b64_tr_b16 v[230:231], v11 offset:45312
  v_cmp_eq_u32 s[30:31], -1, v15
  v_cmp_gt_u32 vcc, v247, v7
  s_cbranch_vccnz L_lsl_605
L_lbk_606:
  v_mfma_f32_32x32x16_bf16 v[192:207], v[212:215], v[124:127], v[192:207]
  ds_read_b64_tr_b16 v[208:209], v10 offset:16384
  ds_read_b64_tr_b16 v[210:211], v10 offset:16640
  s_cmp_lg_u64 s[30:31], 0
  s_cbranch_scc1 L_pl_607
L_plb_608:
  v_mfma_f32_32x32x16_bf16 v[176:191], v[216:219], v[128:131], v[176:191]
  buffer_load_dwordx4 v[40:43], v1, s[4:7], s32 offen offset:2048 sc1
  ds_read_b64_tr_b16 v[212:213], v11 offset:16384
  ds_read_b64_tr_b16 v[214:215], v11 offset:16640
  s_waitcnt lgkmcnt(4)
  v_mfma_f32_32x32x16_bf16 v[192:207], v[220:223], v[128:131], v[192:207]
  ds_read_b64_tr_b16 v[216:217], v10 offset:20480
  ds_read_b64_tr_b16 v[218:219], v10 offset:20736
  v_mfma_f32_32x32x16_bf16 v[176:191], v[224:227], v[132:135], v[176:191]
  buffer_load_dwordx4 v[44:47], v1, s[4:7], s32 offen offset:3072 sc1
  ds_read_b64_tr_b16 v[220:221], v11 offset:20480
  ds_read_b64_tr_b16 v[222:223], v11 offset:20736
  v_mfma_f32_32x32x16_bf16 v[192:207], v[228:231], v[132:135], v[192:207]
  ds_read_b64_tr_b16 v[224:225], v10 offset:24576
  ds_read_b64_tr_b16 v[226:227], v10 offset:24832
  s_waitcnt lgkmcnt(4)
  v_mfma_f32_32x32x16_bf16 v[176:191], v[208:211], v[136:139], v[176:191]
  s_add_u32 s32, s29, 40960
  buffer_load_dwordx4 v[48:51], v1, s[4:7], s32 offen offset:0 sc1
  ds_read_b64_tr_b16 v[228:229], v11 offset:24576
  ds_read_b64_tr_b16 v[230:231], v11 offset:24832
  v_mfma_f32_32x32x16_bf16 v[192:207], v[212:215], v[136:139], v[192:207]
  ds_read_b64_tr_b16 v[208:209], v10 offset:28672
  ds_read_b64_tr_b16 v[210:211], v10 offset:28928
  ds_read_b32 v7, v14 offset:1856
  s_waitcnt vmcnt(6)
  v_max3_u32 v15, v16, v20, v24
  v_mfma_f32_32x32x16_bf16 v[176:191], v[216:219], v[140:143], v[176:191]
  buffer_load_dwordx4 v[52:55], v1, s[4:7], s32 offen offset:1024 sc1
  ds_read_b64_tr_b16 v[212:213], v11 offset:28672
  ds_read_b64_tr_b16 v[214:215], v11 offset:28928
  v_cmp_eq_u32 vcc, -1, v15
  v_add_u32 v10, 0x6000, v10
  v_add_u32 v11, 0x6000, v11
  s_waitcnt lgkmcnt(5)
  v_mfma_f32_32x32x16_bf16 v[192:207], v[220:223], v[140:143], v[192:207]
  ds_read_b64_tr_b16 v[216:217], v10 offset:24576
  ds_read_b64_tr_b16 v[218:219], v10 offset:24832
  s_cbranch_vccnz L_pl_611
L_plb_612:
  v_mfma_f32_32x32x16_bf16 v[176:191], v[224:227], v[16:19], v[176:191]
  buffer_load_dwordx4 v[56:59], v1, s[4:7], s32 offen offset:2048 sc1
  ds_read_b64_tr_b16 v[220:221], v11 offset:24576
  ds_read_b64_tr_b16 v[222:223], v11 offset:24832
  v_mfma_f32_32x32x16_bf16 v[192:207], v[228:231], v[16:19], v[192:207]
  ds_read_b64_tr_b16 v[224:225], v11 offset:28672
  ds_read_b64_tr_b16 v[226:227], v11 offset:28928
  s_waitcnt lgkmcnt(4)
  v_mfma_f32_32x32x16_bf16 v[176:191], v[208:211], v[20:23], v[176:191]
  ds_read_b64_tr_b16 v[228:229], v11 offset:32768
  ds_read_b64_tr_b16 v[230:231], v11 offset:33024
  v_mfma_f32_32x32x16_bf16 v[192:207], v[212:215], v[20:23], v[192:207]
  ds_read_b64_tr_b16 v[208:209], v11 offset:36864
  ds_read_b64_tr_b16 v[210:211], v11 offset:37120
  s_waitcnt vmcnt(4)
  v_max3_u32 v15, v28, v32, v36
  v_max_u32 v15, v15, v40
  v_cmp_gt_u32 vcc, v247, v7
  s_cbranch_vccnz L_lsl_615
L_lbk_616:
  v_mfma_f32_32x32x16_bf16 v[176:191], v[216:219], v[24:27], v[176:191]
  ds_read_b64_tr_b16 v[212:213], v11 offset:40960
  ds_read_b64_tr_b16 v[214:215], v11 offset:41216
  v_cmp_eq_u32 vcc, -1, v15
  s_waitcnt lgkmcnt(4)
  v_mfma_f32_32x32x16_bf16 v[192:207], v[220:223], v[24:27], v[192:207]
  ds_read_b64_tr_b16 v[216:217], v11 offset:45056
  ds_read_b64_tr_b16 v[218:219], v11 offset:45312
  s_cbranch_vccnz L_pl_617
L_plb_618:
  v_mfma_f32_32x32x16_bf16 v[192:207], v[224:227], v[28:31], v[192:207]
  ds_read_b64_tr_b16 v[220:221], v11 offset:49152
  ds_read_b64_tr_b16 v[222:223], v11 offset:49408
  v_mfma_f32_32x32x16_bf16 v[192:207], v[228:231], v[32:35], v[192:207]
  ds_read_b64_tr_b16 v[224:225], v11 offset:53248
  ds_read_b64_tr_b16 v[226:227], v11 offset:53504
  ds_write_b32 v5, v247 offset:2368
  s_waitcnt vmcnt(0)
  v_max3_u32 v15, v44, v48, v52
  v_max_u32 v15, v15, v56
  s_waitcnt lgkmcnt(5)
  v_mfma_f32_32x32x16_bf16 v[192:207], v[208:211], v[36:39], v[192:207]
  ds_read_b64_tr_b16 v[228:229], v11 offset:57344
  ds_read_b64_tr_b16 v[230:231], v11 offset:57600
  v_cmp_eq_u32 vcc, -1, v15
  v_mfma_f32_32x32x16_bf16 v[192:207], v[212:215], v[40:43], v[192:207]
  ds_read_b64_tr_b16 v[208:209], v10 offset:28672
  ds_read_b64_tr_b16 v[210:211], v10 offset:28928
  s_cbranch_vccnz L_pl_620
L_plb_621:
  v_mfma_f32_32x32x16_bf16 v[192:207], v[216:219], v[44:47], v[192:207]
  ds_read_b64_tr_b16 v[212:213], v10 offset:32768
  ds_read_b64_tr_b16 v[214:215], v10 offset:33024
  ds_read_b32 v7, v14 offset:960
  s_waitcnt lgkmcnt(5)
  v_mfma_f32_32x32x16_bf16 v[192:207], v[220:223], v[48:51], v[192:207]
  ds_read_b64_tr_b16 v[216:217], v10 offset:36864
  ds_read_b64_tr_b16 v[218:219], v10 offset:37120
  v_mfma_f32_32x32x16_bf16 v[192:207], v[224:227], v[52:55], v[192:207]
  ds_read_b64_tr_b16 v[220:221], v10 offset:40960
  ds_read_b64_tr_b16 v[222:223], v10 offset:41216
  v_mfma_f32_32x32x16_bf16 v[192:207], v[228:231], v[56:59], v[192:207]
  ds_read_b64_tr_b16 v[224:225], v10 offset:45056
  ds_read_b64_tr_b16 v[226:227], v10 offset:45312
  s_waitcnt lgkmcnt(4)
  v_mfma_f32_32x32x16_bf16 v[176:191], v[208:211], v[28:31], v[176:191]
  ds_read_b64_tr_b16 v[228:229], v10 offset:49152
  ds_read_b64_tr_b16 v[230:231], v10 offset:49408
  v_mfma_f32_32x32x16_bf16 v[176:191], v[212:215], v[32:35], v[176:191]
  ds_read_b64_tr_b16 v[208:209], v10 offset:53248
  ds_read_b64_tr_b16 v[210:211], v10 offset:53504
  v_cmp_gt_u32 vcc, v247, v7
  s_cbranch_vccnz L_lsl_622
L_lbk_623:
  ds_write_b128 v12, v[192:195] offset:0
  ds_write_b128 v12, v[196:199] offset:1024
  ds_write_b128 v12, v[200:203] offset:2048
  ds_write_b128 v12, v[204:207] offset:3072
  ds_write_b32 v5, v247 offset:1024
  v_mfma_f32_32x32x16_bf16 v[176:191], v[216:219], v[36:39], v[176:191]
  ds_read_b64_tr_b16 v[212:213], v10 offset:57344
  ds_read_b64_tr_b16 v[214:215], v10 offset:57600
  s_waitcnt lgkmcnt(9)
  v_mfma_f32_32x32x16_bf16 v[176:191], v[220:223], v[40:43], v[176:191]
  v_mfma_f32_32x32x16_bf16 v[176:191], v[224:227], v[44:47], v[176:191]
  v_mfma_f32_32x32x16_bf16 v[176:191], v[228:231], v[48:51], v[176:191]
  ds_read_b32 v7, v14 offset:1024
  ds_read_b128 v[144:147], v13 offset:0
  ds_read_b128 v[148:151], v13 offset:1024
  ds_read_b128 v[152:155], v13 offset:2048
  ds_read_b128 v[156:159], v13 offset:3072
  s_waitcnt lgkmcnt(5)
  v_mfma_f32_32x32x16_bf16 v[176:191], v[208:211], v[52:55], v[176:191]
  v_mfma_f32_32x32x16_bf16 v[176:191], v[212:215], v[56:59], v[176:191]
  s_nop 11
L_p4dones:
  s_waitcnt lgkmcnt(4)
  v_cmp_gt_u32 vcc, v247, v7
  s_nop 0
  s_and_b64 vcc, vcc, s[36:37]
  s_cbranch_scc1 L_lsl_624
L_lbk_625:
  s_waitcnt lgkmcnt(0)
  ds_write_b32 v5, v247 offset:1088
  v_pk_add_f32 v[176:177], v[176:177], v[144:145]
  v_pk_add_f32 v[178:179], v[178:179], v[146:147]
  v_cvt_pk_bf16_f32 v232, v176, v177
  v_cvt_pk_bf16_f32 v233, v178, v179
  v_pk_add_f32 v[180:181], v[180:181], v[148:149]
  v_pk_add_f32 v[182:183], v[182:183], v[150:151]
  v_cvt_pk_bf16_f32 v234, v180, v181
  v_cvt_pk_bf16_f32 v235, v182, v183
  v_pk_add_f32 v[184:185], v[184:185], v[152:153]
  v_pk_add_f32 v[186:187], v[186:187], v[154:155]
  v_cvt_pk_bf16_f32 v236, v184, v185
  v_cvt_pk_bf16_f32 v237, v186, v187
  v_pk_add_f32 v[188:189], v[188:189], v[156:157]
  v_pk_add_f32 v[190:191], v[190:191], v[158:159]
  v_cvt_pk_bf16_f32 v238, v188, v189
  v_cvt_pk_bf16_f32 v239, v190, v191
  s_cmp_eq_u32 s16, 1
  s_nop 0
  s_cbranch_scc1 L_finals
  buffer_store_dwordx4 v[232:235], v1, s[4:7], s38 offen sc1
  buffer_store_dwordx4 v[236:239], v1, s[4:7], s38 offen offset:1024 sc1
  s_mov_b32 s35, s39
  s_add_u32 s20, s20, 65536
  s_add_u32 s21, s21, 65536
  s_mov_b32 s16, 1
  s_add_u32 s38, s26, 0xffe00000
  s_add_u32 s39, s27, 0xfffc0000
  s_lshl_b32 s44, s100, 12
  s_or_b32 s38, s38, s44
  v_add_u32 v247, 1, v247
  buffer_load_dwordx4 v[16:19], v1, s[4:7], s38 offen offset:0 sc1
  buffer_load_dwordx4 v[20:23], v1, s[4:7], s38 offen offset:1024 sc1
  v_mov_b32 v248, 0
  v_mov_b32 v249, 0
  v_mov_b32 v250, 0
  v_mov_b32 v251, 0
  v_dot2c_f32_bf16 v248, s51, v232
  v_dot2c_f32_bf16 v249, v232, v232
  v_dot2c_f32_bf16 v250, s51, v233
  v_dot2c_f32_bf16 v251, v233, v233
  v_dot2c_f32_bf16 v248, s51, v234
  v_dot2c_f32_bf16 v249, v234, v234
  v_dot2c_f32_bf16 v250, s51, v235
  v_dot2c_f32_bf16 v251, v235, v235
  v_dot2c_f32_bf16 v248, s51, v236
  v_dot2c_f32_bf16 v249, v236, v236
  v_dot2c_f32_bf16 v250, s51, v237
  v_dot2c_f32_bf16 v251, v237, v237
  v_dot2c_f32_bf16 v248, s51, v238
  v_dot2c_f32_bf16 v249, v238, v238
  v_dot2c_f32_bf16 v250, s51, v239
  v_dot2c_f32_bf16 v251, v239, v239
  s_nop 2
  v_pk_add_f32 v[248:249], v[248:249], v[250:251]
  v_mov_b32 v250, v248
  v_mov_b32 v251, v249
  s_nop 0
  v_permlane32_swap_b32 v250, v248
  v_permlane32_swap_b32 v251, v249
  v_pk_add_f32 v[248:249], v[248:249], v[250:251]
  s_mov_b32 exec_hi, 0
  buffer_store_dwordx2 v[248:249], v4, s[4:7], s35 offen sc1
  s_mov_b32 exec_hi, -1
  buffer_load_dwordx4 v[24:27], v1, s[4:7], s38 offen offset:2048 sc1
  buffer_load_dwordx4 v[28:31], v1, s[4:7], s38 offen offset:3072 sc1
  s_xor_b32 s44, s38, 4096
  buffer_load_dwordx4 v[32:35], v1, s[4:7], s44 offen offset:0 sc1
  buffer_load_dwordx4 v[36:39], v1, s[4:7], s44 offen offset:1024 sc1
  buffer_load_dwordx4 v[40:43], v1, s[4:7], s44 offen offset:2048 sc1
  buffer_load_dwordx4 v[44:47], v1, s[4:7], s44 offen offset:3072 sc1
  s_xor_b32 s45, s38, 8192
  buffer_load_dwordx4 v[48:51], v1, s[4:7], s45 offen offset:0 sc1
  buffer_load_dwordx4 v[52:55], v1, s[4:7], s45 offen offset:1024 sc1
  ds_read_b32 v7, v14 offset:2176
  s_waitcnt lgkmcnt(0)
  v_cmp_gt_u32 vcc, v247, v7
  s_cbranch_vccnz L_lsl_626
L_lbk_627:
  ds_read_b128 v[208:211], v1 offset:8192
  ds_read_b128 v[212:215], v1 offset:40960
  ds_read_b128 v[216:219], v1 offset:9216
  ds_read_b128 v[220:223], v1 offset:41984
  ds_read_b128 v[224:227], v1 offset:10240
  s_waitcnt vmcnt(9)
  v_max_u32 v15, v16, v20
  v_cmp_eq_u32 vcc, -1, v15
  s_cbranch_vccnz L_pl_628
L_plb_629:
  s_waitcnt lgkmcnt(2)
  v_mfma_f32_32x32x16_bf16 v[144:159], v[208:211], v[16:19], 0
  s_xor_b32 s32, s38, 8192
  buffer_load_dwordx4 v[56:59], v1, s[4:7], s32 offen offset:2048 sc1
  ds_read_b128 v[228:231], v1 offset:43008
  v_bfe_u32 v249, v1, 6, 2
  v_lshrrev_b32 v251, 8, v1
  v_mfma_f32_32x32x16_bf16 v[160:175], v[212:215], v[16:19], 0
  buffer_load_dwordx4 v[60:63], v1, s[4:7], s32 offen offset:3072 sc1
  ds_read_b128 v[208:211], v1 offset:11264
  v_lshl_add_u32 v252, v251, 3, v249
  s_and_b32 s48, s14, 1
  s_waitcnt vmcnt(8)
  v_max_u32 v15, v24, v28
  v_mfma_f32_32x32x16_bf16 v[144:159], v[216:219], v[20:23], v[144:159]
  s_xor_b32 s32, s38, 12288
  buffer_load_dwordx4 v[64:67], v1, s[4:7], s32 offen offset:0 sc1
  ds_read_b128 v[212:215], v1 offset:44032
  s_lshl_b32 s48, s48, 13
  s_add_u32 s48, s48, 106496
  v_cmp_eq_u32 vcc, -1, v15
  s_waitcnt lgkmcnt(2)
  v_mfma_f32_32x32x16_bf16 v[160:175], v[220:223], v[20:23], v[160:175]
  buffer_load_dwordx4 v[68:71], v1, s[4:7], s32 offen offset:1024 sc1
  ds_read_b128 v[216:219], v1 offset:12288
  v_lshl_add_u32 v252, v252, 6, s48
  v_lshrrev_b32 v249, 1, v249
  s_cbranch_vccnz L_pl_633
L_plb_634:
  v_mfma_f32_32x32x16_bf16 v[144:159], v[224:227], v[24:27], v[144:159]
  buffer_load_dwordx4 v[72:75], v1, s[4:7], s32 offen offset:2048 sc1
  ds_read_b128 v[220:223], v1 offset:45056
  v_and_b32 v251, 1, v251
  v_lshl_or_b32 v249, v251, 1, v249
  ds_read_b32 v7, v14 offset:2240
  v_mfma_f32_32x32x16_bf16 v[160:175], v[228:231], v[24:27], v[160:175]
  ds_read_b128 v[224:227], v1 offset:13312
  v_bfe_u32 v250, v1, 4, 1
  v_bfe_u32 v253, v1, 5, 1
  s_waitcnt vmcnt(7)
  v_max3_u32 v15, v32, v36, v40
  v_max_u32 v15, v15, v44
  s_waitcnt lgkmcnt(3)
  v_mfma_f32_32x32x16_bf16 v[144:159], v[208:211], v[28:31], v[144:159]
  buffer_load_dwordx4 v[76:79], v1, s[4:7], s32 offen offset:3072 sc1
  ds_read_b128 v[228:231], v1 offset:46080
  s_and_b32 s48, s14, 2
  v_or_b32 v10, s48, v253
  v_cmp_eq_u32 vcc, -1, v15
  v_mfma_f32_32x32x16_bf16 v[160:175], v[212:215], v[28:31], v[160:175]
  ds_read_b128 v[208:211], v1 offset:14336
  v_xor_b32 v10, v10, v249
  v_xor_b32 v12, v250, v249
  s_cbranch_vccnz L_pl_638
L_plb_639:
  v_mfma_f32_32x32x16_bf16 v[144:159], v[216:219], v[32:35], v[144:159]
  buffer_load_dwordx2 v[192:193], v4, s[4:7], s39 offen offset:0 sc1
  s_xor_b32 s32, s38, 16384
  buffer_load_dwordx4 v[80:83], v1, s[4:7], s32 offen offset:0 sc1
  ds_read_b128 v[212:215], v1 offset:47104
  v_lshl_add_u32 v10, v10, 4, v252
  v_lshl_add_u32 v12, v12, 4, v252
  s_waitcnt lgkmcnt(2)
  v_mfma_f32_32x32x16_bf16 v[160:175], v[220:223], v[32:35], v[160:175]
  ds_read_b128 v[216:219], v1 offset:15360
  v_lshl_add_u32 v10, v250, 3, v10
  v_lshl_add_u32 v12, v253, 3, v12
  v_mfma_f32_32x32x16_bf16 v[144:159], v[224:227], v[36:39], v[144:159]
  buffer_load_dwordx2 v[194:195], v4, s[4:7], s39 offen offset:512 sc1
  buffer_load_dwordx4 v[84:87], v1, s[4:7], s32 offen offset:1024 sc1
  ds_read_b128 v[220:223], v1 offset:48128
  v_xor_b32 v11, 32, v10
  v_xor_b32 v13, 32, v12
  v_cmp_gt_u32 vcc, v247, v7
  s_cbranch_vccnz L_lsl_642
L_lbk_643:
  v_mfma_f32_32x32x16_bf16 v[160:175], v[228:231], v[36:39], v[160:175]
  ds_read_b128 v[224:227], v1 offset:16384
  v_add_u32 v254, 0x10000, v1
  s_waitcnt lgkmcnt(2)
  v_mfma_f32_32x32x16_bf16 v[144:159], v[208:211], v[40:43], v[144:159]
  buffer_load_dwordx2 v[196:197], v4, s[4:7], s39 offen offset:1024 sc1
  buffer_load_dwordx4 v[88:91], v1, s[4:7], s32 offen offset:2048 sc1
  ds_read_b128 v[228:231], v1 offset:49152
  v_mfma_f32_32x32x16_bf16 v[160:175], v[212:215], v[40:43], v[160:175]
  ds_read_b128 v[208:211], v1 offset:17408
  s_waitcnt vmcnt(10)
  v_max3_u32 v15, v48, v52, v56
  v_max_u32 v15, v15, v60
  v_mfma_f32_32x32x16_bf16 v[144:159], v[216:219], v[44:47], v[144:159]
  buffer_load_dwordx2 v[198:199], v4, s[4:7], s39 offen offset:1536 sc1
  buffer_load_dwordx4 v[92:95], v1, s[4:7], s32 offen offset:3072 sc1
  ds_read_b128 v[212:215], v1 offset:50176
  v_cmp_eq_u32 vcc, -1, v15
  s_waitcnt lgkmcnt(2)
  v_mfma_f32_32x32x16_bf16 v[160:175], v[220:223], v[44:47], v[160:175]
  ds_read_b128 v[216:219], v1 offset:18432
  s_cbranch_vccnz L_pl_644
L_plb_645:
  v_mfma_f32_32x32x16_bf16 v[144:159], v[224:227], v[48:51], v[144:159]
  buffer_load_dwordx2 v[200:201], v4, s[4:7], s39 offen offset:2048 sc1
  s_xor_b32 s32, s38, 20480
  buffer_load_dwordx4 v[96:99], v1, s[4:7], s32 offen offset:0 sc1
  ds_read_b128 v[220:223], v1 offset:51200
  v_mfma_f32_32x32x16_bf16 v[160:175], v[228:231], v[48:51], v[160:175]
  ds_read_b128 v[224:227], v1 offset:19456
  s_waitcnt lgkmcnt(2)
  v_mfma_f32_32x32x16_bf16 v[144:159], v[208:211], v[52:55], v[144:159]
  buffer_load_dwordx2 v[202:203], v4, s[4:7], s39 offen offset:2560 sc1
  buffer_load_dwordx4 v[100:103], v1, s[4:7], s32 offen offset:1024 sc1
  ds_read_b128 v[228:231], v1 offset:52224
  v_mfma_f32_32x32x16_bf16 v[160:175], v[212:215], v[52:55], v[160:175]
  ds_read_b128 v[208:211], v1 offset:20480
  v_mfma_f32_32x32x16_bf16 v[144:159], v[216:219], v[56:59], v[144:159]
  buffer_load_dwordx2 v[204:205], v4, s[4:7], s39 offen offset:3072 sc1
  buffer_load_dwordx4 v[104:107], v1, s[4:7], s32 offen offset:2048 sc1
  ds_read_b128 v[212:215], v1 offset:53248
  ds_read_b32 v7, v14 offset:1216
  s_waitcnt lgkmcnt(3)
  v_mfma_f32_32x32x16_bf16 v[160:175], v[220:223], v[56:59], v[160:175]
  ds_read_b128 v[216:219], v1 offset:21504
  s_waitcnt vmcnt(14)
  v_max3_u32 v15, v64, v68, v72
  v_max_u32 v15, v15, v76
  v_mfma_f32_32x32x16_bf16 v[144:159], v[224:227], v[60:63], v[144:159]
  buffer_load_dwordx2 v[206:207], v4, s[4:7], s39 offen offset:3584 sc1
  buffer_load_dwordx4 v[108:111], v1, s[4:7], s32 offen offset:3072 sc1
  ds_read_b128 v[220:223], v1 offset:54272
  v_cmp_eq_u32 vcc, -1, v15
  v_mfma_f32_32x32x16_bf16 v[160:175], v[228:231], v[60:63], v[160:175]
  ds_read_b128 v[224:227], v1 offset:22528
  s_cbranch_vccnz L_pl_649
L_plb_650:
  s_waitcnt lgkmcnt(2)
  v_mfma_f32_32x32x16_bf16 v[144:159], v[208:211], v[64:67], v[144:159]
  s_xor_b32 s32, s38, 24576
  buffer_load_dwordx4 v[112:115], v1, s[4:7], s32 offen offset:0 sc1
  ds_read_b128 v[228:231], v1 offset:55296
  v_mfma_f32_32x32x16_bf16 v[160:175], v[212:215], v[64:67], v[160:175]
  ds_read_b128 v[208:211], v1 offset:23552
  v_mfma_f32_32x32x16_bf16 v[144:159], v[216:219], v[68:71], v[144:159]
  buffer_load_dwordx4 v[116:119], v1, s[4:7], s32 offen offset:1024 sc1
  ds_read_b128 v[212:215], v1 offset:56320
  v_cmp_gt_u32 vcc, v247, v7
  s_cbranch_vccnz L_lsl_654
L_lbk_655:
  s_waitcnt lgkmcnt(2)
  v_mfma_f32_32x32x16_bf16 v[160:175], v[220:223], v[68:71], v[160:175]
  ds_read_b128 v[216:219], v1 offset:24576
  v_mfma_f32_32x32x16_bf16 v[144:159], v[224:227], v[72:75], v[144:159]
  buffer_load_dwordx4 v[120:123], v1, s[4:7], s32 offen offset:2048 sc1
  ds_read_b128 v[220:223], v1 offset:57344
  v_mfma_f32_32x32x16_bf16 v[160:175], v[228:231], v[72:75], v[160:175]
  ds_read_b128 v[224:227], v1 offset:25600
  s_waitcnt vmcnt(11)
  v_max3_u32 v15, v80, v84, v88
  v_max_u32 v15, v15, v92
  s_waitcnt lgkmcnt(2)
  v_mfma_f32_32x32x16_bf16 v[144:159], v[208:211], v[76:79], v[144:159]
  buffer_load_dwordx4 v[124:127], v1, s[4:7], s32 offen offset:3072 sc1
  ds_read_b128 v[228:231], v1 offset:58368
  v_cmp_eq_u32 vcc, -1, v15
  v_mfma_f32_32x32x16_bf16 v[160:175], v[212:215], v[76:79], v[160:175]
  ds_read_b128 v[208:211], v1 offset:26624
  s_cbranch_vccnz L_pl_656
L_plb_657:
  v_mfma_f32_32x32x16_bf16 v[144:159], v[216:219], v[80:83], v[144:159]
  s_xor_b32 s32, s38, 28672
  buffer_load_dwordx4 v[128:131], v1, s[4:7], s32 offen offset:0 sc1
  ds_read_b128 v[212:215], v1 offset:59392
  s_waitcnt lgkmcnt(2)
  v_mfma_f32_32x32x16_bf16 v[160:175], v[220:223], v[80:83], v[160:175]
  ds_read_b128 v[216:219], v1 offset:27648
  v_mfma_f32_32x32x16_bf16 v[144:159], v[224:227], v[84:87], v[144:159]
  buffer_load_dwordx4 v[132:135], v1, s[4:7], s32 offen offset:1024 sc1
  ds_read_b128 v[220:223], v1 offset:60416
  v_mfma_f32_32x32x16_bf16 v[160:175], v[228:231], v[84:87], v[160:175]
  ds_read_b128 v[224:227], v1 offset:28672
  s_waitcnt lgkmcnt(2)
  v_mfma_f32_32x32x16_bf16 v[144:159], v[208:211], v[88:91], v[144:159]
  buffer_load_dwordx4 v[136:139], v1, s[4:7], s32 offen offset:2048 sc1
  ds_read_b128 v[228:231], v1 offset:61440
  ds_read_b32 v7, v14 offset:1280
  v_mfma_f32_32x32x16_bf16 v[160:175], v[212:215], v[88:91], v[160:175]
  ds_read_b128 v[208:211], v1 offset:29696
  s_waitcnt vmcnt(7)
  v_max3_u32 v15, v96, v100, v104
  v_max_u32 v15, v15, v108
  v_mfma_f32_32x32x16_bf16 v[144:159], v[216:219], v[92:95], v[144:159]
  buffer_load_dwordx4 v[140:143], v1, s[4:7], s32 offen offset:3072 sc1
  ds_read_b128 v[212:215], v1 offset:62464
  v_cmp_eq_u32 vcc, -1, v15
  s_waitcnt lgkmcnt(3)
  v_mfma_f32_32x32x16_bf16 v[160:175], v[220:223], v[92:95], v[160:175]
  ds_read_b128 v[216:219], v1 offset:30720
  s_cbranch_vccnz L_pl_661
L_plb_662:
  v_max3_u32 v15, v192, v194, v196
  v_max3_u32 v15, v15, v198, v200
  v_mfma_f32_32x32x16_bf16 v[144:159], v[224:227], v[96:99], v[144:159]
  ds_read_b128 v[220:223], v1 offset:63488
  v_max3_u32 v15, v15, v202, v204
  v_max_u32 v15, v15, v206
  v_mfma_f32_32x32x16_bf16 v[160:175], v[228:231], v[96:99], v[160:175]
  ds_read_b128 v[224:227], v1 offset:31744
  v_cmp_eq_u32 vcc, -1, v15
  s_waitcnt lgkmcnt(2)
  v_mfma_f32_32x32x16_bf16 v[144:159], v[208:211], v[100:103], v[144:159]
  ds_read_b128 v[228:231], v1 offset:64512
  s_cbranch_vccnz L_pl_667
L_plb_668:
  v_cmp_gt_u32 vcc, v247, v7
  s_cbranch_vccnz L_lsl_672
L_lbk_673:
  v_mfma_f32_32x32x16_bf16 v[160:175], v[212:215], v[100:103], v[160:175]
  ds_read_b128 v[208:211], v1 offset:32768
  v_add_f32 v192, v192, v194
  v_add_f32 v193, v193, v195
  v_mfma_f32_32x32x16_bf16 v[144:159], v[216:219], v[104:107], v[144:159]
  ds_read_b128 v[212:215], v254 offset:0
  v_add_f32 v192, v192, v196
  v_add_f32 v193, v193, v197
  s_waitcnt lgkmcnt(2)
  v_mfma_f32_32x32x16_bf16 v[160:175], v[220:223], v[104:107], v[160:175]
  ds_read_b128 v[216:219], v1 offset:33792
  v_add_f32 v192, v192, v198
  v_add_f32 v193, v193, v199
  s_waitcnt vmcnt(4)
  v_max3_u32 v15, v112, v116, v120
  v_max_u32 v15, v15, v124
  ds_write_b32 v5, v247 offset:0
  v_mfma_f32_32x32x16_bf16 v[144:159], v[224:227], v[108:111], v[144:159]
  ds_read_b128 v[220:223], v254 offset:1024
  v_add_f32 v192, v192, v200
  v_add_f32 v193, v193, v201
  v_cmp_eq_u32 vcc, -1, v15
  v_mfma_f32_32x32x16_bf16 v[160:175], v[228:231], v[108:111], v[160:175]
  ds_read_b128 v[224:227], v1 offset:34816
  v_add_f32 v192, v192, v202
  v_add_f32 v193, v193, v203
  s_cbranch_vccnz L_pl_674
L_plb_675:
  s_waitcnt lgkmcnt(3)
  v_mfma_f32_32x32x16_bf16 v[144:159], v[208:211], v[112:115], v[144:159]
  ds_read_b128 v[228:231], v254 offset:2048
  v_add_f32 v192, v192, v204
  v_add_f32 v193, v193, v205
  v_mfma_f32_32x32x16_bf16 v[160:175], v[212:215], v[112:115], v[160:175]
  ds_read_b128 v[208:211], v1 offset:35840
  v_add_f32 v192, v192, v206
  v_add_f32 v193, v193, v207
  v_mfma_f32_32x32x16_bf16 v[144:159], v[216:219], v[116:119], v[144:159]
  ds_read_b128 v[212:215], v254 offset:3072
  v_mov_b32 v194, v192
  v_mov_b32 v195, v193
  s_waitcnt lgkmcnt(2)
  v_mfma_f32_32x32x16_bf16 v[160:175], v[220:223], v[116:119], v[160:175]
  ds_read_b128 v[216:219], v1 offset:36864
  v_permlane32_swap_b32 v194, v192
  v_permlane32_swap_b32 v195, v193
  ds_read_b32 v7, v14 offset:2112
  v_mfma_f32_32x32x16_bf16 v[144:159], v[224:227], v[120:123], v[144:159]
  ds_read_b128 v[220:223], v254 offset:4096
  v_add_f32 v192, v192, v194
  v_add_f32 v193, v193, v195
  v_mfma_f32_32x32x16_bf16 v[160:175], v[228:231], v[120:123], v[160:175]
  ds_read_b128 v[224:227], v1 offset:37888
  v_mul_f32 v192, 0xbb000000, v192
  v_mul_f32 v193, 0x3b000000, v193
  s_waitcnt vmcnt(2)
  v_max_u32 v15, v128, v132
  s_waitcnt lgkmcnt(3)
  v_mfma_f32_32x32x16_bf16 v[144:159], v[208:211], v[124:127], v[144:159]
  ds_read_b128 v[228:231], v254 offset:5120
  v_fma_f32 v193, -v192, v192, v193
  v_cvt_pk_bf16_f32 v240, v192, v192
  v_cmp_eq_u32 vcc, -1, v15
  v_mfma_f32_32x32x16_bf16 v[160:175], v[212:215], v[124:127], v[160:175]
  ds_read_b128 v[208:211], v1 offset:38912
  v_max_f32 v193, 0, v193
  v_add_f32 v193, 0x3727c5ac, v193
  s_cbranch_vccnz L_pl_678
L_plb_679:
  v_mfma_f32_32x32x16_bf16 v[144:159], v[216:219], v[128:131], v[144:159]
  ds_read_b128 v[212:215], v254 offset:6144
  v_and_b32 v194, s54, v240
  v_rsq_f32 v195, v193
  s_waitcnt lgkmcnt(2)
  v_mfma_f32_32x32x16_bf16 v[160:175], v[220:223], v[128:131], v[160:175]
  ds_read_b128 v[216:219], v1 offset:39936
  v_sub_f32 v194, v192, v194
  v_cvt_pk_bf16_f32 v241, v194, v194
  s_waitcnt vmcnt(0)
  v_max_u32 v15, v136, v140
  v_mfma_f32_32x32x16_bf16 v[144:159], v[224:227], v[132:135], v[144:159]
  ds_read_b128 v[220:223], v254 offset:7168
  v_cndmask_b32 v240, v240, v241, s[42:43]
  v_mov_b32 v241, v240
  v_cmp_eq_u32 s[30:31], -1, v15
  v_cmp_eq_u32 vcc, 0, v7
  s_cbranch_vccnz L_lsl_681
L_lbk_682:
  ds_read_b64 v[224:225], v9 offset:6656
  v_mfma_f32_32x32x16_bf16 v[160:175], v[228:231], v[132:135], v[160:175]
  v_mul_f32 v244, 0x3fb8aa3b, v195
  v_mov_b32 v246, v195
  s_cmp_lg_u64 s[30:31], 0
  s_cbranch_scc1 L_pl_683
L_plb_684:
  ds_read_b64 v[228:229], v9 offset:6912
  s_waitcnt lgkmcnt(3)
  v_mfma_f32_32x32x16_bf16 v[144:159], v[208:211], v[136:139], v[144:159]
  v_mfma_f32_32x32x16_bf16 v[160:175], v[212:215], v[136:139], v[160:175]
  v_mfma_f32_32x32x16_bf16 v[144:159], v[216:219], v[140:143], v[144:159]
  s_waitcnt lgkmcnt(0)
  v_mfma_f32_32x32x16_bf16 v[160:175], v[220:223], v[140:143], v[160:175]
  v_mfma_f32_32x32x16_bf16 v[144:159], v[224:227], v[240:243], v[144:159]
  ds_read_b128 v[216:219], v1 offset:4608
  ds_read_b128 v[220:223], v1 offset:5632
  v_mfma_f32_32x32x16_bf16 v[160:175], v[228:231], v[240:243], v[160:175]
  s_nop 11
  s_branch L_bodys
L_finals:
  v_lshrrev_b32 v248, 4, v1
  v_and_b32 v249, 31, v248
  v_lshrrev_b32 v250, 5, v248
  v_lshlrev_b32 v248, 10, v249
  v_lshl_add_u32 v248, v250, 5, v248
  s_lshl_b32 s44, s18, 15
  s_lshl_b32 s45, s19, 6
  s_add_u32 s44, s44, s45
  buffer_store_dwordx4 v[232:235], v248, s[8:11], s44 offen
  buffer_store_dwordx4 v[236:239], v248, s[8:11], s44 offen offset:16
  s_or_b32 s44, s2, s14
  s_cmp_lg_u32 s44, 0
  s_cbranch_scc1 L_noeps
  v_mov_b32 v249, s3
  s_mov_b32 s45, 0x28000
  s_mov_b64 exec, 1
  buffer_store_dword v249, off, s[4:7], s45 sc1
  s_mov_b64 exec, -1
L_noeps:
  s_endpgm
L_lsl_396:
  ds_read_b32 v7, v14 offset:192
  ds_read_b64_tr_b16 v[144:145], v10 offset:0
  ds_read_b64_tr_b16 v[146:147], v11 offset:256
  ds_read_b64_tr_b16 v[176:177], v12 offset:16384
  ds_read_b64_tr_b16 v[178:179], v13 offset:16640
  ds_read_b64_tr_b16 v[148:149], v10 offset:2048
  ds_read_b64_tr_b16 v[150:151], v11 offset:2304
  ds_read_b64_tr_b16 v[180:181], v12 offset:18432
  ds_read_b64_tr_b16 v[182:183], v13 offset:18688
  ds_read_b64_tr_b16 v[152:153], v10 offset:4096
  ds_read_b64_tr_b16 v[154:155], v11 offset:4352
  ds_read_b64_tr_b16 v[184:185], v12 offset:20480
  ds_read_b64_tr_b16 v[186:187], v13 offset:20736
  s_waitcnt lgkmcnt(0)
  v_cmp_gt_u32 vcc, v247, v7
  s_cbranch_vccz L_lbk_397
  s_sub_u32 s56, s56, 1
  s_cbranch_scc0 L_lsl_396
  s_mov_b32 s56, 0
  s_branch L_lbk_397
L_lsl_398:
  ds_read_b32 v7, v14 offset:2624
  s_waitcnt lgkmcnt(0)
  v_cmp_eq_u32 vcc, 0, v7
  s_cbranch_vccz L_lbk_399
  s_sub_u32 s56, s56, 1
  s_cbranch_scc0 L_lsl_398
  s_mov_b32 s56, 0
  s_branch L_lbk_399
L_lsl_400:
  ds_read_b32 v7, v14 offset:1344
  s_waitcnt lgkmcnt(0)
  v_cmp_gt_u32 vcc, v247, v7
  s_cbranch_vccz L_lbk_401
  s_sub_u32 s56, s56, 1
  s_cbranch_scc0 L_lsl_400
  s_mov_b32 s56, 0
  s_branch L_lbk_401
L_lsl_402:
  ds_read_b32 v7, v14 offset:1344
  s_waitcnt lgkmcnt(0)
  v_cmp_gt_u32 vcc, v247, v7
  s_cbranch_vccz L_lbk_403
  s_sub_u32 s56, s56, 1
  s_cbranch_scc0 L_lsl_402
  s_mov_b32 s56, 0
  s_branch L_lbk_403
L_lsl_404:
  ds_read_b32 v7, v14 offset:2496
  s_mov_b32 exec_hi, 0
  ds_read_b128 v[48:51], v13
  s_cmp_eq_u32 s14, 0
  s_cselect_b32 exec_lo, 0xffff, 0
  ds_read_b128 v[44:47], v12
  s_mov_b64 exec, -1
  s_waitcnt lgkmcnt(0)
  v_cmp_gt_u32 vcc, v247, v7
  s_cbranch_vccz L_lbk_405
  s_sub_u32 s56, s56, 1
  s_cbranch_scc0 L_lsl_404
  s_mov_b32 s56, 0
  s_branch L_lbk_405
L_pl_406:
L_pl_406l:
  s_xor_b32 s57, s20, 57344
  buffer_load_dwordx4 v[16:19], v6, s[4:7], s57 offen offset:0 sc1
  s_xor_b32 s57, s20, 49152
  buffer_load_dwordx4 v[20:23], v6, s[4:7], s57 offen offset:0 sc1
  s_xor_b32 s57, s20, 40960
  buffer_load_dwordx4 v[24:27], v6, s[4:7], s57 offen offset:0 sc1
  s_xor_b32 s57, s20, 32768
  buffer_load_dwordx4 v[28:31], v6, s[4:7], s57 offen offset:0 sc1
  s_waitcnt vmcnt(4)
  v_max3_u32 v15, v32, v36, v40
  v_cmp_eq_u32 vcc, -1, v15
  s_cbranch_vccz L_pls_408
  s_xor_b32 s57, s20, 24576
  buffer_load_dwordx4 v[32:35], v6, s[4:7], s57 offen offset:0 sc1
  s_xor_b32 s57, s20, 16384
  buffer_load_dwordx4 v[36:39], v6, s[4:7], s57 offen offset:0 sc1
  s_xor_b32 s57, s20, 8192
  buffer_load_dwordx4 v[40:43], v6, s[4:7], s57 offen offset:0 sc1
L_pls_408:
  v_max_u32 v15, v44, v48
  v_cmp_eq_u32 vcc, -1, v15
  s_cbranch_vccz L_pls_409
  buffer_load_dwordx4 v[44:47], v11, s[4:7], s34 offen offset:0 sc1
  buffer_load_dwordx4 v[48:51], v6, s[4:7], s20 offen offset:0 sc1
L_pls_409:
  s_waitcnt vmcnt(0)
  v_max3_u32 v15, v16, v20, v24
  v_max_u32 v15, v15, v28
  v_cmp_eq_u32 vcc, -1, v15
  s_cbranch_vccz L_plb_407
  s_sub_u32 s56, s56, 4
  s_cbranch_scc0 L_pl_406l
  s_mov_b32 s56, 0
  s_branch L_plb_407
L_pl_410:
L_pl_410l:
  s_xor_b32 s57, s20, 24576
  buffer_load_dwordx4 v[32:35], v6, s[4:7], s57 offen offset:0 sc1
  s_xor_b32 s57, s20, 16384
  buffer_load_dwordx4 v[36:39], v6, s[4:7], s57 offen offset:0 sc1
  s_xor_b32 s57, s20, 8192
  buffer_load_dwordx4 v[40:43], v6, s[4:7], s57 offen offset:0 sc1
  s_waitcnt vmcnt(3)
  v_max_u32 v15, v44, v48
  v_cmp_eq_u32 vcc, -1, v15
  s_cbranch_vccz L_pls_412
  buffer_load_dwordx4 v[44:47], v11, s[4:7], s34 offen offset:0 sc1
  buffer_load_dwordx4 v[48:51], v6, s[4:7], s20 offen offset:0 sc1
L_pls_412:
  s_waitcnt vmcnt(0)
  v_max3_u32 v15, v32, v36, v40
  v_cmp_eq_u32 vcc, -1, v15
  s_cbranch_vccz L_plb_411
  s_sub_u32 s56, s56, 4
  s_cbranch_scc0 L_pl_410l
  s_mov_b32 s56, 0
  s_branch L_plb_411
L_pl_413:
L_pl_413l:
  buffer_load_dwordx4 v[44:47], v11, s[4:7], s34 offen offset:0 sc1
  buffer_load_dwordx4 v[48:51], v6, s[4:7], s20 offen offset:0 sc1
  s_waitcnt vmcnt(2)
  s_waitcnt vmcnt(0)
  v_max_u32 v15, v44, v48
  v_cmp_eq_u32 vcc, -1, v15
  s_cbranch_vccz L_plb_414
  s_sub_u32 s56, s56, 4
  s_cbranch_scc0 L_pl_413l
  s_mov_b32 s56, 0
  s_branch L_plb_414
L_lsl_415:
  ds_read_b32 v7, v14 offset:320
  ds_read_b128 v[208:211], v72 offset:0
  ds_read_b128 v[212:215], v72 offset:1024
  ds_read_b128 v[216:219], v72 offset:2048
  ds_read_b128 v[220:223], v72 offset:3072
  s_waitcnt lgkmcnt(0)
  v_cmp_gt_u32 vcc, v247, v7
  s_cbranch_vccz L_lbk_416
  s_sub_u32 s56, s56, 1
  s_cbranch_scc0 L_lsl_415
  s_mov_b32 s56, 0
  s_branch L_lbk_416
L_lsl_417:
  ds_read_b32 v7, v14 offset:2688
  s_waitcnt lgkmcnt(0)
  v_cmp_gt_u32 vcc, v247, v7
  s_cbranch_vccz L_lbk_418
  s_sub_u32 s56, s56, 1
  s_cbranch_scc0 L_lsl_417
  s_mov_b32 s56, 0
  s_branch L_lbk_418
L_lsl_419:
  ds_read_b32 v7, v14 offset:1408
  s_waitcnt lgkmcnt(0)
  v_cmp_gt_u32 vcc, v247, v7
  s_cbranch_vccz L_lbk_420
  s_sub_u32 s56, s56, 1
  s_cbranch_scc0 L_lsl_419
  s_mov_b32 s56, 0
  s_branch L_lbk_420
L_pl_421:
L_pl_421l:
  buffer_load_dwordx4 v[16:19], v1, s[4:7], s23 offen offset:0 sc1
  buffer_load_dwordx4 v[20:23], v1, s[4:7], s23 offen offset:1024 sc1
  s_waitcnt vmcnt(2)
  v_max_u32 v15, v24, v28
  v_cmp_eq_u32 vcc, -1, v15
  s_cbranch_vccz L_pls_423
  buffer_load_dwordx4 v[24:27], v1, s[4:7], s23 offen offset:2048 sc1
  buffer_load_dwordx4 v[28:31], v1, s[4:7], s23 offen offset:3072 sc1
L_pls_423:
  v_max3_u32 v15, v32, v36, v40
  v_max_u32 v15, v15, v44
  v_cmp_eq_u32 vcc, -1, v15
  s_cbranch_vccz L_pls_424
  s_add_u32 s57, s23, 4096
  buffer_load_dwordx4 v[32:35], v1, s[4:7], s57 offen offset:0 sc1
  buffer_load_dwordx4 v[36:39], v1, s[4:7], s57 offen offset:1024 sc1
  buffer_load_dwordx4 v[40:43], v1, s[4:7], s57 offen offset:2048 sc1
  buffer_load_dwordx4 v[44:47], v1, s[4:7], s57 offen offset:3072 sc1
L_pls_424:
  s_waitcnt vmcnt(0)
  v_max_u32 v15, v16, v20
  v_cmp_eq_u32 vcc, -1, v15
  s_cbranch_vccz L_plb_422
  s_sub_u32 s56, s56, 4
  s_cbranch_scc0 L_pl_421l
  s_mov_b32 s56, 0
  s_branch L_plb_422
L_pl_425:
L_pl_425l:
  buffer_load_dwordx4 v[24:27], v1, s[4:7], s23 offen offset:2048 sc1
  buffer_load_dwordx4 v[28:31], v1, s[4:7], s23 offen offset:3072 sc1
  s_waitcnt vmcnt(2)
  v_max3_u32 v15, v32, v36, v40
  v_max_u32 v15, v15, v44
  v_cmp_eq_u32 vcc, -1, v15
  s_cbranch_vccz L_pls_427
  s_add_u32 s57, s23, 4096
  buffer_load_dwordx4 v[32:35], v1, s[4:7], s57 offen offset:0 sc1
  buffer_load_dwordx4 v[36:39], v1, s[4:7], s57 offen offset:1024 sc1
  buffer_load_dwordx4 v[40:43], v1, s[4:7], s57 offen offset:2048 sc1
  buffer_load_dwordx4 v[44:47], v1, s[4:7], s57 offen offset:3072 sc1
L_pls_427:
  v_max3_u32 v15, v48, v52, v56
  v_max_u32 v15, v15, v60
  v_cmp_eq_u32 vcc, -1, v15
  s_cbranch_vccz L_pls_428
  s_add_u32 s57, s23, 8192
  buffer_load_dwordx4 v[48:51], v1, s[4:7], s57 offen offset:0 sc1
  buffer_load_dwordx4 v[52:55], v1, s[4:7], s57 offen offset:1024 sc1
  buffer_load_dwordx4 v[56:59], v1, s[4:7], s57 offen offset:2048 sc1
  buffer_load_dwordx4 v[60:63], v1, s[4:7], s57 offen offset:3072 sc1
L_pls_428:
  s_waitcnt vmcnt(0)
  v_max_u32 v15, v24, v28
  v_cmp_eq_u32 vcc, -1, v15
  s_cbranch_vccz L_plb_426
  s_sub_u32 s56, s56, 4
  s_cbranch_scc0 L_pl_425l
  s_mov_b32 s56, 0
  s_branch L_plb_426
L_pl_429:
L_pl_429l:
  s_add_u32 s57, s23, 4096
  buffer_load_dwordx4 v[32:35], v1, s[4:7], s57 offen offset:0 sc1
  buffer_load_dwordx4 v[36:39], v1, s[4:7], s57 offen offset:1024 sc1
  buffer_load_dwordx4 v[40:43], v1, s[4:7], s57 offen offset:2048 sc1
  buffer_load_dwordx4 v[44:47], v1, s[4:7], s57 offen offset:3072 sc1
  s_waitcnt vmcnt(4)
  v_max3_u32 v15, v48, v52, v56
  v_max_u32 v15, v15, v60
  v_cmp_eq_u32 vcc, -1, v15
  s_cbranch_vccz L_pls_431
  s_add_u32 s57, s23, 8192
  buffer_load_dwordx4 v[48:51], v1, s[4:7], s57 offen offset:0 sc1
  buffer_load_dwordx4 v[52:55], v1, s[4:7], s57 offen offset:1024 sc1
  buffer_load_dwordx4 v[56:59], v1, s[4:7], s57 offen offset:2048 sc1
  buffer_load_dwordx4 v[60:63], v1, s[4:7], s57 offen offset:3072 sc1
L_pls_431:
  v_max3_u32 v15, v64, v68, v72
  v_max_u32 v15, v15, v76
  v_cmp_eq_u32 vcc, -1, v15
  s_cbranch_vccz L_pls_432
  s_add_u32 s57, s23, 12288
  buffer_load_dwordx4 v[64:67], v1, s[4:7], s57 offen offset:0 sc1
  buffer_load_dwordx4 v[68:71], v1, s[4:7], s57 offen offset:1024 sc1
  buffer_load_dwordx4 v[72:75], v1, s[4:7], s57 offen offset:2048 sc1
  buffer_load_dwordx4 v[76:79], v1, s[4:7], s57 offen offset:3072 sc1
L_pls_432:
  s_waitcnt vmcnt(0)
  v_max3_u32 v15, v32, v36, v40
  v_max_u32 v15, v15, v44
  v_cmp_eq_u32 vcc, -1, v15
  s_cbranch_vccz L_plb_430
  s_sub_u32 s56, s56, 4
  s_cbranch_scc0 L_pl_429l
  s_mov_b32 s56, 0
  s_branch L_plb_430
L_pl_433:
L_pl_433l:
  s_add_u32 s57, s23, 8192
  buffer_load_dwordx4 v[48:51], v1, s[4:7], s57 offen offset:0 sc1
  buffer_load_dwordx4 v[52:55], v1, s[4:7], s57 offen offset:1024 sc1
  buffer_load_dwordx4 v[56:59], v1, s[4:7], s57 offen offset:2048 sc1
  buffer_load_dwordx4 v[60:63], v1, s[4:7], s57 offen offset:3072 sc1
  s_waitcnt vmcnt(4)
  v_max3_u32 v15, v64, v68, v72
  v_max_u32 v15, v15, v76
  v_cmp_eq_u32 vcc, -1, v15
  s_cbranch_vccz L_pls_435
  s_add_u32 s57, s23, 12288
  buffer_load_dwordx4 v[64:67], v1, s[4:7], s57 offen offset:0 sc1
  buffer_load_dwordx4 v[68:71], v1, s[4:7], s57 offen offset:1024 sc1
  buffer_load_dwordx4 v[72:75], v1, s[4:7], s57 offen offset:2048 sc1
  buffer_load_dwordx4 v[76:79], v1, s[4:7], s57 offen offset:3072 sc1
L_pls_435:
  s_waitcnt vmcnt(0)
  v_max3_u32 v15, v48, v52, v56
  v_max_u32 v15, v15, v60
  v_cmp_eq_u32 vcc, -1, v15
  s_cbranch_vccz L_plb_434
  s_sub_u32 s56, s56, 4
  s_cbranch_scc0 L_pl_433l
  s_mov_b32 s56, 0
  s_branch L_plb_434
L_pl_436:
L_pl_436l:
  s_add_u32 s57, s23, 12288
  buffer_load_dwordx4 v[64:67], v1, s[4:7], s57 offen offset:0 sc1
  buffer_load_dwordx4 v[68:71], v1, s[4:7], s57 offen offset:1024 sc1
  buffer_load_dwordx4 v[72:75], v1, s[4:7], s57 offen offset:2048 sc1
  buffer_load_dwordx4 v[76:79], v1, s[4:7], s57 offen offset:3072 sc1
  s_waitcnt vmcnt(4)
  s_waitcnt vmcnt(0)
  v_max3_u32 v15, v64, v68, v72
  v_max_u32 v15, v15, v76
  v_cmp_eq_u32 vcc, -1, v15
  s_cbranch_vccz L_plb_437
  s_sub_u32 s56, s56, 4
  s_cbranch_scc0 L_pl_436l
  s_mov_b32 s56, 0
  s_branch L_plb_437
L_lsl_438:
  ds_read_b32 v7, v14 offset:384
  ds_read_b128 v[144:147], v13 offset:0
  ds_read_b128 v[148:151], v13 offset:1024
  ds_read_b128 v[152:155], v13 offset:2048
  ds_read_b128 v[156:159], v13 offset:3072
  s_waitcnt lgkmcnt(0)
  v_cmp_gt_u32 vcc, v247, v7
  s_nop 0
  s_and_b64 vcc, vcc, s[36:37]
  s_cbranch_scc0 L_lbk_439
  s_sub_u32 s56, s56, 1
  s_cbranch_scc0 L_lsl_438
  s_mov_b32 s56, 0
  s_branch L_lbk_439
L_pl_440:
L_pl_440l:
  buffer_load_dwordx4 v[16:19], v1, s[4:7], s26 offen offset:0 sc1
  buffer_load_dwordx4 v[20:23], v1, s[4:7], s26 offen offset:1024 sc1
  s_waitcnt vmcnt(2)
  v_max_u32 v15, v24, v28
  v_cmp_eq_u32 vcc, -1, v15
  s_cbranch_vccz L_pls_442
  buffer_load_dwordx4 v[24:27], v1, s[4:7], s26 offen offset:2048 sc1
  buffer_load_dwordx4 v[28:31], v1, s[4:7], s26 offen offset:3072 sc1
L_pls_442:
  v_max3_u32 v15, v32, v36, v40
  v_max_u32 v15, v15, v44
  v_cmp_eq_u32 vcc, -1, v15
  s_cbranch_vccz L_pls_443
  s_add_u32 s57, s26, 4096
  buffer_load_dwordx4 v[32:35], v1, s[4:7], s57 offen offset:0 sc1
  buffer_load_dwordx4 v[36:39], v1, s[4:7], s57 offen offset:1024 sc1
  buffer_load_dwordx4 v[40:43], v1, s[4:7], s57 offen offset:2048 sc1
  buffer_load_dwordx4 v[44:47], v1, s[4:7], s57 offen offset:3072 sc1
L_pls_443:
  v_max_u32 v15, v48, v52
  v_cmp_eq_u32 vcc, -1, v15
  s_cbranch_vccz L_pls_444
  s_add_u32 s57, s26, 8192
  buffer_load_dwordx4 v[48:51], v1, s[4:7], s57 offen offset:0 sc1
  buffer_load_dwordx4 v[52:55], v1, s[4:7], s57 offen offset:1024 sc1
L_pls_444:
  s_waitcnt vmcnt(0)
  v_max_u32 v15, v16, v20
  v_cmp_eq_u32 vcc, -1, v15
  s_cbranch_vccz L_plb_441
  s_sub_u32 s56, s56, 4
  s_cbranch_scc0 L_pl_440l
  s_mov_b32 s56, 0
  s_branch L_plb_441
L_pl_445:
L_pl_445l:
  buffer_load_dwordx4 v[24:27], v1, s[4:7], s26 offen offset:2048 sc1
  buffer_load_dwordx4 v[28:31], v1, s[4:7], s26 offen offset:3072 sc1
  s_waitcnt vmcnt(2)
  v_max3_u32 v15, v32, v36, v40
  v_max_u32 v15, v15, v44
  v_cmp_eq_u32 vcc, -1, v15
  s_cbranch_vccz L_pls_447
  s_add_u32 s57, s26, 4096
  buffer_load_dwordx4 v[32:35], v1, s[4:7], s57 offen offset:0 sc1
  buffer_load_dwordx4 v[36:39], v1, s[4:7], s57 offen offset:1024 sc1
  buffer_load_dwordx4 v[40:43], v1, s[4:7], s57 offen offset:2048 sc1
  buffer_load_dwordx4 v[44:47], v1, s[4:7], s57 offen offset:3072 sc1
L_pls_447:
  v_max3_u32 v15, v48, v52, v56
  v_max_u32 v15, v15, v60
  v_cmp_eq_u32 vcc, -1, v15
  s_cbranch_vccz L_pls_448
  s_add_u32 s57, s26, 8192
  buffer_load_dwordx4 v[48:51], v1, s[4:7], s57 offen offset:0 sc1
  buffer_load_dwordx4 v[52:55], v1, s[4:7], s57 offen offset:1024 sc1
  buffer_load_dwordx4 v[56:59], v1, s[4:7], s57 offen offset:2048 sc1
  buffer_load_dwordx4 v[60:63], v1, s[4:7], s57 offen offset:3072 sc1
L_pls_448:
  v_max_u32 v15, v64, v68
  v_cmp_eq_u32 vcc, -1, v15
  s_cbranch_vccz L_pls_449
  s_add_u32 s57, s26, 12288
  buffer_load_dwordx4 v[64:67], v1, s[4:7], s57 offen offset:0 sc1
  buffer_load_dwordx4 v[68:71], v1, s[4:7], s57 offen offset:1024 sc1
L_pls_449:
  s_waitcnt vmcnt(0)
  v_max_u32 v15, v24, v28
  v_cmp_eq_u32 vcc, -1, v15
  s_cbranch_vccz L_plb_446
  s_sub_u32 s56, s56, 4
  s_cbranch_scc0 L_pl_445l
  s_mov_b32 s56, 0
  s_branch L_plb_446
L_pl_450:
L_pl_450l:
  s_add_u32 s57, s26, 4096
  buffer_load_dwordx4 v[32:35], v1, s[4:7], s57 offen offset:0 sc1
  buffer_load_dwordx4 v[36:39], v1, s[4:7], s57 offen offset:1024 sc1
  buffer_load_dwordx4 v[40:43], v1, s[4:7], s57 offen offset:2048 sc1
  buffer_load_dwordx4 v[44:47], v1, s[4:7], s57 offen offset:3072 sc1
  s_waitcnt vmcnt(4)
  v_max3_u32 v15, v48, v52, v56
  v_max_u32 v15, v15, v60
  v_cmp_eq_u32 vcc, -1, v15
  s_cbranch_vccz L_pls_452
  s_add_u32 s57, s26, 8192
  buffer_load_dwordx4 v[48:51], v1, s[4:7], s57 offen offset:0 sc1
  buffer_load_dwordx4 v[52:55], v1, s[4:7], s57 offen offset:1024 sc1
  buffer_load_dwordx4 v[56:59], v1, s[4:7], s57 offen offset:2048 sc1
  buffer_load_dwordx4 v[60:63], v1, s[4:7], s57 offen offset:3072 sc1
L_pls_452:
  v_max3_u32 v15, v64, v68, v72
  v_max_u32 v15, v15, v76
  v_cmp_eq_u32 vcc, -1, v15
  s_cbranch_vccz L_pls_453
  s_add_u32 s57, s26, 12288
  buffer_load_dwordx4 v[64:67], v1, s[4:7], s57 offen offset:0 sc1
  buffer_load_dwordx4 v[68:71], v1, s[4:7], s57 offen offset:1024 sc1
  buffer_load_dwordx4 v[72:75], v1, s[4:7], s57 offen offset:2048 sc1
  buffer_load_dwordx4 v[76:79], v1, s[4:7], s57 offen offset:3072 sc1
L_pls_453:
  s_waitcnt vmcnt(0)
  v_max3_u32 v15, v32, v36, v40
  v_max_u32 v15, v15, v44
  v_cmp_eq_u32 vcc, -1, v15
  s_cbranch_vccz L_plb_451
  s_sub_u32 s56, s56, 4
  s_cbranch_scc0 L_pl_450l
  s_mov_b32 s56, 0
  s_branch L_plb_451
L_pl_454:
L_pl_454l:
  s_add_u32 s57, s26, 8192
  buffer_load_dwordx4 v[48:51], v1, s[4:7], s57 offen offset:0 sc1
  buffer_load_dwordx4 v[52:55], v1, s[4:7], s57 offen offset:1024 sc1
  buffer_load_dwordx4 v[56:59], v1, s[4:7], s57 offen offset:2048 sc1
  buffer_load_dwordx4 v[60:63], v1, s[4:7], s57 offen offset:3072 sc1
  s_waitcnt vmcnt(4)
  v_max3_u32 v15, v64, v68, v72
  v_max_u32 v15, v15, v76
  v_cmp_eq_u32 vcc, -1, v15
  s_cbranch_vccz L_pls_456
  s_add_u32 s57, s26, 12288
  buffer_load_dwordx4 v[64:67], v1, s[4:7], s57 offen offset:0 sc1
  buffer_load_dwordx4 v[68:71], v1, s[4:7], s57 offen offset:1024 sc1
  buffer_load_dwordx4 v[72:75], v1, s[4:7], s57 offen offset:2048 sc1
  buffer_load_dwordx4 v[76:79], v1, s[4:7], s57 offen offset:3072 sc1
L_pls_456:
  v_max3_u32 v15, v80, v84, v88
  v_max_u32 v15, v15, v92
  v_cmp_eq_u32 vcc, -1, v15
  s_cbranch_vccz L_pls_457
  s_add_u32 s57, s26, 16384
  buffer_load_dwordx4 v[80:83], v1, s[4:7], s57 offen offset:0 sc1
  buffer_load_dwordx4 v[84:87], v1, s[4:7], s57 offen offset:1024 sc1
  buffer_load_dwordx4 v[88:91], v1, s[4:7], s57 offen offset:2048 sc1
  buffer_load_dwordx4 v[92:95], v1, s[4:7], s57 offen offset:3072 sc1
L_pls_457:
  v_max3_u32 v15, v192, v194, v196
  v_max_u32 v15, v15, v198
  v_cmp_eq_u32 vcc, -1, v15
  s_cbranch_vccz L_pls_458
  buffer_load_dwordx2 v[192:193], v4, s[4:7], s27 offen offset:0 sc1
  buffer_load_dwordx2 v[194:195], v4, s[4:7], s27 offen offset:512 sc1
  buffer_load_dwordx2 v[196:197], v4, s[4:7], s27 offen offset:1024 sc1
  buffer_load_dwordx2 v[198:199], v4, s[4:7], s27 offen offset:1536 sc1
L_pls_458:
  s_waitcnt vmcnt(0)
  v_max3_u32 v15, v48, v52, v56
  v_max_u32 v15, v15, v60
  v_cmp_eq_u32 vcc, -1, v15
  s_cbranch_vccz L_plb_455
  s_sub_u32 s56, s56, 4
  s_cbranch_scc0 L_pl_454l
  s_mov_b32 s56, 0
  s_branch L_plb_455
L_pl_459:
L_pl_459l:
  s_add_u32 s57, s26, 12288
  buffer_load_dwordx4 v[64:67], v1, s[4:7], s57 offen offset:0 sc1
  buffer_load_dwordx4 v[68:71], v1, s[4:7], s57 offen offset:1024 sc1
  buffer_load_dwordx4 v[72:75], v1, s[4:7], s57 offen offset:2048 sc1
  buffer_load_dwordx4 v[76:79], v1, s[4:7], s57 offen offset:3072 sc1
  s_waitcnt vmcnt(4)
  v_max3_u32 v15, v80, v84, v88
  v_max_u32 v15, v15, v92
  v_cmp_eq_u32 vcc, -1, v15
  s_cbranch_vccz L_pls_461
  s_add_u32 s57, s26, 16384
  buffer_load_dwordx4 v[80:83], v1, s[4:7], s57 offen offset:0 sc1
  buffer_load_dwordx4 v[84:87], v1, s[4:7], s57 offen offset:1024 sc1
  buffer_load_dwordx4 v[88:91], v1, s[4:7], s57 offen offset:2048 sc1
  buffer_load_dwordx4 v[92:95], v1, s[4:7], s57 offen offset:3072 sc1
L_pls_461:
  v_max3_u32 v15, v96, v100, v104
  v_max_u32 v15, v15, v108
  v_cmp_eq_u32 vcc, -1, v15
  s_cbranch_vccz L_pls_462
  s_add_u32 s57, s26, 20480
  buffer_load_dwordx4 v[96:99], v1, s[4:7], s57 offen offset:0 sc1
  buffer_load_dwordx4 v[100:103], v1, s[4:7], s57 offen offset:1024 sc1
  buffer_load_dwordx4 v[104:107], v1, s[4:7], s57 offen offset:2048 sc1
  buffer_load_dwordx4 v[108:111], v1, s[4:7], s57 offen offset:3072 sc1
L_pls_462:
  v_max3_u32 v15, v192, v194, v196
  v_max3_u32 v15, v15, v198, v200
  v_max3_u32 v15, v15, v202, v204
  v_max_u32 v15, v15, v206
  v_cmp_eq_u32 vcc, -1, v15
  s_cbranch_vccz L_pls_463
  buffer_load_dwordx2 v[192:193], v4, s[4:7], s27 offen offset:0 sc1
  buffer_load_dwordx2 v[194:195], v4, s[4:7], s27 offen offset:512 sc1
  buffer_load_dwordx2 v[196:197], v4, s[4:7], s27 offen offset:1024 sc1
  buffer_load_dwordx2 v[198:199], v4, s[4:7], s27 offen offset:1536 sc1
  buffer_load_dwordx2 v[200:201], v4, s[4:7], s27 offen offset:2048 sc1
  buffer_load_dwordx2 v[202:203], v4, s[4:7], s27 offen offset:2560 sc1
  buffer_load_dwordx2 v[204:205], v4, s[4:7], s27 offen offset:3072 sc1
  buffer_load_dwordx2 v[206:207], v4, s[4:7], s27 offen offset:3584 sc1
L_pls_463:
  s_waitcnt vmcnt(0)
  v_max3_u32 v15, v64, v68, v72
  v_max_u32 v15, v15, v76
  v_cmp_eq_u32 vcc, -1, v15
  s_cbranch_vccz L_plb_460
  s_sub_u32 s56, s56, 4
  s_cbranch_scc0 L_pl_459l
  s_mov_b32 s56, 0
  s_branch L_plb_460
L_pl_464:
L_pl_464l:
  s_add_u32 s57, s26, 16384
  buffer_load_dwordx4 v[80:83], v1, s[4:7], s57 offen offset:0 sc1
  buffer_load_dwordx4 v[84:87], v1, s[4:7], s57 offen offset:1024 sc1
  buffer_load_dwordx4 v[88:91], v1, s[4:7], s57 offen offset:2048 sc1
  buffer_load_dwordx4 v[92:95], v1, s[4:7], s57 offen offset:3072 sc1
  s_waitcnt vmcnt(4)
  v_max3_u32 v15, v96, v100, v104
  v_max_u32 v15, v15, v108
  v_cmp_eq_u32 vcc, -1, v15
  s_cbranch_vccz L_pls_466
  s_add_u32 s57, s26, 20480
  buffer_load_dwordx4 v[96:99], v1, s[4:7], s57 offen offset:0 sc1
  buffer_load_dwordx4 v[100:103], v1, s[4:7], s57 offen offset:1024 sc1
  buffer_load_dwordx4 v[104:107], v1, s[4:7], s57 offen offset:2048 sc1
  buffer_load_dwordx4 v[108:111], v1, s[4:7], s57 offen offset:3072 sc1
L_pls_466:
  v_max3_u32 v15, v112, v116, v120
  v_max_u32 v15, v15, v124
  v_cmp_eq_u32 vcc, -1, v15
  s_cbranch_vccz L_pls_467
  s_add_u32 s57, s26, 24576
  buffer_load_dwordx4 v[112:115], v1, s[4:7], s57 offen offset:0 sc1
  buffer_load_dwordx4 v[116:119], v1, s[4:7], s57 offen offset:1024 sc1
  buffer_load_dwordx4 v[120:123], v1, s[4:7], s57 offen offset:2048 sc1
  buffer_load_dwordx4 v[124:127], v1, s[4:7], s57 offen offset:3072 sc1
L_pls_467:
  v_max3_u32 v15, v192, v194, v196
  v_max3_u32 v15, v15, v198, v200
  v_max3_u32 v15, v15, v202, v204
  v_max_u32 v15, v15, v206
  v_cmp_eq_u32 vcc, -1, v15
  s_cbranch_vccz L_pls_468
  buffer_load_dwordx2 v[192:193], v4, s[4:7], s27 offen offset:0 sc1
  buffer_load_dwordx2 v[194:195], v4, s[4:7], s27 offen offset:512 sc1
  buffer_load_dwordx2 v[196:197], v4, s[4:7], s27 offen offset:1024 sc1
  buffer_load_dwordx2 v[198:199], v4, s[4:7], s27 offen offset:1536 sc1
  buffer_load_dwordx2 v[200:201], v4, s[4:7], s27 offen offset:2048 sc1
  buffer_load_dwordx2 v[202:203], v4, s[4:7], s27 offen offset:2560 sc1
  buffer_load_dwordx2 v[204:205], v4, s[4:7], s27 offen offset:3072 sc1
  buffer_load_dwordx2 v[206:207], v4, s[4:7], s27 offen offset:3584 sc1
L_pls_468:
  s_waitcnt vmcnt(0)
  v_max3_u32 v15, v80, v84, v88
  v_max_u32 v15, v15, v92
  v_cmp_eq_u32 vcc, -1, v15
  s_cbranch_vccz L_plb_465
  s_sub_u32 s56, s56, 4
  s_cbranch_scc0 L_pl_464l
  s_mov_b32 s56, 0
  s_branch L_plb_465
L_pl_469:
L_pl_469l:
  s_add_u32 s57, s26, 20480
  buffer_load_dwordx4 v[96:99], v1, s[4:7], s57 offen offset:0 sc1
  buffer_load_dwordx4 v[100:103], v1, s[4:7], s57 offen offset:1024 sc1
  buffer_load_dwordx4 v[104:107], v1, s[4:7], s57 offen offset:2048 sc1
  buffer_load_dwordx4 v[108:111], v1, s[4:7], s57 offen offset:3072 sc1
  s_waitcnt vmcnt(4)
  v_max3_u32 v15, v112, v116, v120
  v_max_u32 v15, v15, v124
  v_cmp_eq_u32 vcc, -1, v15
  s_cbranch_vccz L_pls_471
  s_add_u32 s57, s26, 24576
  buffer_load_dwordx4 v[112:115], v1, s[4:7], s57 offen offset:0 sc1
  buffer_load_dwordx4 v[116:119], v1, s[4:7], s57 offen offset:1024 sc1
  buffer_load_dwordx4 v[120:123], v1, s[4:7], s57 offen offset:2048 sc1
  buffer_load_dwordx4 v[124:127], v1, s[4:7], s57 offen offset:3072 sc1
L_pls_471:
  v_max_u32 v15, v128, v132
  v_cmp_eq_u32 vcc, -1, v15
  s_cbranch_vccz L_pls_472
  s_add_u32 s57, s26, 28672
  buffer_load_dwordx4 v[128:131], v1, s[4:7], s57 offen offset:0 sc1
  buffer_load_dwordx4 v[132:135], v1, s[4:7], s57 offen offset:1024 sc1
L_pls_472:
  v_max_u32 v15, v136, v140
  v_cmp_eq_u32 vcc, -1, v15
  s_cbranch_vccz L_pls_473
  s_add_u32 s57, s26, 28672
  buffer_load_dwordx4 v[136:139], v1, s[4:7], s57 offen offset:2048 sc1
  buffer_load_dwordx4 v[140:143], v1, s[4:7], s57 offen offset:3072 sc1
L_pls_473:
  v_max3_u32 v15, v192, v194, v196
  v_max3_u32 v15, v15, v198, v200
  v_max3_u32 v15, v15, v202, v204
  v_max_u32 v15, v15, v206
  v_cmp_eq_u32 vcc, -1, v15
  s_cbranch_vccz L_pls_474
  buffer_load_dwordx2 v[192:193], v4, s[4:7], s27 offen offset:0 sc1
  buffer_load_dwordx2 v[194:195], v4, s[4:7], s27 offen offset:512 sc1
  buffer_load_dwordx2 v[196:197], v4, s[4:7], s27 offen offset:1024 sc1
  buffer_load_dwordx2 v[198:199], v4, s[4:7], s27 offen offset:1536 sc1
  buffer_load_dwordx2 v[200:201], v4, s[4:7], s27 offen offset:2048 sc1
  buffer_load_dwordx2 v[202:203], v4, s[4:7], s27 offen offset:2560 sc1
  buffer_load_dwordx2 v[204:205], v4, s[4:7], s27 offen offset:3072 sc1
  buffer_load_dwordx2 v[206:207], v4, s[4:7], s27 offen offset:3584 sc1
L_pls_474:
  s_waitcnt vmcnt(0)
  v_max3_u32 v15, v96, v100, v104
  v_max_u32 v15, v15, v108
  v_cmp_eq_u32 vcc, -1, v15
  s_cbranch_vccz L_plb_470
  s_sub_u32 s56, s56, 4
  s_cbranch_scc0 L_pl_469l
  s_mov_b32 s56, 0
  s_branch L_plb_470
L_pl_475:
L_pl_475l:
  buffer_load_dwordx2 v[192:193], v4, s[4:7], s27 offen offset:0 sc1
  buffer_load_dwordx2 v[194:195], v4, s[4:7], s27 offen offset:512 sc1
  buffer_load_dwordx2 v[196:197], v4, s[4:7], s27 offen offset:1024 sc1
  buffer_load_dwordx2 v[198:199], v4, s[4:7], s27 offen offset:1536 sc1
  buffer_load_dwordx2 v[200:201], v4, s[4:7], s27 offen offset:2048 sc1
  buffer_load_dwordx2 v[202:203], v4, s[4:7], s27 offen offset:2560 sc1
  buffer_load_dwordx2 v[204:205], v4, s[4:7], s27 offen offset:3072 sc1
  buffer_load_dwordx2 v[206:207], v4, s[4:7], s27 offen offset:3584 sc1
  s_waitcnt vmcnt(8)
  v_max3_u32 v15, v112, v116, v120
  v_max_u32 v15, v15, v124
  v_cmp_eq_u32 vcc, -1, v15
  s_cbranch_vccz L_pls_477
  s_add_u32 s57, s26, 24576
  buffer_load_dwordx4 v[112:115], v1, s[4:7], s57 offen offset:0 sc1
  buffer_load_dwordx4 v[116:119], v1, s[4:7], s57 offen offset:1024 sc1
  buffer_load_dwordx4 v[120:123], v1, s[4:7], s57 offen offset:2048 sc1
  buffer_load_dwordx4 v[124:127], v1, s[4:7], s57 offen offset:3072 sc1
L_pls_477:
  v_max_u32 v15, v128, v132
  v_cmp_eq_u32 vcc, -1, v15
  s_cbranch_vccz L_pls_478
  s_add_u32 s57, s26, 28672
  buffer_load_dwordx4 v[128:131], v1, s[4:7], s57 offen offset:0 sc1
  buffer_load_dwordx4 v[132:135], v1, s[4:7], s57 offen offset:1024 sc1
L_pls_478:
  v_max_u32 v15, v136, v140
  v_cmp_eq_u32 vcc, -1, v15
  s_cbranch_vccz L_pls_479
  s_add_u32 s57, s26, 28672
  buffer_load_dwordx4 v[136:139], v1, s[4:7], s57 offen offset:2048 sc1
  buffer_load_dwordx4 v[140:143], v1, s[4:7], s57 offen offset:3072 sc1
L_pls_479:
  s_waitcnt vmcnt(0)
  v_max3_u32 v15, v192, v194, v196
  v_max3_u32 v15, v15, v198, v200
  v_max3_u32 v15, v15, v202, v204
  v_max_u32 v15, v15, v206
  v_cmp_eq_u32 vcc, -1, v15
  s_cbranch_vccz L_plb_476
  s_sub_u32 s56, s56, 4
  s_cbranch_scc0 L_pl_475l
  s_mov_b32 s56, 0
  s_branch L_plb_476
L_pl_480:
L_pl_480l:
  s_add_u32 s57, s26, 24576
  buffer_load_dwordx4 v[112:115], v1, s[4:7], s57 offen offset:0 sc1
  buffer_load_dwordx4 v[116:119], v1, s[4:7], s57 offen offset:1024 sc1
  buffer_load_dwordx4 v[120:123], v1, s[4:7], s57 offen offset:2048 sc1
  buffer_load_dwordx4 v[124:127], v1, s[4:7], s57 offen offset:3072 sc1
  s_waitcnt vmcnt(4)
  v_max_u32 v15, v128, v132
  v_cmp_eq_u32 vcc, -1, v15
  s_cbranch_vccz L_pls_482
  s_add_u32 s57, s26, 28672
  buffer_load_dwordx4 v[128:131], v1, s[4:7], s57 offen offset:0 sc1
  buffer_load_dwordx4 v[132:135], v1, s[4:7], s57 offen offset:1024 sc1
L_pls_482:
  v_max_u32 v15, v136, v140
  v_cmp_eq_u32 vcc, -1, v15
  s_cbranch_vccz L_pls_483
  s_add_u32 s57, s26, 28672
  buffer_load_dwordx4 v[136:139], v1, s[4:7], s57 offen offset:2048 sc1
  buffer_load_dwordx4 v[140:143], v1, s[4:7], s57 offen offset:3072 sc1
L_pls_483:
  s_waitcnt vmcnt(0)
  v_max3_u32 v15, v112, v116, v120
  v_max_u32 v15, v15, v124
  v_cmp_eq_u32 vcc, -1, v15
  s_cbranch_vccz L_plb_481
  s_sub_u32 s56, s56, 4
  s_cbranch_scc0 L_pl_480l
  s_mov_b32 s56, 0
  s_branch L_plb_481
L_pl_484:
L_pl_484l:
  s_add_u32 s57, s26, 28672
  buffer_load_dwordx4 v[128:131], v1, s[4:7], s57 offen offset:0 sc1
  buffer_load_dwordx4 v[132:135], v1, s[4:7], s57 offen offset:1024 sc1
  s_waitcnt vmcnt(2)
  v_max_u32 v15, v136, v140
  v_cmp_eq_u32 vcc, -1, v15
  s_cbranch_vccz L_pls_486
  s_add_u32 s57, s26, 28672
  buffer_load_dwordx4 v[136:139], v1, s[4:7], s57 offen offset:2048 sc1
  buffer_load_dwordx4 v[140:143], v1, s[4:7], s57 offen offset:3072 sc1
L_pls_486:
  s_waitcnt vmcnt(0)
  v_max_u32 v15, v128, v132
  v_cmp_eq_u32 vcc, -1, v15
  s_cbranch_vccz L_plb_485
  s_sub_u32 s56, s56, 4
  s_cbranch_scc0 L_pl_484l
  s_mov_b32 s56, 0
  s_branch L_plb_485
L_lsl_487:
  ds_read_b32 v7, v14 offset:1472
  s_waitcnt lgkmcnt(0)
  v_cmp_gt_u32 vcc, v247, v7
  s_cbranch_vccz L_lbk_488
  s_sub_u32 s56, s56, 1
  s_cbranch_scc0 L_lsl_487
  s_mov_b32 s56, 0
  s_branch L_lbk_488
L_pl_489:
L_pl_489l:
  s_add_u32 s57, s26, 28672
  buffer_load_dwordx4 v[136:139], v1, s[4:7], s57 offen offset:2048 sc1
  buffer_load_dwordx4 v[140:143], v1, s[4:7], s57 offen offset:3072 sc1
  s_waitcnt vmcnt(2)
  s_waitcnt vmcnt(0)
  v_max_u32 v15, v136, v140
  v_cmp_eq_u32 vcc, -1, v15
  s_cbranch_vccz L_plb_490
  s_sub_u32 s56, s56, 4
  s_cbranch_scc0 L_pl_489l
  s_mov_b32 s56, 0
  s_branch L_plb_490
L_lsl_491:
  ds_read_b32 v7, v14 offset:1536
  s_waitcnt lgkmcnt(0)
  v_cmp_gt_u32 vcc, v247, v7
  s_cbranch_vccz L_lbk_492
  s_sub_u32 s56, s56, 1
  s_cbranch_scc0 L_lsl_491
  s_mov_b32 s56, 0
  s_branch L_lbk_492
L_lsl_493:
  ds_read_b32 v7, v14 offset:1600
  s_waitcnt lgkmcnt(0)
  v_cmp_gt_u32 vcc, v247, v7
  s_cbranch_vccz L_lbk_494
  s_sub_u32 s56, s56, 1
  s_cbranch_scc0 L_lsl_493
  s_mov_b32 s56, 0
  s_branch L_lbk_494
L_lsl_495:
  ds_read_b32 v7, v14 offset:1664
  s_waitcnt lgkmcnt(0)
  v_cmp_gt_u32 vcc, v247, v7
  s_cbranch_vccz L_lbk_496
  s_sub_u32 s56, s56, 1
  s_cbranch_scc0 L_lsl_495
  s_mov_b32 s56, 0
  s_branch L_lbk_496
L_pl_497:
L_pl_497l:
  buffer_load_dwordx4 v[16:19], v1, s[4:7], s29 offen offset:0 sc1
  buffer_load_dwordx4 v[20:23], v1, s[4:7], s29 offen offset:1024 sc1
  s_waitcnt vmcnt(2)
  v_max_u32 v15, v24, v28
  v_cmp_eq_u32 vcc, -1, v15
  s_cbranch_vccz L_pls_499
  buffer_load_dwordx4 v[24:27], v1, s[4:7], s29 offen offset:2048 sc1
  buffer_load_dwordx4 v[28:31], v1, s[4:7], s29 offen offset:3072 sc1
L_pls_499:
  v_max3_u32 v15, v32, v36, v40
  v_max_u32 v15, v15, v44
  v_cmp_eq_u32 vcc, -1, v15
  s_cbranch_vccz L_pls_500
  s_add_u32 s57, s29, 4096
  buffer_load_dwordx4 v[32:35], v1, s[4:7], s57 offen offset:0 sc1
  buffer_load_dwordx4 v[36:39], v1, s[4:7], s57 offen offset:1024 sc1
  buffer_load_dwordx4 v[40:43], v1, s[4:7], s57 offen offset:2048 sc1
  buffer_load_dwordx4 v[44:47], v1, s[4:7], s57 offen offset:3072 sc1
L_pls_500:
  v_max3_u32 v15, v48, v52, v56
  v_max_u32 v15, v15, v60
  v_cmp_eq_u32 vcc, -1, v15
  s_cbranch_vccz L_pls_501
  s_add_u32 s57, s29, 8192
  buffer_load_dwordx4 v[48:51], v1, s[4:7], s57 offen offset:0 sc1
  buffer_load_dwordx4 v[52:55], v1, s[4:7], s57 offen offset:1024 sc1
  buffer_load_dwordx4 v[56:59], v1, s[4:7], s57 offen offset:2048 sc1
  buffer_load_dwordx4 v[60:63], v1, s[4:7], s57 offen offset:3072 sc1
L_pls_501:
  v_max3_u32 v15, v64, v68, v72
  v_max_u32 v15, v15, v76
  v_cmp_eq_u32 vcc, -1, v15
  s_cbranch_vccz L_pls_502
  s_add_u32 s57, s29, 12288
  buffer_load_dwordx4 v[64:67], v1, s[4:7], s57 offen offset:0 sc1
  buffer_load_dwordx4 v[68:71], v1, s[4:7], s57 offen offset:1024 sc1
  buffer_load_dwordx4 v[72:75], v1, s[4:7], s57 offen offset:2048 sc1
  buffer_load_dwordx4 v[76:79], v1, s[4:7], s57 offen offset:3072 sc1
L_pls_502:
  s_waitcnt vmcnt(0)
  v_max_u32 v15, v16, v20
  v_cmp_eq_u32 vcc, -1, v15
  s_cbranch_vccz L_plb_498
  s_sub_u32 s56, s56, 4
  s_cbranch_scc0 L_pl_497l
  s_mov_b32 s56, 0
  s_branch L_plb_498
L_pl_503:
L_pl_503l:
  buffer_load_dwordx4 v[24:27], v1, s[4:7], s29 offen offset:2048 sc1
  buffer_load_dwordx4 v[28:31], v1, s[4:7], s29 offen offset:3072 sc1
  s_waitcnt vmcnt(2)
  v_max3_u32 v15, v32, v36, v40
  v_max_u32 v15, v15, v44
  v_cmp_eq_u32 vcc, -1, v15
  s_cbranch_vccz L_pls_505
  s_add_u32 s57, s29, 4096
  buffer_load_dwordx4 v[32:35], v1, s[4:7], s57 offen offset:0 sc1
  buffer_load_dwordx4 v[36:39], v1, s[4:7], s57 offen offset:1024 sc1
  buffer_load_dwordx4 v[40:43], v1, s[4:7], s57 offen offset:2048 sc1
  buffer_load_dwordx4 v[44:47], v1, s[4:7], s57 offen offset:3072 sc1
L_pls_505:
  v_max3_u32 v15, v48, v52, v56
  v_max_u32 v15, v15, v60
  v_cmp_eq_u32 vcc, -1, v15
  s_cbranch_vccz L_pls_506
  s_add_u32 s57, s29, 8192
  buffer_load_dwordx4 v[48:51], v1, s[4:7], s57 offen offset:0 sc1
  buffer_load_dwordx4 v[52:55], v1, s[4:7], s57 offen offset:1024 sc1
  buffer_load_dwordx4 v[56:59], v1, s[4:7], s57 offen offset:2048 sc1
  buffer_load_dwordx4 v[60:63], v1, s[4:7], s57 offen offset:3072 sc1
L_pls_506:
  v_max3_u32 v15, v64, v68, v72
  v_max_u32 v15, v15, v76
  v_cmp_eq_u32 vcc, -1, v15
  s_cbranch_vccz L_pls_507
  s_add_u32 s57, s29, 12288
  buffer_load_dwordx4 v[64:67], v1, s[4:7], s57 offen offset:0 sc1
  buffer_load_dwordx4 v[68:71], v1, s[4:7], s57 offen offset:1024 sc1
  buffer_load_dwordx4 v[72:75], v1, s[4:7], s57 offen offset:2048 sc1
  buffer_load_dwordx4 v[76:79], v1, s[4:7], s57 offen offset:3072 sc1
L_pls_507:
  v_cmp_eq_u32 vcc, -1, v80
  s_cbranch_vccz L_pls_508
  s_add_u32 s57, s29, 16384
  buffer_load_dwordx4 v[80:83], v1, s[4:7], s57 offen offset:0 sc1
L_pls_508:
  s_waitcnt vmcnt(0)
  v_max_u32 v15, v24, v28
  v_cmp_eq_u32 vcc, -1, v15
  s_cbranch_vccz L_plb_504
  s_sub_u32 s56, s56, 4
  s_cbranch_scc0 L_pl_503l
  s_mov_b32 s56, 0
  s_branch L_plb_504
L_pl_509:
L_pl_509l:
  s_add_u32 s57, s29, 4096
  buffer_load_dwordx4 v[32:35], v1, s[4:7], s57 offen offset:0 sc1
  buffer_load_dwordx4 v[36:39], v1, s[4:7], s57 offen offset:1024 sc1
  buffer_load_dwordx4 v[40:43], v1, s[4:7], s57 offen offset:2048 sc1
  buffer_load_dwordx4 v[44:47], v1, s[4:7], s57 offen offset:3072 sc1
  s_waitcnt vmcnt(4)
  v_max3_u32 v15, v48, v52, v56
  v_max_u32 v15, v15, v60
  v_cmp_eq_u32 vcc, -1, v15
  s_cbranch_vccz L_pls_511
  s_add_u32 s57, s29, 8192
  buffer_load_dwordx4 v[48:51], v1, s[4:7], s57 offen offset:0 sc1
  buffer_load_dwordx4 v[52:55], v1, s[4:7], s57 offen offset:1024 sc1
  buffer_load_dwordx4 v[56:59], v1, s[4:7], s57 offen offset:2048 sc1
  buffer_load_dwordx4 v[60:63], v1, s[4:7], s57 offen offset:3072 sc1
L_pls_511:
  v_max3_u32 v15, v64, v68, v72
  v_max_u32 v15, v15, v76
  v_cmp_eq_u32 vcc, -1, v15
  s_cbranch_vccz L_pls_512
  s_add_u32 s57, s29, 12288
  buffer_load_dwordx4 v[64:67], v1, s[4:7], s57 offen offset:0 sc1
  buffer_load_dwordx4 v[68:71], v1, s[4:7], s57 offen offset:1024 sc1
  buffer_load_dwordx4 v[72:75], v1, s[4:7], s57 offen offset:2048 sc1
  buffer_load_dwordx4 v[76:79], v1, s[4:7], s57 offen offset:3072 sc1
L_pls_512:
  v_max3_u32 v15, v80, v84, v88
  v_cmp_eq_u32 vcc, -1, v15
  s_cbranch_vccz L_pls_513
  s_add_u32 s57, s29, 16384
  buffer_load_dwordx4 v[80:83], v1, s[4:7], s57 offen offset:0 sc1
  buffer_load_dwordx4 v[84:87], v1, s[4:7], s57 offen offset:1024 sc1
  buffer_load_dwordx4 v[88:91], v1, s[4:7], s57 offen offset:2048 sc1
L_pls_513:
  s_waitcnt vmcnt(0)
  v_max3_u32 v15, v32, v36, v40
  v_max_u32 v15, v15, v44
  v_cmp_eq_u32 vcc, -1, v15
  s_cbranch_vccz L_plb_510
  s_sub_u32 s56, s56, 4
  s_cbranch_scc0 L_pl_509l
  s_mov_b32 s56, 0
  s_branch L_plb_510
L_pl_514:
L_pl_514l:
  s_add_u32 s57, s29, 8192
  buffer_load_dwordx4 v[48:51], v1, s[4:7], s57 offen offset:0 sc1
  buffer_load_dwordx4 v[52:55], v1, s[4:7], s57 offen offset:1024 sc1
  buffer_load_dwordx4 v[56:59], v1, s[4:7], s57 offen offset:2048 sc1
  buffer_load_dwordx4 v[60:63], v1, s[4:7], s57 offen offset:3072 sc1
  s_waitcnt vmcnt(4)
  v_max3_u32 v15, v64, v68, v72
  v_max_u32 v15, v15, v76
  v_cmp_eq_u32 vcc, -1, v15
  s_cbranch_vccz L_pls_516
  s_add_u32 s57, s29, 12288
  buffer_load_dwordx4 v[64:67], v1, s[4:7], s57 offen offset:0 sc1
  buffer_load_dwordx4 v[68:71], v1, s[4:7], s57 offen offset:1024 sc1
  buffer_load_dwordx4 v[72:75], v1, s[4:7], s57 offen offset:2048 sc1
  buffer_load_dwordx4 v[76:79], v1, s[4:7], s57 offen offset:3072 sc1
L_pls_516:
  v_max3_u32 v15, v80, v84, v88
  v_max_u32 v15, v15, v92
  v_cmp_eq_u32 vcc, -1, v15
  s_cbranch_vccz L_pls_517
  s_add_u32 s57, s29, 16384
  buffer_load_dwordx4 v[80:83], v1, s[4:7], s57 offen offset:0 sc1
  buffer_load_dwordx4 v[84:87], v1, s[4:7], s57 offen offset:1024 sc1
  buffer_load_dwordx4 v[88:91], v1, s[4:7], s57 offen offset:2048 sc1
  buffer_load_dwordx4 v[92:95], v1, s[4:7], s57 offen offset:3072 sc1
L_pls_517:
  v_max3_u32 v15, v96, v100, v104
  v_cmp_eq_u32 vcc, -1, v15
  s_cbranch_vccz L_pls_518
  s_add_u32 s57, s29, 20480
  buffer_load_dwordx4 v[96:99], v1, s[4:7], s57 offen offset:0 sc1
  buffer_load_dwordx4 v[100:103], v1, s[4:7], s57 offen offset:1024 sc1
  buffer_load_dwordx4 v[104:107], v1, s[4:7], s57 offen offset:2048 sc1
L_pls_518:
  s_waitcnt vmcnt(0)
  v_max3_u32 v15, v48, v52, v56
  v_max_u32 v15, v15, v60
  v_cmp_eq_u32 vcc, -1, v15
  s_cbranch_vccz L_plb_515
  s_sub_u32 s56, s56, 4
  s_cbranch_scc0 L_pl_514l
  s_mov_b32 s56, 0
  s_branch L_plb_515
L_pl_519:
L_pl_519l:
  s_add_u32 s57, s29, 12288
  buffer_load_dwordx4 v[64:67], v1, s[4:7], s57 offen offset:0 sc1
  buffer_load_dwordx4 v[68:71], v1, s[4:7], s57 offen offset:1024 sc1
  buffer_load_dwordx4 v[72:75], v1, s[4:7], s57 offen offset:2048 sc1
  buffer_load_dwordx4 v[76:79], v1, s[4:7], s57 offen offset:3072 sc1
  s_waitcnt vmcnt(4)
  v_max3_u32 v15, v80, v84, v88
  v_max_u32 v15, v15, v92
  v_cmp_eq_u32 vcc, -1, v15
  s_cbranch_vccz L_pls_521
  s_add_u32 s57, s29, 16384
  buffer_load_dwordx4 v[80:83], v1, s[4:7], s57 offen offset:0 sc1
  buffer_load_dwordx4 v[84:87], v1, s[4:7], s57 offen offset:1024 sc1
  buffer_load_dwordx4 v[88:91], v1, s[4:7], s57 offen offset:2048 sc1
  buffer_load_dwordx4 v[92:95], v1, s[4:7], s57 offen offset:3072 sc1
L_pls_521:
  v_max3_u32 v15, v96, v100, v104
  v_max_u32 v15, v15, v108
  v_cmp_eq_u32 vcc, -1, v15
  s_cbranch_vccz L_pls_522
  s_add_u32 s57, s29, 20480
  buffer_load_dwordx4 v[96:99], v1, s[4:7], s57 offen offset:0 sc1
  buffer_load_dwordx4 v[100:103], v1, s[4:7], s57 offen offset:1024 sc1
  buffer_load_dwordx4 v[104:107], v1, s[4:7], s57 offen offset:2048 sc1
  buffer_load_dwordx4 v[108:111], v1, s[4:7], s57 offen offset:3072 sc1
L_pls_522:
  v_max3_u32 v15, v112, v116, v120
  v_cmp_eq_u32 vcc, -1, v15
  s_cbranch_vccz L_pls_523
  s_add_u32 s57, s29, 24576
  buffer_load_dwordx4 v[112:115], v1, s[4:7], s57 offen offset:0 sc1
  buffer_load_dwordx4 v[116:119], v1, s[4:7], s57 offen offset:1024 sc1
  buffer_load_dwordx4 v[120:123], v1, s[4:7], s57 offen offset:2048 sc1
L_pls_523:
  s_waitcnt vmcnt(0)
  v_max3_u32 v15, v64, v68, v72
  v_max_u32 v15, v15, v76
  v_cmp_eq_u32 vcc, -1, v15
  s_cbranch_vccz L_plb_520
  s_sub_u32 s56, s56, 4
  s_cbranch_scc0 L_pl_519l
  s_mov_b32 s56, 0
  s_branch L_plb_520
L_pl_524:
L_pl_524l:
  s_add_u32 s57, s29, 16384
  buffer_load_dwordx4 v[80:83], v1, s[4:7], s57 offen offset:0 sc1
  buffer_load_dwordx4 v[84:87], v1, s[4:7], s57 offen offset:1024 sc1
  buffer_load_dwordx4 v[88:91], v1, s[4:7], s57 offen offset:2048 sc1
  buffer_load_dwordx4 v[92:95], v1, s[4:7], s57 offen offset:3072 sc1
  s_waitcnt vmcnt(4)
  v_max3_u32 v15, v96, v100, v104
  v_max_u32 v15, v15, v108
  v_cmp_eq_u32 vcc, -1, v15
  s_cbranch_vccz L_pls_526
  s_add_u32 s57, s29, 20480
  buffer_load_dwordx4 v[96:99], v1, s[4:7], s57 offen offset:0 sc1
  buffer_load_dwordx4 v[100:103], v1, s[4:7], s57 offen offset:1024 sc1
  buffer_load_dwordx4 v[104:107], v1, s[4:7], s57 offen offset:2048 sc1
  buffer_load_dwordx4 v[108:111], v1, s[4:7], s57 offen offset:3072 sc1
L_pls_526:
  v_max3_u32 v15, v112, v116, v120
  v_max_u32 v15, v15, v124
  v_cmp_eq_u32 vcc, -1, v15
  s_cbranch_vccz L_pls_527
  s_add_u32 s57, s29, 24576
  buffer_load_dwordx4 v[112:115], v1, s[4:7], s57 offen offset:0 sc1
  buffer_load_dwordx4 v[116:119], v1, s[4:7], s57 offen offset:1024 sc1
  buffer_load_dwordx4 v[120:123], v1, s[4:7], s57 offen offset:2048 sc1
  buffer_load_dwordx4 v[124:127], v1, s[4:7], s57 offen offset:3072 sc1
L_pls_527:
  v_max3_u32 v15, v128, v132, v136
  v_cmp_eq_u32 vcc, -1, v15
  s_cbranch_vccz L_pls_528
  s_add_u32 s57, s29, 28672
  buffer_load_dwordx4 v[128:131], v1, s[4:7], s57 offen offset:0 sc1
  buffer_load_dwordx4 v[132:135], v1, s[4:7], s57 offen offset:1024 sc1
  buffer_load_dwordx4 v[136:139], v1, s[4:7], s57 offen offset:2048 sc1
L_pls_528:
  s_waitcnt vmcnt(0)
  v_max3_u32 v15, v80, v84, v88
  v_max_u32 v15, v15, v92
  v_cmp_eq_u32 vcc, -1, v15
  s_cbranch_vccz L_plb_525
  s_sub_u32 s56, s56, 4
  s_cbranch_scc0 L_pl_524l
  s_mov_b32 s56, 0
  s_branch L_plb_525
L_lsl_529:
  ds_read_b32 v7, v14 offset:1728
  s_waitcnt lgkmcnt(0)
  v_cmp_gt_u32 vcc, v247, v7
  s_cbranch_vccz L_lbk_530
  s_sub_u32 s56, s56, 1
  s_cbranch_scc0 L_lsl_529
  s_mov_b32 s56, 0
  s_branch L_lbk_530
L_pl_531:
L_pl_531l:
  s_add_u32 s57, s29, 20480
  buffer_load_dwordx4 v[96:99], v1, s[4:7], s57 offen offset:0 sc1
  buffer_load_dwordx4 v[100:103], v1, s[4:7], s57 offen offset:1024 sc1
  buffer_load_dwordx4 v[104:107], v1, s[4:7], s57 offen offset:2048 sc1
  buffer_load_dwordx4 v[108:111], v1, s[4:7], s57 offen offset:3072 sc1
  s_waitcnt vmcnt(4)
  v_max3_u32 v15, v112, v116, v120
  v_max_u32 v15, v15, v124
  v_cmp_eq_u32 vcc, -1, v15
  s_cbranch_vccz L_pls_533
  s_add_u32 s57, s29, 24576
  buffer_load_dwordx4 v[112:115], v1, s[4:7], s57 offen offset:0 sc1
  buffer_load_dwordx4 v[116:119], v1, s[4:7], s57 offen offset:1024 sc1
  buffer_load_dwordx4 v[120:123], v1, s[4:7], s57 offen offset:2048 sc1
  buffer_load_dwordx4 v[124:127], v1, s[4:7], s57 offen offset:3072 sc1
L_pls_533:
  v_max3_u32 v15, v128, v132, v136
  v_max_u32 v15, v15, v140
  v_cmp_eq_u32 vcc, -1, v15
  s_cbranch_vccz L_pls_534
  s_add_u32 s57, s29, 28672
  buffer_load_dwordx4 v[128:131], v1, s[4:7], s57 offen offset:0 sc1
  buffer_load_dwordx4 v[132:135], v1, s[4:7], s57 offen offset:1024 sc1
  buffer_load_dwordx4 v[136:139], v1, s[4:7], s57 offen offset:2048 sc1
  buffer_load_dwordx4 v[140:143], v1, s[4:7], s57 offen offset:3072 sc1
L_pls_534:
  v_max_u32 v15, v16, v20
  v_cmp_eq_u32 vcc, -1, v15
  s_cbranch_vccz L_pls_535
  s_add_u32 s57, s29, 32768
  buffer_load_dwordx4 v[16:19], v1, s[4:7], s57 offen offset:0 sc1
  buffer_load_dwordx4 v[20:23], v1, s[4:7], s57 offen offset:1024 sc1
L_pls_535:
  s_waitcnt vmcnt(0)
  v_max3_u32 v15, v96, v100, v104
  v_max_u32 v15, v15, v108
  v_cmp_eq_u32 vcc, -1, v15
  s_cbranch_vccz L_plb_532
  s_sub_u32 s56, s56, 4
  s_cbranch_scc0 L_pl_531l
  s_mov_b32 s56, 0
  s_branch L_plb_532
L_pl_536:
L_pl_536l:
  s_add_u32 s57, s29, 24576
  buffer_load_dwordx4 v[112:115], v1, s[4:7], s57 offen offset:0 sc1
  buffer_load_dwordx4 v[116:119], v1, s[4:7], s57 offen offset:1024 sc1
  buffer_load_dwordx4 v[120:123], v1, s[4:7], s57 offen offset:2048 sc1
  buffer_load_dwordx4 v[124:127], v1, s[4:7], s57 offen offset:3072 sc1
  s_waitcnt vmcnt(4)
  v_max3_u32 v15, v128, v132, v136
  v_max_u32 v15, v15, v140
  v_cmp_eq_u32 vcc, -1, v15
  s_cbranch_vccz L_pls_538
  s_add_u32 s57, s29, 28672
  buffer_load_dwordx4 v[128:131], v1, s[4:7], s57 offen offset:0 sc1
  buffer_load_dwordx4 v[132:135], v1, s[4:7], s57 offen offset:1024 sc1
  buffer_load_dwordx4 v[136:139], v1, s[4:7], s57 offen offset:2048 sc1
  buffer_load_dwordx4 v[140:143], v1, s[4:7], s57 offen offset:3072 sc1
L_pls_538:
  v_max3_u32 v15, v16, v20, v24
  v_cmp_eq_u32 vcc, -1, v15
  s_cbranch_vccz L_pls_539
  s_add_u32 s57, s29, 32768
  buffer_load_dwordx4 v[16:19], v1, s[4:7], s57 offen offset:0 sc1
  buffer_load_dwordx4 v[20:23], v1, s[4:7], s57 offen offset:1024 sc1
  buffer_load_dwordx4 v[24:27], v1, s[4:7], s57 offen offset:2048 sc1
L_pls_539:
  v_max3_u32 v15, v28, v32, v36
  v_cmp_eq_u32 vcc, -1, v15
  s_cbranch_vccz L_pls_540
  s_add_u32 s57, s29, 32768
  buffer_load_dwordx4 v[28:31], v1, s[4:7], s57 offen offset:3072 sc1
  s_add_u32 s57, s29, 36864
  buffer_load_dwordx4 v[32:35], v1, s[4:7], s57 offen offset:0 sc1
  buffer_load_dwordx4 v[36:39], v1, s[4:7], s57 offen offset:1024 sc1
L_pls_540:
  s_waitcnt vmcnt(0)
  v_max3_u32 v15, v112, v116, v120
  v_max_u32 v15, v15, v124
  v_cmp_eq_u32 vcc, -1, v15
  s_cbranch_vccz L_plb_537
  s_sub_u32 s56, s56, 4
  s_cbranch_scc0 L_pl_536l
  s_mov_b32 s56, 0
  s_branch L_plb_537
L_lsl_541:
  ds_read_b32 v7, v14 offset:1792
  s_waitcnt lgkmcnt(0)
  v_cmp_gt_u32 vcc, v247, v7
  s_cbranch_vccz L_lbk_542
  s_sub_u32 s56, s56, 1
  s_cbranch_scc0 L_lsl_541
  s_mov_b32 s56, 0
  s_branch L_lbk_542
L_pl_543:
L_pl_543l:
  s_add_u32 s57, s29, 28672
  buffer_load_dwordx4 v[128:131], v1, s[4:7], s57 offen offset:0 sc1
  buffer_load_dwordx4 v[132:135], v1, s[4:7], s57 offen offset:1024 sc1
  buffer_load_dwordx4 v[136:139], v1, s[4:7], s57 offen offset:2048 sc1
  buffer_load_dwordx4 v[140:143], v1, s[4:7], s57 offen offset:3072 sc1
  s_waitcnt vmcnt(4)
  v_max3_u32 v15, v16, v20, v24
  v_cmp_eq_u32 vcc, -1, v15
  s_cbranch_vccz L_pls_545
  s_add_u32 s57, s29, 32768
  buffer_load_dwordx4 v[16:19], v1, s[4:7], s57 offen offset:0 sc1
  buffer_load_dwordx4 v[20:23], v1, s[4:7], s57 offen offset:1024 sc1
  buffer_load_dwordx4 v[24:27], v1, s[4:7], s57 offen offset:2048 sc1
L_pls_545:
  v_max3_u32 v15, v28, v32, v36
  v_max_u32 v15, v15, v40
  v_cmp_eq_u32 vcc, -1, v15
  s_cbranch_vccz L_pls_546
  s_add_u32 s57, s29, 32768
  buffer_load_dwordx4 v[28:31], v1, s[4:7], s57 offen offset:3072 sc1
  s_add_u32 s57, s29, 36864
  buffer_load_dwordx4 v[32:35], v1, s[4:7], s57 offen offset:0 sc1
  buffer_load_dwordx4 v[36:39], v1, s[4:7], s57 offen offset:1024 sc1
  buffer_load_dwordx4 v[40:43], v1, s[4:7], s57 offen offset:2048 sc1
L_pls_546:
  v_max3_u32 v15, v44, v48, v52
  v_cmp_eq_u32 vcc, -1, v15
  s_cbranch_vccz L_pls_547
  s_add_u32 s57, s29, 36864
  buffer_load_dwordx4 v[44:47], v1, s[4:7], s57 offen offset:3072 sc1
  s_add_u32 s57, s29, 40960
  buffer_load_dwordx4 v[48:51], v1, s[4:7], s57 offen offset:0 sc1
  buffer_load_dwordx4 v[52:55], v1, s[4:7], s57 offen offset:1024 sc1
L_pls_547:
  s_waitcnt vmcnt(0)
  v_max3_u32 v15, v128, v132, v136
  v_max_u32 v15, v15, v140
  v_cmp_eq_u32 vcc, -1, v15
  s_cbranch_vccz L_plb_544
  s_sub_u32 s56, s56, 4
  s_cbranch_scc0 L_pl_543l
  s_mov_b32 s56, 0
  s_branch L_plb_544
L_pl_548:
L_pl_548l:
  s_add_u32 s57, s29, 32768
  buffer_load_dwordx4 v[16:19], v1, s[4:7], s57 offen offset:0 sc1
  buffer_load_dwordx4 v[20:23], v1, s[4:7], s57 offen offset:1024 sc1
  buffer_load_dwordx4 v[24:27], v1, s[4:7], s57 offen offset:2048 sc1
  s_waitcnt vmcnt(3)
  v_max3_u32 v15, v28, v32, v36
  v_max_u32 v15, v15, v40
  v_cmp_eq_u32 vcc, -1, v15
  s_cbranch_vccz L_pls_550
  s_add_u32 s57, s29, 32768
  buffer_load_dwordx4 v[28:31], v1, s[4:7], s57 offen offset:3072 sc1
  s_add_u32 s57, s29, 36864
  buffer_load_dwordx4 v[32:35], v1, s[4:7], s57 offen offset:0 sc1
  buffer_load_dwordx4 v[36:39], v1, s[4:7], s57 offen offset:1024 sc1
  buffer_load_dwordx4 v[40:43], v1, s[4:7], s57 offen offset:2048 sc1
L_pls_550:
  v_max3_u32 v15, v44, v48, v52
  v_max_u32 v15, v15, v56
  v_cmp_eq_u32 vcc, -1, v15
  s_cbranch_vccz L_pls_551
  s_add_u32 s57, s29, 36864
  buffer_load_dwordx4 v[44:47], v1, s[4:7], s57 offen offset:3072 sc1
  s_add_u32 s57, s29, 40960
  buffer_load_dwordx4 v[48:51], v1, s[4:7], s57 offen offset:0 sc1
  buffer_load_dwordx4 v[52:55], v1, s[4:7], s57 offen offset:1024 sc1
  buffer_load_dwordx4 v[56:59], v1, s[4:7], s57 offen offset:2048 sc1
L_pls_551:
  s_waitcnt vmcnt(0)
  v_max3_u32 v15, v16, v20, v24
  v_cmp_eq_u32 vcc, -1, v15
  s_cbranch_vccz L_plb_549
  s_sub_u32 s56, s56, 4
  s_cbranch_scc0 L_pl_548l
  s_mov_b32 s56, 0
  s_branch L_plb_549
L_lsl_552:
  ds_read_b32 v7, v14 offset:1856
  s_waitcnt lgkmcnt(0)
  v_cmp_gt_u32 vcc, v247, v7
  s_cbranch_vccz L_lbk_553
  s_sub_u32 s56, s56, 1
  s_cbranch_scc0 L_lsl_552
  s_mov_b32 s56, 0
  s_branch L_lbk_553
L_pl_554:
L_pl_554l:
  s_add_u32 s57, s29, 32768
  buffer_load_dwordx4 v[28:31], v1, s[4:7], s57 offen offset:3072 sc1
  s_add_u32 s57, s29, 36864
  buffer_load_dwordx4 v[32:35], v1, s[4:7], s57 offen offset:0 sc1
  buffer_load_dwordx4 v[36:39], v1, s[4:7], s57 offen offset:1024 sc1
  buffer_load_dwordx4 v[40:43], v1, s[4:7], s57 offen offset:2048 sc1
  s_waitcnt vmcnt(4)
  v_max3_u32 v15, v44, v48, v52
  v_max_u32 v15, v15, v56
  v_cmp_eq_u32 vcc, -1, v15
  s_cbranch_vccz L_pls_556
  s_add_u32 s57, s29, 36864
  buffer_load_dwordx4 v[44:47], v1, s[4:7], s57 offen offset:3072 sc1
  s_add_u32 s57, s29, 40960
  buffer_load_dwordx4 v[48:51], v1, s[4:7], s57 offen offset:0 sc1
  buffer_load_dwordx4 v[52:55], v1, s[4:7], s57 offen offset:1024 sc1
  buffer_load_dwordx4 v[56:59], v1, s[4:7], s57 offen offset:2048 sc1
L_pls_556:
  s_waitcnt vmcnt(0)
  v_max3_u32 v15, v28, v32, v36
  v_max_u32 v15, v15, v40
  v_cmp_eq_u32 vcc, -1, v15
  s_cbranch_vccz L_plb_555
  s_sub_u32 s56, s56, 4
  s_cbranch_scc0 L_pl_554l
  s_mov_b32 s56, 0
  s_branch L_plb_555
L_pl_557:
L_pl_557l:
  s_add_u32 s57, s29, 36864
  buffer_load_dwordx4 v[44:47], v1, s[4:7], s57 offen offset:3072 sc1
  s_add_u32 s57, s29, 40960
  buffer_load_dwordx4 v[48:51], v1, s[4:7], s57 offen offset:0 sc1
  buffer_load_dwordx4 v[52:55], v1, s[4:7], s57 offen offset:1024 sc1
  buffer_load_dwordx4 v[56:59], v1, s[4:7], s57 offen offset:2048 sc1
  s_waitcnt vmcnt(4)
  s_waitcnt vmcnt(0)
  v_max3_u32 v15, v44, v48, v52
  v_max_u32 v15, v15, v56
  v_cmp_eq_u32 vcc, -1, v15
  s_cbranch_vccz L_plb_558
  s_sub_u32 s56, s56, 4
  s_cbranch_scc0 L_pl_557l
  s_mov_b32 s56, 0
  s_branch L_plb_558
L_lsl_559:
  ds_read_b32 v7, v14 offset:960
  s_waitcnt lgkmcnt(0)
  v_cmp_gt_u32 vcc, v247, v7
  s_cbranch_vccz L_lbk_560
  s_sub_u32 s56, s56, 1
  s_cbranch_scc0 L_lsl_559
  s_mov_b32 s56, 0
  s_branch L_lbk_560
L_lsl_561:
  ds_read_b32 v7, v14 offset:1664
  s_waitcnt lgkmcnt(0)
  v_cmp_gt_u32 vcc, v247, v7
  s_cbranch_vccz L_lbk_562
  s_sub_u32 s56, s56, 1
  s_cbranch_scc0 L_lsl_561
  s_mov_b32 s56, 0
  s_branch L_lbk_562
L_pl_563:
L_pl_563l:
  buffer_load_dwordx4 v[16:19], v1, s[4:7], s29 offen offset:0 sc1
  buffer_load_dwordx4 v[20:23], v1, s[4:7], s29 offen offset:1024 sc1
  s_waitcnt vmcnt(2)
  v_max_u32 v15, v24, v28
  v_cmp_eq_u32 vcc, -1, v15
  s_cbranch_vccz L_pls_565
  buffer_load_dwordx4 v[24:27], v1, s[4:7], s29 offen offset:2048 sc1
  buffer_load_dwordx4 v[28:31], v1, s[4:7], s29 offen offset:3072 sc1
L_pls_565:
  v_max3_u32 v15, v32, v36, v40
  v_max_u32 v15, v15, v44
  v_cmp_eq_u32 vcc, -1, v15
  s_cbranch_vccz L_pls_566
  s_add_u32 s57, s29, 4096
  buffer_load_dwordx4 v[32:35], v1, s[4:7], s57 offen offset:0 sc1
  buffer_load_dwordx4 v[36:39], v1, s[4:7], s57 offen offset:1024 sc1
  buffer_load_dwordx4 v[40:43], v1, s[4:7], s57 offen offset:2048 sc1
  buffer_load_dwordx4 v[44:47], v1, s[4:7], s57 offen offset:3072 sc1
L_pls_566:
  v_max3_u32 v15, v48, v52, v56
  v_max_u32 v15, v15, v60
  v_cmp_eq_u32 vcc, -1, v15
  s_cbranch_vccz L_pls_567
  s_add_u32 s57, s29, 8192
  buffer_load_dwordx4 v[48:51], v1, s[4:7], s57 offen offset:0 sc1
  buffer_load_dwordx4 v[52:55], v1, s[4:7], s57 offen offset:1024 sc1
  buffer_load_dwordx4 v[56:59], v1, s[4:7], s57 offen offset:2048 sc1
  buffer_load_dwordx4 v[60:63], v1, s[4:7], s57 offen offset:3072 sc1
L_pls_567:
  v_max3_u32 v15, v64, v68, v72
  v_max_u32 v15, v15, v76
  v_cmp_eq_u32 vcc, -1, v15
  s_cbranch_vccz L_pls_568
  s_add_u32 s57, s29, 12288
  buffer_load_dwordx4 v[64:67], v1, s[4:7], s57 offen offset:0 sc1
  buffer_load_dwordx4 v[68:71], v1, s[4:7], s57 offen offset:1024 sc1
  buffer_load_dwordx4 v[72:75], v1, s[4:7], s57 offen offset:2048 sc1
  buffer_load_dwordx4 v[76:79], v1, s[4:7], s57 offen offset:3072 sc1
L_pls_568:
  s_waitcnt vmcnt(0)
  v_max_u32 v15, v16, v20
  v_cmp_eq_u32 vcc, -1, v15
  s_cbranch_vccz L_plb_564
  s_sub_u32 s56, s56, 4
  s_cbranch_scc0 L_pl_563l
  s_mov_b32 s56, 0
  s_branch L_plb_564
L_pl_569:
L_pl_569l:
  buffer_load_dwordx4 v[24:27], v1, s[4:7], s29 offen offset:2048 sc1
  buffer_load_dwordx4 v[28:31], v1, s[4:7], s29 offen offset:3072 sc1
  s_waitcnt vmcnt(2)
  v_max3_u32 v15, v32, v36, v40
  v_max_u32 v15, v15, v44
  v_cmp_eq_u32 vcc, -1, v15
  s_cbranch_vccz L_pls_571
  s_add_u32 s57, s29, 4096
  buffer_load_dwordx4 v[32:35], v1, s[4:7], s57 offen offset:0 sc1
  buffer_load_dwordx4 v[36:39], v1, s[4:7], s57 offen offset:1024 sc1
  buffer_load_dwordx4 v[40:43], v1, s[4:7], s57 offen offset:2048 sc1
  buffer_load_dwordx4 v[44:47], v1, s[4:7], s57 offen offset:3072 sc1
L_pls_571:
  v_max3_u32 v15, v48, v52, v56
  v_max_u32 v15, v15, v60
  v_cmp_eq_u32 vcc, -1, v15
  s_cbranch_vccz L_pls_572
  s_add_u32 s57, s29, 8192
  buffer_load_dwordx4 v[48:51], v1, s[4:7], s57 offen offset:0 sc1
  buffer_load_dwordx4 v[52:55], v1, s[4:7], s57 offen offset:1024 sc1
  buffer_load_dwordx4 v[56:59], v1, s[4:7], s57 offen offset:2048 sc1
  buffer_load_dwordx4 v[60:63], v1, s[4:7], s57 offen offset:3072 sc1
L_pls_572:
  v_max3_u32 v15, v64, v68, v72
  v_max_u32 v15, v15, v76
  v_cmp_eq_u32 vcc, -1, v15
  s_cbranch_vccz L_pls_573
  s_add_u32 s57, s29, 12288
  buffer_load_dwordx4 v[64:67], v1, s[4:7], s57 offen offset:0 sc1
  buffer_load_dwordx4 v[68:71], v1, s[4:7], s57 offen offset:1024 sc1
  buffer_load_dwordx4 v[72:75], v1, s[4:7], s57 offen offset:2048 sc1
  buffer_load_dwordx4 v[76:79], v1, s[4:7], s57 offen offset:3072 sc1
L_pls_573:
  v_cmp_eq_u32 vcc, -1, v80
  s_cbranch_vccz L_pls_574
  s_add_u32 s57, s29, 16384
  buffer_load_dwordx4 v[80:83], v1, s[4:7], s57 offen offset:0 sc1
L_pls_574:
  s_waitcnt vmcnt(0)
  v_max_u32 v15, v24, v28
  v_cmp_eq_u32 vcc, -1, v15
  s_cbranch_vccz L_plb_570
  s_sub_u32 s56, s56, 4
  s_cbranch_scc0 L_pl_569l
  s_mov_b32 s56, 0
  s_branch L_plb_570
L_pl_575:
L_pl_575l:
  s_add_u32 s57, s29, 4096
  buffer_load_dwordx4 v[32:35], v1, s[4:7], s57 offen offset:0 sc1
  buffer_load_dwordx4 v[36:39], v1, s[4:7], s57 offen offset:1024 sc1
  buffer_load_dwordx4 v[40:43], v1, s[4:7], s57 offen offset:2048 sc1
  buffer_load_dwordx4 v[44:47], v1, s[4:7], s57 offen offset:3072 sc1
  s_waitcnt vmcnt(4)
  v_max3_u32 v15, v48, v52, v56
  v_max_u32 v15, v15, v60
  v_cmp_eq_u32 vcc, -1, v15
  s_cbranch_vccz L_pls_577
  s_add_u32 s57, s29, 8192
  buffer_load_dwordx4 v[48:51], v1, s[4:7], s57 offen offset:0 sc1
  buffer_load_dwordx4 v[52:55], v1, s[4:7], s57 offen offset:1024 sc1
  buffer_load_dwordx4 v[56:59], v1, s[4:7], s57 offen offset:2048 sc1
  buffer_load_dwordx4 v[60:63], v1, s[4:7], s57 offen offset:3072 sc1
L_pls_577:
  v_max3_u32 v15, v64, v68, v72
  v_max_u32 v15, v15, v76
  v_cmp_eq_u32 vcc, -1, v15
  s_cbranch_vccz L_pls_578
  s_add_u32 s57, s29, 12288
  buffer_load_dwordx4 v[64:67], v1, s[4:7], s57 offen offset:0 sc1
  buffer_load_dwordx4 v[68:71], v1, s[4:7], s57 offen offset:1024 sc1
  buffer_load_dwordx4 v[72:75], v1, s[4:7], s57 offen offset:2048 sc1
  buffer_load_dwordx4 v[76:79], v1, s[4:7], s57 offen offset:3072 sc1
L_pls_578:
  v_max3_u32 v15, v80, v84, v88
  v_cmp_eq_u32 vcc, -1, v15
  s_cbranch_vccz L_pls_579
  s_add_u32 s57, s29, 16384
  buffer_load_dwordx4 v[80:83], v1, s[4:7], s57 offen offset:0 sc1
  buffer_load_dwordx4 v[84:87], v1, s[4:7], s57 offen offset:1024 sc1
  buffer_load_dwordx4 v[88:91], v1, s[4:7], s57 offen offset:2048 sc1
L_pls_579:
  s_waitcnt vmcnt(0)
  v_max3_u32 v15, v32, v36, v40
  v_max_u32 v15, v15, v44
  v_cmp_eq_u32 vcc, -1, v15
  s_cbranch_vccz L_plb_576
  s_sub_u32 s56, s56, 4
  s_cbranch_scc0 L_pl_575l
  s_mov_b32 s56, 0
  s_branch L_plb_576
L_pl_580:
L_pl_580l:
  s_add_u32 s57, s29, 8192
  buffer_load_dwordx4 v[48:51], v1, s[4:7], s57 offen offset:0 sc1
  buffer_load_dwordx4 v[52:55], v1, s[4:7], s57 offen offset:1024 sc1
  buffer_load_dwordx4 v[56:59], v1, s[4:7], s57 offen offset:2048 sc1
  buffer_load_dwordx4 v[60:63], v1, s[4:7], s57 offen offset:3072 sc1
  s_waitcnt vmcnt(4)
  v_max3_u32 v15, v64, v68, v72
  v_max_u32 v15, v15, v76
  v_cmp_eq_u32 vcc, -1, v15
  s_cbranch_vccz L_pls_582
  s_add_u32 s57, s29, 12288
  buffer_load_dwordx4 v[64:67], v1, s[4:7], s57 offen offset:0 sc1
  buffer_load_dwordx4 v[68:71], v1, s[4:7], s57 offen offset:1024 sc1
  buffer_load_dwordx4 v[72:75], v1, s[4:7], s57 offen offset:2048 sc1
  buffer_load_dwordx4 v[76:79], v1, s[4:7], s57 offen offset:3072 sc1
L_pls_582:
  v_max3_u32 v15, v80, v84, v88
  v_max_u32 v15, v15, v92
  v_cmp_eq_u32 vcc, -1, v15
  s_cbranch_vccz L_pls_583
  s_add_u32 s57, s29, 16384
  buffer_load_dwordx4 v[80:83], v1, s[4:7], s57 offen offset:0 sc1
  buffer_load_dwordx4 v[84:87], v1, s[4:7], s57 offen offset:1024 sc1
  buffer_load_dwordx4 v[88:91], v1, s[4:7], s57 offen offset:2048 sc1
  buffer_load_dwordx4 v[92:95], v1, s[4:7], s57 offen offset:3072 sc1
L_pls_583:
  v_max3_u32 v15, v96, v100, v104
  v_cmp_eq_u32 vcc, -1, v15
  s_cbranch_vccz L_pls_584
  s_add_u32 s57, s29, 20480
  buffer_load_dwordx4 v[96:99], v1, s[4:7], s57 offen offset:0 sc1
  buffer_load_dwordx4 v[100:103], v1, s[4:7], s57 offen offset:1024 sc1
  buffer_load_dwordx4 v[104:107], v1, s[4:7], s57 offen offset:2048 sc1
L_pls_584:
  s_waitcnt vmcnt(0)
  v_max3_u32 v15, v48, v52, v56
  v_max_u32 v15, v15, v60
  v_cmp_eq_u32 vcc, -1, v15
  s_cbranch_vccz L_plb_581
  s_sub_u32 s56, s56, 4
  s_cbranch_scc0 L_pl_580l
  s_mov_b32 s56, 0
  s_branch L_plb_581
L_pl_585:
L_pl_585l:
  s_add_u32 s57, s29, 12288
  buffer_load_dwordx4 v[64:67], v1, s[4:7], s57 offen offset:0 sc1
  buffer_load_dwordx4 v[68:71], v1, s[4:7], s57 offen offset:1024 sc1
  buffer_load_dwordx4 v[72:75], v1, s[4:7], s57 offen offset:2048 sc1
  buffer_load_dwordx4 v[76:79], v1, s[4:7], s57 offen offset:3072 sc1
  s_waitcnt vmcnt(4)
  v_max3_u32 v15, v80, v84, v88
  v_max_u32 v15, v15, v92
  v_cmp_eq_u32 vcc, -1, v15
  s_cbranch_vccz L_pls_587
  s_add_u32 s57, s29, 16384
  buffer_load_dwordx4 v[80:83], v1, s[4:7], s57 offen offset:0 sc1
  buffer_load_dwordx4 v[84:87], v1, s[4:7], s57 offen offset:1024 sc1
  buffer_load_dwordx4 v[88:91], v1, s[4:7], s57 offen offset:2048 sc1
  buffer_load_dwordx4 v[92:95], v1, s[4:7], s57 offen offset:3072 sc1
L_pls_587:
  v_max3_u32 v15, v96, v100, v104
  v_max_u32 v15, v15, v108
  v_cmp_eq_u32 vcc, -1, v15
  s_cbranch_vccz L_pls_588
  s_add_u32 s57, s29, 20480
  buffer_load_dwordx4 v[96:99], v1, s[4:7], s57 offen offset:0 sc1
  buffer_load_dwordx4 v[100:103], v1, s[4:7], s57 offen offset:1024 sc1
  buffer_load_dwordx4 v[104:107], v1, s[4:7], s57 offen offset:2048 sc1
  buffer_load_dwordx4 v[108:111], v1, s[4:7], s57 offen offset:3072 sc1
L_pls_588:
  v_max3_u32 v15, v112, v116, v120
  v_cmp_eq_u32 vcc, -1, v15
  s_cbranch_vccz L_pls_589
  s_add_u32 s57, s29, 24576
  buffer_load_dwordx4 v[112:115], v1, s[4:7], s57 offen offset:0 sc1
  buffer_load_dwordx4 v[116:119], v1, s[4:7], s57 offen offset:1024 sc1
  buffer_load_dwordx4 v[120:123], v1, s[4:7], s57 offen offset:2048 sc1
L_pls_589:
  s_waitcnt vmcnt(0)
  v_max3_u32 v15, v64, v68, v72
  v_max_u32 v15, v15, v76
  v_cmp_eq_u32 vcc, -1, v15
  s_cbranch_vccz L_plb_586
  s_sub_u32 s56, s56, 4
  s_cbranch_scc0 L_pl_585l
  s_mov_b32 s56, 0
  s_branch L_plb_586
L_pl_590:
L_pl_590l:
  s_add_u32 s57, s29, 16384
  buffer_load_dwordx4 v[80:83], v1, s[4:7], s57 offen offset:0 sc1
  buffer_load_dwordx4 v[84:87], v1, s[4:7], s57 offen offset:1024 sc1
  buffer_load_dwordx4 v[88:91], v1, s[4:7], s57 offen offset:2048 sc1
  buffer_load_dwordx4 v[92:95], v1, s[4:7], s57 offen offset:3072 sc1
  s_waitcnt vmcnt(4)
  v_max3_u32 v15, v96, v100, v104
  v_max_u32 v15, v15, v108
  v_cmp_eq_u32 vcc, -1, v15
  s_cbranch_vccz L_pls_592
  s_add_u32 s57, s29, 20480
  buffer_load_dwordx4 v[96:99], v1, s[4:7], s57 offen offset:0 sc1
  buffer_load_dwordx4 v[100:103], v1, s[4:7], s57 offen offset:1024 sc1
  buffer_load_dwordx4 v[104:107], v1, s[4:7], s57 offen offset:2048 sc1
  buffer_load_dwordx4 v[108:111], v1, s[4:7], s57 offen offset:3072 sc1
L_pls_592:
  v_max3_u32 v15, v112, v116, v120
  v_max_u32 v15, v15, v124
  v_cmp_eq_u32 vcc, -1, v15
  s_cbranch_vccz L_pls_593
  s_add_u32 s57, s29, 24576
  buffer_load_dwordx4 v[112:115], v1, s[4:7], s57 offen offset:0 sc1
  buffer_load_dwordx4 v[116:119], v1, s[4:7], s57 offen offset:1024 sc1
  buffer_load_dwordx4 v[120:123], v1, s[4:7], s57 offen offset:2048 sc1
  buffer_load_dwordx4 v[124:127], v1, s[4:7], s57 offen offset:3072 sc1
L_pls_593:
  v_max3_u32 v15, v128, v132, v136
  v_cmp_eq_u32 vcc, -1, v15
  s_cbranch_vccz L_pls_594
  s_add_u32 s57, s29, 28672
  buffer_load_dwordx4 v[128:131], v1, s[4:7], s57 offen offset:0 sc1
  buffer_load_dwordx4 v[132:135], v1, s[4:7], s57 offen offset:1024 sc1
  buffer_load_dwordx4 v[136:139], v1, s[4:7], s57 offen offset:2048 sc1
L_pls_594:
  s_waitcnt vmcnt(0)
  v_max3_u32 v15, v80, v84, v88
  v_max_u32 v15, v15, v92
  v_cmp_eq_u32 vcc, -1, v15
  s_cbranch_vccz L_plb_591
  s_sub_u32 s56, s56, 4
  s_cbranch_scc0 L_pl_590l
  s_mov_b32 s56, 0
  s_branch L_plb_591
L_lsl_595:
  ds_read_b32 v7, v14 offset:1728
  s_waitcnt lgkmcnt(0)
  v_cmp_gt_u32 vcc, v247, v7
  s_cbranch_vccz L_lbk_596
  s_sub_u32 s56, s56, 1
  s_cbranch_scc0 L_lsl_595
  s_mov_b32 s56, 0
  s_branch L_lbk_596
L_pl_597:
L_pl_597l:
  s_add_u32 s57, s29, 20480
  buffer_load_dwordx4 v[96:99], v1, s[4:7], s57 offen offset:0 sc1
  buffer_load_dwordx4 v[100:103], v1, s[4:7], s57 offen offset:1024 sc1
  buffer_load_dwordx4 v[104:107], v1, s[4:7], s57 offen offset:2048 sc1
  buffer_load_dwordx4 v[108:111], v1, s[4:7], s57 offen offset:3072 sc1
  s_waitcnt vmcnt(4)
  v_max3_u32 v15, v112, v116, v120
  v_max_u32 v15, v15, v124
  v_cmp_eq_u32 vcc, -1, v15
  s_cbranch_vccz L_pls_599
  s_add_u32 s57, s29, 24576
  buffer_load_dwordx4 v[112:115], v1, s[4:7], s57 offen offset:0 sc1
  buffer_load_dwordx4 v[116:119], v1, s[4:7], s57 offen offset:1024 sc1
  buffer_load_dwordx4 v[120:123], v1, s[4:7], s57 offen offset:2048 sc1
  buffer_load_dwordx4 v[124:127], v1, s[4:7], s57 offen offset:3072 sc1
L_pls_599:
  v_max3_u32 v15, v128, v132, v136
  v_max_u32 v15, v15, v140
  v_cmp_eq_u32 vcc, -1, v15
  s_cbranch_vccz L_pls_600
  s_add_u32 s57, s29, 28672
  buffer_load_dwordx4 v[128:131], v1, s[4:7], s57 offen offset:0 sc1
  buffer_load_dwordx4 v[132:135], v1, s[4:7], s57 offen offset:1024 sc1
  buffer_load_dwordx4 v[136:139], v1, s[4:7], s57 offen offset:2048 sc1
  buffer_load_dwordx4 v[140:143], v1, s[4:7], s57 offen offset:3072 sc1
L_pls_600:
  s_waitcnt vmcnt(0)
  v_max3_u32 v15, v96, v100, v104
  v_max_u32 v15, v15, v108
  v_cmp_eq_u32 vcc, -1, v15
  s_cbranch_vccz L_plb_598
  s_sub_u32 s56, s56, 4
  s_cbranch_scc0 L_pl_597l
  s_mov_b32 s56, 0
  s_branch L_plb_598
L_pl_601:
L_pl_601l:
  s_add_u32 s57, s29, 24576
  buffer_load_dwordx4 v[112:115], v1, s[4:7], s57 offen offset:0 sc1
  buffer_load_dwordx4 v[116:119], v1, s[4:7], s57 offen offset:1024 sc1
  buffer_load_dwordx4 v[120:123], v1, s[4:7], s57 offen offset:2048 sc1
  buffer_load_dwordx4 v[124:127], v1, s[4:7], s57 offen offset:3072 sc1
  s_waitcnt vmcnt(4)
  v_max3_u32 v15, v128, v132, v136
  v_max_u32 v15, v15, v140
  v_cmp_eq_u32 vcc, -1, v15
  s_cbranch_vccz L_pls_603
  s_add_u32 s57, s29, 28672
  buffer_load_dwordx4 v[128:131], v1, s[4:7], s57 offen offset:0 sc1
  buffer_load_dwordx4 v[132:135], v1, s[4:7], s57 offen offset:1024 sc1
  buffer_load_dwordx4 v[136:139], v1, s[4:7], s57 offen offset:2048 sc1
  buffer_load_dwordx4 v[140:143], v1, s[4:7], s57 offen offset:3072 sc1
L_pls_603:
  v_max_u32 v15, v16, v20
  v_cmp_eq_u32 vcc, -1, v15
  s_cbranch_vccz L_pls_604
  s_add_u32 s57, s29, 32768
  buffer_load_dwordx4 v[16:19], v1, s[4:7], s57 offen offset:0 sc1
  buffer_load_dwordx4 v[20:23], v1, s[4:7], s57 offen offset:1024 sc1
L_pls_604:
  s_waitcnt vmcnt(0)
  v_max3_u32 v15, v112, v116, v120
  v_max_u32 v15, v15, v124
  v_cmp_eq_u32 vcc, -1, v15
  s_cbranch_vccz L_plb_602
  s_sub_u32 s56, s56, 4
  s_cbranch_scc0 L_pl_601l
  s_mov_b32 s56, 0
  s_branch L_plb_602
L_lsl_605:
  ds_read_b32 v7, v14 offset:1792
  s_waitcnt lgkmcnt(0)
  v_cmp_gt_u32 vcc, v247, v7
  s_cbranch_vccz L_lbk_606
  s_sub_u32 s56, s56, 1
  s_cbranch_scc0 L_lsl_605
  s_mov_b32 s56, 0
  s_branch L_lbk_606
L_pl_607:
L_pl_607l:
  s_add_u32 s57, s29, 28672
  buffer_load_dwordx4 v[128:131], v1, s[4:7], s57 offen offset:0 sc1
  buffer_load_dwordx4 v[132:135], v1, s[4:7], s57 offen offset:1024 sc1
  buffer_load_dwordx4 v[136:139], v1, s[4:7], s57 offen offset:2048 sc1
  buffer_load_dwordx4 v[140:143], v1, s[4:7], s57 offen offset:3072 sc1
  s_waitcnt vmcnt(4)
  v_max3_u32 v15, v16, v20, v24
  v_cmp_eq_u32 vcc, -1, v15
  s_cbranch_vccz L_pls_609
  s_add_u32 s57, s29, 32768
  buffer_load_dwordx4 v[16:19], v1, s[4:7], s57 offen offset:0 sc1
  buffer_load_dwordx4 v[20:23], v1, s[4:7], s57 offen offset:1024 sc1
  buffer_load_dwordx4 v[24:27], v1, s[4:7], s57 offen offset:2048 sc1
L_pls_609:
  v_max3_u32 v15, v28, v32, v36
  v_cmp_eq_u32 vcc, -1, v15
  s_cbranch_vccz L_pls_610
  s_add_u32 s57, s29, 32768
  buffer_load_dwordx4 v[28:31], v1, s[4:7], s57 offen offset:3072 sc1
  s_add_u32 s57, s29, 36864
  buffer_load_dwordx4 v[32:35], v1, s[4:7], s57 offen offset:0 sc1
  buffer_load_dwordx4 v[36:39], v1, s[4:7], s57 offen offset:1024 sc1
L_pls_610:
  s_waitcnt vmcnt(0)
  v_max3_u32 v15, v128, v132, v136
  v_max_u32 v15, v15, v140
  v_cmp_eq_u32 vcc, -1, v15
  s_cbranch_vccz L_plb_608
  s_sub_u32 s56, s56, 4
  s_cbranch_scc0 L_pl_607l
  s_mov_b32 s56, 0
  s_branch L_plb_608
L_pl_611:
L_pl_611l:
  s_add_u32 s57, s29, 32768
  buffer_load_dwordx4 v[16:19], v1, s[4:7], s57 offen offset:0 sc1
  buffer_load_dwordx4 v[20:23], v1, s[4:7], s57 offen offset:1024 sc1
  buffer_load_dwordx4 v[24:27], v1, s[4:7], s57 offen offset:2048 sc1
  s_waitcnt vmcnt(3)
  v_max3_u32 v15, v28, v32, v36
  v_max_u32 v15, v15, v40
  v_cmp_eq_u32 vcc, -1, v15
  s_cbranch_vccz L_pls_613
  s_add_u32 s57, s29, 32768
  buffer_load_dwordx4 v[28:31], v1, s[4:7], s57 offen offset:3072 sc1
  s_add_u32 s57, s29, 36864
  buffer_load_dwordx4 v[32:35], v1, s[4:7], s57 offen offset:0 sc1
  buffer_load_dwordx4 v[36:39], v1, s[4:7], s57 offen offset:1024 sc1
  buffer_load_dwordx4 v[40:43], v1, s[4:7], s57 offen offset:2048 sc1
L_pls_613:
  v_max3_u32 v15, v44, v48, v52
  v_cmp_eq_u32 vcc, -1, v15
  s_cbranch_vccz L_pls_614
  s_add_u32 s57, s29, 36864
  buffer_load_dwordx4 v[44:47], v1, s[4:7], s57 offen offset:3072 sc1
  s_add_u32 s57, s29, 40960
  buffer_load_dwordx4 v[48:51], v1, s[4:7], s57 offen offset:0 sc1
  buffer_load_dwordx4 v[52:55], v1, s[4:7], s57 offen offset:1024 sc1
L_pls_614:
  s_waitcnt vmcnt(0)
  v_max3_u32 v15, v16, v20, v24
  v_cmp_eq_u32 vcc, -1, v15
  s_cbranch_vccz L_plb_612
  s_sub_u32 s56, s56, 4
  s_cbranch_scc0 L_pl_611l
  s_mov_b32 s56, 0
  s_branch L_plb_612
L_lsl_615:
  ds_read_b32 v7, v14 offset:1856
  s_waitcnt lgkmcnt(0)
  v_cmp_gt_u32 vcc, v247, v7
  s_cbranch_vccz L_lbk_616
  s_sub_u32 s56, s56, 1
  s_cbranch_scc0 L_lsl_615
  s_mov_b32 s56, 0
  s_branch L_lbk_616
L_pl_617:
L_pl_617l:
  s_add_u32 s57, s29, 32768
  buffer_load_dwordx4 v[28:31], v1, s[4:7], s57 offen offset:3072 sc1
  s_add_u32 s57, s29, 36864
  buffer_load_dwordx4 v[32:35], v1, s[4:7], s57 offen offset:0 sc1
  buffer_load_dwordx4 v[36:39], v1, s[4:7], s57 offen offset:1024 sc1
  buffer_load_dwordx4 v[40:43], v1, s[4:7], s57 offen offset:2048 sc1
  s_waitcnt vmcnt(4)
  v_max3_u32 v15, v44, v48, v52
  v_max_u32 v15, v15, v56
  v_cmp_eq_u32 vcc, -1, v15
  s_cbranch_vccz L_pls_619
  s_add_u32 s57, s29, 36864
  buffer_load_dwordx4 v[44:47], v1, s[4:7], s57 offen offset:3072 sc1
  s_add_u32 s57, s29, 40960
  buffer_load_dwordx4 v[48:51], v1, s[4:7], s57 offen offset:0 sc1
  buffer_load_dwordx4 v[52:55], v1, s[4:7], s57 offen offset:1024 sc1
  buffer_load_dwordx4 v[56:59], v1, s[4:7], s57 offen offset:2048 sc1
L_pls_619:
  s_waitcnt vmcnt(0)
  v_max3_u32 v15, v28, v32, v36
  v_max_u32 v15, v15, v40
  v_cmp_eq_u32 vcc, -1, v15
  s_cbranch_vccz L_plb_618
  s_sub_u32 s56, s56, 4
  s_cbranch_scc0 L_pl_617l
  s_mov_b32 s56, 0
  s_branch L_plb_618
L_pl_620:
L_pl_620l:
  s_add_u32 s57, s29, 36864
  buffer_load_dwordx4 v[44:47], v1, s[4:7], s57 offen offset:3072 sc1
  s_add_u32 s57, s29, 40960
  buffer_load_dwordx4 v[48:51], v1, s[4:7], s57 offen offset:0 sc1
  buffer_load_dwordx4 v[52:55], v1, s[4:7], s57 offen offset:1024 sc1
  buffer_load_dwordx4 v[56:59], v1, s[4:7], s57 offen offset:2048 sc1
  s_waitcnt vmcnt(4)
  s_waitcnt vmcnt(0)
  v_max3_u32 v15, v44, v48, v52
  v_max_u32 v15, v15, v56
  v_cmp_eq_u32 vcc, -1, v15
  s_cbranch_vccz L_plb_621
  s_sub_u32 s56, s56, 4
  s_cbranch_scc0 L_pl_620l
  s_mov_b32 s56, 0
  s_branch L_plb_621
L_lsl_622:
  ds_read_b32 v7, v14 offset:960
  s_waitcnt lgkmcnt(0)
  v_cmp_gt_u32 vcc, v247, v7
  s_cbranch_vccz L_lbk_623
  s_sub_u32 s56, s56, 1
  s_cbranch_scc0 L_lsl_622
  s_mov_b32 s56, 0
  s_branch L_lbk_623
L_lsl_624:
  ds_read_b32 v7, v14 offset:1024
  ds_read_b128 v[144:147], v13 offset:0
  ds_read_b128 v[148:151], v13 offset:1024
  ds_read_b128 v[152:155], v13 offset:2048
  ds_read_b128 v[156:159], v13 offset:3072
  s_waitcnt lgkmcnt(0)
  v_cmp_gt_u32 vcc, v247, v7
  s_nop 0
  s_and_b64 vcc, vcc, s[36:37]
  s_cbranch_scc0 L_lbk_625
  s_sub_u32 s56, s56, 1
  s_cbranch_scc0 L_lsl_624
  s_mov_b32 s56, 0
  s_branch L_lbk_625
L_lsl_626:
  ds_read_b32 v7, v14 offset:2176
  s_waitcnt lgkmcnt(0)
  v_cmp_gt_u32 vcc, v247, v7
  s_cbranch_vccz L_lbk_627
  s_sub_u32 s56, s56, 1
  s_cbranch_scc0 L_lsl_626
  s_mov_b32 s56, 0
  s_branch L_lbk_627
L_pl_628:
L_pl_628l:
  buffer_load_dwordx4 v[16:19], v1, s[4:7], s38 offen offset:0 sc1
  buffer_load_dwordx4 v[20:23], v1, s[4:7], s38 offen offset:1024 sc1
  s_waitcnt vmcnt(2)
  v_max_u32 v15, v24, v28
  v_cmp_eq_u32 vcc, -1, v15
  s_cbranch_vccz L_pls_630
  buffer_load_dwordx4 v[24:27], v1, s[4:7], s38 offen offset:2048 sc1
  buffer_load_dwordx4 v[28:31], v1, s[4:7], s38 offen offset:3072 sc1
L_pls_630:
  v_max3_u32 v15, v32, v36, v40
  v_max_u32 v15, v15, v44
  v_cmp_eq_u32 vcc, -1, v15
  s_cbranch_vccz L_pls_631
  s_xor_b32 s57, s38, 4096
  buffer_load_dwordx4 v[32:35], v1, s[4:7], s57 offen offset:0 sc1
  buffer_load_dwordx4 v[36:39], v1, s[4:7], s57 offen offset:1024 sc1
  buffer_load_dwordx4 v[40:43], v1, s[4:7], s57 offen offset:2048 sc1
  buffer_load_dwordx4 v[44:47], v1, s[4:7], s57 offen offset:3072 sc1
L_pls_631:
  v_max_u32 v15, v48, v52
  v_cmp_eq_u32 vcc, -1, v15
  s_cbranch_vccz L_pls_632
  s_xor_b32 s57, s38, 8192
  buffer_load_dwordx4 v[48:51], v1, s[4:7], s57 offen offset:0 sc1
  buffer_load_dwordx4 v[52:55], v1, s[4:7], s57 offen offset:1024 sc1
L_pls_632:
  s_waitcnt vmcnt(0)
  v_max_u32 v15, v16, v20
  v_cmp_eq_u32 vcc, -1, v15
  s_cbranch_vccz L_plb_629
  s_sub_u32 s56, s56, 4
  s_cbranch_scc0 L_pl_628l
  s_mov_b32 s56, 0
  s_branch L_plb_629
L_pl_633:
L_pl_633l:
  buffer_load_dwordx4 v[24:27], v1, s[4:7], s38 offen offset:2048 sc1
  buffer_load_dwordx4 v[28:31], v1, s[4:7], s38 offen offset:3072 sc1
  s_waitcnt vmcnt(2)
  v_max3_u32 v15, v32, v36, v40
  v_max_u32 v15, v15, v44
  v_cmp_eq_u32 vcc, -1, v15
  s_cbranch_vccz L_pls_635
  s_xor_b32 s57, s38, 4096
  buffer_load_dwordx4 v[32:35], v1, s[4:7], s57 offen offset:0 sc1
  buffer_load_dwordx4 v[36:39], v1, s[4:7], s57 offen offset:1024 sc1
  buffer_load_dwordx4 v[40:43], v1, s[4:7], s57 offen offset:2048 sc1
  buffer_load_dwordx4 v[44:47], v1, s[4:7], s57 offen offset:3072 sc1
L_pls_635:
  v_max3_u32 v15, v48, v52, v56
  v_max_u32 v15, v15, v60
  v_cmp_eq_u32 vcc, -1, v15
  s_cbranch_vccz L_pls_636
  s_xor_b32 s57, s38, 8192
  buffer_load_dwordx4 v[48:51], v1, s[4:7], s57 offen offset:0 sc1
  buffer_load_dwordx4 v[52:55], v1, s[4:7], s57 offen offset:1024 sc1
  buffer_load_dwordx4 v[56:59], v1, s[4:7], s57 offen offset:2048 sc1
  buffer_load_dwordx4 v[60:63], v1, s[4:7], s57 offen offset:3072 sc1
L_pls_636:
  v_max_u32 v15, v64, v68
  v_cmp_eq_u32 vcc, -1, v15
  s_cbranch_vccz L_pls_637
  s_xor_b32 s57, s38, 12288
  buffer_load_dwordx4 v[64:67], v1, s[4:7], s57 offen offset:0 sc1
  buffer_load_dwordx4 v[68:71], v1, s[4:7], s57 offen offset:1024 sc1
L_pls_637:
  s_waitcnt vmcnt(0)
  v_max_u32 v15, v24, v28
  v_cmp_eq_u32 vcc, -1, v15
  s_cbranch_vccz L_plb_634
  s_sub_u32 s56, s56, 4
  s_cbranch_scc0 L_pl_633l
  s_mov_b32 s56, 0
  s_branch L_plb_634
L_pl_638:
L_pl_638l:
  s_xor_b32 s57, s38, 4096
  buffer_load_dwordx4 v[32:35], v1, s[4:7], s57 offen offset:0 sc1
  buffer_load_dwordx4 v[36:39], v1, s[4:7], s57 offen offset:1024 sc1
  buffer_load_dwordx4 v[40:43], v1, s[4:7], s57 offen offset:2048 sc1
  buffer_load_dwordx4 v[44:47], v1, s[4:7], s57 offen offset:3072 sc1
  s_waitcnt vmcnt(4)
  v_max3_u32 v15, v48, v52, v56
  v_max_u32 v15, v15, v60
  v_cmp_eq_u32 vcc, -1, v15
  s_cbranch_vccz L_pls_640
  s_xor_b32 s57, s38, 8192
  buffer_load_dwordx4 v[48:51], v1, s[4:7], s57 offen offset:0 sc1
  buffer_load_dwordx4 v[52:55], v1, s[4:7], s57 offen offset:1024 sc1
  buffer_load_dwordx4 v[56:59], v1, s[4:7], s57 offen offset:2048 sc1
  buffer_load_dwordx4 v[60:63], v1, s[4:7], s57 offen offset:3072 sc1
L_pls_640:
  v_max3_u32 v15, v64, v68, v72
  v_max_u32 v15, v15, v76
  v_cmp_eq_u32 vcc, -1, v15
  s_cbranch_vccz L_pls_641
  s_xor_b32 s57, s38, 12288
  buffer_load_dwordx4 v[64:67], v1, s[4:7], s57 offen offset:0 sc1
  buffer_load_dwordx4 v[68:71], v1, s[4:7], s57 offen offset:1024 sc1
  buffer_load_dwordx4 v[72:75], v1, s[4:7], s57 offen offset:2048 sc1
  buffer_load_dwordx4 v[76:79], v1, s[4:7], s57 offen offset:3072 sc1
L_pls_641:
  s_waitcnt vmcnt(0)
  v_max3_u32 v15, v32, v36, v40
  v_max_u32 v15, v15, v44
  v_cmp_eq_u32 vcc, -1, v15
  s_cbranch_vccz L_plb_639
  s_sub_u32 s56, s56, 4
  s_cbranch_scc0 L_pl_638l
  s_mov_b32 s56, 0
  s_branch L_plb_639
L_lsl_642:
  ds_read_b32 v7, v14 offset:2240
  s_waitcnt lgkmcnt(0)
  v_cmp_gt_u32 vcc, v247, v7
  s_cbranch_vccz L_lbk_643
  s_sub_u32 s56, s56, 1
  s_cbranch_scc0 L_lsl_642
  s_mov_b32 s56, 0
  s_branch L_lbk_643
L_pl_644:
L_pl_644l:
  s_xor_b32 s57, s38, 8192
  buffer_load_dwordx4 v[48:51], v1, s[4:7], s57 offen offset:0 sc1
  buffer_load_dwordx4 v[52:55], v1, s[4:7], s57 offen offset:1024 sc1
  buffer_load_dwordx4 v[56:59], v1, s[4:7], s57 offen offset:2048 sc1
  buffer_load_dwordx4 v[60:63], v1, s[4:7], s57 offen offset:3072 sc1
  s_waitcnt vmcnt(4)
  v_max3_u32 v15, v64, v68, v72
  v_max_u32 v15, v15, v76
  v_cmp_eq_u32 vcc, -1, v15
  s_cbranch_vccz L_pls_646
  s_xor_b32 s57, s38, 12288
  buffer_load_dwordx4 v[64:67], v1, s[4:7], s57 offen offset:0 sc1
  buffer_load_dwordx4 v[68:71], v1, s[4:7], s57 offen offset:1024 sc1
  buffer_load_dwordx4 v[72:75], v1, s[4:7], s57 offen offset:2048 sc1
  buffer_load_dwordx4 v[76:79], v1, s[4:7], s57 offen offset:3072 sc1
L_pls_646:
  v_max3_u32 v15, v80, v84, v88
  v_max_u32 v15, v15, v92
  v_cmp_eq_u32 vcc, -1, v15
  s_cbranch_vccz L_pls_647
  s_xor_b32 s57, s38, 16384
  buffer_load_dwordx4 v[80:83], v1, s[4:7], s57 offen offset:0 sc1
  buffer_load_dwordx4 v[84:87], v1, s[4:7], s57 offen offset:1024 sc1
  buffer_load_dwordx4 v[88:91], v1, s[4:7], s57 offen offset:2048 sc1
  buffer_load_dwordx4 v[92:95], v1, s[4:7], s57 offen offset:3072 sc1
L_pls_647:
  v_max3_u32 v15, v192, v194, v196
  v_max_u32 v15, v15, v198
  v_cmp_eq_u32 vcc, -1, v15
  s_cbranch_vccz L_pls_648
  buffer_load_dwordx2 v[192:193], v4, s[4:7], s39 offen offset:0 sc1
  buffer_load_dwordx2 v[194:195], v4, s[4:7], s39 offen offset:512 sc1
  buffer_load_dwordx2 v[196:197], v4, s[4:7], s39 offen offset:1024 sc1
  buffer_load_dwordx2 v[198:199], v4, s[4:7], s39 offen offset:1536 sc1
L_pls_648:
  s_waitcnt vmcnt(0)
  v_max3_u32 v15, v48, v52, v56
  v_max_u32 v15, v15, v60
  v_cmp_eq_u32 vcc, -1, v15
  s_cbranch_vccz L_plb_645
  s_sub_u32 s56, s56, 4
  s_cbranch_scc0 L_pl_644l
  s_mov_b32 s56, 0
  s_branch L_plb_645
L_pl_649:
L_pl_649l:
  s_xor_b32 s57, s38, 12288
  buffer_load_dwordx4 v[64:67], v1, s[4:7], s57 offen offset:0 sc1
  buffer_load_dwordx4 v[68:71], v1, s[4:7], s57 offen offset:1024 sc1
  buffer_load_dwordx4 v[72:75], v1, s[4:7], s57 offen offset:2048 sc1
  buffer_load_dwordx4 v[76:79], v1, s[4:7], s57 offen offset:3072 sc1
  s_waitcnt vmcnt(4)
  v_max3_u32 v15, v80, v84, v88
  v_max_u32 v15, v15, v92
  v_cmp_eq_u32 vcc, -1, v15
  s_cbranch_vccz L_pls_651
  s_xor_b32 s57, s38, 16384
  buffer_load_dwordx4 v[80:83], v1, s[4:7], s57 offen offset:0 sc1
  buffer_load_dwordx4 v[84:87], v1, s[4:7], s57 offen offset:1024 sc1
  buffer_load_dwordx4 v[88:91], v1, s[4:7], s57 offen offset:2048 sc1
  buffer_load_dwordx4 v[92:95], v1, s[4:7], s57 offen offset:3072 sc1
L_pls_651:
  v_max3_u32 v15, v96, v100, v104
  v_max_u32 v15, v15, v108
  v_cmp_eq_u32 vcc, -1, v15
  s_cbranch_vccz L_pls_652
  s_xor_b32 s57, s38, 20480
  buffer_load_dwordx4 v[96:99], v1, s[4:7], s57 offen offset:0 sc1
  buffer_load_dwordx4 v[100:103], v1, s[4:7], s57 offen offset:1024 sc1
  buffer_load_dwordx4 v[104:107], v1, s[4:7], s57 offen offset:2048 sc1
  buffer_load_dwordx4 v[108:111], v1, s[4:7], s57 offen offset:3072 sc1
L_pls_652:
  v_max3_u32 v15, v192, v194, v196
  v_max3_u32 v15, v15, v198, v200
  v_max3_u32 v15, v15, v202, v204
  v_max_u32 v15, v15, v206
  v_cmp_eq_u32 vcc, -1, v15
  s_cbranch_vccz L_pls_653
  buffer_load_dwordx2 v[192:193], v4, s[4:7], s39 offen offset:0 sc1
  buffer_load_dwordx2 v[194:195], v4, s[4:7], s39 offen offset:512 sc1
  buffer_load_dwordx2 v[196:197], v4, s[4:7], s39 offen offset:1024 sc1
  buffer_load_dwordx2 v[198:199], v4, s[4:7], s39 offen offset:1536 sc1
  buffer_load_dwordx2 v[200:201], v4, s[4:7], s39 offen offset:2048 sc1
  buffer_load_dwordx2 v[202:203], v4, s[4:7], s39 offen offset:2560 sc1
  buffer_load_dwordx2 v[204:205], v4, s[4:7], s39 offen offset:3072 sc1
  buffer_load_dwordx2 v[206:207], v4, s[4:7], s39 offen offset:3584 sc1
L_pls_653:
  s_waitcnt vmcnt(0)
  v_max3_u32 v15, v64, v68, v72
  v_max_u32 v15, v15, v76
  v_cmp_eq_u32 vcc, -1, v15
  s_cbranch_vccz L_plb_650
  s_sub_u32 s56, s56, 4
  s_cbranch_scc0 L_pl_649l
  s_mov_b32 s56, 0
  s_branch L_plb_650
L_lsl_654:
  ds_read_b32 v7, v14 offset:1216
  s_waitcnt lgkmcnt(0)
  v_cmp_gt_u32 vcc, v247, v7
  s_cbranch_vccz L_lbk_655
  s_sub_u32 s56, s56, 1
  s_cbranch_scc0 L_lsl_654
  s_mov_b32 s56, 0
  s_branch L_lbk_655
L_pl_656:
L_pl_656l:
  s_xor_b32 s57, s38, 16384
  buffer_load_dwordx4 v[80:83], v1, s[4:7], s57 offen offset:0 sc1
  buffer_load_dwordx4 v[84:87], v1, s[4:7], s57 offen offset:1024 sc1
  buffer_load_dwordx4 v[88:91], v1, s[4:7], s57 offen offset:2048 sc1
  buffer_load_dwordx4 v[92:95], v1, s[4:7], s57 offen offset:3072 sc1
  s_waitcnt vmcnt(4)
  v_max3_u32 v15, v96, v100, v104
  v_max_u32 v15, v15, v108
  v_cmp_eq_u32 vcc, -1, v15
  s_cbranch_vccz L_pls_658
  s_xor_b32 s57, s38, 20480
  buffer_load_dwordx4 v[96:99], v1, s[4:7], s57 offen offset:0 sc1
  buffer_load_dwordx4 v[100:103], v1, s[4:7], s57 offen offset:1024 sc1
  buffer_load_dwordx4 v[104:107], v1, s[4:7], s57 offen offset:2048 sc1
  buffer_load_dwordx4 v[108:111], v1, s[4:7], s57 offen offset:3072 sc1
L_pls_658:
  v_max3_u32 v15, v112, v116, v120
  v_max_u32 v15, v15, v124
  v_cmp_eq_u32 vcc, -1, v15
  s_cbranch_vccz L_pls_659
  s_xor_b32 s57, s38, 24576
  buffer_load_dwordx4 v[112:115], v1, s[4:7], s57 offen offset:0 sc1
  buffer_load_dwordx4 v[116:119], v1, s[4:7], s57 offen offset:1024 sc1
  buffer_load_dwordx4 v[120:123], v1, s[4:7], s57 offen offset:2048 sc1
  buffer_load_dwordx4 v[124:127], v1, s[4:7], s57 offen offset:3072 sc1
L_pls_659:
  v_max3_u32 v15, v192, v194, v196
  v_max3_u32 v15, v15, v198, v200
  v_max3_u32 v15, v15, v202, v204
  v_max_u32 v15, v15, v206
  v_cmp_eq_u32 vcc, -1, v15
  s_cbranch_vccz L_pls_660
  buffer_load_dwordx2 v[192:193], v4, s[4:7], s39 offen offset:0 sc1
  buffer_load_dwordx2 v[194:195], v4, s[4:7], s39 offen offset:512 sc1
  buffer_load_dwordx2 v[196:197], v4, s[4:7], s39 offen offset:1024 sc1
  buffer_load_dwordx2 v[198:199], v4, s[4:7], s39 offen offset:1536 sc1
  buffer_load_dwordx2 v[200:201], v4, s[4:7], s39 offen offset:2048 sc1
  buffer_load_dwordx2 v[202:203], v4, s[4:7], s39 offen offset:2560 sc1
  buffer_load_dwordx2 v[204:205], v4, s[4:7], s39 offen offset:3072 sc1
  buffer_load_dwordx2 v[206:207], v4, s[4:7], s39 offen offset:3584 sc1
L_pls_660:
  s_waitcnt vmcnt(0)
  v_max3_u32 v15, v80, v84, v88
  v_max_u32 v15, v15, v92
  v_cmp_eq_u32 vcc, -1, v15
  s_cbranch_vccz L_plb_657
  s_sub_u32 s56, s56, 4
  s_cbranch_scc0 L_pl_656l
  s_mov_b32 s56, 0
  s_branch L_plb_657
L_pl_661:
L_pl_661l:
  s_xor_b32 s57, s38, 20480
  buffer_load_dwordx4 v[96:99], v1, s[4:7], s57 offen offset:0 sc1
  buffer_load_dwordx4 v[100:103], v1, s[4:7], s57 offen offset:1024 sc1
  buffer_load_dwordx4 v[104:107], v1, s[4:7], s57 offen offset:2048 sc1
  buffer_load_dwordx4 v[108:111], v1, s[4:7], s57 offen offset:3072 sc1
  s_waitcnt vmcnt(4)
  v_max3_u32 v15, v112, v116, v120
  v_max_u32 v15, v15, v124
  v_cmp_eq_u32 vcc, -1, v15
  s_cbranch_vccz L_pls_663
  s_xor_b32 s57, s38, 24576
  buffer_load_dwordx4 v[112:115], v1, s[4:7], s57 offen offset:0 sc1
  buffer_load_dwordx4 v[116:119], v1, s[4:7], s57 offen offset:1024 sc1
  buffer_load_dwordx4 v[120:123], v1, s[4:7], s57 offen offset:2048 sc1
  buffer_load_dwordx4 v[124:127], v1, s[4:7], s57 offen offset:3072 sc1
L_pls_663:
  v_max_u32 v15, v128, v132
  v_cmp_eq_u32 vcc, -1, v15
  s_cbranch_vccz L_pls_664
  s_xor_b32 s57, s38, 28672
  buffer_load_dwordx4 v[128:131], v1, s[4:7], s57 offen offset:0 sc1
  buffer_load_dwordx4 v[132:135], v1, s[4:7], s57 offen offset:1024 sc1
L_pls_664:
  v_max_u32 v15, v136, v140
  v_cmp_eq_u32 vcc, -1, v15
  s_cbranch_vccz L_pls_665
  s_xor_b32 s57, s38, 28672
  buffer_load_dwordx4 v[136:139], v1, s[4:7], s57 offen offset:2048 sc1
  buffer_load_dwordx4 v[140:143], v1, s[4:7], s57 offen offset:3072 sc1
L_pls_665:
  v_max3_u32 v15, v192, v194, v196
  v_max3_u32 v15, v15, v198, v200
  v_max3_u32 v15, v15, v202, v204
  v_max_u32 v15, v15, v206
  v_cmp_eq_u32 vcc, -1, v15
  s_cbranch_vccz L_pls_666
  buffer_load_dwordx2 v[192:193], v4, s[4:7], s39 offen offset:0 sc1
  buffer_load_dwordx2 v[194:195], v4, s[4:7], s39 offen offset:512 sc1
  buffer_load_dwordx2 v[196:197], v4, s[4:7], s39 offen offset:1024 sc1
  buffer_load_dwordx2 v[198:199], v4, s[4:7], s39 offen offset:1536 sc1
  buffer_load_dwordx2 v[200:201], v4, s[4:7], s39 offen offset:2048 sc1
  buffer_load_dwordx2 v[202:203], v4, s[4:7], s39 offen offset:2560 sc1
  buffer_load_dwordx2 v[204:205], v4, s[4:7], s39 offen offset:3072 sc1
  buffer_load_dwordx2 v[206:207], v4, s[4:7], s39 offen offset:3584 sc1
L_pls_666:
  s_waitcnt vmcnt(0)
  v_max3_u32 v15, v96, v100, v104
  v_max_u32 v15, v15, v108
  v_cmp_eq_u32 vcc, -1, v15
  s_cbranch_vccz L_plb_662
  s_sub_u32 s56, s56, 4
  s_cbranch_scc0 L_pl_661l
  s_mov_b32 s56, 0
  s_branch L_plb_662
L_pl_667:
L_pl_667l:
  buffer_load_dwordx2 v[192:193], v4, s[4:7], s39 offen offset:0 sc1
  buffer_load_dwordx2 v[194:195], v4, s[4:7], s39 offen offset:512 sc1
  buffer_load_dwordx2 v[196:197], v4, s[4:7], s39 offen offset:1024 sc1
  buffer_load_dwordx2 v[198:199], v4, s[4:7], s39 offen offset:1536 sc1
  buffer_load_dwordx2 v[200:201], v4, s[4:7], s39 offen offset:2048 sc1
  buffer_load_dwordx2 v[202:203], v4, s[4:7], s39 offen offset:2560 sc1
  buffer_load_dwordx2 v[204:205], v4, s[4:7], s39 offen offset:3072 sc1
  buffer_load_dwordx2 v[206:207], v4, s[4:7], s39 offen offset:3584 sc1
  s_waitcnt vmcnt(8)
  v_max3_u32 v15, v112, v116, v120
  v_max_u32 v15, v15, v124
  v_cmp_eq_u32 vcc, -1, v15
  s_cbranch_vccz L_pls_669
  s_xor_b32 s57, s38, 24576
  buffer_load_dwordx4 v[112:115], v1, s[4:7], s57 offen offset:0 sc1
  buffer_load_dwordx4 v[116:119], v1, s[4:7], s57 offen offset:1024 sc1
  buffer_load_dwordx4 v[120:123], v1, s[4:7], s57 offen offset:2048 sc1
  buffer_load_dwordx4 v[124:127], v1, s[4:7], s57 offen offset:3072 sc1
L_pls_669:
  v_max_u32 v15, v128, v132
  v_cmp_eq_u32 vcc, -1, v15
  s_cbranch_vccz L_pls_670
  s_xor_b32 s57, s38, 28672
  buffer_load_dwordx4 v[128:131], v1, s[4:7], s57 offen offset:0 sc1
  buffer_load_dwordx4 v[132:135], v1, s[4:7], s57 offen offset:1024 sc1
L_pls_670:
  v_max_u32 v15, v136, v140
  v_cmp_eq_u32 vcc, -1, v15
  s_cbranch_vccz L_pls_671
  s_xor_b32 s57, s38, 28672
  buffer_load_dwordx4 v[136:139], v1, s[4:7], s57 offen offset:2048 sc1
  buffer_load_dwordx4 v[140:143], v1, s[4:7], s57 offen offset:3072 sc1
L_pls_671:
  s_waitcnt vmcnt(0)
  v_max3_u32 v15, v192, v194, v196
  v_max3_u32 v15, v15, v198, v200
  v_max3_u32 v15, v15, v202, v204
  v_max_u32 v15, v15, v206
  v_cmp_eq_u32 vcc, -1, v15
  s_cbranch_vccz L_plb_668
  s_sub_u32 s56, s56, 4
  s_cbranch_scc0 L_pl_667l
  s_mov_b32 s56, 0
  s_branch L_plb_668
L_lsl_672:
  ds_read_b32 v7, v14 offset:1280
  s_waitcnt lgkmcnt(0)
  v_cmp_gt_u32 vcc, v247, v7
  s_cbranch_vccz L_lbk_673
  s_sub_u32 s56, s56, 1
  s_cbranch_scc0 L_lsl_672
  s_mov_b32 s56, 0
  s_branch L_lbk_673
L_pl_674:
L_pl_674l:
  s_xor_b32 s57, s38, 24576
  buffer_load_dwordx4 v[112:115], v1, s[4:7], s57 offen offset:0 sc1
  buffer_load_dwordx4 v[116:119], v1, s[4:7], s57 offen offset:1024 sc1
  buffer_load_dwordx4 v[120:123], v1, s[4:7], s57 offen offset:2048 sc1
  buffer_load_dwordx4 v[124:127], v1, s[4:7], s57 offen offset:3072 sc1
  s_waitcnt vmcnt(4)
  v_max_u32 v15, v128, v132
  v_cmp_eq_u32 vcc, -1, v15
  s_cbranch_vccz L_pls_676
  s_xor_b32 s57, s38, 28672
  buffer_load_dwordx4 v[128:131], v1, s[4:7], s57 offen offset:0 sc1
  buffer_load_dwordx4 v[132:135], v1, s[4:7], s57 offen offset:1024 sc1
L_pls_676:
  v_max_u32 v15, v136, v140
  v_cmp_eq_u32 vcc, -1, v15
  s_cbranch_vccz L_pls_677
  s_xor_b32 s57, s38, 28672
  buffer_load_dwordx4 v[136:139], v1, s[4:7], s57 offen offset:2048 sc1
  buffer_load_dwordx4 v[140:143], v1, s[4:7], s57 offen offset:3072 sc1
L_pls_677:
  s_waitcnt vmcnt(0)
  v_max3_u32 v15, v112, v116, v120
  v_max_u32 v15, v15, v124
  v_cmp_eq_u32 vcc, -1, v15
  s_cbranch_vccz L_plb_675
  s_sub_u32 s56, s56, 4
  s_cbranch_scc0 L_pl_674l
  s_mov_b32 s56, 0
  s_branch L_plb_675
L_pl_678:
L_pl_678l:
  s_xor_b32 s57, s38, 28672
  buffer_load_dwordx4 v[128:131], v1, s[4:7], s57 offen offset:0 sc1
  buffer_load_dwordx4 v[132:135], v1, s[4:7], s57 offen offset:1024 sc1
  s_waitcnt vmcnt(2)
  v_max_u32 v15, v136, v140
  v_cmp_eq_u32 vcc, -1, v15
  s_cbranch_vccz L_pls_680
  s_xor_b32 s57, s38, 28672
  buffer_load_dwordx4 v[136:139], v1, s[4:7], s57 offen offset:2048 sc1
  buffer_load_dwordx4 v[140:143], v1, s[4:7], s57 offen offset:3072 sc1
L_pls_680:
  s_waitcnt vmcnt(0)
  v_max_u32 v15, v128, v132
  v_cmp_eq_u32 vcc, -1, v15
  s_cbranch_vccz L_plb_679
  s_sub_u32 s56, s56, 4
  s_cbranch_scc0 L_pl_678l
  s_mov_b32 s56, 0
  s_branch L_plb_679
L_lsl_681:
  ds_read_b32 v7, v14 offset:2112
  s_waitcnt lgkmcnt(0)
  v_cmp_eq_u32 vcc, 0, v7
  s_cbranch_vccz L_lbk_682
  s_sub_u32 s56, s56, 1
  s_cbranch_scc0 L_lsl_681
  s_mov_b32 s56, 0
  s_branch L_lbk_682
L_pl_683:
L_pl_683l:
  s_xor_b32 s57, s38, 28672
  buffer_load_dwordx4 v[136:139], v1, s[4:7], s57 offen offset:2048 sc1
  buffer_load_dwordx4 v[140:143], v1, s[4:7], s57 offen offset:3072 sc1
  s_waitcnt vmcnt(2)
  s_waitcnt vmcnt(0)
  v_max_u32 v15, v136, v140
  v_cmp_eq_u32 vcc, -1, v15
  s_cbranch_vccz L_plb_684
  s_sub_u32 s56, s56, 4
  s_cbranch_scc0 L_pl_683l
  s_mov_b32 s56, 0
  s_branch L_plb_684
.section .rodata,"a"
.p2align 6
.amdhsa_kernel interleave_layers__linear_kernel_hedgehog__geglu_ffn__prompt_kernel
  .amdhsa_next_free_vgpr 256
  .amdhsa_next_free_sgpr 102
  .amdhsa_accum_offset 256
  .amdhsa_group_segment_fixed_size 0
  .amdhsa_kernarg_size 88
  .amdhsa_user_sgpr_count 2
  .amdhsa_user_sgpr_kernarg_segment_ptr 1
  .amdhsa_system_sgpr_workgroup_id_x 1
.end_amdhsa_kernel
```
